```python
import torch

def _softmax(x, axis=-1):
    return torch.softmax(x, dim=axis)
def _gelu(x):
    return torch.nn.functional.gelu(x, approximate="tanh")
def _silu(x):
    return torch.nn.functional.silu(x)
def _sigmoid(x):
    return torch.sigmoid(x)
def _layernorm(x, axis=-1, eps=1e-5):
    m = x.mean(dim=axis, keepdim=True)
    v = x.var(dim=axis, keepdim=True, unbiased=False)
    return (x - m) / torch.sqrt(v + eps)
def _scatter_add(tgt, idx, src, axis=0):
    return tgt.clone().index_add_(axis, idx, src)
def _segment_sum(src, seg, n):
    out = torch.zeros((n,) + src.shape[1:], dtype=src.dtype)
    return out.index_add_(0, seg, src)
def _pad(x, pw):
    flat = tuple(v for pair in reversed(pw) for v in pair)
    return torch.nn.functional.pad(x, flat)

kernel_name = 'gated_mix__ssm_conv_h3__compressed_kv_cla__prompt'

def setup_inputs():

    _w = (lambda a: (lambda t: t.to(torch.bfloat16) if t.is_floating_point() else t)(torch.as_tensor(a)))
    def _A_setup():
        B, S, D = 1, 2048, 512
        ks = 4
        return {
            "q": _w((lambda *s: torch.randn(*s, dtype=torch.bfloat16) * 0.05)(B, S, D)),
            "k": _w((lambda *s: torch.randn(*s, dtype=torch.bfloat16) * 0.4)(B, S, D)),
            "v": _w((lambda *s: torch.randn(*s, dtype=torch.bfloat16) * 0.4)(B, S, D)),
            "shift_k": _w((lambda *s: torch.randn(*s, dtype=torch.bfloat16) * 0.4)(D, ks) * 0.5),
            "ssm_k": _w((lambda *s: torch.randn(*s, dtype=torch.bfloat16) * 0.8)(D, S) * (1.0 / S ** 0.5)),
            "ssm_D": _w((lambda *s: torch.randn(*s, dtype=torch.bfloat16) * 0.4)(D)),
        }
    _A_in = _A_setup()

    def _B_setup():
        B, H, Sq, Sk, D, M = 1, 32, 2048, 2048, 128, 512
        Dc = 4 * D
        return {
            "x": _w((lambda *s: torch.randn(*s, dtype=torch.bfloat16) * 0.05)(B, Sq, M)),
            "c_kv": _w((lambda *s: torch.randn(*s, dtype=torch.bfloat16) * 0.4)(B, Sk, Dc)),
            "w_q": _w((lambda *s: torch.randn(*s, dtype=torch.bfloat16) * 6.4)(M, H, D) * (M ** -0.5)),
            "w_uk": _w((lambda *s: torch.randn(*s, dtype=torch.bfloat16) * 6.4)(Dc, H, D) * (Dc ** -0.5)),
            "w_uv": _w((lambda *s: torch.randn(*s, dtype=torch.bfloat16) * 0.4)(Dc, H, D) * (Dc ** -0.5)),
            "w_o": _w((lambda *s: torch.randn(*s, dtype=torch.bfloat16) * 0.4)(H, D, M) * ((H * D) ** -0.5)),
        }
    _B_in = _B_setup()

    return {
        "A_q": _A_in["q"],
        "A_k": _A_in["k"],
        "A_v": _A_in["v"],
        "A_shift_k": _A_in["shift_k"],
        "A_ssm_k": _A_in["ssm_k"],
        "A_ssm_D": _A_in["ssm_D"],
        "B_x": _B_in["x"],
        "B_c_kv": _B_in["c_kv"],
        "B_w_q": _B_in["w_q"],
        "B_w_uk": _B_in["w_uk"],
        "B_w_uv": _B_in["w_uv"],
        "B_w_o": _B_in["w_o"],
        "gate_w": _w((lambda *s: torch.randn(*s, dtype=torch.bfloat16) * 0.05)(512) * 16.0),
    }

def reference(A_q, A_k, A_v, A_shift_k, A_ssm_k, A_ssm_D, B_x, B_c_kv, B_w_q, B_w_uk, B_w_uv, B_w_o, gate_w):
    def _A_ref(q, k, v, shift_k, ssm_k, ssm_D):
        B, S, D = q.shape
        ks = shift_k.shape[-1]
        k_pad = _pad(k, ((0, 0), (ks - 1, 0), (0, 0)))
        k_shift = torch.zeros_like(k)
        for t in range(ks):
            k_shift = k_shift + k_pad[:, t:t + S, :] * shift_k[:, ks - 1 - t][None, None, :]
        kv = k_shift * v
        L = 2 * S
        kv_pad = _pad(kv, ((0, 0), (0, S), (0, 0)))
        kf_pad = _pad(ssm_k, ((0, 0), (0, S)))
        kv_f = (lambda x, axes=(-2,-1): torch.fft.rfft2(x.float(), dim=axes))(kv_pad[:, None, :, :], axes=(1, 2))
        kf_f = (lambda x, axes=(-2,-1): torch.fft.rfft2(x.float(), dim=axes))(kf_pad[:, None, :], axes=(1, 2))
        kf_f = (lambda x, *d: x.permute(*d))(kf_f, 1, 2, 0)
        y_f = kv_f * kf_f[None, :, :, :]
        y = (lambda x, s, axes=(-2,-1): torch.fft.irfft2(x, s=s, dim=axes).to(torch.bfloat16))(y_f, (1, L), axes=(1, 2))[:, 0, :S, :]
        y = y + kv * ssm_D[None, None, :]
        return q * y

    def _B_ref(x, c_kv, w_q, w_uk, w_uv, w_o):
        B, Sq, M = x.shape[0], x.shape[1], x.shape[2]
        Sk = c_kv.shape[1]
        H, D = w_q.shape[1], w_q.shape[2]
        q = torch.einsum("bqm,mhd->bhqd", x, w_q)
        k = torch.einsum("bkc,chd->bhkd", c_kv, w_uk)
        v = torch.einsum("bkc,chd->bhkd", c_kv, w_uv)
        scores = torch.einsum("bhqd,bhkd->bhqk", q, k) * (D ** -0.5)
        off = Sk - Sq
        qi = torch.arange(Sq)[:, None]
        kj = torch.arange(Sk)[None, :]
        cmask = kj <= (qi + off)
        scores = torch.where(cmask[None, None], scores, -1e9)
        p = _softmax(scores, axis=-1)
        ctx = torch.einsum("bhqk,bhkd->bhqd", p, v)
        return torch.einsum("bhqd,hdm->bqm", ctx, w_o)

    x = A_q
    g = _sigmoid((x * gate_w).sum(-1, keepdims=True))
    a = _A_ref(x, A_k, A_v, A_shift_k, A_ssm_k, A_ssm_D)
    b = _B_ref(x, B_c_kv, B_w_q, B_w_uk, B_w_uv, B_w_o)
    return g * a + (1 - g) * b
```

```asm
; @launch grid=(256,1,1) block=(256,1,1) lds=163840
.amdgcn_target "amdgcn-amd-amdhsa--gfx950"
.text
.globl gated_mix__ssm_conv_h3__compressed_kv_cla__prompt_kernel
.p2align 8
.type gated_mix__ssm_conv_h3__compressed_kv_cla__prompt_kernel,@function
gated_mix__ssm_conv_h3__compressed_kv_cla__prompt_kernel:
    s_cmp_ge_u32 s2, 256
    s_cbranch_scc1 K3_END
    s_load_dwordx16 s[16:31], s[0:1], 0
    s_load_dwordx16 s[32:47], s[0:1], 64
    v_lshrrev_b32 v1, 6, v0
    v_and_b32 v0, 63, v0
    v_readfirstlane_b32 s3, v1
    v_lshlrev_b32 v1, 4, v0
    s_getpc_b64 s[4:5]
K3_PC:
    s_mov_b32 s6, GM_HOT_END - K3_PC
    s_mov_b32 s7, 0x00020000
    s_lshr_b32 s8, s2, 3
    s_lshl_b32 s8, s8, 2
    s_add_u32 s8, s8, s3
    s_lshl_b32 s8, s8, 13
    v_lshlrev_b32 v2, 7, v0
    buffer_load_dword v255, v2, s[4:7], s8 offen
    s_and_b32 s4, s2, 1
    s_lshl_b32 s4, s4, 2
    s_lshr_b32 s5, s2, 3
    s_and_b32 s10, s5, 3
    s_add_u32 s6, s10, s4
    s_bfe_u32 s7, s2, 0x20001
    s_lshl_b32 s7, s7, 3
    s_and_b32 s8, s5, 28
    s_lshr_b32 s8, 0x51764320, s8
    s_and_b32 s8, s8, 7
    s_add_u32 s7, s7, s8
    v_lshrrev_b32 v30, 3, v0
    v_lshlrev_b32 v30, 10, v30
    v_and_b32 v32, 7, v0
    v_lshl_add_u32 v26, v32, 6, v30
    v_lshrrev_b32 v29, 2, v0
    v_lshlrev_b32 v29, 13, v29
    v_and_b32 v33, 3, v0
    v_lshl_add_u32 v29, v33, 6, v29
    s_lshl_b32 s13, s5, 2
    s_add_u32 s13, s13, s3
    s_lshl_b32 s13, s13, 13
    s_lshl_b32 s14, s4, 18
    s_add_u32 s13, s13, s14
    s_lshl_b32 s14, s10, 2
    s_add_u32 s14, s14, s3
    s_lshl_b32 s14, s14, 17
    s_lshl_b32 s9, s7, 8
    s_add_u32 s14, s14, s9
    s_add_u32 s15, s14, 2097152
    s_waitcnt lgkmcnt(0)
    s_mov_b32 s60, s30
    s_mov_b32 s61, s31
    s_mov_b32 s62, 2097152
    s_mov_b32 s63, 0x00020000
    s_mov_b32 s52, s34
    s_mov_b32 s53, s35
    s_mov_b32 s54, 4194304
    s_mov_b32 s55, 0x00020000
    buffer_load_dword v34, v26, s[60:63], s13 offen offset:0
    buffer_load_dword v34, v29, s[52:55], s14 offen
    v_lshrrev_b32 v31, 4, v0
    v_xor_b32 v32, v32, v31
    v_lshl_add_u32 v2, v32, 4, v30
    v_xor_b32 v32, 4, v32
    v_lshl_add_u32 v3, v32, 4, v30
    v_add_u32 v3, 7168, v3
    v_add_u32 v4, 14336, v2
    v_add_u32 v5, 14336, v3
    s_lshl_b32 s8, s6, 18
    s_lshl_b32 s10, s3, 16
    s_add_u32 s8, s8, s10
    s_lshl_b32 s11, s3, 12
    s_lshl_b32 s12, s3, 14
    s_add_u32 s12, s12, 98304
    s_lshr_b32 s4, s3, 1
    s_lshl_b32 s4, s4, 18
    s_and_b32 s10, s3, 1
    s_lshl_b32 s10, s10, 7
    s_add_u32 s4, s4, s10
    s_add_u32 s4, s4, s9
    s_lshl_b32 s10, s3, 18
    s_add_u32 s9, s9, s10
    v_lshrrev_b32 v30, 3, v0
    v_lshlrev_b32 v30, 13, v30
    v_and_b32 v33, 1, v0
    v_lshl_add_u32 v30, v33, 4, v30
    v_bfe_u32 v33, v0, 1, 2
    v_and_b32 v27, 1, v31
    v_xor_b32 v33, v33, v27
    v_lshl_add_u32 v6, v33, 5, v30
    v_xor_b32 v33, 2, v33
    v_lshl_add_u32 v7, v33, 5, v30
    v_add_u32 v7, 64512, v7
    v_add_u32 v8, 129024, v6
    v_add_u32 v9, 129024, v7
    s_add_u32 m0, s12, 0
    s_add_u32 s28, s8, 0
    buffer_load_dwordx4 v2, s[60:63], s28 offen offset:0 lds
    buffer_load_dwordx4 v3, s[60:63], s28 offen offset:1024 lds
    buffer_load_dwordx4 v4, s[60:63], s28 offen offset:2048 lds
    buffer_load_dwordx4 v5, s[60:63], s28 offen offset:3072 lds
    s_add_u32 m0, s12, 4096
    s_add_u32 s28, s8, 32768
    buffer_load_dwordx4 v2, s[60:63], s28 offen offset:0 lds
    buffer_load_dwordx4 v3, s[60:63], s28 offen offset:1024 lds
    buffer_load_dwordx4 v4, s[60:63], s28 offen offset:2048 lds
    buffer_load_dwordx4 v5, s[60:63], s28 offen offset:3072 lds
    s_add_u32 m0, s11, 0
    s_add_u32 s1, s4, 0
    buffer_load_dwordx4 v6, s[52:55], s1 offen offset:0 lds
    buffer_load_dwordx4 v7, s[52:55], s1 offen offset:1024 lds
    buffer_load_dwordx4 v8, s[52:55], s1 offen offset:2048 lds
    buffer_load_dwordx4 v9, s[52:55], s1 offen offset:3072 lds
    v_and_b32 v33, 15, v0
    v_lshlrev_b32 v32, 7, v33
    v_add_u32 v32, s12, v32
    v_lshrrev_b32 v33, 1, v33
    v_xor_b32 v33, v33, v31
    v_lshl_add_u32 v10, v33, 4, v32
    v_xor_b32 v33, 4, v33
    v_lshl_add_u32 v35, v33, 4, v32
    v_bfe_u32 v30, v0, 2, 2
    v_lshl_add_u32 v32, v31, 3, v30
    v_lshlrev_b32 v32, 7, v32
    v_and_b32 v33, 3, v0
    v_lshl_add_u32 v32, v33, 3, v32
    v_bfe_u32 v33, v0, 3, 2
    v_xor_b32 v27, 0, v33
    v_lshl_add_u32 v11, v27, 5, v32
    v_xor_b32 v27, 1, v33
    v_lshl_add_u32 v12, v27, 5, v32
    v_xor_b32 v27, 2, v33
    v_lshl_add_u32 v13, v27, 5, v32
    v_xor_b32 v27, 3, v33
    v_lshl_add_u32 v14, v27, 5, v32
    v_add_u32 v15, 32768, v11
    v_add_u32 v16, 32768, v12
    v_add_u32 v17, 32768, v13
    v_add_u32 v18, 32768, v14
    s_mov_b32 s56, s36
    s_mov_b32 s57, s37
    s_mov_b32 s58, 4194304
    s_mov_b32 s59, 0x00020000
    s_mov_b32 s48, s46
    s_mov_b32 s49, s47
    s_mov_b32 s50, 125829120
    s_mov_b32 s51, 0x00020000
    s_mul_i32 s0, s7, 529408
    s_mul_i32 s10, s6, 65536
    s_add_u32 s0, s0, s10
    s_mul_i32 s10, s3, 16384
    s_add_u32 s0, s0, s10
    s_add_u32 m0, s12, 8192
    s_add_u32 s28, s8, 128
    buffer_load_dwordx4 v2, s[60:63], s28 offen offset:0 lds
    buffer_load_dwordx4 v3, s[60:63], s28 offen offset:1024 lds
    buffer_load_dwordx4 v4, s[60:63], s28 offen offset:2048 lds
    buffer_load_dwordx4 v5, s[60:63], s28 offen offset:3072 lds
    s_add_u32 m0, s11, 16384
    s_add_u32 s1, s4, 524288
    buffer_load_dwordx4 v6, s[52:55], s1 offen offset:0 lds
    buffer_load_dwordx4 v7, s[52:55], s1 offen offset:1024 lds
    buffer_load_dwordx4 v8, s[52:55], s1 offen offset:2048 lds
    buffer_load_dwordx4 v9, s[52:55], s1 offen offset:3072 lds
    s_add_u32 m0, s12, 12288
    s_add_u32 s28, s8, 32896
    buffer_load_dwordx4 v2, s[60:63], s28 offen offset:0 lds
    buffer_load_dwordx4 v3, s[60:63], s28 offen offset:1024 lds
    buffer_load_dwordx4 v4, s[60:63], s28 offen offset:2048 lds
    buffer_load_dwordx4 v5, s[60:63], s28 offen offset:3072 lds
    buffer_load_dword v34, v26, s[60:63], s13 offen offset:512
    buffer_load_dword v34, v29, s[52:55], s15 offen
    s_waitcnt vmcnt(14)
    s_barrier
    ds_read_b128 a[0:3], v10 offset:0
    ds_read_b128 a[4:7], v10 offset:2048
    ds_read_b128 a[16:19], v35 offset:0
    ds_read_b128 a[20:23], v35 offset:2048
    ds_read_b128 a[8:11], v10 offset:4096
    ds_read_b128 a[12:15], v10 offset:6144
    ds_read_b128 a[24:27], v35 offset:4096
    ds_read_b128 a[28:31], v35 offset:6144
    ds_read_b64_tr_b16 v[96:97], v11 offset:0
    ds_read_b64_tr_b16 v[98:99], v11 offset:512
    ds_read_b64_tr_b16 v[100:101], v12 offset:0
    ds_read_b64_tr_b16 v[102:103], v12 offset:512
    ds_read_b64_tr_b16 v[104:105], v13 offset:0
    ds_read_b64_tr_b16 v[106:107], v13 offset:512
    ds_read_b64_tr_b16 v[108:109], v14 offset:0
    ds_read_b64_tr_b16 v[110:111], v14 offset:512
    ds_read_b64_tr_b16 v[112:113], v11 offset:4096
    ds_read_b64_tr_b16 v[114:115], v11 offset:4608
    ds_read_b64_tr_b16 v[116:117], v12 offset:4096
    ds_read_b64_tr_b16 v[118:119], v12 offset:4608
    ds_read_b64_tr_b16 v[120:121], v13 offset:4096
    ds_read_b64_tr_b16 v[122:123], v13 offset:4608
    ds_read_b64_tr_b16 v[124:125], v14 offset:4096
    ds_read_b64_tr_b16 v[126:127], v14 offset:4608
    s_waitcnt lgkmcnt(0)
    v_mfma_f32_16x16x32_bf16 v[128:131], v[96:99], a[0:3], 0
    ds_read_b64_tr_b16 v[64:65], v11 offset:8192
    v_mfma_f32_16x16x32_bf16 v[136:139], v[96:99], a[4:7], 0
    ds_read_b64_tr_b16 v[66:67], v11 offset:8704
    v_mfma_f32_16x16x32_bf16 v[144:147], v[96:99], a[8:11], 0
    ds_read_b64_tr_b16 v[68:69], v12 offset:8192
    v_mfma_f32_16x16x32_bf16 v[152:155], v[96:99], a[12:15], 0
    ds_read_b64_tr_b16 v[70:71], v12 offset:8704
    s_add_u32 m0, s12, 0
    s_add_u32 s28, s8, 256
    v_mfma_f32_16x16x32_bf16 v[132:135], v[100:103], a[0:3], 0
    ds_read_b64_tr_b16 v[72:73], v13 offset:8192
    v_mfma_f32_16x16x32_bf16 v[140:143], v[100:103], a[4:7], 0
    ds_read_b64_tr_b16 v[74:75], v13 offset:8704
    buffer_load_dwordx4 v2, s[60:63], s28 offen offset:0 lds
    v_mfma_f32_16x16x32_bf16 v[148:151], v[100:103], a[8:11], 0
    ds_read_b64_tr_b16 v[76:77], v14 offset:8192
    buffer_load_dwordx4 v3, s[60:63], s28 offen offset:1024 lds
    v_mfma_f32_16x16x32_bf16 v[156:159], v[100:103], a[12:15], 0
    ds_read_b64_tr_b16 v[78:79], v14 offset:8704
    v_mfma_f32_16x16x32_bf16 v[160:163], v[104:107], a[0:3], 0
    ds_read_b64_tr_b16 v[80:81], v11 offset:12288
    buffer_load_dwordx4 v4, s[60:63], s28 offen offset:2048 lds
    v_mfma_f32_16x16x32_bf16 v[168:171], v[104:107], a[4:7], 0
    ds_read_b64_tr_b16 v[82:83], v11 offset:12800
    v_mfma_f32_16x16x32_bf16 v[176:179], v[104:107], a[8:11], 0
    ds_read_b64_tr_b16 v[84:85], v12 offset:12288
    buffer_load_dwordx4 v5, s[60:63], s28 offen offset:3072 lds
    v_mfma_f32_16x16x32_bf16 v[184:187], v[104:107], a[12:15], 0
    ds_read_b64_tr_b16 v[86:87], v12 offset:12800
    v_mfma_f32_16x16x32_bf16 v[164:167], v[108:111], a[0:3], 0
    ds_read_b64_tr_b16 v[88:89], v13 offset:12288
    s_add_u32 m0, s12, 4096
    s_add_u32 s28, s8, 33024
    v_mfma_f32_16x16x32_bf16 v[172:175], v[108:111], a[4:7], 0
    ds_read_b64_tr_b16 v[90:91], v13 offset:12800
    buffer_load_dwordx4 v2, s[60:63], s28 offen offset:0 lds
    v_mfma_f32_16x16x32_bf16 v[180:183], v[108:111], a[8:11], 0
    ds_read_b64_tr_b16 v[92:93], v14 offset:12288
    v_mfma_f32_16x16x32_bf16 v[188:191], v[108:111], a[12:15], 0
    ds_read_b64_tr_b16 v[94:95], v14 offset:12800
    buffer_load_dwordx4 v3, s[60:63], s28 offen offset:1024 lds
    v_mfma_f32_16x16x32_bf16 v[192:195], v[112:115], a[0:3], 0
    buffer_load_dwordx4 v4, s[60:63], s28 offen offset:2048 lds
    v_mfma_f32_16x16x32_bf16 v[200:203], v[112:115], a[4:7], 0
    buffer_load_dwordx4 v5, s[60:63], s28 offen offset:3072 lds
    v_mfma_f32_16x16x32_bf16 v[208:211], v[112:115], a[8:11], 0
    s_add_u32 m0, s11, 32768
    s_add_u32 s1, s4, 1048576
    v_mfma_f32_16x16x32_bf16 v[216:219], v[112:115], a[12:15], 0
    buffer_load_dwordx4 v6, s[52:55], s1 offen offset:0 lds
    v_mfma_f32_16x16x32_bf16 v[196:199], v[116:119], a[0:3], 0
    buffer_load_dwordx4 v7, s[52:55], s1 offen offset:1024 lds
    v_mfma_f32_16x16x32_bf16 v[204:207], v[116:119], a[4:7], 0
    buffer_load_dwordx4 v8, s[52:55], s1 offen offset:2048 lds
    v_mfma_f32_16x16x32_bf16 v[212:215], v[116:119], a[8:11], 0
    buffer_load_dwordx4 v9, s[52:55], s1 offen offset:3072 lds
    v_mfma_f32_16x16x32_bf16 v[220:223], v[116:119], a[12:15], 0
    v_mfma_f32_16x16x32_bf16 v[224:227], v[120:123], a[0:3], 0
    v_mfma_f32_16x16x32_bf16 v[232:235], v[120:123], a[4:7], 0
    s_waitcnt vmcnt(22)
    ds_read_b128 a[32:35], v10 offset:8192
    v_mfma_f32_16x16x32_bf16 v[240:243], v[120:123], a[8:11], 0
    ds_read_b128 a[36:39], v10 offset:10240
    v_mfma_f32_16x16x32_bf16 v[248:251], v[120:123], a[12:15], 0
    ds_read_b128 a[48:51], v35 offset:8192
    v_mfma_f32_16x16x32_bf16 v[228:231], v[124:127], a[0:3], 0
    ds_read_b128 a[52:55], v35 offset:10240
    v_mfma_f32_16x16x32_bf16 v[236:239], v[124:127], a[4:7], 0
    v_mfma_f32_16x16x32_bf16 v[244:247], v[124:127], a[8:11], 0
    v_mfma_f32_16x16x32_bf16 v[252:255], v[124:127], a[12:15], 0
    s_waitcnt vmcnt(18) lgkmcnt(0)
    v_mfma_f32_16x16x32_bf16 v[128:131], v[64:67], a[16:19], v[128:131]
    s_barrier
    ds_read_b64_tr_b16 v[96:97], v11 offset:16384
    v_mfma_f32_16x16x32_bf16 v[136:139], v[64:67], a[20:23], v[136:139]
    ds_read_b64_tr_b16 v[98:99], v11 offset:16896
    v_mfma_f32_16x16x32_bf16 v[144:147], v[64:67], a[24:27], v[144:147]
    ds_read_b64_tr_b16 v[100:101], v12 offset:16384
    v_mfma_f32_16x16x32_bf16 v[152:155], v[64:67], a[28:31], v[152:155]
    ds_read_b64_tr_b16 v[102:103], v12 offset:16896
    v_mfma_f32_16x16x32_bf16 v[132:135], v[68:71], a[16:19], v[132:135]
    ds_read_b64_tr_b16 v[104:105], v13 offset:16384
    v_mfma_f32_16x16x32_bf16 v[140:143], v[68:71], a[20:23], v[140:143]
    ds_read_b64_tr_b16 v[106:107], v13 offset:16896
    s_add_u32 m0, s12, 8192
    s_add_u32 s28, s8, 384
    v_mfma_f32_16x16x32_bf16 v[148:151], v[68:71], a[24:27], v[148:151]
    ds_read_b64_tr_b16 v[108:109], v14 offset:16384
    v_mfma_f32_16x16x32_bf16 v[156:159], v[68:71], a[28:31], v[156:159]
    ds_read_b64_tr_b16 v[110:111], v14 offset:16896
    buffer_load_dwordx4 v2, s[60:63], s28 offen offset:0 lds
    v_mfma_f32_16x16x32_bf16 v[160:163], v[72:75], a[16:19], v[160:163]
    ds_read_b64_tr_b16 v[112:113], v11 offset:20480
    v_mfma_f32_16x16x32_bf16 v[168:171], v[72:75], a[20:23], v[168:171]
    ds_read_b64_tr_b16 v[114:115], v11 offset:20992
    v_mfma_f32_16x16x32_bf16 v[176:179], v[72:75], a[24:27], v[176:179]
    ds_read_b64_tr_b16 v[116:117], v12 offset:20480
    buffer_load_dwordx4 v3, s[60:63], s28 offen offset:1024 lds
    v_mfma_f32_16x16x32_bf16 v[184:187], v[72:75], a[28:31], v[184:187]
    ds_read_b64_tr_b16 v[118:119], v12 offset:20992
    v_mfma_f32_16x16x32_bf16 v[164:167], v[76:79], a[16:19], v[164:167]
    ds_read_b64_tr_b16 v[120:121], v13 offset:20480
    buffer_load_dwordx4 v4, s[60:63], s28 offen offset:2048 lds
    v_mfma_f32_16x16x32_bf16 v[172:175], v[76:79], a[20:23], v[172:175]
    ds_read_b64_tr_b16 v[122:123], v13 offset:20992
    v_mfma_f32_16x16x32_bf16 v[180:183], v[76:79], a[24:27], v[180:183]
    ds_read_b64_tr_b16 v[124:125], v14 offset:20480
    v_mfma_f32_16x16x32_bf16 v[188:191], v[76:79], a[28:31], v[188:191]
    ds_read_b64_tr_b16 v[126:127], v14 offset:20992
    buffer_load_dwordx4 v5, s[60:63], s28 offen offset:3072 lds
    v_mfma_f32_16x16x32_bf16 v[192:195], v[80:83], a[16:19], v[192:195]
    s_add_u32 m0, s11, 0
    s_add_u32 s1, s4, 1572864
    v_mfma_f32_16x16x32_bf16 v[200:203], v[80:83], a[20:23], v[200:203]
    buffer_load_dwordx4 v6, s[52:55], s1 offen offset:0 lds
    v_mfma_f32_16x16x32_bf16 v[208:211], v[80:83], a[24:27], v[208:211]
    buffer_load_dwordx4 v7, s[52:55], s1 offen offset:1024 lds
    v_mfma_f32_16x16x32_bf16 v[216:219], v[80:83], a[28:31], v[216:219]
    s_waitcnt vmcnt(20)
    ds_read_b128 a[40:43], v10 offset:12288
    v_mfma_f32_16x16x32_bf16 v[196:199], v[84:87], a[16:19], v[196:199]
    ds_read_b128 a[44:47], v10 offset:14336
    v_mfma_f32_16x16x32_bf16 v[204:207], v[84:87], a[20:23], v[204:207]
    ds_read_b128 a[56:59], v35 offset:12288
    v_mfma_f32_16x16x32_bf16 v[212:215], v[84:87], a[24:27], v[212:215]
    ds_read_b128 a[60:63], v35 offset:14336
    v_mfma_f32_16x16x32_bf16 v[220:223], v[84:87], a[28:31], v[220:223]
    buffer_load_dwordx4 v8, s[52:55], s1 offen offset:2048 lds
    v_mfma_f32_16x16x32_bf16 v[224:227], v[88:91], a[16:19], v[224:227]
    buffer_load_dwordx4 v9, s[52:55], s1 offen offset:3072 lds
    v_mfma_f32_16x16x32_bf16 v[232:235], v[88:91], a[20:23], v[232:235]
    s_waitcnt vmcnt(16)
    ds_read_b128 a[64:67], v10 offset:0
    v_mfma_f32_16x16x32_bf16 v[240:243], v[88:91], a[24:27], v[240:243]
    ds_read_b128 a[68:71], v10 offset:2048
    v_mfma_f32_16x16x32_bf16 v[248:251], v[88:91], a[28:31], v[248:251]
    ds_read_b128 a[80:83], v35 offset:0
    v_mfma_f32_16x16x32_bf16 v[228:231], v[92:95], a[16:19], v[228:231]
    ds_read_b128 a[84:87], v35 offset:2048
    v_mfma_f32_16x16x32_bf16 v[236:239], v[92:95], a[20:23], v[236:239]
    v_mfma_f32_16x16x32_bf16 v[244:247], v[92:95], a[24:27], v[244:247]
    v_mfma_f32_16x16x32_bf16 v[252:255], v[92:95], a[28:31], v[252:255]
    s_waitcnt lgkmcnt(0)
    v_mfma_f32_16x16x32_bf16 v[128:131], v[96:99], a[32:35], v[128:131]
    ds_read_b64_tr_b16 v[64:65], v11 offset:24576
    v_mfma_f32_16x16x32_bf16 v[136:139], v[96:99], a[36:39], v[136:139]
    ds_read_b64_tr_b16 v[66:67], v11 offset:25088
    v_mfma_f32_16x16x32_bf16 v[144:147], v[96:99], a[40:43], v[144:147]
    ds_read_b64_tr_b16 v[68:69], v12 offset:24576
    v_mfma_f32_16x16x32_bf16 v[152:155], v[96:99], a[44:47], v[152:155]
    ds_read_b64_tr_b16 v[70:71], v12 offset:25088
    v_mfma_f32_16x16x32_bf16 v[132:135], v[100:103], a[32:35], v[132:135]
    ds_read_b64_tr_b16 v[72:73], v13 offset:24576
    v_mfma_f32_16x16x32_bf16 v[140:143], v[100:103], a[36:39], v[140:143]
    ds_read_b64_tr_b16 v[74:75], v13 offset:25088
    s_add_u32 m0, s12, 12288
    s_add_u32 s28, s8, 33152
    v_mfma_f32_16x16x32_bf16 v[148:151], v[100:103], a[40:43], v[148:151]
    ds_read_b64_tr_b16 v[76:77], v14 offset:24576
    v_mfma_f32_16x16x32_bf16 v[156:159], v[100:103], a[44:47], v[156:159]
    ds_read_b64_tr_b16 v[78:79], v14 offset:25088
    buffer_load_dwordx4 v2, s[60:63], s28 offen offset:0 lds
    v_mfma_f32_16x16x32_bf16 v[160:163], v[104:107], a[32:35], v[160:163]
    ds_read_b64_tr_b16 v[80:81], v11 offset:28672
    v_mfma_f32_16x16x32_bf16 v[168:171], v[104:107], a[36:39], v[168:171]
    ds_read_b64_tr_b16 v[82:83], v11 offset:29184
    v_mfma_f32_16x16x32_bf16 v[176:179], v[104:107], a[40:43], v[176:179]
    ds_read_b64_tr_b16 v[84:85], v12 offset:28672
    buffer_load_dwordx4 v3, s[60:63], s28 offen offset:1024 lds
    v_mfma_f32_16x16x32_bf16 v[184:187], v[104:107], a[44:47], v[184:187]
    ds_read_b64_tr_b16 v[86:87], v12 offset:29184
    v_mfma_f32_16x16x32_bf16 v[164:167], v[108:111], a[32:35], v[164:167]
    ds_read_b64_tr_b16 v[88:89], v13 offset:28672
    buffer_load_dwordx4 v4, s[60:63], s28 offen offset:2048 lds
    v_mfma_f32_16x16x32_bf16 v[172:175], v[108:111], a[36:39], v[172:175]
    ds_read_b64_tr_b16 v[90:91], v13 offset:29184
    v_mfma_f32_16x16x32_bf16 v[180:183], v[108:111], a[40:43], v[180:183]
    ds_read_b64_tr_b16 v[92:93], v14 offset:28672
    v_mfma_f32_16x16x32_bf16 v[188:191], v[108:111], a[44:47], v[188:191]
    ds_read_b64_tr_b16 v[94:95], v14 offset:29184
    buffer_load_dwordx4 v5, s[60:63], s28 offen offset:3072 lds
    v_mfma_f32_16x16x32_bf16 v[192:195], v[112:115], a[32:35], v[192:195]
    s_add_u32 m0, s12, 0
    s_add_u32 s28, s8, 512
    v_mfma_f32_16x16x32_bf16 v[200:203], v[112:115], a[36:39], v[200:203]
    buffer_load_dwordx4 v2, s[60:63], s28 offen offset:0 lds
    v_mfma_f32_16x16x32_bf16 v[208:211], v[112:115], a[40:43], v[208:211]
    buffer_load_dwordx4 v3, s[60:63], s28 offen offset:1024 lds
    v_mfma_f32_16x16x32_bf16 v[216:219], v[112:115], a[44:47], v[216:219]
    buffer_load_dwordx4 v4, s[60:63], s28 offen offset:2048 lds
    v_mfma_f32_16x16x32_bf16 v[196:199], v[116:119], a[32:35], v[196:199]
    buffer_load_dwordx4 v5, s[60:63], s28 offen offset:3072 lds
    v_mfma_f32_16x16x32_bf16 v[204:207], v[116:119], a[36:39], v[204:207]
    v_mfma_f32_16x16x32_bf16 v[212:215], v[116:119], a[40:43], v[212:215]
    v_mfma_f32_16x16x32_bf16 v[220:223], v[116:119], a[44:47], v[220:223]
    v_mfma_f32_16x16x32_bf16 v[224:227], v[120:123], a[32:35], v[224:227]
    v_mfma_f32_16x16x32_bf16 v[232:235], v[120:123], a[36:39], v[232:235]
    s_waitcnt vmcnt(20)
    ds_read_b128 a[72:75], v10 offset:4096
    v_mfma_f32_16x16x32_bf16 v[240:243], v[120:123], a[40:43], v[240:243]
    ds_read_b128 a[76:79], v10 offset:6144
    v_mfma_f32_16x16x32_bf16 v[248:251], v[120:123], a[44:47], v[248:251]
    ds_read_b128 a[88:91], v35 offset:4096
    v_mfma_f32_16x16x32_bf16 v[228:231], v[124:127], a[32:35], v[228:231]
    ds_read_b128 a[92:95], v35 offset:6144
    v_mfma_f32_16x16x32_bf16 v[236:239], v[124:127], a[36:39], v[236:239]
    v_mfma_f32_16x16x32_bf16 v[244:247], v[124:127], a[40:43], v[244:247]
    v_mfma_f32_16x16x32_bf16 v[252:255], v[124:127], a[44:47], v[252:255]
    s_waitcnt vmcnt(16) lgkmcnt(0)
    v_mfma_f32_16x16x32_bf16 v[128:131], v[64:67], a[48:51], v[128:131]
    s_barrier
    ds_read_b64_tr_b16 v[96:97], v11 offset:32768
    s_mov_b32 s80, s40
    v_mfma_f32_16x16x32_bf16 v[136:139], v[64:67], a[52:55], v[136:139]
    ds_read_b64_tr_b16 v[98:99], v11 offset:33280
    s_mov_b32 s81, s41
    v_mfma_f32_16x16x32_bf16 v[144:147], v[64:67], a[56:59], v[144:147]
    ds_read_b64_tr_b16 v[100:101], v12 offset:32768
    s_mov_b32 s82, 1024
    v_mfma_f32_16x16x32_bf16 v[152:155], v[64:67], a[60:63], v[152:155]
    ds_read_b64_tr_b16 v[102:103], v12 offset:33280
    s_mov_b32 s83, 0x00020000
    v_mfma_f32_16x16x32_bf16 v[132:135], v[68:71], a[48:51], v[132:135]
    ds_read_b64_tr_b16 v[104:105], v13 offset:32768
    s_mov_b32 s84, s16
    v_mfma_f32_16x16x32_bf16 v[140:143], v[68:71], a[52:55], v[140:143]
    ds_read_b64_tr_b16 v[106:107], v13 offset:33280
    s_add_u32 m0, s12, 4096
    s_add_u32 s28, s8, 33280
    v_mfma_f32_16x16x32_bf16 v[148:151], v[68:71], a[56:59], v[148:151]
    ds_read_b64_tr_b16 v[108:109], v14 offset:32768
    s_mov_b32 s85, s17
    v_mfma_f32_16x16x32_bf16 v[156:159], v[68:71], a[60:63], v[156:159]
    ds_read_b64_tr_b16 v[110:111], v14 offset:33280
    buffer_load_dwordx4 v2, s[60:63], s28 offen offset:0 lds
    v_mfma_f32_16x16x32_bf16 v[160:163], v[72:75], a[48:51], v[160:163]
    ds_read_b64_tr_b16 v[112:113], v11 offset:36864
    s_mov_b32 s86, 2097152
    v_mfma_f32_16x16x32_bf16 v[168:171], v[72:75], a[52:55], v[168:171]
    ds_read_b64_tr_b16 v[114:115], v11 offset:37376
    s_mov_b32 s87, 0x00020000
    v_mfma_f32_16x16x32_bf16 v[176:179], v[72:75], a[56:59], v[176:179]
    ds_read_b64_tr_b16 v[116:117], v12 offset:36864
    buffer_load_dwordx4 v3, s[60:63], s28 offen offset:1024 lds
    v_mfma_f32_16x16x32_bf16 v[184:187], v[72:75], a[60:63], v[184:187]
    ds_read_b64_tr_b16 v[118:119], v12 offset:37376
    v_lshrrev_b32 v30, 5, v0
    v_mfma_f32_16x16x32_bf16 v[164:167], v[76:79], a[48:51], v[164:167]
    ds_read_b64_tr_b16 v[120:121], v13 offset:36864
    buffer_load_dwordx4 v4, s[60:63], s28 offen offset:2048 lds
    v_mfma_f32_16x16x32_bf16 v[172:175], v[76:79], a[52:55], v[172:175]
    ds_read_b64_tr_b16 v[122:123], v13 offset:37376
    v_and_b32 v31, 31, v0
    v_mfma_f32_16x16x32_bf16 v[180:183], v[76:79], a[56:59], v[180:183]
    ds_read_b64_tr_b16 v[124:125], v14 offset:36864
    s_lshl_b32 s6, s2, 3
    v_mfma_f32_16x16x32_bf16 v[188:191], v[76:79], a[60:63], v[188:191]
    ds_read_b64_tr_b16 v[126:127], v14 offset:37376
    buffer_load_dwordx4 v5, s[60:63], s28 offen offset:3072 lds
    v_mfma_f32_16x16x32_bf16 v[192:195], v[80:83], a[48:51], v[192:195]
    s_add_u32 m0, s11, 16384
    s_add_u32 s1, s4, 2097152
    s_lshl_b32 s10, s3, 1
    v_mfma_f32_16x16x32_bf16 v[200:203], v[80:83], a[52:55], v[200:203]
    buffer_load_dwordx4 v6, s[52:55], s1 offen offset:0 lds
    s_add_u32 s6, s6, s10
    v_mfma_f32_16x16x32_bf16 v[208:211], v[80:83], a[56:59], v[208:211]
    buffer_load_dwordx4 v7, s[52:55], s1 offen offset:1024 lds
    v_add_u32 v32, s6, v30
    v_mfma_f32_16x16x32_bf16 v[216:219], v[80:83], a[60:63], v[216:219]
    s_waitcnt vmcnt(18)
    ds_read_b128 a[96:99], v10 offset:8192
    v_lshlrev_b32 v33, 5, v31
    v_mfma_f32_16x16x32_bf16 v[196:199], v[84:87], a[48:51], v[196:199]
    ds_read_b128 a[100:103], v10 offset:10240
    v_lshl_add_u32 v27, v32, 10, v33
    v_mfma_f32_16x16x32_bf16 v[204:207], v[84:87], a[52:55], v[204:207]
    ds_read_b128 a[112:115], v35 offset:8192
    buffer_load_dwordx4 v[36:39], v27, s[84:87], 0 offen
    v_mfma_f32_16x16x32_bf16 v[212:215], v[84:87], a[56:59], v[212:215]
    ds_read_b128 a[116:119], v35 offset:10240
    buffer_load_dwordx4 v[40:43], v27, s[84:87], 0 offen offset:16
    v_mfma_f32_16x16x32_bf16 v[220:223], v[84:87], a[60:63], v[220:223]
    buffer_load_dwordx4 v8, s[52:55], s1 offen offset:2048 lds
    buffer_load_dwordx4 v[44:47], v33, s[80:83], 0 offen
    v_mfma_f32_16x16x32_bf16 v[224:227], v[88:91], a[48:51], v[224:227]
    buffer_load_dwordx4 v9, s[52:55], s1 offen offset:3072 lds
    buffer_load_dwordx4 v[48:51], v33, s[80:83], 0 offen offset:16
    v_mfma_f32_16x16x32_bf16 v[232:235], v[88:91], a[52:55], v[232:235]
    s_waitcnt vmcnt(16)
    ds_read_b128 a[104:107], v10 offset:12288
    v_and_b32 v32, 7, v32
    v_mfma_f32_16x16x32_bf16 v[240:243], v[88:91], a[56:59], v[240:243]
    ds_read_b128 a[108:111], v10 offset:14336
    v_lshlrev_b32 v32, 2, v32
    v_mfma_f32_16x16x32_bf16 v[248:251], v[88:91], a[60:63], v[248:251]
    ds_read_b128 a[120:123], v35 offset:12288
    v_add_u32 v32, 8192, v32
    v_mfma_f32_16x16x32_bf16 v[228:231], v[92:95], a[48:51], v[228:231]
    ds_read_b128 a[124:127], v35 offset:14336
    v_cmp_eq_u32 vcc, 31, v31
    v_mfma_f32_16x16x32_bf16 v[236:239], v[92:95], a[52:55], v[236:239]
    v_mov_b32 v33, 8256
    s_nop 0
    v_mfma_f32_16x16x32_bf16 v[244:247], v[92:95], a[56:59], v[244:247]
    v_cndmask_b32 v28, v33, v32, vcc
    s_mov_b32 s64, s18
    v_mfma_f32_16x16x32_bf16 v[252:255], v[92:95], a[60:63], v[252:255]
    s_mov_b32 s65, s19
    s_mov_b32 s66, 2097152
    s_waitcnt lgkmcnt(0)
    v_mfma_f32_16x16x32_bf16 v[128:131], v[96:99], a[64:67], v[128:131]
    ds_read_b64_tr_b16 v[64:65], v11 offset:40960
    s_mov_b32 s67, 0x00020000
    v_mfma_f32_16x16x32_bf16 v[136:139], v[96:99], a[68:71], v[136:139]
    ds_read_b64_tr_b16 v[66:67], v11 offset:41472
    s_mov_b32 s68, s20
    v_mfma_f32_16x16x32_bf16 v[144:147], v[96:99], a[72:75], v[144:147]
    ds_read_b64_tr_b16 v[68:69], v12 offset:40960
    s_mov_b32 s69, s21
    v_mfma_f32_16x16x32_bf16 v[152:155], v[96:99], a[76:79], v[152:155]
    ds_read_b64_tr_b16 v[70:71], v12 offset:41472
    s_mov_b32 s70, 2097152
    v_mfma_f32_16x16x32_bf16 v[132:135], v[100:103], a[64:67], v[132:135]
    ds_read_b64_tr_b16 v[72:73], v13 offset:40960
    s_mov_b32 s71, 0x00020000
    v_mfma_f32_16x16x32_bf16 v[140:143], v[100:103], a[68:71], v[140:143]
    ds_read_b64_tr_b16 v[74:75], v13 offset:41472
    s_add_u32 m0, s12, 8192
    s_add_u32 s28, s8, 640
    v_mfma_f32_16x16x32_bf16 v[148:151], v[100:103], a[72:75], v[148:151]
    ds_read_b64_tr_b16 v[76:77], v14 offset:40960
    s_mov_b32 s72, s22
    v_mfma_f32_16x16x32_bf16 v[156:159], v[100:103], a[76:79], v[156:159]
    ds_read_b64_tr_b16 v[78:79], v14 offset:41472
    buffer_load_dwordx4 v2, s[60:63], s28 offen offset:0 lds
    v_mfma_f32_16x16x32_bf16 v[160:163], v[104:107], a[64:67], v[160:163]
    ds_read_b64_tr_b16 v[80:81], v11 offset:45056
    s_mov_b32 s73, s23
    v_mfma_f32_16x16x32_bf16 v[168:171], v[104:107], a[68:71], v[168:171]
    ds_read_b64_tr_b16 v[82:83], v11 offset:45568
    s_mov_b32 s74, 4096
    v_mfma_f32_16x16x32_bf16 v[176:179], v[104:107], a[72:75], v[176:179]
    ds_read_b64_tr_b16 v[84:85], v12 offset:45056
    buffer_load_dwordx4 v3, s[60:63], s28 offen offset:1024 lds
    v_mfma_f32_16x16x32_bf16 v[184:187], v[104:107], a[76:79], v[184:187]
    ds_read_b64_tr_b16 v[86:87], v12 offset:45568
    s_mov_b32 s75, 0x00020000
    v_mfma_f32_16x16x32_bf16 v[164:167], v[108:111], a[64:67], v[164:167]
    ds_read_b64_tr_b16 v[88:89], v13 offset:45056
    buffer_load_dwordx4 v4, s[60:63], s28 offen offset:2048 lds
    v_mfma_f32_16x16x32_bf16 v[172:175], v[108:111], a[68:71], v[172:175]
    ds_read_b64_tr_b16 v[90:91], v13 offset:45568
    s_lshl_b32 s6, s5, 6
    v_mfma_f32_16x16x32_bf16 v[180:183], v[108:111], a[72:75], v[180:183]
    ds_read_b64_tr_b16 v[92:93], v14 offset:45056
    s_lshl_b32 s10, s3, 4
    v_mfma_f32_16x16x32_bf16 v[188:191], v[108:111], a[76:79], v[188:191]
    ds_read_b64_tr_b16 v[94:95], v14 offset:45568
    buffer_load_dwordx4 v5, s[60:63], s28 offen offset:3072 lds
    v_mfma_f32_16x16x32_bf16 v[192:195], v[112:115], a[64:67], v[192:195]
    s_add_u32 m0, s12, 12288
    s_add_u32 s28, s8, 33408
    s_add_u32 s6, s6, s10
    v_mfma_f32_16x16x32_bf16 v[200:203], v[112:115], a[68:71], v[200:203]
    buffer_load_dwordx4 v2, s[60:63], s28 offen offset:0 lds
    v_lshlrev_b32 v32, 3, v30
    v_mfma_f32_16x16x32_bf16 v[208:211], v[112:115], a[72:75], v[208:211]
    buffer_load_dwordx4 v3, s[60:63], s28 offen offset:1024 lds
    v_add_u32 v32, s6, v32
    v_mfma_f32_16x16x32_bf16 v[216:219], v[112:115], a[76:79], v[216:219]
    buffer_load_dwordx4 v4, s[60:63], s28 offen offset:2048 lds
    s_and_b32 s10, s2, 7
    v_mfma_f32_16x16x32_bf16 v[196:199], v[116:119], a[64:67], v[196:199]
    buffer_load_dwordx4 v5, s[60:63], s28 offen offset:3072 lds
    s_lshl_b32 s6, s10, 7
    v_mfma_f32_16x16x32_bf16 v[204:207], v[116:119], a[68:71], v[204:207]
    v_lshlrev_b32 v33, 10, v32
    v_lshl_add_u32 v33, v31, 2, v33
    v_mfma_f32_16x16x32_bf16 v[212:215], v[116:119], a[72:75], v[212:215]
    v_add_u32 v20, s6, v33
    v_subrev_u32 v19, 3072, v20
    v_mfma_f32_16x16x32_bf16 v[220:223], v[116:119], a[76:79], v[220:223]
    v_add_u32 v21, 4096, v20
    s_lshl_b32 s6, s10, 9
    v_mfma_f32_16x16x32_bf16 v[224:227], v[120:123], a[64:67], v[224:227]
    v_lshlrev_b32 v33, 4, v31
    v_add_u32 v22, s6, v33
    v_mfma_f32_16x16x32_bf16 v[232:235], v[120:123], a[68:71], v[232:235]
    s_waitcnt vmcnt(20)
    ds_read_b128 a[128:131], v10 offset:0
    s_lshl_b32 s6, s3, 5
    v_mfma_f32_16x16x32_bf16 v[240:243], v[120:123], a[72:75], v[240:243]
    ds_read_b128 a[132:135], v10 offset:2048
    s_add_u32 s6, s6, 0
    v_mfma_f32_16x16x32_bf16 v[248:251], v[120:123], a[76:79], v[248:251]
    ds_read_b128 a[144:147], v35 offset:0
    v_lshlrev_b32 v33, 8, v31
    v_mfma_f32_16x16x32_bf16 v[228:231], v[124:127], a[64:67], v[228:231]
    ds_read_b128 a[148:151], v35 offset:2048
    v_lshl_add_u32 v33, v30, 4, v33
    v_mfma_f32_16x16x32_bf16 v[236:239], v[124:127], a[68:71], v[236:239]
    v_add_u32 v23, s6, v33
    s_lshl_b32 s6, s10, 18
    v_mfma_f32_16x16x32_bf16 v[244:247], v[124:127], a[72:75], v[244:247]
    s_lshl_b32 s10, s3, 16
    s_add_u32 s6, s6, s10
    v_mfma_f32_16x16x32_bf16 v[252:255], v[124:127], a[76:79], v[252:255]
    s_lshl_b32 s10, s5, 7
    s_add_u32 s6, s6, s10
    s_waitcnt lgkmcnt(0)
    v_mfma_f32_16x16x32_bf16 v[128:131], v[64:67], a[80:83], v[128:131]
    s_barrier
    ds_read_b64_tr_b16 v[96:97], v11 offset:0
    s_add_u32 s6, s6, 71303168
    v_mfma_f32_16x16x32_bf16 v[136:139], v[64:67], a[84:87], v[136:139]
    ds_read_b64_tr_b16 v[98:99], v11 offset:512
    v_lshrrev_b32 v33, 3, v0
    v_mfma_f32_16x16x32_bf16 v[144:147], v[64:67], a[88:91], v[144:147]
    ds_read_b64_tr_b16 v[100:101], v12 offset:0
    v_lshlrev_b32 v33, 12, v33
    v_mfma_f32_16x16x32_bf16 v[152:155], v[64:67], a[92:95], v[152:155]
    ds_read_b64_tr_b16 v[102:103], v12 offset:512
    v_and_b32 v32, 7, v0
    v_mfma_f32_16x16x32_bf16 v[132:135], v[68:71], a[80:83], v[132:135]
    ds_read_b64_tr_b16 v[104:105], v13 offset:0
    v_lshl_add_u32 v33, v32, 4, v33
    v_mfma_f32_16x16x32_bf16 v[140:143], v[68:71], a[84:87], v[140:143]
    ds_read_b64_tr_b16 v[106:107], v13 offset:512
    s_add_u32 m0, s12, 0
    s_add_u32 s28, s8, 768
    v_mfma_f32_16x16x32_bf16 v[148:151], v[68:71], a[88:91], v[148:151]
    ds_read_b64_tr_b16 v[108:109], v14 offset:0
    v_add_u32 v24, s6, v33
    v_mfma_f32_16x16x32_bf16 v[156:159], v[68:71], a[92:95], v[156:159]
    ds_read_b64_tr_b16 v[110:111], v14 offset:512
    buffer_load_dwordx4 v2, s[60:63], s28 offen offset:0 lds
    v_mfma_f32_16x16x32_bf16 v[160:163], v[72:75], a[80:83], v[160:163]
    ds_read_b64_tr_b16 v[112:113], v11 offset:4096
    s_lshr_b32 s20, s2, 5
    v_mfma_f32_16x16x32_bf16 v[168:171], v[72:75], a[84:87], v[168:171]
    ds_read_b64_tr_b16 v[114:115], v11 offset:4608
    s_lshl_b32 s20, s20, 10
    v_mfma_f32_16x16x32_bf16 v[176:179], v[72:75], a[88:91], v[176:179]
    ds_read_b64_tr_b16 v[116:117], v12 offset:4096
    buffer_load_dwordx4 v3, s[60:63], s28 offen offset:1024 lds
    v_mfma_f32_16x16x32_bf16 v[184:187], v[72:75], a[92:95], v[184:187]
    ds_read_b64_tr_b16 v[118:119], v12 offset:4608
    s_and_b32 s10, s2, 31
    v_mfma_f32_16x16x32_bf16 v[164:167], v[76:79], a[80:83], v[164:167]
    ds_read_b64_tr_b16 v[120:121], v13 offset:4096
    buffer_load_dwordx4 v4, s[60:63], s28 offen offset:2048 lds
    v_mfma_f32_16x16x32_bf16 v[172:175], v[76:79], a[84:87], v[172:175]
    ds_read_b64_tr_b16 v[122:123], v13 offset:4608
    s_lshl_b32 s10, s10, 2
    v_mfma_f32_16x16x32_bf16 v[180:183], v[76:79], a[88:91], v[180:183]
    ds_read_b64_tr_b16 v[124:125], v14 offset:4096
    s_add_u32 s20, s20, s10
    v_mfma_f32_16x16x32_bf16 v[188:191], v[76:79], a[92:95], v[188:191]
    ds_read_b64_tr_b16 v[126:127], v14 offset:4608
    buffer_load_dwordx4 v5, s[60:63], s28 offen offset:3072 lds
    v_mfma_f32_16x16x32_bf16 v[192:195], v[80:83], a[80:83], v[192:195]
    s_add_u32 m0, s11, 32768
    s_add_u32 s1, s4, 2621440
    s_add_u32 s20, s20, 75530240
    v_mfma_f32_16x16x32_bf16 v[200:203], v[80:83], a[84:87], v[200:203]
    buffer_load_dwordx4 v6, s[52:55], s1 offen offset:0 lds
    s_lshl_b32 s10, s3, 28
    v_mfma_f32_16x16x32_bf16 v[208:211], v[80:83], a[88:91], v[208:211]
    buffer_load_dwordx4 v7, s[52:55], s1 offen offset:1024 lds
    v_mov_b32 v32, s10
    v_mfma_f32_16x16x32_bf16 v[216:219], v[80:83], a[92:95], v[216:219]
    s_waitcnt vmcnt(22)
    ds_read_b128 a[136:139], v10 offset:4096
    v_mov_b32 v33, 0
    s_mov_b64 exec, 1
    buffer_store_dword v33, v32, s[48:51], s20 offen offset:512 sc1
    s_mov_b64 exec, -1
    v_mfma_f32_16x16x32_bf16 v[196:199], v[84:87], a[80:83], v[196:199]
    ds_read_b128 a[140:143], v10 offset:6144
    s_lshl_b32 s10, s2, 2
    v_mfma_f32_16x16x32_bf16 v[204:207], v[84:87], a[84:87], v[204:207]
    ds_read_b128 a[152:155], v35 offset:4096
    s_add_u32 s10, s10, s3
    v_mfma_f32_16x16x32_bf16 v[212:215], v[84:87], a[88:91], v[212:215]
    ds_read_b128 a[156:159], v35 offset:6144
    s_lshl_b32 s10, s10, 8
    v_mfma_f32_16x16x32_bf16 v[220:223], v[84:87], a[92:95], v[220:223]
    buffer_load_dwordx4 v8, s[52:55], s1 offen offset:2048 lds
    s_add_u32 s10, s10, 75563008
    v_mfma_f32_16x16x32_bf16 v[224:227], v[88:91], a[80:83], v[224:227]
    buffer_load_dwordx4 v9, s[52:55], s1 offen offset:3072 lds
    v_lshlrev_b32 v32, 2, v0
    v_mfma_f32_16x16x32_bf16 v[232:235], v[88:91], a[84:87], v[232:235]
    s_waitcnt vmcnt(13)
    ds_read_b128 a[160:163], v10 offset:8192
    buffer_store_dword v33, v32, s[48:51], s10 offen sc1
    v_mfma_f32_16x16x32_bf16 v[240:243], v[88:91], a[88:91], v[240:243]
    ds_read_b128 a[164:167], v10 offset:10240
    v_mfma_f32_16x16x32_bf16 v[248:251], v[88:91], a[92:95], v[248:251]
    ds_read_b128 a[176:179], v35 offset:8192
    v_mfma_f32_16x16x32_bf16 v[228:231], v[92:95], a[80:83], v[228:231]
    ds_read_b128 a[180:183], v35 offset:10240
    v_mfma_f32_16x16x32_bf16 v[236:239], v[92:95], a[84:87], v[236:239]
    v_mfma_f32_16x16x32_bf16 v[244:247], v[92:95], a[88:91], v[244:247]
    v_mfma_f32_16x16x32_bf16 v[252:255], v[92:95], a[92:95], v[252:255]
    s_waitcnt lgkmcnt(0)
    v_mfma_f32_16x16x32_bf16 v[128:131], v[96:99], a[96:99], v[128:131]
    ds_read_b64_tr_b16 v[64:65], v11 offset:8192
    v_mfma_f32_16x16x32_bf16 v[136:139], v[96:99], a[100:103], v[136:139]
    ds_read_b64_tr_b16 v[66:67], v11 offset:8704
    v_mfma_f32_16x16x32_bf16 v[144:147], v[96:99], a[104:107], v[144:147]
    ds_read_b64_tr_b16 v[68:69], v12 offset:8192
    v_mfma_f32_16x16x32_bf16 v[152:155], v[96:99], a[108:111], v[152:155]
    ds_read_b64_tr_b16 v[70:71], v12 offset:8704
    v_mfma_f32_16x16x32_bf16 v[132:135], v[100:103], a[96:99], v[132:135]
    ds_read_b64_tr_b16 v[72:73], v13 offset:8192
    v_mfma_f32_16x16x32_bf16 v[140:143], v[100:103], a[100:103], v[140:143]
    ds_read_b64_tr_b16 v[74:75], v13 offset:8704
    s_add_u32 m0, s12, 4096
    s_add_u32 s28, s8, 33536
    v_mfma_f32_16x16x32_bf16 v[148:151], v[100:103], a[104:107], v[148:151]
    ds_read_b64_tr_b16 v[76:77], v14 offset:8192
    v_mfma_f32_16x16x32_bf16 v[156:159], v[100:103], a[108:111], v[156:159]
    ds_read_b64_tr_b16 v[78:79], v14 offset:8704
    buffer_load_dwordx4 v2, s[60:63], s28 offen offset:0 lds
    v_mfma_f32_16x16x32_bf16 v[160:163], v[104:107], a[96:99], v[160:163]
    ds_read_b64_tr_b16 v[80:81], v11 offset:12288
    v_mfma_f32_16x16x32_bf16 v[168:171], v[104:107], a[100:103], v[168:171]
    ds_read_b64_tr_b16 v[82:83], v11 offset:12800
    v_mfma_f32_16x16x32_bf16 v[176:179], v[104:107], a[104:107], v[176:179]
    ds_read_b64_tr_b16 v[84:85], v12 offset:12288
    buffer_load_dwordx4 v3, s[60:63], s28 offen offset:1024 lds
    v_mfma_f32_16x16x32_bf16 v[184:187], v[104:107], a[108:111], v[184:187]
    ds_read_b64_tr_b16 v[86:87], v12 offset:12800
    v_mfma_f32_16x16x32_bf16 v[164:167], v[108:111], a[96:99], v[164:167]
    ds_read_b64_tr_b16 v[88:89], v13 offset:12288
    buffer_load_dwordx4 v4, s[60:63], s28 offen offset:2048 lds
    v_mfma_f32_16x16x32_bf16 v[172:175], v[108:111], a[100:103], v[172:175]
    ds_read_b64_tr_b16 v[90:91], v13 offset:12800
    v_mfma_f32_16x16x32_bf16 v[180:183], v[108:111], a[104:107], v[180:183]
    ds_read_b64_tr_b16 v[92:93], v14 offset:12288
    v_mfma_f32_16x16x32_bf16 v[188:191], v[108:111], a[108:111], v[188:191]
    ds_read_b64_tr_b16 v[94:95], v14 offset:12800
    buffer_load_dwordx4 v5, s[60:63], s28 offen offset:3072 lds
    v_mfma_f32_16x16x32_bf16 v[192:195], v[112:115], a[96:99], v[192:195]
    s_add_u32 m0, s12, 8192
    s_add_u32 s28, s8, 896
    v_mfma_f32_16x16x32_bf16 v[200:203], v[112:115], a[100:103], v[200:203]
    buffer_load_dwordx4 v2, s[60:63], s28 offen offset:0 lds
    v_mfma_f32_16x16x32_bf16 v[208:211], v[112:115], a[104:107], v[208:211]
    buffer_load_dwordx4 v3, s[60:63], s28 offen offset:1024 lds
    v_mfma_f32_16x16x32_bf16 v[216:219], v[112:115], a[108:111], v[216:219]
    buffer_load_dwordx4 v4, s[60:63], s28 offen offset:2048 lds
    v_mfma_f32_16x16x32_bf16 v[196:199], v[116:119], a[96:99], v[196:199]
    buffer_load_dwordx4 v5, s[60:63], s28 offen offset:3072 lds
    v_mfma_f32_16x16x32_bf16 v[204:207], v[116:119], a[100:103], v[204:207]
    v_mfma_f32_16x16x32_bf16 v[212:215], v[116:119], a[104:107], v[212:215]
    v_mfma_f32_16x16x32_bf16 v[220:223], v[116:119], a[108:111], v[220:223]
    v_mfma_f32_16x16x32_bf16 v[224:227], v[120:123], a[96:99], v[224:227]
    v_mfma_f32_16x16x32_bf16 v[232:235], v[120:123], a[100:103], v[232:235]
    s_waitcnt vmcnt(18)
    ds_read_b128 a[168:171], v10 offset:12288
    v_mfma_f32_16x16x32_bf16 v[240:243], v[120:123], a[104:107], v[240:243]
    ds_read_b128 a[172:175], v10 offset:14336
    v_mfma_f32_16x16x32_bf16 v[248:251], v[120:123], a[108:111], v[248:251]
    ds_read_b128 a[184:187], v35 offset:12288
    v_mfma_f32_16x16x32_bf16 v[228:231], v[124:127], a[96:99], v[228:231]
    ds_read_b128 a[188:191], v35 offset:14336
    v_mfma_f32_16x16x32_bf16 v[236:239], v[124:127], a[100:103], v[236:239]
    v_mfma_f32_16x16x32_bf16 v[244:247], v[124:127], a[104:107], v[244:247]
    v_mfma_f32_16x16x32_bf16 v[252:255], v[124:127], a[108:111], v[252:255]
    s_waitcnt lgkmcnt(0)
    v_mfma_f32_16x16x32_bf16 v[128:131], v[64:67], a[112:115], v[128:131]
    s_barrier
    ds_read_b64_tr_b16 v[96:97], v11 offset:16384
    v_mfma_f32_16x16x32_bf16 v[136:139], v[64:67], a[116:119], v[136:139]
    ds_read_b64_tr_b16 v[98:99], v11 offset:16896
    v_mfma_f32_16x16x32_bf16 v[144:147], v[64:67], a[120:123], v[144:147]
    ds_read_b64_tr_b16 v[100:101], v12 offset:16384
    v_mfma_f32_16x16x32_bf16 v[152:155], v[64:67], a[124:127], v[152:155]
    ds_read_b64_tr_b16 v[102:103], v12 offset:16896
    v_mfma_f32_16x16x32_bf16 v[132:135], v[68:71], a[112:115], v[132:135]
    ds_read_b64_tr_b16 v[104:105], v13 offset:16384
    s_add_u32 m0, s12, 12288
    s_add_u32 s28, s8, 33664
    v_mfma_f32_16x16x32_bf16 v[140:143], v[68:71], a[116:119], v[140:143]
    ds_read_b64_tr_b16 v[106:107], v13 offset:16896
    v_mfma_f32_16x16x32_bf16 v[148:151], v[68:71], a[120:123], v[148:151]
    ds_read_b64_tr_b16 v[108:109], v14 offset:16384
    buffer_load_dwordx4 v2, s[60:63], s28 offen offset:0 lds
    v_mfma_f32_16x16x32_bf16 v[156:159], v[68:71], a[124:127], v[156:159]
    ds_read_b64_tr_b16 v[110:111], v14 offset:16896
    v_mfma_f32_16x16x32_bf16 v[160:163], v[72:75], a[112:115], v[160:163]
    ds_read_b64_tr_b16 v[112:113], v11 offset:20480
    buffer_load_dwordx4 v3, s[60:63], s28 offen offset:1024 lds
    v_mfma_f32_16x16x32_bf16 v[168:171], v[72:75], a[116:119], v[168:171]
    ds_read_b64_tr_b16 v[114:115], v11 offset:20992
    v_mfma_f32_16x16x32_bf16 v[176:179], v[72:75], a[120:123], v[176:179]
    ds_read_b64_tr_b16 v[116:117], v12 offset:20480
    buffer_load_dwordx4 v4, s[60:63], s28 offen offset:2048 lds
    v_mfma_f32_16x16x32_bf16 v[184:187], v[72:75], a[124:127], v[184:187]
    ds_read_b64_tr_b16 v[118:119], v12 offset:20992
    v_mfma_f32_16x16x32_bf16 v[164:167], v[76:79], a[112:115], v[164:167]
    ds_read_b64_tr_b16 v[120:121], v13 offset:20480
    buffer_load_dwordx4 v5, s[60:63], s28 offen offset:3072 lds
    v_mfma_f32_16x16x32_bf16 v[172:175], v[76:79], a[116:119], v[172:175]
    ds_read_b64_tr_b16 v[122:123], v13 offset:20992
    v_mfma_f32_16x16x32_bf16 v[180:183], v[76:79], a[120:123], v[180:183]
    ds_read_b64_tr_b16 v[124:125], v14 offset:20480
    v_mfma_f32_16x16x32_bf16 v[188:191], v[76:79], a[124:127], v[188:191]
    ds_read_b64_tr_b16 v[126:127], v14 offset:20992
    s_add_u32 m0, s11, 0
    s_add_u32 s1, s4, 3145728
    v_mfma_f32_16x16x32_bf16 v[192:195], v[80:83], a[112:115], v[192:195]
    buffer_load_dwordx4 v6, s[52:55], s1 offen offset:0 lds
    v_mfma_f32_16x16x32_bf16 v[200:203], v[80:83], a[116:119], v[200:203]
    buffer_load_dwordx4 v7, s[52:55], s1 offen offset:1024 lds
    v_mfma_f32_16x16x32_bf16 v[208:211], v[80:83], a[120:123], v[208:211]
    buffer_load_dwordx4 v8, s[52:55], s1 offen offset:2048 lds
    v_mfma_f32_16x16x32_bf16 v[216:219], v[80:83], a[124:127], v[216:219]
    s_waitcnt vmcnt(21)
    ds_read_b128 a[192:195], v10 offset:0
    v_mfma_f32_16x16x32_bf16 v[196:199], v[84:87], a[112:115], v[196:199]
    ds_read_b128 a[196:199], v10 offset:2048
    v_mfma_f32_16x16x32_bf16 v[204:207], v[84:87], a[116:119], v[204:207]
    ds_read_b128 a[208:211], v35 offset:0
    v_mfma_f32_16x16x32_bf16 v[212:215], v[84:87], a[120:123], v[212:215]
    ds_read_b128 a[212:215], v35 offset:2048
    v_mfma_f32_16x16x32_bf16 v[220:223], v[84:87], a[124:127], v[220:223]
    buffer_load_dwordx4 v9, s[52:55], s1 offen offset:3072 lds
    v_mfma_f32_16x16x32_bf16 v[224:227], v[88:91], a[112:115], v[224:227]
    buffer_load_dword v34, v29, s[56:59], s14 offen
    v_mfma_f32_16x16x32_bf16 v[232:235], v[88:91], a[116:119], v[232:235]
    s_waitcnt vmcnt(13)
    ds_read_b128 a[200:203], v10 offset:4096
    v_mfma_f32_16x16x32_bf16 v[240:243], v[88:91], a[120:123], v[240:243]
    ds_read_b128 a[204:207], v10 offset:6144
    v_mfma_f32_16x16x32_bf16 v[248:251], v[88:91], a[124:127], v[248:251]
    ds_read_b128 a[216:219], v35 offset:4096
    v_mfma_f32_16x16x32_bf16 v[228:231], v[92:95], a[112:115], v[228:231]
    ds_read_b128 a[220:223], v35 offset:6144
    buffer_load_dword v34, v29, s[56:59], s15 offen
    v_mfma_f32_16x16x32_bf16 v[236:239], v[92:95], a[116:119], v[236:239]
    v_mfma_f32_16x16x32_bf16 v[244:247], v[92:95], a[120:123], v[244:247]
    v_mfma_f32_16x16x32_bf16 v[252:255], v[92:95], a[124:127], v[252:255]
    s_waitcnt lgkmcnt(0)
    v_mfma_f32_16x16x32_bf16 v[128:131], v[96:99], a[128:131], v[128:131]
    ds_read_b64_tr_b16 v[64:65], v11 offset:24576
    v_mfma_f32_16x16x32_bf16 v[136:139], v[96:99], a[132:135], v[136:139]
    ds_read_b64_tr_b16 v[66:67], v11 offset:25088
    v_mov_b32 v63, 0
    v_mfma_f32_16x16x32_bf16 v[144:147], v[96:99], a[136:139], v[144:147]
    ds_read_b64_tr_b16 v[68:69], v12 offset:24576
    v_dot2c_f32_bf16 v63, v36, v44
    v_mfma_f32_16x16x32_bf16 v[152:155], v[96:99], a[140:143], v[152:155]
    ds_read_b64_tr_b16 v[70:71], v12 offset:25088
    v_dot2c_f32_bf16 v63, v37, v45
    v_mfma_f32_16x16x32_bf16 v[132:135], v[100:103], a[128:131], v[132:135]
    ds_read_b64_tr_b16 v[72:73], v13 offset:24576
    v_dot2c_f32_bf16 v63, v38, v46
    v_mfma_f32_16x16x32_bf16 v[140:143], v[100:103], a[132:135], v[140:143]
    ds_read_b64_tr_b16 v[74:75], v13 offset:25088
    v_dot2c_f32_bf16 v63, v39, v47
    v_mfma_f32_16x16x32_bf16 v[148:151], v[100:103], a[136:139], v[148:151]
    ds_read_b64_tr_b16 v[76:77], v14 offset:24576
    v_dot2c_f32_bf16 v63, v40, v48
    v_mfma_f32_16x16x32_bf16 v[156:159], v[100:103], a[140:143], v[156:159]
    ds_read_b64_tr_b16 v[78:79], v14 offset:25088
    v_dot2c_f32_bf16 v63, v41, v49
    v_mfma_f32_16x16x32_bf16 v[160:163], v[104:107], a[128:131], v[160:163]
    ds_read_b64_tr_b16 v[80:81], v11 offset:28672
    v_dot2c_f32_bf16 v63, v42, v50
    v_mfma_f32_16x16x32_bf16 v[168:171], v[104:107], a[132:135], v[168:171]
    ds_read_b64_tr_b16 v[82:83], v11 offset:29184
    v_dot2c_f32_bf16 v63, v43, v51
    v_mfma_f32_16x16x32_bf16 v[176:179], v[104:107], a[136:139], v[176:179]
    ds_read_b64_tr_b16 v[84:85], v12 offset:28672
    s_nop 3
    v_mfma_f32_16x16x32_bf16 v[184:187], v[104:107], a[140:143], v[184:187]
    ds_read_b64_tr_b16 v[86:87], v12 offset:29184
    v_add_f32_dpp v63, v63, v63 row_shr:1 row_mask:0xf bank_mask:0xf bound_ctrl:0
    v_mfma_f32_16x16x32_bf16 v[164:167], v[108:111], a[128:131], v[164:167]
    ds_read_b64_tr_b16 v[88:89], v13 offset:28672
    s_nop 1
    v_mfma_f32_16x16x32_bf16 v[172:175], v[108:111], a[132:135], v[172:175]
    ds_read_b64_tr_b16 v[90:91], v13 offset:29184
    v_add_f32_dpp v63, v63, v63 row_shr:2 row_mask:0xf bank_mask:0xf bound_ctrl:0
    v_mfma_f32_16x16x32_bf16 v[180:183], v[108:111], a[136:139], v[180:183]
    ds_read_b64_tr_b16 v[92:93], v14 offset:28672
    s_nop 1
    v_mfma_f32_16x16x32_bf16 v[188:191], v[108:111], a[140:143], v[188:191]
    ds_read_b64_tr_b16 v[94:95], v14 offset:29184
    v_add_f32_dpp v63, v63, v63 row_shr:4 row_mask:0xf bank_mask:0xf bound_ctrl:0
    v_mfma_f32_16x16x32_bf16 v[192:195], v[112:115], a[128:131], v[192:195]
    s_nop 1
    v_add_f32_dpp v63, v63, v63 row_shr:8 row_mask:0xf bank_mask:0xf bound_ctrl:0
    v_mfma_f32_16x16x32_bf16 v[200:203], v[112:115], a[132:135], v[200:203]
    s_nop 1
    v_add_f32_dpp v63, v63, v63 row_bcast:15 row_mask:0xa bank_mask:0xf
    v_mfma_f32_16x16x32_bf16 v[208:211], v[112:115], a[136:139], v[208:211]
    v_cvt_pk_bf16_f32 v63, v63, v63
    v_lshlrev_b32 v63, 16, v63
    v_mfma_f32_16x16x32_bf16 v[216:219], v[112:115], a[140:143], v[216:219]
    v_mul_f32 v63, 0xbfb8aa3b, v63
    v_exp_f32 v63, v63
    v_mfma_f32_16x16x32_bf16 v[196:199], v[116:119], a[128:131], v[196:199]
    s_nop 0
    v_add_f32 v63, 1.0, v63
    v_mfma_f32_16x16x32_bf16 v[204:207], v[116:119], a[132:135], v[204:207]
    v_rcp_f32 v63, v63
    s_nop 0
    v_mfma_f32_16x16x32_bf16 v[212:215], v[116:119], a[136:139], v[212:215]
    v_cvt_pk_bf16_f32 v63, v63, v63
    v_lshlrev_b32 v63, 16, v63
    v_mfma_f32_16x16x32_bf16 v[220:223], v[116:119], a[140:143], v[220:223]
    v_mfma_f32_16x16x32_bf16 v[224:227], v[120:123], a[128:131], v[224:227]
    v_mfma_f32_16x16x32_bf16 v[232:235], v[120:123], a[132:135], v[232:235]
    s_waitcnt vmcnt(10)
    ds_read_b128 a[224:227], v10 offset:8192
    v_mfma_f32_16x16x32_bf16 v[240:243], v[120:123], a[136:139], v[240:243]
    ds_read_b128 a[228:231], v10 offset:10240
    v_mfma_f32_16x16x32_bf16 v[248:251], v[120:123], a[140:143], v[248:251]
    ds_read_b128 a[240:243], v35 offset:8192
    v_mfma_f32_16x16x32_bf16 v[228:231], v[124:127], a[128:131], v[228:231]
    ds_read_b128 a[244:247], v35 offset:10240
    v_mfma_f32_16x16x32_bf16 v[236:239], v[124:127], a[132:135], v[236:239]
    v_mfma_f32_16x16x32_bf16 v[244:247], v[124:127], a[136:139], v[244:247]
    v_mfma_f32_16x16x32_bf16 v[252:255], v[124:127], a[140:143], v[252:255]
    s_waitcnt lgkmcnt(0)
    v_mfma_f32_16x16x32_bf16 v[128:131], v[64:67], a[144:147], v[128:131]
    s_barrier
    ds_read_b64_tr_b16 v[96:97], v11 offset:32768
    v_mfma_f32_16x16x32_bf16 v[136:139], v[64:67], a[148:151], v[136:139]
    ds_read_b64_tr_b16 v[98:99], v11 offset:33280
    v_mfma_f32_16x16x32_bf16 v[144:147], v[64:67], a[152:155], v[144:147]
    ds_read_b64_tr_b16 v[100:101], v12 offset:32768
    v_mfma_f32_16x16x32_bf16 v[152:155], v[64:67], a[156:159], v[152:155]
    ds_read_b64_tr_b16 v[102:103], v12 offset:33280
    v_mfma_f32_16x16x32_bf16 v[132:135], v[68:71], a[144:147], v[132:135]
    ds_read_b64_tr_b16 v[104:105], v13 offset:32768
    v_mfma_f32_16x16x32_bf16 v[140:143], v[68:71], a[148:151], v[140:143]
    ds_read_b64_tr_b16 v[106:107], v13 offset:33280
    v_mfma_f32_16x16x32_bf16 v[148:151], v[68:71], a[152:155], v[148:151]
    ds_read_b64_tr_b16 v[108:109], v14 offset:32768
    v_mfma_f32_16x16x32_bf16 v[156:159], v[68:71], a[156:159], v[156:159]
    ds_read_b64_tr_b16 v[110:111], v14 offset:33280
    v_mfma_f32_16x16x32_bf16 v[160:163], v[72:75], a[144:147], v[160:163]
    ds_read_b64_tr_b16 v[112:113], v11 offset:36864
    v_mfma_f32_16x16x32_bf16 v[168:171], v[72:75], a[148:151], v[168:171]
    ds_read_b64_tr_b16 v[114:115], v11 offset:37376
    v_mfma_f32_16x16x32_bf16 v[176:179], v[72:75], a[152:155], v[176:179]
    ds_read_b64_tr_b16 v[116:117], v12 offset:36864
    s_add_u32 m0, s11, 16384
    s_add_u32 s1, s4, 3670016
    v_mfma_f32_16x16x32_bf16 v[184:187], v[72:75], a[156:159], v[184:187]
    ds_read_b64_tr_b16 v[118:119], v12 offset:37376
    v_mfma_f32_16x16x32_bf16 v[164:167], v[76:79], a[144:147], v[164:167]
    ds_read_b64_tr_b16 v[120:121], v13 offset:36864
    v_mfma_f32_16x16x32_bf16 v[172:175], v[76:79], a[148:151], v[172:175]
    ds_read_b64_tr_b16 v[122:123], v13 offset:37376
    v_mfma_f32_16x16x32_bf16 v[180:183], v[76:79], a[152:155], v[180:183]
    ds_read_b64_tr_b16 v[124:125], v14 offset:36864
    v_mfma_f32_16x16x32_bf16 v[188:191], v[76:79], a[156:159], v[188:191]
    ds_read_b64_tr_b16 v[126:127], v14 offset:37376
    buffer_load_dwordx4 v6, s[52:55], s1 offen offset:0 lds
    v_mfma_f32_16x16x32_bf16 v[192:195], v[80:83], a[144:147], v[192:195]
    buffer_load_dwordx4 v7, s[52:55], s1 offen offset:1024 lds
    v_mfma_f32_16x16x32_bf16 v[200:203], v[80:83], a[148:151], v[200:203]
    buffer_load_dwordx4 v8, s[52:55], s1 offen offset:2048 lds
    v_mfma_f32_16x16x32_bf16 v[208:211], v[80:83], a[152:155], v[208:211]
    buffer_load_dwordx4 v9, s[52:55], s1 offen offset:3072 lds
    v_mfma_f32_16x16x32_bf16 v[216:219], v[80:83], a[156:159], v[216:219]
    v_mfma_f32_16x16x32_bf16 v[196:199], v[84:87], a[144:147], v[196:199]
    v_mfma_f32_16x16x32_bf16 v[204:207], v[84:87], a[148:151], v[204:207]
    v_mfma_f32_16x16x32_bf16 v[212:215], v[84:87], a[152:155], v[212:215]
    v_mfma_f32_16x16x32_bf16 v[220:223], v[84:87], a[156:159], v[220:223]
    v_mfma_f32_16x16x32_bf16 v[224:227], v[88:91], a[144:147], v[224:227]
    v_mfma_f32_16x16x32_bf16 v[232:235], v[88:91], a[148:151], v[232:235]
    s_waitcnt vmcnt(10)
    ds_read_b128 a[232:235], v10 offset:12288
    v_mfma_f32_16x16x32_bf16 v[240:243], v[88:91], a[152:155], v[240:243]
    ds_read_b128 a[236:239], v10 offset:14336
    v_mfma_f32_16x16x32_bf16 v[248:251], v[88:91], a[156:159], v[248:251]
    ds_read_b128 a[248:251], v35 offset:12288
    v_mfma_f32_16x16x32_bf16 v[228:231], v[92:95], a[144:147], v[228:231]
    ds_read_b128 a[252:255], v35 offset:14336
    v_mfma_f32_16x16x32_bf16 v[236:239], v[92:95], a[148:151], v[236:239]
    v_mfma_f32_16x16x32_bf16 v[244:247], v[92:95], a[152:155], v[244:247]
    v_mfma_f32_16x16x32_bf16 v[252:255], v[92:95], a[156:159], v[252:255]
    s_waitcnt lgkmcnt(0)
    v_mfma_f32_16x16x32_bf16 v[128:131], v[96:99], a[160:163], v[128:131]
    ds_read_b64_tr_b16 v[64:65], v11 offset:40960
    v_mfma_f32_16x16x32_bf16 v[136:139], v[96:99], a[164:167], v[136:139]
    ds_read_b64_tr_b16 v[66:67], v11 offset:41472
    v_mfma_f32_16x16x32_bf16 v[144:147], v[96:99], a[168:171], v[144:147]
    ds_read_b64_tr_b16 v[68:69], v12 offset:40960
    v_mfma_f32_16x16x32_bf16 v[152:155], v[96:99], a[172:175], v[152:155]
    ds_read_b64_tr_b16 v[70:71], v12 offset:41472
    v_mfma_f32_16x16x32_bf16 v[132:135], v[100:103], a[160:163], v[132:135]
    ds_read_b64_tr_b16 v[72:73], v13 offset:40960
    v_mfma_f32_16x16x32_bf16 v[140:143], v[100:103], a[164:167], v[140:143]
    ds_read_b64_tr_b16 v[74:75], v13 offset:41472
    v_mfma_f32_16x16x32_bf16 v[148:151], v[100:103], a[168:171], v[148:151]
    ds_read_b64_tr_b16 v[76:77], v14 offset:40960
    v_mfma_f32_16x16x32_bf16 v[156:159], v[100:103], a[172:175], v[156:159]
    ds_read_b64_tr_b16 v[78:79], v14 offset:41472
    v_mfma_f32_16x16x32_bf16 v[160:163], v[104:107], a[160:163], v[160:163]
    ds_read_b64_tr_b16 v[80:81], v11 offset:45056
    v_mfma_f32_16x16x32_bf16 v[168:171], v[104:107], a[164:167], v[168:171]
    ds_read_b64_tr_b16 v[82:83], v11 offset:45568
    v_mfma_f32_16x16x32_bf16 v[176:179], v[104:107], a[168:171], v[176:179]
    ds_read_b64_tr_b16 v[84:85], v12 offset:45056
    v_mfma_f32_16x16x32_bf16 v[184:187], v[104:107], a[172:175], v[184:187]
    ds_read_b64_tr_b16 v[86:87], v12 offset:45568
    v_mfma_f32_16x16x32_bf16 v[164:167], v[108:111], a[160:163], v[164:167]
    ds_read_b64_tr_b16 v[88:89], v13 offset:45056
    v_mfma_f32_16x16x32_bf16 v[172:175], v[108:111], a[164:167], v[172:175]
    ds_read_b64_tr_b16 v[90:91], v13 offset:45568
    v_mfma_f32_16x16x32_bf16 v[180:183], v[108:111], a[168:171], v[180:183]
    ds_read_b64_tr_b16 v[92:93], v14 offset:45056
    v_mfma_f32_16x16x32_bf16 v[188:191], v[108:111], a[172:175], v[188:191]
    ds_read_b64_tr_b16 v[94:95], v14 offset:45568
    v_mfma_f32_16x16x32_bf16 v[192:195], v[112:115], a[160:163], v[192:195]
    v_mfma_f32_16x16x32_bf16 v[200:203], v[112:115], a[164:167], v[200:203]
    v_mfma_f32_16x16x32_bf16 v[208:211], v[112:115], a[168:171], v[208:211]
    v_mfma_f32_16x16x32_bf16 v[216:219], v[112:115], a[172:175], v[216:219]
    v_mfma_f32_16x16x32_bf16 v[196:199], v[116:119], a[160:163], v[196:199]
    v_mfma_f32_16x16x32_bf16 v[204:207], v[116:119], a[164:167], v[204:207]
    v_mfma_f32_16x16x32_bf16 v[212:215], v[116:119], a[168:171], v[212:215]
    v_mfma_f32_16x16x32_bf16 v[220:223], v[116:119], a[172:175], v[220:223]
    v_mfma_f32_16x16x32_bf16 v[224:227], v[120:123], a[160:163], v[224:227]
    v_mfma_f32_16x16x32_bf16 v[232:235], v[120:123], a[164:167], v[232:235]
    v_mfma_f32_16x16x32_bf16 v[240:243], v[120:123], a[168:171], v[240:243]
    v_mfma_f32_16x16x32_bf16 v[248:251], v[120:123], a[172:175], v[248:251]
    v_mfma_f32_16x16x32_bf16 v[228:231], v[124:127], a[160:163], v[228:231]
    v_mfma_f32_16x16x32_bf16 v[236:239], v[124:127], a[164:167], v[236:239]
    v_mfma_f32_16x16x32_bf16 v[244:247], v[124:127], a[168:171], v[244:247]
    v_mfma_f32_16x16x32_bf16 v[252:255], v[124:127], a[172:175], v[252:255]
    s_waitcnt vmcnt(6) lgkmcnt(0)
    v_mfma_f32_16x16x32_bf16 v[128:131], v[64:67], a[176:179], v[128:131]
    s_barrier
    ds_read_b64_tr_b16 v[96:97], v11 offset:0
    buffer_load_dwordx4 v[56:59], v22, s[72:75], 0 offen
    v_mfma_f32_16x16x32_bf16 v[136:139], v[64:67], a[180:183], v[136:139]
    ds_read_b64_tr_b16 v[98:99], v11 offset:512
    buffer_load_dword v36, v19, s[64:67], 0 offen offset:0 nt
    v_mfma_f32_16x16x32_bf16 v[144:147], v[64:67], a[184:187], v[144:147]
    ds_read_b64_tr_b16 v[100:101], v12 offset:0
    buffer_load_dword v37, v19, s[64:67], 0 offen offset:1024 nt
    v_mfma_f32_16x16x32_bf16 v[152:155], v[64:67], a[188:191], v[152:155]
    ds_read_b64_tr_b16 v[102:103], v12 offset:512
    buffer_load_dword v38, v19, s[64:67], 0 offen offset:2048 nt
    v_mfma_f32_16x16x32_bf16 v[132:135], v[68:71], a[176:179], v[132:135]
    ds_read_b64_tr_b16 v[104:105], v13 offset:0
    buffer_load_dword v39, v20, s[64:67], 0 offen offset:0 nt
    v_mfma_f32_16x16x32_bf16 v[140:143], v[68:71], a[180:183], v[140:143]
    ds_read_b64_tr_b16 v[106:107], v13 offset:512
    buffer_load_dword v40, v20, s[64:67], 0 offen offset:1024 nt
    v_mfma_f32_16x16x32_bf16 v[148:151], v[68:71], a[184:187], v[148:151]
    ds_read_b64_tr_b16 v[108:109], v14 offset:0
    buffer_load_dword v41, v20, s[64:67], 0 offen offset:2048 nt
    v_mfma_f32_16x16x32_bf16 v[156:159], v[68:71], a[188:191], v[156:159]
    ds_read_b64_tr_b16 v[110:111], v14 offset:512
    buffer_load_dword v42, v20, s[64:67], 0 offen offset:3072 nt
    v_mfma_f32_16x16x32_bf16 v[160:163], v[72:75], a[176:179], v[160:163]
    ds_read_b64_tr_b16 v[112:113], v11 offset:4096
    buffer_load_dword v43, v21, s[64:67], 0 offen offset:0 nt
    v_mfma_f32_16x16x32_bf16 v[168:171], v[72:75], a[180:183], v[168:171]
    ds_read_b64_tr_b16 v[114:115], v11 offset:4608
    buffer_load_dword v44, v21, s[64:67], 0 offen offset:1024 nt
    v_mfma_f32_16x16x32_bf16 v[176:179], v[72:75], a[184:187], v[176:179]
    ds_read_b64_tr_b16 v[116:117], v12 offset:4096
    buffer_load_dword v45, v21, s[64:67], 0 offen offset:2048 nt
    v_mfma_f32_16x16x32_bf16 v[184:187], v[72:75], a[188:191], v[184:187]
    ds_read_b64_tr_b16 v[118:119], v12 offset:4608
    buffer_load_dword v46, v21, s[64:67], 0 offen offset:3072 nt
    v_mfma_f32_16x16x32_bf16 v[164:167], v[76:79], a[176:179], v[164:167]
    ds_read_b64_tr_b16 v[120:121], v13 offset:4096
    buffer_load_dword v47, v20, s[68:71], 0 offen offset:0 nt
    v_mfma_f32_16x16x32_bf16 v[172:175], v[76:79], a[180:183], v[172:175]
    ds_read_b64_tr_b16 v[122:123], v13 offset:4608
    buffer_load_dword v48, v20, s[68:71], 0 offen offset:1024 nt
    v_mfma_f32_16x16x32_bf16 v[180:183], v[76:79], a[184:187], v[180:183]
    ds_read_b64_tr_b16 v[124:125], v14 offset:4096
    buffer_load_dword v49, v20, s[68:71], 0 offen offset:2048 nt
    v_mfma_f32_16x16x32_bf16 v[188:191], v[76:79], a[188:191], v[188:191]
    ds_read_b64_tr_b16 v[126:127], v14 offset:4608
    buffer_load_dword v50, v20, s[68:71], 0 offen offset:3072 nt
    v_mfma_f32_16x16x32_bf16 v[192:195], v[80:83], a[176:179], v[192:195]
    buffer_load_dword v51, v21, s[68:71], 0 offen offset:0 nt
    buffer_load_dword v52, v21, s[68:71], 0 offen offset:1024 nt
    v_mfma_f32_16x16x32_bf16 v[200:203], v[80:83], a[180:183], v[200:203]
    buffer_load_dword v53, v21, s[68:71], 0 offen offset:2048 nt
    buffer_load_dword v54, v21, s[68:71], 0 offen offset:3072 nt
    v_mfma_f32_16x16x32_bf16 v[208:211], v[80:83], a[184:187], v[208:211]
    v_mfma_f32_16x16x32_bf16 v[216:219], v[80:83], a[188:191], v[216:219]
    v_mfma_f32_16x16x32_bf16 v[196:199], v[84:87], a[176:179], v[196:199]
    v_mfma_f32_16x16x32_bf16 v[204:207], v[84:87], a[180:183], v[204:207]
    v_mfma_f32_16x16x32_bf16 v[212:215], v[84:87], a[184:187], v[212:215]
    v_mfma_f32_16x16x32_bf16 v[220:223], v[84:87], a[188:191], v[220:223]
    v_mfma_f32_16x16x32_bf16 v[224:227], v[88:91], a[176:179], v[224:227]
    v_mfma_f32_16x16x32_bf16 v[232:235], v[88:91], a[180:183], v[232:235]
    v_mfma_f32_16x16x32_bf16 v[240:243], v[88:91], a[184:187], v[240:243]
    v_mfma_f32_16x16x32_bf16 v[248:251], v[88:91], a[188:191], v[248:251]
    v_mfma_f32_16x16x32_bf16 v[228:231], v[92:95], a[176:179], v[228:231]
    v_mfma_f32_16x16x32_bf16 v[236:239], v[92:95], a[180:183], v[236:239]
    v_mfma_f32_16x16x32_bf16 v[244:247], v[92:95], a[184:187], v[244:247]
    v_mfma_f32_16x16x32_bf16 v[252:255], v[92:95], a[188:191], v[252:255]
    s_waitcnt lgkmcnt(0)
    v_mfma_f32_16x16x32_bf16 v[128:131], v[96:99], a[192:195], v[128:131]
    ds_read_b64_tr_b16 v[64:65], v11 offset:8192
    v_mfma_f32_16x16x32_bf16 v[136:139], v[96:99], a[196:199], v[136:139]
    ds_read_b64_tr_b16 v[66:67], v11 offset:8704
    v_mfma_f32_16x16x32_bf16 v[144:147], v[96:99], a[200:203], v[144:147]
    ds_read_b64_tr_b16 v[68:69], v12 offset:8192
    v_mfma_f32_16x16x32_bf16 v[152:155], v[96:99], a[204:207], v[152:155]
    ds_read_b64_tr_b16 v[70:71], v12 offset:8704
    v_mfma_f32_16x16x32_bf16 v[132:135], v[100:103], a[192:195], v[132:135]
    ds_read_b64_tr_b16 v[72:73], v13 offset:8192
    v_mfma_f32_16x16x32_bf16 v[140:143], v[100:103], a[196:199], v[140:143]
    ds_read_b64_tr_b16 v[74:75], v13 offset:8704
    s_add_u32 m0, s11, 49152
    s_add_u32 s29, s9, 0
    v_mfma_f32_16x16x32_bf16 v[148:151], v[100:103], a[200:203], v[148:151]
    ds_read_b64_tr_b16 v[76:77], v14 offset:8192
    v_mfma_f32_16x16x32_bf16 v[156:159], v[100:103], a[204:207], v[156:159]
    ds_read_b64_tr_b16 v[78:79], v14 offset:8704
    buffer_load_dwordx4 v6, s[56:59], s29 offen offset:0 lds
    v_mfma_f32_16x16x32_bf16 v[160:163], v[104:107], a[192:195], v[160:163]
    ds_read_b64_tr_b16 v[80:81], v11 offset:12288
    v_mfma_f32_16x16x32_bf16 v[168:171], v[104:107], a[196:199], v[168:171]
    ds_read_b64_tr_b16 v[82:83], v11 offset:12800
    v_mfma_f32_16x16x32_bf16 v[176:179], v[104:107], a[200:203], v[176:179]
    ds_read_b64_tr_b16 v[84:85], v12 offset:12288
    buffer_load_dwordx4 v7, s[56:59], s29 offen offset:1024 lds
    v_mfma_f32_16x16x32_bf16 v[184:187], v[104:107], a[204:207], v[184:187]
    ds_read_b64_tr_b16 v[86:87], v12 offset:12800
    v_mfma_f32_16x16x32_bf16 v[164:167], v[108:111], a[192:195], v[164:167]
    ds_read_b64_tr_b16 v[88:89], v13 offset:12288
    buffer_load_dwordx4 v8, s[56:59], s29 offen offset:2048 lds
    v_mfma_f32_16x16x32_bf16 v[172:175], v[108:111], a[196:199], v[172:175]
    ds_read_b64_tr_b16 v[90:91], v13 offset:12800
    v_mfma_f32_16x16x32_bf16 v[180:183], v[108:111], a[200:203], v[180:183]
    ds_read_b64_tr_b16 v[92:93], v14 offset:12288
    v_mfma_f32_16x16x32_bf16 v[188:191], v[108:111], a[204:207], v[188:191]
    ds_read_b64_tr_b16 v[94:95], v14 offset:12800
    buffer_load_dwordx4 v9, s[56:59], s29 offen offset:3072 lds
    v_mfma_f32_16x16x32_bf16 v[192:195], v[112:115], a[192:195], v[192:195]
    s_add_u32 m0, s11, 65536
    s_add_u32 s29, s9, 1048576
    v_mfma_f32_16x16x32_bf16 v[200:203], v[112:115], a[196:199], v[200:203]
    buffer_load_dwordx4 v6, s[56:59], s29 offen offset:0 lds
    v_mfma_f32_16x16x32_bf16 v[208:211], v[112:115], a[200:203], v[208:211]
    buffer_load_dwordx4 v7, s[56:59], s29 offen offset:1024 lds
    v_mfma_f32_16x16x32_bf16 v[216:219], v[112:115], a[204:207], v[216:219]
    buffer_load_dwordx4 v8, s[56:59], s29 offen offset:2048 lds
    v_mfma_f32_16x16x32_bf16 v[196:199], v[116:119], a[192:195], v[196:199]
    buffer_load_dwordx4 v9, s[56:59], s29 offen offset:3072 lds
    v_mfma_f32_16x16x32_bf16 v[204:207], v[116:119], a[196:199], v[204:207]
    v_mfma_f32_16x16x32_bf16 v[212:215], v[116:119], a[200:203], v[212:215]
    v_mfma_f32_16x16x32_bf16 v[220:223], v[116:119], a[204:207], v[220:223]
    v_mfma_f32_16x16x32_bf16 v[224:227], v[120:123], a[192:195], v[224:227]
    v_mfma_f32_16x16x32_bf16 v[232:235], v[120:123], a[196:199], v[232:235]
    v_mfma_f32_16x16x32_bf16 v[240:243], v[120:123], a[200:203], v[240:243]
    v_mfma_f32_16x16x32_bf16 v[248:251], v[120:123], a[204:207], v[248:251]
    v_mfma_f32_16x16x32_bf16 v[228:231], v[124:127], a[192:195], v[228:231]
    v_mfma_f32_16x16x32_bf16 v[236:239], v[124:127], a[196:199], v[236:239]
    v_mfma_f32_16x16x32_bf16 v[244:247], v[124:127], a[200:203], v[244:247]
    v_mfma_f32_16x16x32_bf16 v[252:255], v[124:127], a[204:207], v[252:255]
    s_waitcnt vmcnt(28) lgkmcnt(0)
    v_mfma_f32_16x16x32_bf16 v[128:131], v[64:67], a[208:211], v[128:131]
    s_barrier
    ds_read_b64_tr_b16 v[96:97], v11 offset:16384
    v_mfma_f32_16x16x32_bf16 v[136:139], v[64:67], a[212:215], v[136:139]
    ds_read_b64_tr_b16 v[98:99], v11 offset:16896
    v_mfma_f32_16x16x32_bf16 v[144:147], v[64:67], a[216:219], v[144:147]
    ds_read_b64_tr_b16 v[100:101], v12 offset:16384
    v_mfma_f32_16x16x32_bf16 v[152:155], v[64:67], a[220:223], v[152:155]
    ds_read_b64_tr_b16 v[102:103], v12 offset:16896
    v_mfma_f32_16x16x32_bf16 v[132:135], v[68:71], a[208:211], v[132:135]
    ds_read_b64_tr_b16 v[104:105], v13 offset:16384
    v_mfma_f32_16x16x32_bf16 v[140:143], v[68:71], a[212:215], v[140:143]
    ds_read_b64_tr_b16 v[106:107], v13 offset:16896
    s_add_u32 m0, s11, 81920
    s_add_u32 s29, s9, 2097152
    v_mfma_f32_16x16x32_bf16 v[148:151], v[68:71], a[216:219], v[148:151]
    ds_read_b64_tr_b16 v[108:109], v14 offset:16384
    v_mfma_f32_16x16x32_bf16 v[156:159], v[68:71], a[220:223], v[156:159]
    ds_read_b64_tr_b16 v[110:111], v14 offset:16896
    buffer_load_dwordx4 v6, s[56:59], s29 offen offset:0 lds
    v_mfma_f32_16x16x32_bf16 v[160:163], v[72:75], a[208:211], v[160:163]
    ds_read_b64_tr_b16 v[112:113], v11 offset:20480
    v_mfma_f32_16x16x32_bf16 v[168:171], v[72:75], a[212:215], v[168:171]
    ds_read_b64_tr_b16 v[114:115], v11 offset:20992
    v_mfma_f32_16x16x32_bf16 v[176:179], v[72:75], a[216:219], v[176:179]
    ds_read_b64_tr_b16 v[116:117], v12 offset:20480
    buffer_load_dwordx4 v7, s[56:59], s29 offen offset:1024 lds
    v_mfma_f32_16x16x32_bf16 v[184:187], v[72:75], a[220:223], v[184:187]
    ds_read_b64_tr_b16 v[118:119], v12 offset:20992
    v_mfma_f32_16x16x32_bf16 v[164:167], v[76:79], a[208:211], v[164:167]
    ds_read_b64_tr_b16 v[120:121], v13 offset:20480
    buffer_load_dwordx4 v8, s[56:59], s29 offen offset:2048 lds
    v_mfma_f32_16x16x32_bf16 v[172:175], v[76:79], a[212:215], v[172:175]
    ds_read_b64_tr_b16 v[122:123], v13 offset:20992
    v_mfma_f32_16x16x32_bf16 v[180:183], v[76:79], a[216:219], v[180:183]
    ds_read_b64_tr_b16 v[124:125], v14 offset:20480
    v_mfma_f32_16x16x32_bf16 v[188:191], v[76:79], a[220:223], v[188:191]
    ds_read_b64_tr_b16 v[126:127], v14 offset:20992
    buffer_load_dwordx4 v9, s[56:59], s29 offen offset:3072 lds
    v_mfma_f32_16x16x32_bf16 v[192:195], v[80:83], a[208:211], v[192:195]
    s_add_u32 m0, s11, 32768
    s_add_u32 s29, s9, 3145728
    v_mfma_f32_16x16x32_bf16 v[200:203], v[80:83], a[212:215], v[200:203]
    buffer_load_dwordx4 v6, s[56:59], s29 offen offset:0 lds
    v_mfma_f32_16x16x32_bf16 v[208:211], v[80:83], a[216:219], v[208:211]
    buffer_load_dwordx4 v7, s[56:59], s29 offen offset:1024 lds
    v_mfma_f32_16x16x32_bf16 v[216:219], v[80:83], a[220:223], v[216:219]
    buffer_load_dwordx4 v8, s[56:59], s29 offen offset:2048 lds
    v_mfma_f32_16x16x32_bf16 v[196:199], v[84:87], a[208:211], v[196:199]
    buffer_load_dwordx4 v9, s[56:59], s29 offen offset:3072 lds
    v_mfma_f32_16x16x32_bf16 v[204:207], v[84:87], a[212:215], v[204:207]
    v_mfma_f32_16x16x32_bf16 v[212:215], v[84:87], a[216:219], v[212:215]
    v_mfma_f32_16x16x32_bf16 v[220:223], v[84:87], a[220:223], v[220:223]
    v_mfma_f32_16x16x32_bf16 v[224:227], v[88:91], a[208:211], v[224:227]
    v_mfma_f32_16x16x32_bf16 v[232:235], v[88:91], a[212:215], v[232:235]
    v_mfma_f32_16x16x32_bf16 v[240:243], v[88:91], a[216:219], v[240:243]
    v_mfma_f32_16x16x32_bf16 v[248:251], v[88:91], a[220:223], v[248:251]
    v_mfma_f32_16x16x32_bf16 v[228:231], v[92:95], a[208:211], v[228:231]
    v_mfma_f32_16x16x32_bf16 v[236:239], v[92:95], a[212:215], v[236:239]
    v_mfma_f32_16x16x32_bf16 v[244:247], v[92:95], a[216:219], v[244:247]
    v_mfma_f32_16x16x32_bf16 v[252:255], v[92:95], a[220:223], v[252:255]
    s_waitcnt lgkmcnt(0)
    v_mfma_f32_16x16x32_bf16 v[128:131], v[96:99], a[224:227], v[128:131]
    ds_read_b64_tr_b16 v[64:65], v11 offset:24576
    v_mfma_f32_16x16x32_bf16 v[136:139], v[96:99], a[228:231], v[136:139]
    ds_read_b64_tr_b16 v[66:67], v11 offset:25088
    v_mfma_f32_16x16x32_bf16 v[144:147], v[96:99], a[232:235], v[144:147]
    ds_read_b64_tr_b16 v[68:69], v12 offset:24576
    v_mfma_f32_16x16x32_bf16 v[152:155], v[96:99], a[236:239], v[152:155]
    ds_read_b64_tr_b16 v[70:71], v12 offset:25088
    v_mfma_f32_16x16x32_bf16 v[132:135], v[100:103], a[224:227], v[132:135]
    ds_read_b64_tr_b16 v[72:73], v13 offset:24576
    v_mfma_f32_16x16x32_bf16 v[140:143], v[100:103], a[228:231], v[140:143]
    ds_read_b64_tr_b16 v[74:75], v13 offset:25088
    s_add_u32 m0, s11, 98304
    s_add_u32 s29, s9, 128
    v_mfma_f32_16x16x32_bf16 v[148:151], v[100:103], a[232:235], v[148:151]
    ds_read_b64_tr_b16 v[76:77], v14 offset:24576
    v_mfma_f32_16x16x32_bf16 v[156:159], v[100:103], a[236:239], v[156:159]
    ds_read_b64_tr_b16 v[78:79], v14 offset:25088
    buffer_load_dwordx4 v6, s[56:59], s29 offen offset:0 lds
    v_mfma_f32_16x16x32_bf16 v[160:163], v[104:107], a[224:227], v[160:163]
    ds_read_b64_tr_b16 v[80:81], v11 offset:28672
    v_mfma_f32_16x16x32_bf16 v[168:171], v[104:107], a[228:231], v[168:171]
    ds_read_b64_tr_b16 v[82:83], v11 offset:29184
    v_mfma_f32_16x16x32_bf16 v[176:179], v[104:107], a[232:235], v[176:179]
    ds_read_b64_tr_b16 v[84:85], v12 offset:28672
    buffer_load_dwordx4 v7, s[56:59], s29 offen offset:1024 lds
    v_mfma_f32_16x16x32_bf16 v[184:187], v[104:107], a[236:239], v[184:187]
    ds_read_b64_tr_b16 v[86:87], v12 offset:29184
    v_mfma_f32_16x16x32_bf16 v[164:167], v[108:111], a[224:227], v[164:167]
    ds_read_b64_tr_b16 v[88:89], v13 offset:28672
    buffer_load_dwordx4 v8, s[56:59], s29 offen offset:2048 lds
    v_mfma_f32_16x16x32_bf16 v[172:175], v[108:111], a[228:231], v[172:175]
    ds_read_b64_tr_b16 v[90:91], v13 offset:29184
    v_mfma_f32_16x16x32_bf16 v[180:183], v[108:111], a[232:235], v[180:183]
    ds_read_b64_tr_b16 v[92:93], v14 offset:28672
    v_mfma_f32_16x16x32_bf16 v[188:191], v[108:111], a[236:239], v[188:191]
    ds_read_b64_tr_b16 v[94:95], v14 offset:29184
    buffer_load_dwordx4 v9, s[56:59], s29 offen offset:3072 lds
    v_mfma_f32_16x16x32_bf16 v[192:195], v[112:115], a[224:227], v[192:195]
    s_add_u32 m0, s11, 114688
    s_add_u32 s29, s9, 1048704
    v_mfma_f32_16x16x32_bf16 v[200:203], v[112:115], a[228:231], v[200:203]
    buffer_load_dwordx4 v6, s[56:59], s29 offen offset:0 lds
    v_mfma_f32_16x16x32_bf16 v[208:211], v[112:115], a[232:235], v[208:211]
    buffer_load_dwordx4 v7, s[56:59], s29 offen offset:1024 lds
    v_mfma_f32_16x16x32_bf16 v[216:219], v[112:115], a[236:239], v[216:219]
    buffer_load_dwordx4 v8, s[56:59], s29 offen offset:2048 lds
    v_mfma_f32_16x16x32_bf16 v[196:199], v[116:119], a[224:227], v[196:199]
    buffer_load_dwordx4 v9, s[56:59], s29 offen offset:3072 lds
    v_mfma_f32_16x16x32_bf16 v[204:207], v[116:119], a[228:231], v[204:207]
    v_mfma_f32_16x16x32_bf16 v[212:215], v[116:119], a[232:235], v[212:215]
    v_mfma_f32_16x16x32_bf16 v[220:223], v[116:119], a[236:239], v[220:223]
    v_mfma_f32_16x16x32_bf16 v[224:227], v[120:123], a[224:227], v[224:227]
    v_mfma_f32_16x16x32_bf16 v[232:235], v[120:123], a[228:231], v[232:235]
    v_mfma_f32_16x16x32_bf16 v[240:243], v[120:123], a[232:235], v[240:243]
    v_mfma_f32_16x16x32_bf16 v[248:251], v[120:123], a[236:239], v[248:251]
    v_mfma_f32_16x16x32_bf16 v[228:231], v[124:127], a[224:227], v[228:231]
    v_mfma_f32_16x16x32_bf16 v[236:239], v[124:127], a[228:231], v[236:239]
    v_mfma_f32_16x16x32_bf16 v[244:247], v[124:127], a[232:235], v[244:247]
    v_mfma_f32_16x16x32_bf16 v[252:255], v[124:127], a[236:239], v[252:255]
    s_waitcnt vmcnt(8) lgkmcnt(0)
    v_mfma_f32_16x16x32_bf16 v[128:131], v[64:67], a[240:243], v[128:131]
    s_barrier
    ds_read_b64_tr_b16 v[96:97], v15 offset:16384
    v_mfma_f32_16x16x32_bf16 v[136:139], v[64:67], a[244:247], v[136:139]
    ds_read_b64_tr_b16 v[98:99], v15 offset:16896
    v_mfma_f32_16x16x32_bf16 v[144:147], v[64:67], a[248:251], v[144:147]
    ds_read_b64_tr_b16 v[100:101], v15 offset:20480
    v_mfma_f32_16x16x32_bf16 v[152:155], v[64:67], a[252:255], v[152:155]
    ds_read_b64_tr_b16 v[102:103], v15 offset:20992
    v_mfma_f32_16x16x32_bf16 v[132:135], v[68:71], a[240:243], v[132:135]
    ds_read_b64_tr_b16 v[104:105], v15 offset:24576
    v_mfma_f32_16x16x32_bf16 v[140:143], v[68:71], a[244:247], v[140:143]
    ds_read_b64_tr_b16 v[106:107], v15 offset:25088
    s_add_u32 m0, s11, 131072
    s_add_u32 s29, s9, 2097280
    v_mfma_f32_16x16x32_bf16 v[148:151], v[68:71], a[248:251], v[148:151]
    ds_read_b64_tr_b16 v[108:109], v15 offset:28672
    v_mfma_f32_16x16x32_bf16 v[156:159], v[68:71], a[252:255], v[156:159]
    ds_read_b64_tr_b16 v[110:111], v15 offset:29184
    buffer_load_dwordx4 v6, s[56:59], s29 offen offset:0 lds
    v_mfma_f32_16x16x32_bf16 v[160:163], v[72:75], a[240:243], v[160:163]
    buffer_load_dwordx4 v7, s[56:59], s29 offen offset:1024 lds
    v_mfma_f32_16x16x32_bf16 v[168:171], v[72:75], a[244:247], v[168:171]
    buffer_load_dwordx4 v8, s[56:59], s29 offen offset:2048 lds
    v_mfma_f32_16x16x32_bf16 v[176:179], v[72:75], a[248:251], v[176:179]
    buffer_load_dwordx4 v9, s[56:59], s29 offen offset:3072 lds
    v_mfma_f32_16x16x32_bf16 v[184:187], v[72:75], a[252:255], v[184:187]
    s_add_u32 m0, s11, 147456
    s_add_u32 s29, s9, 3145856
    v_mfma_f32_16x16x32_bf16 v[164:167], v[76:79], a[240:243], v[164:167]
    buffer_load_dwordx4 v6, s[56:59], s29 offen offset:0 lds
    v_mfma_f32_16x16x32_bf16 v[172:175], v[76:79], a[244:247], v[172:175]
    buffer_load_dwordx4 v7, s[56:59], s29 offen offset:1024 lds
    v_mfma_f32_16x16x32_bf16 v[180:183], v[76:79], a[248:251], v[180:183]
    buffer_load_dwordx4 v8, s[56:59], s29 offen offset:2048 lds
    v_mfma_f32_16x16x32_bf16 v[188:191], v[76:79], a[252:255], v[188:191]
    buffer_load_dwordx4 v9, s[56:59], s29 offen offset:3072 lds
    v_mfma_f32_16x16x32_bf16 v[192:195], v[80:83], a[240:243], v[192:195]
    v_mfma_f32_16x16x32_bf16 v[200:203], v[80:83], a[244:247], v[200:203]
    v_mfma_f32_16x16x32_bf16 v[208:211], v[80:83], a[248:251], v[208:211]
    v_mfma_f32_16x16x32_bf16 v[216:219], v[80:83], a[252:255], v[216:219]
    v_mfma_f32_16x16x32_bf16 v[196:199], v[84:87], a[240:243], v[196:199]
    v_mfma_f32_16x16x32_bf16 v[204:207], v[84:87], a[244:247], v[204:207]
    v_mfma_f32_16x16x32_bf16 v[212:215], v[84:87], a[248:251], v[212:215]
    v_mfma_f32_16x16x32_bf16 v[220:223], v[84:87], a[252:255], v[220:223]
    v_mfma_f32_16x16x32_bf16 v[224:227], v[88:91], a[240:243], v[224:227]
    v_mfma_f32_16x16x32_bf16 v[232:235], v[88:91], a[244:247], v[232:235]
    v_mfma_f32_16x16x32_bf16 v[240:243], v[88:91], a[248:251], v[240:243]
    v_mfma_f32_16x16x32_bf16 v[248:251], v[88:91], a[252:255], v[248:251]
    v_mfma_f32_16x16x32_bf16 v[228:231], v[92:95], a[240:243], v[228:231]
    v_mfma_f32_16x16x32_bf16 v[236:239], v[92:95], a[244:247], v[236:239]
    v_mfma_f32_16x16x32_bf16 v[244:247], v[92:95], a[248:251], v[244:247]
    v_mfma_f32_16x16x32_bf16 v[252:255], v[92:95], a[252:255], v[252:255]
    s_waitcnt lgkmcnt(0)
    v_mfma_f32_16x16x32_bf16 v[64:67], a[0:3], v[96:99], 0
    ds_read_b64_tr_b16 v[112:113], v15 offset:32768
    v_add_u32 v11, 98304, v11
    v_mfma_f32_16x16x32_bf16 v[64:67], a[16:19], v[100:103], v[64:67]
    v_add_u32 v12, 98304, v12
    v_add_u32 v13, 98304, v13
    v_mfma_f32_16x16x32_bf16 v[64:67], a[32:35], v[104:107], v[64:67]
    ds_read_b64_tr_b16 v[114:115], v15 offset:33280
    v_add_u32 v14, 98304, v14
    v_mfma_f32_16x16x32_bf16 v[64:67], a[48:51], v[108:111], v[64:67]
    s_mov_b32 s88, s32
    s_mov_b32 s89, s33
    v_mfma_f32_16x16x32_bf16 v[68:71], a[4:7], v[96:99], 0
    ds_read_b64_tr_b16 v[116:117], v15 offset:36864
    s_mov_b32 s90, 4194304
    v_mfma_f32_16x16x32_bf16 v[68:71], a[20:23], v[100:103], v[68:71]
    s_mov_b32 s91, 0x00020000
    s_lshl_b32 s6, s5, 2
    v_mfma_f32_16x16x32_bf16 v[68:71], a[36:39], v[104:107], v[68:71]
    ds_read_b64_tr_b16 v[118:119], v15 offset:37376
    s_add_u32 s6, s6, s3
    v_mfma_f32_16x16x32_bf16 v[68:71], a[52:55], v[108:111], v[68:71]
    s_lshl_b32 s6, s6, 15
    s_and_b32 s10, s2, 7
    v_mfma_f32_16x16x32_bf16 v[72:75], a[8:11], v[96:99], 0
    ds_read_b64_tr_b16 v[120:121], v15 offset:40960
    s_lshl_b32 s10, s10, 10
    v_mfma_f32_16x16x32_bf16 v[72:75], a[24:27], v[100:103], v[72:75]
    s_add_u32 s6, s6, s10
    v_lshrrev_b32 v27, 4, v0
    v_mfma_f32_16x16x32_bf16 v[72:75], a[40:43], v[104:107], v[72:75]
    ds_read_b64_tr_b16 v[122:123], v15 offset:41472
    v_lshlrev_b32 v27, 13, v27
    v_mfma_f32_16x16x32_bf16 v[72:75], a[56:59], v[108:111], v[72:75]
    v_and_b32 v31, 15, v0
    v_lshl_add_u32 v27, v31, 6, v27
    v_mfma_f32_16x16x32_bf16 v[76:79], a[12:15], v[96:99], 0
    ds_read_b64_tr_b16 v[124:125], v15 offset:45056
    buffer_load_dword v34, v27, s[88:91], s6 offen
    v_mfma_f32_16x16x32_bf16 v[76:79], a[28:31], v[100:103], v[76:79]
    v_mfma_f32_16x16x32_bf16 v[76:79], a[44:47], v[104:107], v[76:79]
    ds_read_b64_tr_b16 v[126:127], v15 offset:45568
    v_mfma_f32_16x16x32_bf16 v[76:79], a[60:63], v[108:111], v[76:79]
    s_waitcnt lgkmcnt(0)
    v_mfma_f32_16x16x32_bf16 v[64:67], a[64:67], v[112:115], v[64:67]
    ds_read_b64_tr_b16 v[96:97], v15 offset:49152
    v_mul_f32 v128, 0x3e0293ee, v128
    v_mfma_f32_16x16x32_bf16 v[64:67], a[80:83], v[116:119], v[64:67]
    v_mul_f32 v129, 0x3e0293ee, v129
    v_mul_f32 v130, 0x3e0293ee, v130
    v_mfma_f32_16x16x32_bf16 v[64:67], a[96:99], v[120:123], v[64:67]
    ds_read_b64_tr_b16 v[98:99], v15 offset:49664
    v_mul_f32 v131, 0x3e0293ee, v131
    v_mfma_f32_16x16x32_bf16 v[64:67], a[112:115], v[124:127], v[64:67]
    v_mul_f32 v132, 0x3e0293ee, v132
    v_mul_f32 v133, 0x3e0293ee, v133
    v_mfma_f32_16x16x32_bf16 v[68:71], a[68:71], v[112:115], v[68:71]
    ds_read_b64_tr_b16 v[100:101], v15 offset:53248
    v_mul_f32 v134, 0x3e0293ee, v134
    v_mfma_f32_16x16x32_bf16 v[68:71], a[84:87], v[116:119], v[68:71]
    v_mul_f32 v135, 0x3e0293ee, v135
    v_cvt_pk_bf16_f32 v128, v128, v129
    v_mfma_f32_16x16x32_bf16 v[68:71], a[100:103], v[120:123], v[68:71]
    ds_read_b64_tr_b16 v[102:103], v15 offset:53760
    v_cvt_pk_bf16_f32 v129, v130, v131
    v_mfma_f32_16x16x32_bf16 v[68:71], a[116:119], v[124:127], v[68:71]
    v_cvt_pk_bf16_f32 v130, v132, v133
    v_cvt_pk_bf16_f32 v131, v134, v135
    v_mfma_f32_16x16x32_bf16 v[72:75], a[72:75], v[112:115], v[72:75]
    ds_read_b64_tr_b16 v[104:105], v15 offset:57344
    s_add_u32 s1, s0, 83886080
    v_mfma_f32_16x16x32_bf16 v[72:75], a[88:91], v[116:119], v[72:75]
    buffer_store_dwordx4 v[128:131], v1, s[48:51], s1 offen offset:0 sc1
    v_mul_f32 v136, 0x3e0293ee, v136
    v_mfma_f32_16x16x32_bf16 v[72:75], a[104:107], v[120:123], v[72:75]
    ds_read_b64_tr_b16 v[106:107], v15 offset:57856
    v_mul_f32 v137, 0x3e0293ee, v137
    v_mfma_f32_16x16x32_bf16 v[72:75], a[120:123], v[124:127], v[72:75]
    v_mul_f32 v138, 0x3e0293ee, v138
    v_mul_f32 v139, 0x3e0293ee, v139
    v_mfma_f32_16x16x32_bf16 v[76:79], a[76:79], v[112:115], v[76:79]
    ds_read_b64_tr_b16 v[108:109], v15 offset:61440
    v_mul_f32 v140, 0x3e0293ee, v140
    v_mfma_f32_16x16x32_bf16 v[76:79], a[92:95], v[116:119], v[76:79]
    v_mul_f32 v141, 0x3e0293ee, v141
    v_mul_f32 v142, 0x3e0293ee, v142
    v_mfma_f32_16x16x32_bf16 v[76:79], a[108:111], v[120:123], v[76:79]
    ds_read_b64_tr_b16 v[110:111], v15 offset:61952
    v_mul_f32 v143, 0x3e0293ee, v143
    v_mfma_f32_16x16x32_bf16 v[76:79], a[124:127], v[124:127], v[76:79]
    v_cvt_pk_bf16_f32 v136, v136, v137
    v_cvt_pk_bf16_f32 v137, v138, v139
    s_waitcnt lgkmcnt(0)
    v_mfma_f32_16x16x32_bf16 v[64:67], a[128:131], v[96:99], v[64:67]
    ds_read_b64_tr_b16 v[112:113], v15 offset:0
    v_cvt_pk_bf16_f32 v138, v140, v141
    v_mfma_f32_16x16x32_bf16 v[64:67], a[144:147], v[100:103], v[64:67]
    v_cvt_pk_bf16_f32 v139, v142, v143
    s_add_u32 s1, s0, 83890176
    v_mfma_f32_16x16x32_bf16 v[64:67], a[160:163], v[104:107], v[64:67]
    ds_read_b64_tr_b16 v[114:115], v15 offset:512
    buffer_store_dwordx4 v[136:139], v1, s[48:51], s1 offen offset:0 sc1
    v_mfma_f32_16x16x32_bf16 v[64:67], a[176:179], v[108:111], v[64:67]
    v_mul_f32 v144, 0x3e0293ee, v144
    v_mul_f32 v145, 0x3e0293ee, v145
    v_mfma_f32_16x16x32_bf16 v[68:71], a[132:135], v[96:99], v[68:71]
    ds_read_b64_tr_b16 v[116:117], v15 offset:4096
    v_mul_f32 v146, 0x3e0293ee, v146
    v_mfma_f32_16x16x32_bf16 v[68:71], a[148:151], v[100:103], v[68:71]
    v_mul_f32 v147, 0x3e0293ee, v147
    v_mul_f32 v148, 0x3e0293ee, v148
    v_mfma_f32_16x16x32_bf16 v[68:71], a[164:167], v[104:107], v[68:71]
    ds_read_b64_tr_b16 v[118:119], v15 offset:4608
    v_mul_f32 v149, 0x3e0293ee, v149
    v_mfma_f32_16x16x32_bf16 v[68:71], a[180:183], v[108:111], v[68:71]
    v_mul_f32 v150, 0x3e0293ee, v150
    v_mul_f32 v151, 0x3e0293ee, v151
    v_mfma_f32_16x16x32_bf16 v[72:75], a[136:139], v[96:99], v[72:75]
    ds_read_b64_tr_b16 v[120:121], v15 offset:8192
    v_cvt_pk_bf16_f32 v144, v144, v145
    v_mfma_f32_16x16x32_bf16 v[72:75], a[152:155], v[100:103], v[72:75]
    v_cvt_pk_bf16_f32 v145, v146, v147
    v_cvt_pk_bf16_f32 v146, v148, v149
    v_mfma_f32_16x16x32_bf16 v[72:75], a[168:171], v[104:107], v[72:75]
    ds_read_b64_tr_b16 v[122:123], v15 offset:8704
    v_cvt_pk_bf16_f32 v147, v150, v151
    v_mfma_f32_16x16x32_bf16 v[72:75], a[184:187], v[108:111], v[72:75]
    s_add_u32 s1, s0, 83894272
    buffer_store_dwordx4 v[144:147], v1, s[48:51], s1 offen offset:0 sc1
    v_mfma_f32_16x16x32_bf16 v[76:79], a[140:143], v[96:99], v[76:79]
    ds_read_b64_tr_b16 v[124:125], v15 offset:12288
    v_mul_f32 v152, 0x3e0293ee, v152
    v_mfma_f32_16x16x32_bf16 v[76:79], a[156:159], v[100:103], v[76:79]
    v_mul_f32 v153, 0x3e0293ee, v153
    v_mul_f32 v154, 0x3e0293ee, v154
    v_mfma_f32_16x16x32_bf16 v[76:79], a[172:175], v[104:107], v[76:79]
    ds_read_b64_tr_b16 v[126:127], v15 offset:12800
    v_mul_f32 v155, 0x3e0293ee, v155
    v_mfma_f32_16x16x32_bf16 v[76:79], a[188:191], v[108:111], v[76:79]
    v_mul_f32 v156, 0x3e0293ee, v156
    v_mul_f32 v157, 0x3e0293ee, v157
    s_waitcnt lgkmcnt(0)
    v_mfma_f32_16x16x32_bf16 v[64:67], a[192:195], v[112:115], v[64:67]
    ds_read_b64_tr_b16 v[96:97], v16 offset:16384
    v_mul_f32 v158, 0x3e0293ee, v158
    v_mfma_f32_16x16x32_bf16 v[64:67], a[208:211], v[116:119], v[64:67]
    v_mul_f32 v159, 0x3e0293ee, v159
    v_cvt_pk_bf16_f32 v152, v152, v153
    v_mfma_f32_16x16x32_bf16 v[64:67], a[224:227], v[120:123], v[64:67]
    ds_read_b64_tr_b16 v[98:99], v16 offset:16896
    v_cvt_pk_bf16_f32 v153, v154, v155
    v_mfma_f32_16x16x32_bf16 v[64:67], a[240:243], v[124:127], v[64:67]
    v_cvt_pk_bf16_f32 v154, v156, v157
    v_cvt_pk_bf16_f32 v155, v158, v159
    v_mfma_f32_16x16x32_bf16 v[68:71], a[196:199], v[112:115], v[68:71]
    ds_read_b64_tr_b16 v[100:101], v16 offset:20480
    s_add_u32 s1, s0, 83898368
    v_mfma_f32_16x16x32_bf16 v[68:71], a[212:215], v[116:119], v[68:71]
    buffer_store_dwordx4 v[152:155], v1, s[48:51], s1 offen offset:0 sc1
    v_mfma_f32_16x16x32_bf16 v[68:71], a[228:231], v[120:123], v[68:71]
    ds_read_b64_tr_b16 v[102:103], v16 offset:20992
    ds_write_b32 v28, v63
    v_mfma_f32_16x16x32_bf16 v[68:71], a[244:247], v[124:127], v[68:71]
    v_lshlrev_b32 v132, 16, v36
    v_lshlrev_b32 v133, 16, v37
    v_mfma_f32_16x16x32_bf16 v[72:75], a[200:203], v[112:115], v[72:75]
    ds_read_b64_tr_b16 v[104:105], v16 offset:24576
    v_lshlrev_b32 v134, 16, v38
    v_mfma_f32_16x16x32_bf16 v[72:75], a[216:219], v[116:119], v[72:75]
    v_lshlrev_b32 v135, 16, v39
    v_lshlrev_b32 v136, 16, v40
    v_mfma_f32_16x16x32_bf16 v[72:75], a[232:235], v[120:123], v[72:75]
    ds_read_b64_tr_b16 v[106:107], v16 offset:25088
    v_lshlrev_b32 v137, 16, v41
    v_mfma_f32_16x16x32_bf16 v[72:75], a[248:251], v[124:127], v[72:75]
    v_lshlrev_b32 v138, 16, v42
    v_lshlrev_b32 v139, 16, v43
    v_mfma_f32_16x16x32_bf16 v[76:79], a[204:207], v[112:115], v[76:79]
    ds_read_b64_tr_b16 v[108:109], v16 offset:28672
    v_lshlrev_b32 v140, 16, v44
    v_mfma_f32_16x16x32_bf16 v[76:79], a[220:223], v[116:119], v[76:79]
    v_lshlrev_b32 v141, 16, v45
    v_lshlrev_b32 v142, 16, v46
    v_mfma_f32_16x16x32_bf16 v[76:79], a[236:239], v[120:123], v[76:79]
    ds_read_b64_tr_b16 v[110:111], v16 offset:29184
    v_lshlrev_b32 v143, 16, v56
    v_mfma_f32_16x16x32_bf16 v[76:79], a[252:255], v[124:127], v[76:79]
    v_and_b32 v144, 0xffff0000, v56
    v_lshlrev_b32 v145, 16, v57
    s_waitcnt lgkmcnt(0)
    v_mfma_f32_16x16x32_bf16 v[80:83], a[0:3], v[96:99], 0
    ds_read_b64_tr_b16 v[112:113], v16 offset:32768
    v_and_b32 v146, 0xffff0000, v57
    v_mfma_f32_16x16x32_bf16 v[80:83], a[16:19], v[100:103], v[80:83]
    v_mul_f32 v160, 0x3e0293ee, v160
    v_mul_f32 v148, v132, v146
    v_mfma_f32_16x16x32_bf16 v[80:83], a[32:35], v[104:107], v[80:83]
    ds_read_b64_tr_b16 v[114:115], v16 offset:33280
    v_mul_f32 v161, 0x3e0293ee, v161
    v_mfma_f32_16x16x32_bf16 v[80:83], a[48:51], v[108:111], v[80:83]
    v_mul_f32 v162, 0x3e0293ee, v162
    v_mul_f32 v149, v133, v146
    v_mfma_f32_16x16x32_bf16 v[84:87], a[4:7], v[96:99], 0
    ds_read_b64_tr_b16 v[116:117], v16 offset:36864
    v_mul_f32 v150, v134, v146
    v_mfma_f32_16x16x32_bf16 v[84:87], a[20:23], v[100:103], v[84:87]
    v_mul_f32 v163, 0x3e0293ee, v163
    v_mul_f32 v151, v135, v146
    v_mfma_f32_16x16x32_bf16 v[84:87], a[36:39], v[104:107], v[84:87]
    ds_read_b64_tr_b16 v[118:119], v16 offset:37376
    v_mul_f32 v164, 0x3e0293ee, v164
    v_mfma_f32_16x16x32_bf16 v[84:87], a[52:55], v[108:111], v[84:87]
    v_mul_f32 v165, 0x3e0293ee, v165
    v_mul_f32 v152, v136, v146
    v_mfma_f32_16x16x32_bf16 v[88:91], a[8:11], v[96:99], 0
    ds_read_b64_tr_b16 v[120:121], v16 offset:40960
    v_mul_f32 v153, v137, v146
    v_mfma_f32_16x16x32_bf16 v[88:91], a[24:27], v[100:103], v[88:91]
    v_cvt_pk_bf16_f32 v64, v64, v65
    v_mul_f32 v166, 0x3e0293ee, v166
    v_mfma_f32_16x16x32_bf16 v[88:91], a[40:43], v[104:107], v[88:91]
    ds_read_b64_tr_b16 v[122:123], v16 offset:41472
    v_mul_f32 v167, 0x3e0293ee, v167
    v_mfma_f32_16x16x32_bf16 v[88:91], a[56:59], v[108:111], v[88:91]
    v_cvt_pk_bf16_f32 v160, v160, v161
    v_mul_f32 v154, v138, v146
    v_mfma_f32_16x16x32_bf16 v[92:95], a[12:15], v[96:99], 0
    ds_read_b64_tr_b16 v[124:125], v16 offset:45056
    v_mul_f32 v155, v139, v146
    v_mfma_f32_16x16x32_bf16 v[92:95], a[28:31], v[100:103], v[92:95]
    v_cvt_pk_bf16_f32 v65, v66, v67
    v_cvt_pk_bf16_f32 v161, v162, v163
    v_mfma_f32_16x16x32_bf16 v[92:95], a[44:47], v[104:107], v[92:95]
    ds_read_b64_tr_b16 v[126:127], v16 offset:45568
    v_cvt_pk_bf16_f32 v162, v164, v165
    v_mfma_f32_16x16x32_bf16 v[92:95], a[60:63], v[108:111], v[92:95]
    v_cvt_pk_bf16_f32 v163, v166, v167
    v_fmac_f32 v148, v133, v145
    s_waitcnt lgkmcnt(0)
    v_mfma_f32_16x16x32_bf16 v[80:83], a[64:67], v[112:115], v[80:83]
    ds_read_b64_tr_b16 v[96:97], v16 offset:49152
    v_fmac_f32 v149, v134, v145
    v_mfma_f32_16x16x32_bf16 v[80:83], a[80:83], v[116:119], v[80:83]
    v_cvt_pk_bf16_f32 v66, v68, v69
    s_add_u32 s1, s0, 83886080
    v_mfma_f32_16x16x32_bf16 v[80:83], a[96:99], v[120:123], v[80:83]
    ds_read_b64_tr_b16 v[98:99], v16 offset:49664
    buffer_store_dwordx4 v[160:163], v1, s[48:51], s1 offen offset:1024 sc1
    v_mfma_f32_16x16x32_bf16 v[80:83], a[112:115], v[124:127], v[80:83]
    v_mul_f32 v168, 0x3e0293ee, v168
    v_fmac_f32 v150, v135, v145
    v_mfma_f32_16x16x32_bf16 v[84:87], a[68:71], v[112:115], v[84:87]
    ds_read_b64_tr_b16 v[100:101], v16 offset:53248
    v_fmac_f32 v151, v136, v145
    v_mfma_f32_16x16x32_bf16 v[84:87], a[84:87], v[116:119], v[84:87]
    v_cvt_pk_bf16_f32 v67, v70, v71
    v_mul_f32 v169, 0x3e0293ee, v169
    v_mfma_f32_16x16x32_bf16 v[84:87], a[100:103], v[120:123], v[84:87]
    ds_read_b64_tr_b16 v[102:103], v16 offset:53760
    v_mul_f32 v170, 0x3e0293ee, v170
    v_mfma_f32_16x16x32_bf16 v[84:87], a[116:119], v[124:127], v[84:87]
    v_mul_f32 v171, 0x3e0293ee, v171
    v_fmac_f32 v152, v137, v145
    v_mfma_f32_16x16x32_bf16 v[88:91], a[72:75], v[112:115], v[88:91]
    ds_read_b64_tr_b16 v[104:105], v16 offset:57344
    v_fmac_f32 v153, v138, v145
    v_mfma_f32_16x16x32_bf16 v[88:91], a[88:91], v[116:119], v[88:91]
    s_add_u32 s28, s0, 104865792
    v_mul_f32 v172, 0x3e0293ee, v172
    v_mfma_f32_16x16x32_bf16 v[88:91], a[104:107], v[120:123], v[88:91]
    ds_read_b64_tr_b16 v[106:107], v16 offset:57856
    v_mul_f32 v173, 0x3e0293ee, v173
    v_mfma_f32_16x16x32_bf16 v[88:91], a[120:123], v[124:127], v[88:91]
    v_mul_f32 v174, 0x3e0293ee, v174
    v_fmac_f32 v154, v139, v145
    v_mfma_f32_16x16x32_bf16 v[92:95], a[76:79], v[112:115], v[92:95]
    ds_read_b64_tr_b16 v[108:109], v16 offset:61440
    v_fmac_f32 v155, v140, v145
    v_mfma_f32_16x16x32_bf16 v[92:95], a[92:95], v[116:119], v[92:95]
    buffer_store_dwordx4 v[64:67], v1, s[48:51], s28 offen offset:0 sc1
    v_mul_f32 v175, 0x3e0293ee, v175
    v_mfma_f32_16x16x32_bf16 v[92:95], a[108:111], v[120:123], v[92:95]
    ds_read_b64_tr_b16 v[110:111], v16 offset:61952
    v_cvt_pk_bf16_f32 v168, v168, v169
    v_mfma_f32_16x16x32_bf16 v[92:95], a[124:127], v[124:127], v[92:95]
    v_cvt_pk_bf16_f32 v169, v170, v171
    v_fmac_f32 v148, v134, v144
    s_waitcnt lgkmcnt(0)
    v_mfma_f32_16x16x32_bf16 v[80:83], a[128:131], v[96:99], v[80:83]
    ds_read_b64_tr_b16 v[112:113], v16 offset:0
    v_fmac_f32 v149, v135, v144
    v_mfma_f32_16x16x32_bf16 v[80:83], a[144:147], v[100:103], v[80:83]
    v_cvt_pk_bf16_f32 v72, v72, v73
    v_cvt_pk_bf16_f32 v170, v172, v173
    v_mfma_f32_16x16x32_bf16 v[80:83], a[160:163], v[104:107], v[80:83]
    ds_read_b64_tr_b16 v[114:115], v16 offset:512
    v_cvt_pk_bf16_f32 v171, v174, v175
    v_mfma_f32_16x16x32_bf16 v[80:83], a[176:179], v[108:111], v[80:83]
    s_add_u32 s1, s0, 83890176
    v_fmac_f32 v150, v136, v144
    v_mfma_f32_16x16x32_bf16 v[84:87], a[132:135], v[96:99], v[84:87]
    ds_read_b64_tr_b16 v[116:117], v16 offset:4096
    v_fmac_f32 v151, v137, v144
    v_mfma_f32_16x16x32_bf16 v[84:87], a[148:151], v[100:103], v[84:87]
    v_cvt_pk_bf16_f32 v73, v74, v75
    buffer_store_dwordx4 v[168:171], v1, s[48:51], s1 offen offset:1024 sc1
    v_mfma_f32_16x16x32_bf16 v[84:87], a[164:167], v[104:107], v[84:87]
    ds_read_b64_tr_b16 v[118:119], v16 offset:4608
    v_mul_f32 v176, 0x3e0293ee, v176
    v_mfma_f32_16x16x32_bf16 v[84:87], a[180:183], v[108:111], v[84:87]
    v_mul_f32 v177, 0x3e0293ee, v177
    v_fmac_f32 v152, v138, v144
    v_mfma_f32_16x16x32_bf16 v[88:91], a[136:139], v[96:99], v[88:91]
    ds_read_b64_tr_b16 v[120:121], v16 offset:8192
    v_fmac_f32 v153, v139, v144
    v_mfma_f32_16x16x32_bf16 v[88:91], a[152:155], v[100:103], v[88:91]
    v_cvt_pk_bf16_f32 v74, v76, v77
    v_mul_f32 v178, 0x3e0293ee, v178
    v_mfma_f32_16x16x32_bf16 v[88:91], a[168:171], v[104:107], v[88:91]
    ds_read_b64_tr_b16 v[122:123], v16 offset:8704
    v_mul_f32 v179, 0x3e0293ee, v179
    v_mfma_f32_16x16x32_bf16 v[88:91], a[184:187], v[108:111], v[88:91]
    v_mul_f32 v180, 0x3e0293ee, v180
    v_fmac_f32 v154, v140, v144
    v_mfma_f32_16x16x32_bf16 v[92:95], a[140:143], v[96:99], v[92:95]
    ds_read_b64_tr_b16 v[124:125], v16 offset:12288
    v_fmac_f32 v155, v141, v144
    v_mfma_f32_16x16x32_bf16 v[92:95], a[156:159], v[100:103], v[92:95]
    v_cvt_pk_bf16_f32 v75, v78, v79
    v_mul_f32 v181, 0x3e0293ee, v181
    v_mfma_f32_16x16x32_bf16 v[92:95], a[172:175], v[104:107], v[92:95]
    ds_read_b64_tr_b16 v[126:127], v16 offset:12800
    v_mul_f32 v182, 0x3e0293ee, v182
    v_mfma_f32_16x16x32_bf16 v[92:95], a[188:191], v[108:111], v[92:95]
    v_mul_f32 v183, 0x3e0293ee, v183
    v_fmac_f32 v148, v135, v143
    s_waitcnt lgkmcnt(0)
    v_mfma_f32_16x16x32_bf16 v[80:83], a[192:195], v[112:115], v[80:83]
    ds_read_b64_tr_b16 v[96:97], v17 offset:16384
    v_fmac_f32 v149, v136, v143
    v_mfma_f32_16x16x32_bf16 v[80:83], a[208:211], v[116:119], v[80:83]
    s_add_u32 s28, s0, 104873984
    v_cvt_pk_bf16_f32 v176, v176, v177
    v_mfma_f32_16x16x32_bf16 v[80:83], a[224:227], v[120:123], v[80:83]
    ds_read_b64_tr_b16 v[98:99], v17 offset:16896
    v_cvt_pk_bf16_f32 v177, v178, v179
    v_mfma_f32_16x16x32_bf16 v[80:83], a[240:243], v[124:127], v[80:83]
    v_cvt_pk_bf16_f32 v178, v180, v181
    v_fmac_f32 v150, v137, v143
    v_mfma_f32_16x16x32_bf16 v[84:87], a[196:199], v[112:115], v[84:87]
    ds_read_b64_tr_b16 v[100:101], v17 offset:20480
    v_fmac_f32 v151, v138, v143
    v_mfma_f32_16x16x32_bf16 v[84:87], a[212:215], v[116:119], v[84:87]
    buffer_store_dwordx4 v[72:75], v1, s[48:51], s28 offen offset:0 sc1
    v_cvt_pk_bf16_f32 v179, v182, v183
    v_mfma_f32_16x16x32_bf16 v[84:87], a[228:231], v[120:123], v[84:87]
    ds_read_b64_tr_b16 v[102:103], v17 offset:20992
    s_add_u32 s1, s0, 83894272
    v_mfma_f32_16x16x32_bf16 v[84:87], a[244:247], v[124:127], v[84:87]
    buffer_store_dwordx4 v[176:179], v1, s[48:51], s1 offen offset:1024 sc1
    v_fmac_f32 v152, v139, v143
    v_mfma_f32_16x16x32_bf16 v[88:91], a[200:203], v[112:115], v[88:91]
    ds_read_b64_tr_b16 v[104:105], v17 offset:24576
    v_fmac_f32 v153, v140, v143
    v_mfma_f32_16x16x32_bf16 v[88:91], a[216:219], v[116:119], v[88:91]
    v_mul_f32 v184, 0x3e0293ee, v184
    v_fmac_f32 v154, v141, v143
    v_mfma_f32_16x16x32_bf16 v[88:91], a[232:235], v[120:123], v[88:91]
    ds_read_b64_tr_b16 v[106:107], v17 offset:25088
    v_mul_f32 v185, 0x3e0293ee, v185
    v_mfma_f32_16x16x32_bf16 v[88:91], a[248:251], v[124:127], v[88:91]
    v_mul_f32 v186, 0x3e0293ee, v186
    v_fmac_f32 v155, v142, v143
    v_mfma_f32_16x16x32_bf16 v[92:95], a[204:207], v[112:115], v[92:95]
    ds_read_b64_tr_b16 v[108:109], v17 offset:28672
    v_lshlrev_b32 v132, 16, v47
    v_mfma_f32_16x16x32_bf16 v[92:95], a[220:223], v[116:119], v[92:95]
    v_mul_f32 v187, 0x3e0293ee, v187
    v_lshlrev_b32 v133, 16, v48
    v_mfma_f32_16x16x32_bf16 v[92:95], a[236:239], v[120:123], v[92:95]
    ds_read_b64_tr_b16 v[110:111], v17 offset:29184
    v_mul_f32 v188, 0x3e0293ee, v188
    v_mfma_f32_16x16x32_bf16 v[92:95], a[252:255], v[124:127], v[92:95]
    v_mul_f32 v189, 0x3e0293ee, v189
    v_lshlrev_b32 v134, 16, v49
    s_waitcnt lgkmcnt(0)
    v_mfma_f32_16x16x32_bf16 v[64:67], a[0:3], v[96:99], 0
    ds_read_b64_tr_b16 v[112:113], v17 offset:32768
    v_lshlrev_b32 v135, 16, v50
    v_mfma_f32_16x16x32_bf16 v[64:67], a[16:19], v[100:103], v[64:67]
    v_mul_f32 v190, 0x3e0293ee, v190
    v_lshlrev_b32 v136, 16, v51
    v_mfma_f32_16x16x32_bf16 v[64:67], a[32:35], v[104:107], v[64:67]
    ds_read_b64_tr_b16 v[114:115], v17 offset:33280
    v_mul_f32 v191, 0x3e0293ee, v191
    v_mfma_f32_16x16x32_bf16 v[64:67], a[48:51], v[108:111], v[64:67]
    v_cvt_pk_bf16_f32 v184, v184, v185
    v_lshlrev_b32 v137, 16, v52
    v_mfma_f32_16x16x32_bf16 v[68:71], a[4:7], v[96:99], 0
    ds_read_b64_tr_b16 v[116:117], v17 offset:36864
    v_lshlrev_b32 v138, 16, v53
    v_mfma_f32_16x16x32_bf16 v[68:71], a[20:23], v[100:103], v[68:71]
    v_cvt_pk_bf16_f32 v185, v186, v187
    v_lshlrev_b32 v139, 16, v54
    v_mfma_f32_16x16x32_bf16 v[68:71], a[36:39], v[104:107], v[68:71]
    ds_read_b64_tr_b16 v[118:119], v17 offset:37376
    v_cvt_pk_bf16_f32 v186, v188, v189
    v_mfma_f32_16x16x32_bf16 v[68:71], a[52:55], v[108:111], v[68:71]
    v_cvt_pk_bf16_f32 v187, v190, v191
    v_mul_f32 v148, v148, v132
    v_mfma_f32_16x16x32_bf16 v[72:75], a[8:11], v[96:99], 0
    ds_read_b64_tr_b16 v[120:121], v17 offset:40960
    v_mul_f32 v149, v149, v133
    v_mfma_f32_16x16x32_bf16 v[72:75], a[24:27], v[100:103], v[72:75]
    v_cvt_pk_bf16_f32 v80, v80, v81
    s_add_u32 s1, s0, 83898368
    v_mfma_f32_16x16x32_bf16 v[72:75], a[40:43], v[104:107], v[72:75]
    ds_read_b64_tr_b16 v[122:123], v17 offset:41472
    buffer_store_dwordx4 v[184:187], v1, s[48:51], s1 offen offset:1024 sc1
    v_mfma_f32_16x16x32_bf16 v[72:75], a[56:59], v[108:111], v[72:75]
    v_mul_f32 v192, 0x3e0293ee, v192
    v_mul_f32 v150, v150, v134
    v_mfma_f32_16x16x32_bf16 v[76:79], a[12:15], v[96:99], 0
    ds_read_b64_tr_b16 v[124:125], v17 offset:45056
    v_mul_f32 v151, v151, v135
    v_mfma_f32_16x16x32_bf16 v[76:79], a[28:31], v[100:103], v[76:79]
    v_cvt_pk_bf16_f32 v81, v82, v83
    v_mul_f32 v193, 0x3e0293ee, v193
    v_mfma_f32_16x16x32_bf16 v[76:79], a[44:47], v[104:107], v[76:79]
    ds_read_b64_tr_b16 v[126:127], v17 offset:45568
    v_mul_f32 v194, 0x3e0293ee, v194
    v_mfma_f32_16x16x32_bf16 v[76:79], a[60:63], v[108:111], v[76:79]
    v_mul_f32 v195, 0x3e0293ee, v195
    v_mul_f32 v152, v152, v136
    s_waitcnt lgkmcnt(0)
    v_mfma_f32_16x16x32_bf16 v[64:67], a[64:67], v[112:115], v[64:67]
    ds_read_b64_tr_b16 v[96:97], v17 offset:49152
    v_mul_f32 v153, v153, v137
    v_mfma_f32_16x16x32_bf16 v[64:67], a[80:83], v[116:119], v[64:67]
    v_cvt_pk_bf16_f32 v82, v84, v85
    v_mul_f32 v196, 0x3e0293ee, v196
    v_mfma_f32_16x16x32_bf16 v[64:67], a[96:99], v[120:123], v[64:67]
    ds_read_b64_tr_b16 v[98:99], v17 offset:49664
    v_mul_f32 v197, 0x3e0293ee, v197
    v_mfma_f32_16x16x32_bf16 v[64:67], a[112:115], v[124:127], v[64:67]
    v_mul_f32 v198, 0x3e0293ee, v198
    v_mul_f32 v154, v154, v138
    v_mfma_f32_16x16x32_bf16 v[68:71], a[68:71], v[112:115], v[68:71]
    ds_read_b64_tr_b16 v[100:101], v17 offset:53248
    v_mul_f32 v155, v155, v139
    v_mfma_f32_16x16x32_bf16 v[68:71], a[84:87], v[116:119], v[68:71]
    v_cvt_pk_bf16_f32 v83, v86, v87
    v_mul_f32 v199, 0x3e0293ee, v199
    v_mfma_f32_16x16x32_bf16 v[68:71], a[100:103], v[120:123], v[68:71]
    ds_read_b64_tr_b16 v[102:103], v17 offset:53760
    v_cvt_pk_bf16_f32 v192, v192, v193
    v_mfma_f32_16x16x32_bf16 v[68:71], a[116:119], v[124:127], v[68:71]
    v_cvt_pk_bf16_f32 v193, v194, v195
    v_cvt_pk_bf16_f32 v156, v155, v154
    v_mfma_f32_16x16x32_bf16 v[72:75], a[72:75], v[112:115], v[72:75]
    ds_read_b64_tr_b16 v[104:105], v17 offset:57344
    v_cvt_pk_bf16_f32 v157, v153, v152
    v_mfma_f32_16x16x32_bf16 v[72:75], a[88:91], v[116:119], v[72:75]
    s_add_u32 s28, s0, 104865792
    v_cvt_pk_bf16_f32 v194, v196, v197
    v_mfma_f32_16x16x32_bf16 v[72:75], a[104:107], v[120:123], v[72:75]
    ds_read_b64_tr_b16 v[106:107], v17 offset:57856
    v_cvt_pk_bf16_f32 v195, v198, v199
    v_mfma_f32_16x16x32_bf16 v[72:75], a[120:123], v[124:127], v[72:75]
    s_add_u32 s1, s0, 83886080
    v_cvt_pk_bf16_f32 v158, v151, v150
    v_mfma_f32_16x16x32_bf16 v[76:79], a[76:79], v[112:115], v[76:79]
    ds_read_b64_tr_b16 v[108:109], v17 offset:61440
    v_cvt_pk_bf16_f32 v159, v149, v148
    v_mfma_f32_16x16x32_bf16 v[76:79], a[92:95], v[116:119], v[76:79]
    buffer_store_dwordx4 v[80:83], v1, s[48:51], s28 offen offset:1024 sc1
    buffer_store_dwordx4 v[192:195], v1, s[48:51], s1 offen offset:2048 sc1
    v_mfma_f32_16x16x32_bf16 v[76:79], a[108:111], v[120:123], v[76:79]
    ds_read_b64_tr_b16 v[110:111], v17 offset:61952
    v_mul_f32 v200, 0x3e0293ee, v200
    v_mfma_f32_16x16x32_bf16 v[76:79], a[124:127], v[124:127], v[76:79]
    v_mul_f32 v201, 0x3e0293ee, v201
    ds_write_b128 v23, v[156:159] offset:0
    s_waitcnt lgkmcnt(1)
    v_mfma_f32_16x16x32_bf16 v[64:67], a[128:131], v[96:99], v[64:67]
    ds_read_b64_tr_b16 v[112:113], v17 offset:0
    v_and_b32 v132, 0xffff0000, v36
    v_mfma_f32_16x16x32_bf16 v[64:67], a[144:147], v[100:103], v[64:67]
    v_cvt_pk_bf16_f32 v88, v88, v89
    v_mul_f32 v202, 0x3e0293ee, v202
    v_mfma_f32_16x16x32_bf16 v[64:67], a[160:163], v[104:107], v[64:67]
    ds_read_b64_tr_b16 v[114:115], v17 offset:512
    v_mul_f32 v203, 0x3e0293ee, v203
    v_mfma_f32_16x16x32_bf16 v[64:67], a[176:179], v[108:111], v[64:67]
    v_mul_f32 v204, 0x3e0293ee, v204
    v_and_b32 v133, 0xffff0000, v37
    v_mfma_f32_16x16x32_bf16 v[68:71], a[132:135], v[96:99], v[68:71]
    ds_read_b64_tr_b16 v[116:117], v17 offset:4096
    v_and_b32 v134, 0xffff0000, v38
    v_mfma_f32_16x16x32_bf16 v[68:71], a[148:151], v[100:103], v[68:71]
    v_cvt_pk_bf16_f32 v89, v90, v91
    v_mul_f32 v205, 0x3e0293ee, v205
    v_mfma_f32_16x16x32_bf16 v[68:71], a[164:167], v[104:107], v[68:71]
    ds_read_b64_tr_b16 v[118:119], v17 offset:4608
    v_mul_f32 v206, 0x3e0293ee, v206
    v_mfma_f32_16x16x32_bf16 v[68:71], a[180:183], v[108:111], v[68:71]
    v_mul_f32 v207, 0x3e0293ee, v207
    v_and_b32 v135, 0xffff0000, v39
    v_mfma_f32_16x16x32_bf16 v[72:75], a[136:139], v[96:99], v[72:75]
    ds_read_b64_tr_b16 v[120:121], v17 offset:8192
    v_and_b32 v136, 0xffff0000, v40
    v_mfma_f32_16x16x32_bf16 v[72:75], a[152:155], v[100:103], v[72:75]
    v_cvt_pk_bf16_f32 v90, v92, v93
    v_cvt_pk_bf16_f32 v200, v200, v201
    v_mfma_f32_16x16x32_bf16 v[72:75], a[168:171], v[104:107], v[72:75]
    ds_read_b64_tr_b16 v[122:123], v17 offset:8704
    v_cvt_pk_bf16_f32 v201, v202, v203
    v_mfma_f32_16x16x32_bf16 v[72:75], a[184:187], v[108:111], v[72:75]
    v_cvt_pk_bf16_f32 v202, v204, v205
    v_and_b32 v137, 0xffff0000, v41
    v_mfma_f32_16x16x32_bf16 v[76:79], a[140:143], v[96:99], v[76:79]
    ds_read_b64_tr_b16 v[124:125], v17 offset:12288
    v_and_b32 v138, 0xffff0000, v42
    v_mfma_f32_16x16x32_bf16 v[76:79], a[156:159], v[100:103], v[76:79]
    v_cvt_pk_bf16_f32 v91, v94, v95
    v_cvt_pk_bf16_f32 v203, v206, v207
    v_mfma_f32_16x16x32_bf16 v[76:79], a[172:175], v[104:107], v[76:79]
    ds_read_b64_tr_b16 v[126:127], v17 offset:12800
    s_add_u32 s1, s0, 83890176
    v_mfma_f32_16x16x32_bf16 v[76:79], a[188:191], v[108:111], v[76:79]
    buffer_store_dwordx4 v[200:203], v1, s[48:51], s1 offen offset:2048 sc1
    v_and_b32 v139, 0xffff0000, v43
    s_waitcnt lgkmcnt(0)
    v_mfma_f32_16x16x32_bf16 v[64:67], a[192:195], v[112:115], v[64:67]
    ds_read_b64_tr_b16 v[96:97], v18 offset:16384
    v_and_b32 v140, 0xffff0000, v44
    v_mfma_f32_16x16x32_bf16 v[64:67], a[208:211], v[116:119], v[64:67]
    s_add_u32 s28, s0, 104873984
    v_mul_f32 v208, 0x3e0293ee, v208
    v_mfma_f32_16x16x32_bf16 v[64:67], a[224:227], v[120:123], v[64:67]
    ds_read_b64_tr_b16 v[98:99], v18 offset:16896
    v_mul_f32 v209, 0x3e0293ee, v209
    v_mfma_f32_16x16x32_bf16 v[64:67], a[240:243], v[124:127], v[64:67]
    v_mul_f32 v210, 0x3e0293ee, v210
    v_and_b32 v141, 0xffff0000, v45
    v_mfma_f32_16x16x32_bf16 v[68:71], a[196:199], v[112:115], v[68:71]
    ds_read_b64_tr_b16 v[100:101], v18 offset:20480
    v_and_b32 v142, 0xffff0000, v46
    v_mfma_f32_16x16x32_bf16 v[68:71], a[212:215], v[116:119], v[68:71]
    buffer_store_dwordx4 v[88:91], v1, s[48:51], s28 offen offset:1024 sc1
    v_mul_f32 v211, 0x3e0293ee, v211
    v_mfma_f32_16x16x32_bf16 v[68:71], a[228:231], v[120:123], v[68:71]
    ds_read_b64_tr_b16 v[102:103], v18 offset:20992
    v_mul_f32 v212, 0x3e0293ee, v212
    v_mfma_f32_16x16x32_bf16 v[68:71], a[244:247], v[124:127], v[68:71]
    v_mul_f32 v213, 0x3e0293ee, v213
    v_lshlrev_b32 v143, 16, v58
    v_mfma_f32_16x16x32_bf16 v[72:75], a[200:203], v[112:115], v[72:75]
    ds_read_b64_tr_b16 v[104:105], v18 offset:24576
    v_and_b32 v144, 0xffff0000, v58
    v_mfma_f32_16x16x32_bf16 v[72:75], a[216:219], v[116:119], v[72:75]
    v_mul_f32 v214, 0x3e0293ee, v214
    v_lshlrev_b32 v145, 16, v59
    v_mfma_f32_16x16x32_bf16 v[72:75], a[232:235], v[120:123], v[72:75]
    ds_read_b64_tr_b16 v[106:107], v18 offset:25088
    v_mul_f32 v215, 0x3e0293ee, v215
    v_mfma_f32_16x16x32_bf16 v[72:75], a[248:251], v[124:127], v[72:75]
    v_cvt_pk_bf16_f32 v208, v208, v209
    v_and_b32 v146, 0xffff0000, v59
    v_mfma_f32_16x16x32_bf16 v[76:79], a[204:207], v[112:115], v[76:79]
    ds_read_b64_tr_b16 v[108:109], v18 offset:28672
    v_mul_f32 v148, v132, v146
    v_mfma_f32_16x16x32_bf16 v[76:79], a[220:223], v[116:119], v[76:79]
    v_cvt_pk_bf16_f32 v209, v210, v211
    v_mul_f32 v149, v133, v146
    v_mfma_f32_16x16x32_bf16 v[76:79], a[236:239], v[120:123], v[76:79]
    ds_read_b64_tr_b16 v[110:111], v18 offset:29184
    v_cvt_pk_bf16_f32 v210, v212, v213
    v_mfma_f32_16x16x32_bf16 v[76:79], a[252:255], v[124:127], v[76:79]
    v_cvt_pk_bf16_f32 v211, v214, v215
    v_mul_f32 v150, v134, v146
    s_waitcnt lgkmcnt(0)
    v_mfma_f32_16x16x32_bf16 v[80:83], a[0:3], v[96:99], 0
    ds_read_b64_tr_b16 v[112:113], v18 offset:32768
    v_mul_f32 v151, v135, v146
    v_mfma_f32_16x16x32_bf16 v[80:83], a[16:19], v[100:103], v[80:83]
    s_add_u32 s1, s0, 83894272
    v_mul_f32 v152, v136, v146
    v_mfma_f32_16x16x32_bf16 v[80:83], a[32:35], v[104:107], v[80:83]
    ds_read_b64_tr_b16 v[114:115], v18 offset:33280
    buffer_store_dwordx4 v[208:211], v1, s[48:51], s1 offen offset:2048 sc1
    v_mfma_f32_16x16x32_bf16 v[80:83], a[48:51], v[108:111], v[80:83]
    v_mul_f32 v216, 0x3e0293ee, v216
    v_mul_f32 v153, v137, v146
    v_mfma_f32_16x16x32_bf16 v[84:87], a[4:7], v[96:99], 0
    ds_read_b64_tr_b16 v[116:117], v18 offset:36864
    v_mul_f32 v154, v138, v146
    v_mfma_f32_16x16x32_bf16 v[84:87], a[20:23], v[100:103], v[84:87]
    v_mul_f32 v217, 0x3e0293ee, v217
    v_mul_f32 v155, v139, v146
    v_mfma_f32_16x16x32_bf16 v[84:87], a[36:39], v[104:107], v[84:87]
    ds_read_b64_tr_b16 v[118:119], v18 offset:37376
    v_mul_f32 v218, 0x3e0293ee, v218
    v_mfma_f32_16x16x32_bf16 v[84:87], a[52:55], v[108:111], v[84:87]
    v_mul_f32 v219, 0x3e0293ee, v219
    v_fmac_f32 v148, v133, v145
    v_mfma_f32_16x16x32_bf16 v[88:91], a[8:11], v[96:99], 0
    ds_read_b64_tr_b16 v[120:121], v18 offset:40960
    v_fmac_f32 v149, v134, v145
    v_mfma_f32_16x16x32_bf16 v[88:91], a[24:27], v[100:103], v[88:91]
    v_cvt_pk_bf16_f32 v64, v64, v65
    v_mul_f32 v220, 0x3e0293ee, v220
    v_mfma_f32_16x16x32_bf16 v[88:91], a[40:43], v[104:107], v[88:91]
    ds_read_b64_tr_b16 v[122:123], v18 offset:41472
    v_mul_f32 v221, 0x3e0293ee, v221
    v_mfma_f32_16x16x32_bf16 v[88:91], a[56:59], v[108:111], v[88:91]
    v_mul_f32 v222, 0x3e0293ee, v222
    v_fmac_f32 v150, v135, v145
    v_mfma_f32_16x16x32_bf16 v[92:95], a[12:15], v[96:99], 0
    ds_read_b64_tr_b16 v[124:125], v18 offset:45056
    v_fmac_f32 v151, v136, v145
    v_mfma_f32_16x16x32_bf16 v[92:95], a[28:31], v[100:103], v[92:95]
    v_cvt_pk_bf16_f32 v65, v66, v67
    v_mul_f32 v223, 0x3e0293ee, v223
    v_mfma_f32_16x16x32_bf16 v[92:95], a[44:47], v[104:107], v[92:95]
    ds_read_b64_tr_b16 v[126:127], v18 offset:45568
    v_cvt_pk_bf16_f32 v216, v216, v217
    v_mfma_f32_16x16x32_bf16 v[92:95], a[60:63], v[108:111], v[92:95]
    v_cvt_pk_bf16_f32 v217, v218, v219
    v_fmac_f32 v152, v137, v145
    s_waitcnt lgkmcnt(0)
    v_mfma_f32_16x16x32_bf16 v[80:83], a[64:67], v[112:115], v[80:83]
    ds_read_b64_tr_b16 v[96:97], v18 offset:49152
    v_fmac_f32 v153, v138, v145
    v_mfma_f32_16x16x32_bf16 v[80:83], a[80:83], v[116:119], v[80:83]
    v_cvt_pk_bf16_f32 v66, v68, v69
    v_cvt_pk_bf16_f32 v218, v220, v221
    v_mfma_f32_16x16x32_bf16 v[80:83], a[96:99], v[120:123], v[80:83]
    ds_read_b64_tr_b16 v[98:99], v18 offset:49664
    v_cvt_pk_bf16_f32 v219, v222, v223
    v_mfma_f32_16x16x32_bf16 v[80:83], a[112:115], v[124:127], v[80:83]
    s_add_u32 s1, s0, 83898368
    v_fmac_f32 v154, v139, v145
    v_mfma_f32_16x16x32_bf16 v[84:87], a[68:71], v[112:115], v[84:87]
    ds_read_b64_tr_b16 v[100:101], v18 offset:53248
    v_fmac_f32 v155, v140, v145
    v_mfma_f32_16x16x32_bf16 v[84:87], a[84:87], v[116:119], v[84:87]
    v_cvt_pk_bf16_f32 v67, v70, v71
    buffer_store_dwordx4 v[216:219], v1, s[48:51], s1 offen offset:2048 sc1
    v_mfma_f32_16x16x32_bf16 v[84:87], a[100:103], v[120:123], v[84:87]
    ds_read_b64_tr_b16 v[102:103], v18 offset:53760
    v_mul_f32 v224, 0x3e0293ee, v224
    v_mfma_f32_16x16x32_bf16 v[84:87], a[116:119], v[124:127], v[84:87]
    v_mul_f32 v225, 0x3e0293ee, v225
    v_fmac_f32 v148, v134, v144
    v_mfma_f32_16x16x32_bf16 v[88:91], a[72:75], v[112:115], v[88:91]
    ds_read_b64_tr_b16 v[104:105], v18 offset:57344
    v_fmac_f32 v149, v135, v144
    v_mfma_f32_16x16x32_bf16 v[88:91], a[88:91], v[116:119], v[88:91]
    s_add_u32 s28, s0, 104865792
    v_mul_f32 v226, 0x3e0293ee, v226
    v_mfma_f32_16x16x32_bf16 v[88:91], a[104:107], v[120:123], v[88:91]
    ds_read_b64_tr_b16 v[106:107], v18 offset:57856
    v_mul_f32 v227, 0x3e0293ee, v227
    v_mfma_f32_16x16x32_bf16 v[88:91], a[120:123], v[124:127], v[88:91]
    v_mul_f32 v228, 0x3e0293ee, v228
    v_fmac_f32 v150, v136, v144
    v_mfma_f32_16x16x32_bf16 v[92:95], a[76:79], v[112:115], v[92:95]
    ds_read_b64_tr_b16 v[108:109], v18 offset:61440
    v_fmac_f32 v151, v137, v144
    v_mfma_f32_16x16x32_bf16 v[92:95], a[92:95], v[116:119], v[92:95]
    buffer_store_dwordx4 v[64:67], v1, s[48:51], s28 offen offset:2048 sc1
    v_mul_f32 v229, 0x3e0293ee, v229
    v_mfma_f32_16x16x32_bf16 v[92:95], a[108:111], v[120:123], v[92:95]
    ds_read_b64_tr_b16 v[110:111], v18 offset:61952
    v_mul_f32 v230, 0x3e0293ee, v230
    v_mfma_f32_16x16x32_bf16 v[92:95], a[124:127], v[124:127], v[92:95]
    v_mul_f32 v231, 0x3e0293ee, v231
    v_fmac_f32 v152, v138, v144
    s_waitcnt lgkmcnt(0)
    v_mfma_f32_16x16x32_bf16 v[80:83], a[128:131], v[96:99], v[80:83]
    ds_read_b64_tr_b16 v[112:113], v18 offset:0
    v_fmac_f32 v153, v139, v144
    v_mfma_f32_16x16x32_bf16 v[80:83], a[144:147], v[100:103], v[80:83]
    v_cvt_pk_bf16_f32 v72, v72, v73
    v_cvt_pk_bf16_f32 v224, v224, v225
    v_mfma_f32_16x16x32_bf16 v[80:83], a[160:163], v[104:107], v[80:83]
    ds_read_b64_tr_b16 v[114:115], v18 offset:512
    v_cvt_pk_bf16_f32 v225, v226, v227
    v_mfma_f32_16x16x32_bf16 v[80:83], a[176:179], v[108:111], v[80:83]
    v_cvt_pk_bf16_f32 v226, v228, v229
    v_fmac_f32 v154, v140, v144
    v_mfma_f32_16x16x32_bf16 v[84:87], a[132:135], v[96:99], v[84:87]
    ds_read_b64_tr_b16 v[116:117], v18 offset:4096
    v_fmac_f32 v155, v141, v144
    v_mfma_f32_16x16x32_bf16 v[84:87], a[148:151], v[100:103], v[84:87]
    v_cvt_pk_bf16_f32 v73, v74, v75
    v_cvt_pk_bf16_f32 v227, v230, v231
    v_mfma_f32_16x16x32_bf16 v[84:87], a[164:167], v[104:107], v[84:87]
    ds_read_b64_tr_b16 v[118:119], v18 offset:4608
    s_add_u32 s1, s0, 83886080
    v_mfma_f32_16x16x32_bf16 v[84:87], a[180:183], v[108:111], v[84:87]
    buffer_store_dwordx4 v[224:227], v1, s[48:51], s1 offen offset:3072 sc1
    v_fmac_f32 v148, v135, v143
    v_mfma_f32_16x16x32_bf16 v[88:91], a[136:139], v[96:99], v[88:91]
    ds_read_b64_tr_b16 v[120:121], v18 offset:8192
    v_fmac_f32 v149, v136, v143
    v_mfma_f32_16x16x32_bf16 v[88:91], a[152:155], v[100:103], v[88:91]
    v_cvt_pk_bf16_f32 v74, v76, v77
    v_mul_f32 v232, 0x3e0293ee, v232
    v_mfma_f32_16x16x32_bf16 v[88:91], a[168:171], v[104:107], v[88:91]
    ds_read_b64_tr_b16 v[122:123], v18 offset:8704
    v_mul_f32 v233, 0x3e0293ee, v233
    v_mfma_f32_16x16x32_bf16 v[88:91], a[184:187], v[108:111], v[88:91]
    v_mul_f32 v234, 0x3e0293ee, v234
    v_fmac_f32 v150, v137, v143
    v_mfma_f32_16x16x32_bf16 v[92:95], a[140:143], v[96:99], v[92:95]
    ds_read_b64_tr_b16 v[124:125], v18 offset:12288
    v_fmac_f32 v151, v138, v143
    v_mfma_f32_16x16x32_bf16 v[92:95], a[156:159], v[100:103], v[92:95]
    v_cvt_pk_bf16_f32 v75, v78, v79
    v_mul_f32 v235, 0x3e0293ee, v235
    v_mfma_f32_16x16x32_bf16 v[92:95], a[172:175], v[104:107], v[92:95]
    ds_read_b64_tr_b16 v[126:127], v18 offset:12800
    v_mul_f32 v236, 0x3e0293ee, v236
    v_mfma_f32_16x16x32_bf16 v[92:95], a[188:191], v[108:111], v[92:95]
    v_mul_f32 v237, 0x3e0293ee, v237
    v_fmac_f32 v152, v139, v143
    s_waitcnt vmcnt(19) lgkmcnt(0)
    v_mfma_f32_16x16x32_bf16 v[80:83], a[192:195], v[112:115], v[80:83]
    s_barrier
    ds_read_b64_tr_b16 v[96:97], v11 offset:0
    v_fmac_f32 v153, v140, v143
    v_mfma_f32_16x16x32_bf16 v[80:83], a[208:211], v[116:119], v[80:83]
    s_add_u32 s28, s0, 104873984
    v_mul_f32 v238, 0x3e0293ee, v238
    v_mfma_f32_16x16x32_bf16 v[80:83], a[224:227], v[120:123], v[80:83]
    ds_read_b64_tr_b16 v[98:99], v11 offset:512
    v_mul_f32 v239, 0x3e0293ee, v239
    v_mfma_f32_16x16x32_bf16 v[80:83], a[240:243], v[124:127], v[80:83]
    v_cvt_pk_bf16_f32 v232, v232, v233
    v_fmac_f32 v154, v141, v143
    v_mfma_f32_16x16x32_bf16 v[84:87], a[196:199], v[112:115], v[84:87]
    ds_read_b64_tr_b16 v[100:101], v11 offset:4096
    v_fmac_f32 v155, v142, v143
    v_mfma_f32_16x16x32_bf16 v[84:87], a[212:215], v[116:119], v[84:87]
    buffer_store_dwordx4 v[72:75], v1, s[48:51], s28 offen offset:2048 sc1
    v_cvt_pk_bf16_f32 v233, v234, v235
    v_mfma_f32_16x16x32_bf16 v[84:87], a[228:231], v[120:123], v[84:87]
    ds_read_b64_tr_b16 v[102:103], v11 offset:4608
    v_cvt_pk_bf16_f32 v234, v236, v237
    v_mfma_f32_16x16x32_bf16 v[84:87], a[244:247], v[124:127], v[84:87]
    v_cvt_pk_bf16_f32 v235, v238, v239
    v_and_b32 v132, 0xffff0000, v47
    v_mfma_f32_16x16x32_bf16 v[88:91], a[200:203], v[112:115], v[88:91]
    ds_read_b64_tr_b16 v[104:105], v11 offset:8192
    v_and_b32 v133, 0xffff0000, v48
    v_mfma_f32_16x16x32_bf16 v[88:91], a[216:219], v[116:119], v[88:91]
    s_add_u32 s1, s0, 83890176
    v_and_b32 v134, 0xffff0000, v49
    v_mfma_f32_16x16x32_bf16 v[88:91], a[232:235], v[120:123], v[88:91]
    ds_read_b64_tr_b16 v[106:107], v11 offset:8704
    buffer_store_dwordx4 v[232:235], v1, s[48:51], s1 offen offset:3072 sc1
    v_mfma_f32_16x16x32_bf16 v[88:91], a[248:251], v[124:127], v[88:91]
    v_mul_f32 v240, 0x3e0293ee, v240
    v_and_b32 v135, 0xffff0000, v50
    v_mfma_f32_16x16x32_bf16 v[92:95], a[204:207], v[112:115], v[92:95]
    ds_read_b64_tr_b16 v[108:109], v11 offset:12288
    v_and_b32 v136, 0xffff0000, v51
    v_mfma_f32_16x16x32_bf16 v[92:95], a[220:223], v[116:119], v[92:95]
    v_mul_f32 v241, 0x3e0293ee, v241
    v_and_b32 v137, 0xffff0000, v52
    v_mfma_f32_16x16x32_bf16 v[92:95], a[236:239], v[120:123], v[92:95]
    ds_read_b64_tr_b16 v[110:111], v11 offset:12800
    v_mul_f32 v242, 0x3e0293ee, v242
    v_mfma_f32_16x16x32_bf16 v[92:95], a[252:255], v[124:127], v[92:95]
    v_mul_f32 v243, 0x3e0293ee, v243
    v_and_b32 v138, 0xffff0000, v53
    s_waitcnt lgkmcnt(0)
    v_mfma_f32_16x16x32_bf16 v[64:67], a[0:3], v[96:99], 0
    ds_read_b64_tr_b16 v[112:113], v11 offset:16384
    v_and_b32 v139, 0xffff0000, v54
    v_mfma_f32_16x16x32_bf16 v[64:67], a[16:19], v[100:103], v[64:67]
    v_mul_f32 v244, 0x3e0293ee, v244
    v_mul_f32 v148, v148, v132
    v_mfma_f32_16x16x32_bf16 v[64:67], a[32:35], v[104:107], v[64:67]
    ds_read_b64_tr_b16 v[114:115], v11 offset:16896
    v_mul_f32 v245, 0x3e0293ee, v245
    v_mfma_f32_16x16x32_bf16 v[64:67], a[48:51], v[108:111], v[64:67]
    v_mul_f32 v246, 0x3e0293ee, v246
    v_mul_f32 v149, v149, v133
    v_mfma_f32_16x16x32_bf16 v[68:71], a[4:7], v[96:99], 0
    ds_read_b64_tr_b16 v[116:117], v11 offset:20480
    v_mul_f32 v150, v150, v134
    v_mfma_f32_16x16x32_bf16 v[68:71], a[20:23], v[100:103], v[68:71]
    v_mul_f32 v247, 0x3e0293ee, v247
    v_mul_f32 v151, v151, v135
    v_mfma_f32_16x16x32_bf16 v[68:71], a[36:39], v[104:107], v[68:71]
    ds_read_b64_tr_b16 v[118:119], v11 offset:20992
    v_cvt_pk_bf16_f32 v240, v240, v241
    v_mfma_f32_16x16x32_bf16 v[68:71], a[52:55], v[108:111], v[68:71]
    v_cvt_pk_bf16_f32 v241, v242, v243
    v_mul_f32 v152, v152, v136
    v_mfma_f32_16x16x32_bf16 v[72:75], a[8:11], v[96:99], 0
    ds_read_b64_tr_b16 v[120:121], v11 offset:24576
    v_mul_f32 v153, v153, v137
    v_mfma_f32_16x16x32_bf16 v[72:75], a[24:27], v[100:103], v[72:75]
    v_cvt_pk_bf16_f32 v80, v80, v81
    v_cvt_pk_bf16_f32 v242, v244, v245
    v_mfma_f32_16x16x32_bf16 v[72:75], a[40:43], v[104:107], v[72:75]
    ds_read_b64_tr_b16 v[122:123], v11 offset:25088
    v_cvt_pk_bf16_f32 v243, v246, v247
    v_mfma_f32_16x16x32_bf16 v[72:75], a[56:59], v[108:111], v[72:75]
    s_add_u32 s1, s0, 83894272
    v_mul_f32 v154, v154, v138
    v_mfma_f32_16x16x32_bf16 v[76:79], a[12:15], v[96:99], 0
    ds_read_b64_tr_b16 v[124:125], v11 offset:28672
    v_mul_f32 v155, v155, v139
    v_mfma_f32_16x16x32_bf16 v[76:79], a[28:31], v[100:103], v[76:79]
    v_cvt_pk_bf16_f32 v81, v82, v83
    buffer_store_dwordx4 v[240:243], v1, s[48:51], s1 offen offset:3072 sc1
    v_mfma_f32_16x16x32_bf16 v[76:79], a[44:47], v[104:107], v[76:79]
    ds_read_b64_tr_b16 v[126:127], v11 offset:29184
    v_mul_f32 v248, 0x3e0293ee, v248
    v_mfma_f32_16x16x32_bf16 v[76:79], a[60:63], v[108:111], v[76:79]
    v_mul_f32 v249, 0x3e0293ee, v249
    v_cvt_pk_bf16_f32 v156, v155, v154
    s_waitcnt lgkmcnt(0)
    v_mfma_f32_16x16x32_bf16 v[64:67], a[64:67], v[112:115], v[64:67]
    ds_read_b64_tr_b16 v[96:97], v11 offset:32768
    v_cvt_pk_bf16_f32 v157, v153, v152
    v_mfma_f32_16x16x32_bf16 v[64:67], a[80:83], v[116:119], v[64:67]
    v_cvt_pk_bf16_f32 v82, v84, v85
    v_mul_f32 v250, 0x3e0293ee, v250
    v_mfma_f32_16x16x32_bf16 v[64:67], a[96:99], v[120:123], v[64:67]
    ds_read_b64_tr_b16 v[98:99], v11 offset:33280
    v_mul_f32 v251, 0x3e0293ee, v251
    v_mfma_f32_16x16x32_bf16 v[64:67], a[112:115], v[124:127], v[64:67]
    v_mul_f32 v252, 0x3e0293ee, v252
    v_cvt_pk_bf16_f32 v158, v151, v150
    v_mfma_f32_16x16x32_bf16 v[68:71], a[68:71], v[112:115], v[68:71]
    ds_read_b64_tr_b16 v[100:101], v11 offset:36864
    v_cvt_pk_bf16_f32 v159, v149, v148
    v_mfma_f32_16x16x32_bf16 v[68:71], a[84:87], v[116:119], v[68:71]
    v_cvt_pk_bf16_f32 v83, v86, v87
    v_mul_f32 v253, 0x3e0293ee, v253
    v_mfma_f32_16x16x32_bf16 v[68:71], a[100:103], v[120:123], v[68:71]
    ds_read_b64_tr_b16 v[102:103], v11 offset:37376
    v_mul_f32 v254, 0x3e0293ee, v254
    v_mfma_f32_16x16x32_bf16 v[68:71], a[116:119], v[124:127], v[68:71]
    v_mul_f32 v255, 0x3e0293ee, v255
    ds_write_b128 v23, v[156:159] offset:128
    v_mfma_f32_16x16x32_bf16 v[72:75], a[72:75], v[112:115], v[72:75]
    ds_read_b64_tr_b16 v[104:105], v11 offset:40960
    s_lshl_b32 s10, s3, 11
    v_mfma_f32_16x16x32_bf16 v[72:75], a[88:91], v[116:119], v[72:75]
    s_add_u32 s28, s0, 104865792
    v_cvt_pk_bf16_f32 v248, v248, v249
    v_mfma_f32_16x16x32_bf16 v[72:75], a[104:107], v[120:123], v[72:75]
    ds_read_b64_tr_b16 v[106:107], v11 offset:41472
    v_cvt_pk_bf16_f32 v249, v250, v251
    v_mfma_f32_16x16x32_bf16 v[72:75], a[120:123], v[124:127], v[72:75]
    v_cvt_pk_bf16_f32 v250, v252, v253
    s_add_u32 s10, s10, 0
    v_mfma_f32_16x16x32_bf16 v[76:79], a[76:79], v[112:115], v[76:79]
    ds_read_b64_tr_b16 v[108:109], v11 offset:45056
    v_add_u32 v30, s10, v1
    v_mfma_f32_16x16x32_bf16 v[76:79], a[92:95], v[116:119], v[76:79]
    buffer_store_dwordx4 v[80:83], v1, s[48:51], s28 offen offset:3072 sc1
    v_cvt_pk_bf16_f32 v251, v254, v255
    v_mfma_f32_16x16x32_bf16 v[76:79], a[108:111], v[120:123], v[76:79]
    ds_read_b64_tr_b16 v[110:111], v11 offset:45568
    s_add_u32 s1, s0, 83898368
    v_mfma_f32_16x16x32_bf16 v[76:79], a[124:127], v[124:127], v[76:79]
    buffer_store_dwordx4 v[248:251], v1, s[48:51], s1 offen offset:3072 sc1
    v_lshlrev_b32 v31, 2, v0
    s_waitcnt lgkmcnt(0)
    v_mfma_f32_16x16x32_bf16 v[64:67], a[128:131], v[96:99], v[64:67]
    ds_read_b64_tr_b16 v[112:113], v11 offset:49152
    v_add_u32 v32, 8192, v31
    v_mfma_f32_16x16x32_bf16 v[64:67], a[144:147], v[100:103], v[64:67]
    v_cvt_pk_bf16_f32 v88, v88, v89
    v_add_u32 v33, 32768, v24
    v_mfma_f32_16x16x32_bf16 v[64:67], a[160:163], v[104:107], v[64:67]
    ds_read_b64_tr_b16 v[114:115], v11 offset:49664
    s_lshl_b32 s6, s2, 7
    v_mfma_f32_16x16x32_bf16 v[64:67], a[176:179], v[108:111], v[64:67]
    s_add_u32 s6, s6, 75497472
    s_lshl_b32 s10, s3, 30
    v_mfma_f32_16x16x32_bf16 v[68:71], a[132:135], v[96:99], v[68:71]
    ds_read_b64_tr_b16 v[116:117], v11 offset:53248
    s_add_u32 s6, s6, s10
    v_mfma_f32_16x16x32_bf16 v[68:71], a[148:151], v[100:103], v[68:71]
    v_cvt_pk_bf16_f32 v89, v90, v91
    v_and_b32 v31, 127, v31
    v_mfma_f32_16x16x32_bf16 v[68:71], a[164:167], v[104:107], v[68:71]
    ds_read_b64_tr_b16 v[118:119], v11 offset:53760
    v_mfma_f32_16x16x32_bf16 v[68:71], a[180:183], v[108:111], v[68:71]
    v_mfma_f32_16x16x32_bf16 v[72:75], a[136:139], v[96:99], v[72:75]
    ds_read_b64_tr_b16 v[120:121], v11 offset:57344
    v_mfma_f32_16x16x32_bf16 v[72:75], a[152:155], v[100:103], v[72:75]
    v_cvt_pk_bf16_f32 v90, v92, v93
    v_mfma_f32_16x16x32_bf16 v[72:75], a[168:171], v[104:107], v[72:75]
    ds_read_b64_tr_b16 v[122:123], v11 offset:57856
    v_mfma_f32_16x16x32_bf16 v[72:75], a[184:187], v[108:111], v[72:75]
    v_mfma_f32_16x16x32_bf16 v[76:79], a[140:143], v[96:99], v[76:79]
    ds_read_b64_tr_b16 v[124:125], v11 offset:61440
    v_mfma_f32_16x16x32_bf16 v[76:79], a[156:159], v[100:103], v[76:79]
    v_cvt_pk_bf16_f32 v91, v94, v95
    v_mfma_f32_16x16x32_bf16 v[76:79], a[172:175], v[104:107], v[76:79]
    ds_read_b64_tr_b16 v[126:127], v11 offset:61952
    v_mfma_f32_16x16x32_bf16 v[76:79], a[188:191], v[108:111], v[76:79]
    s_waitcnt lgkmcnt(0)
    v_mfma_f32_16x16x32_bf16 v[64:67], a[192:195], v[112:115], v[64:67]
    ds_read_b64_tr_b16 v[96:97], v12 offset:0
    v_mfma_f32_16x16x32_bf16 v[64:67], a[208:211], v[116:119], v[64:67]
    s_add_u32 s28, s0, 104873984
    v_mfma_f32_16x16x32_bf16 v[64:67], a[224:227], v[120:123], v[64:67]
    ds_read_b64_tr_b16 v[98:99], v12 offset:512
    v_mfma_f32_16x16x32_bf16 v[64:67], a[240:243], v[124:127], v[64:67]
    v_mfma_f32_16x16x32_bf16 v[68:71], a[196:199], v[112:115], v[68:71]
    ds_read_b64_tr_b16 v[100:101], v12 offset:4096
    v_mfma_f32_16x16x32_bf16 v[68:71], a[212:215], v[116:119], v[68:71]
    buffer_store_dwordx4 v[88:91], v1, s[48:51], s28 offen offset:3072 sc1
    v_mfma_f32_16x16x32_bf16 v[68:71], a[228:231], v[120:123], v[68:71]
    ds_read_b64_tr_b16 v[102:103], v12 offset:4608
    v_mfma_f32_16x16x32_bf16 v[68:71], a[244:247], v[124:127], v[68:71]
    v_mfma_f32_16x16x32_bf16 v[72:75], a[200:203], v[112:115], v[72:75]
    ds_read_b64_tr_b16 v[104:105], v12 offset:8192
    v_mfma_f32_16x16x32_bf16 v[72:75], a[216:219], v[116:119], v[72:75]
    v_mfma_f32_16x16x32_bf16 v[72:75], a[232:235], v[120:123], v[72:75]
    ds_read_b64_tr_b16 v[106:107], v12 offset:8704
    v_mfma_f32_16x16x32_bf16 v[72:75], a[248:251], v[124:127], v[72:75]
    v_mfma_f32_16x16x32_bf16 v[76:79], a[204:207], v[112:115], v[76:79]
    ds_read_b64_tr_b16 v[108:109], v12 offset:12288
    v_mfma_f32_16x16x32_bf16 v[76:79], a[220:223], v[116:119], v[76:79]
    v_mfma_f32_16x16x32_bf16 v[76:79], a[236:239], v[120:123], v[76:79]
    ds_read_b64_tr_b16 v[110:111], v12 offset:12800
    v_mfma_f32_16x16x32_bf16 v[76:79], a[252:255], v[124:127], v[76:79]
    s_waitcnt lgkmcnt(0)
    v_mfma_f32_16x16x32_bf16 v[80:83], a[0:3], v[96:99], 0
    s_barrier
    ds_read_b64_tr_b16 v[112:113], v12 offset:16384
    ds_read_b128 v[144:147], v30
    v_mfma_f32_16x16x32_bf16 v[80:83], a[16:19], v[100:103], v[80:83]
    ds_read_b128 v[148:151], v30 offset:1024
    ds_read_b32 v152, v32
    v_mfma_f32_16x16x32_bf16 v[80:83], a[32:35], v[104:107], v[80:83]
    ds_read_b64_tr_b16 v[114:115], v12 offset:16896
    v_mfma_f32_16x16x32_bf16 v[80:83], a[48:51], v[108:111], v[80:83]
    v_mfma_f32_16x16x32_bf16 v[84:87], a[4:7], v[96:99], 0
    ds_read_b64_tr_b16 v[116:117], v12 offset:20480
    v_mfma_f32_16x16x32_bf16 v[84:87], a[20:23], v[100:103], v[84:87]
    v_mfma_f32_16x16x32_bf16 v[84:87], a[36:39], v[104:107], v[84:87]
    ds_read_b64_tr_b16 v[118:119], v12 offset:20992
    v_mfma_f32_16x16x32_bf16 v[84:87], a[52:55], v[108:111], v[84:87]
    s_waitcnt lgkmcnt(3)
    v_mfma_f32_16x16x32_bf16 v[88:91], a[8:11], v[96:99], 0
    ds_read_b64_tr_b16 v[120:121], v12 offset:24576
    buffer_store_dwordx4 v[144:147], v24, s[48:51], 0 offen sc1
    v_mfma_f32_16x16x32_bf16 v[88:91], a[24:27], v[100:103], v[88:91]
    v_cvt_pk_bf16_f32 v64, v64, v65
    buffer_store_dwordx4 v[148:151], v33, s[48:51], 0 offen sc1
    v_mfma_f32_16x16x32_bf16 v[88:91], a[40:43], v[104:107], v[88:91]
    ds_read_b64_tr_b16 v[122:123], v12 offset:25088
    s_mov_b32 exec_hi, 0
    buffer_store_dword v152, v31, s[48:51], s6 offen sc1
    s_mov_b32 exec_hi, -1
    v_mfma_f32_16x16x32_bf16 v[88:91], a[56:59], v[108:111], v[88:91]
    v_mfma_f32_16x16x32_bf16 v[92:95], a[12:15], v[96:99], 0
    ds_read_b64_tr_b16 v[124:125], v12 offset:28672
    v_mfma_f32_16x16x32_bf16 v[92:95], a[28:31], v[100:103], v[92:95]
    v_cvt_pk_bf16_f32 v65, v66, v67
    v_mfma_f32_16x16x32_bf16 v[92:95], a[44:47], v[104:107], v[92:95]
    ds_read_b64_tr_b16 v[126:127], v12 offset:29184
    v_mfma_f32_16x16x32_bf16 v[92:95], a[60:63], v[108:111], v[92:95]
    s_waitcnt lgkmcnt(0)
    v_mfma_f32_16x16x32_bf16 v[80:83], a[64:67], v[112:115], v[80:83]
    ds_read_b64_tr_b16 v[96:97], v12 offset:32768
    v_mfma_f32_16x16x32_bf16 v[80:83], a[80:83], v[116:119], v[80:83]
    v_cvt_pk_bf16_f32 v66, v68, v69
    v_mfma_f32_16x16x32_bf16 v[80:83], a[96:99], v[120:123], v[80:83]
    ds_read_b64_tr_b16 v[98:99], v12 offset:33280
    v_mfma_f32_16x16x32_bf16 v[80:83], a[112:115], v[124:127], v[80:83]
    v_mfma_f32_16x16x32_bf16 v[84:87], a[68:71], v[112:115], v[84:87]
    ds_read_b64_tr_b16 v[100:101], v12 offset:36864
    v_mfma_f32_16x16x32_bf16 v[84:87], a[84:87], v[116:119], v[84:87]
    v_cvt_pk_bf16_f32 v67, v70, v71
    v_mfma_f32_16x16x32_bf16 v[84:87], a[100:103], v[120:123], v[84:87]
    ds_read_b64_tr_b16 v[102:103], v12 offset:37376
    v_mfma_f32_16x16x32_bf16 v[84:87], a[116:119], v[124:127], v[84:87]
    v_mfma_f32_16x16x32_bf16 v[88:91], a[72:75], v[112:115], v[88:91]
    ds_read_b64_tr_b16 v[104:105], v12 offset:40960
    v_mfma_f32_16x16x32_bf16 v[88:91], a[88:91], v[116:119], v[88:91]
    s_add_u32 s28, s0, 104869888
    v_mfma_f32_16x16x32_bf16 v[88:91], a[104:107], v[120:123], v[88:91]
    ds_read_b64_tr_b16 v[106:107], v12 offset:41472
    v_mfma_f32_16x16x32_bf16 v[88:91], a[120:123], v[124:127], v[88:91]
    v_mfma_f32_16x16x32_bf16 v[92:95], a[76:79], v[112:115], v[92:95]
    ds_read_b64_tr_b16 v[108:109], v12 offset:45056
    v_mfma_f32_16x16x32_bf16 v[92:95], a[92:95], v[116:119], v[92:95]
    buffer_store_dwordx4 v[64:67], v1, s[48:51], s28 offen offset:0 sc1
    v_mfma_f32_16x16x32_bf16 v[92:95], a[108:111], v[120:123], v[92:95]
    ds_read_b64_tr_b16 v[110:111], v12 offset:45568
    v_mfma_f32_16x16x32_bf16 v[92:95], a[124:127], v[124:127], v[92:95]
    s_waitcnt lgkmcnt(0)
    s_waitcnt vmcnt(28)
    v_mfma_f32_16x16x32_bf16 v[80:83], a[128:131], v[96:99], v[80:83]
    ds_read_b64_tr_b16 v[112:113], v12 offset:49152
    s_lshl_b32 s72, s7, 3
    v_mfma_f32_16x16x32_bf16 v[80:83], a[144:147], v[100:103], v[80:83]
    v_cvt_pk_bf16_f32 v72, v72, v73
    v_lshrrev_b32 v31, 4, v0
    v_mfma_f32_16x16x32_bf16 v[80:83], a[160:163], v[104:107], v[80:83]
    ds_read_b64_tr_b16 v[114:115], v12 offset:49664
    v_lshrrev_b32 v30, 3, v0
    v_mfma_f32_16x16x32_bf16 v[80:83], a[176:179], v[108:111], v[80:83]
    v_lshlrev_b32 v30, 10, v30
    v_and_b32 v32, 7, v0
    v_mfma_f32_16x16x32_bf16 v[84:87], a[132:135], v[96:99], v[84:87]
    ds_read_b64_tr_b16 v[116:117], v12 offset:53248
    v_xor_b32 v32, v32, v31
    v_mfma_f32_16x16x32_bf16 v[84:87], a[148:151], v[100:103], v[84:87]
    v_cvt_pk_bf16_f32 v73, v74, v75
    v_lshl_add_u32 v16, v32, 4, v30
    v_mfma_f32_16x16x32_bf16 v[84:87], a[164:167], v[104:107], v[84:87]
    ds_read_b64_tr_b16 v[118:119], v12 offset:53760
    v_xor_b32 v32, 4, v32
    v_mfma_f32_16x16x32_bf16 v[84:87], a[180:183], v[108:111], v[84:87]
    v_lshl_add_u32 v17, v32, 4, v30
    v_add_u32 v17, 7168, v17
    v_mfma_f32_16x16x32_bf16 v[88:91], a[136:139], v[96:99], v[88:91]
    ds_read_b64_tr_b16 v[120:121], v12 offset:57344
    v_lshrrev_b32 v30, 3, v0
    v_mfma_f32_16x16x32_bf16 v[88:91], a[152:155], v[100:103], v[88:91]
    v_cvt_pk_bf16_f32 v74, v76, v77
    v_lshlrev_b32 v30, 13, v30
    v_mfma_f32_16x16x32_bf16 v[88:91], a[168:171], v[104:107], v[88:91]
    ds_read_b64_tr_b16 v[122:123], v12 offset:57856
    v_and_b32 v33, 1, v0
    v_mfma_f32_16x16x32_bf16 v[88:91], a[184:187], v[108:111], v[88:91]
    v_lshl_add_u32 v30, v33, 4, v30
    v_bfe_u32 v33, v0, 1, 2
    v_mfma_f32_16x16x32_bf16 v[92:95], a[140:143], v[96:99], v[92:95]
    ds_read_b64_tr_b16 v[124:125], v12 offset:61440
    v_and_b32 v34, 1, v31
    v_mfma_f32_16x16x32_bf16 v[92:95], a[156:159], v[100:103], v[92:95]
    v_cvt_pk_bf16_f32 v75, v78, v79
    v_xor_b32 v33, v33, v34
    v_mfma_f32_16x16x32_bf16 v[92:95], a[172:175], v[104:107], v[92:95]
    ds_read_b64_tr_b16 v[126:127], v12 offset:61952
    v_lshl_add_u32 v20, v33, 5, v30
    v_mfma_f32_16x16x32_bf16 v[92:95], a[188:191], v[108:111], v[92:95]
    v_xor_b32 v33, 2, v33
    v_lshl_add_u32 v21, v33, 5, v30
    s_waitcnt lgkmcnt(0)
    v_mfma_f32_16x16x32_bf16 v[80:83], a[192:195], v[112:115], v[80:83]
    ds_read_b64_tr_b16 v[96:97], v13 offset:0
    v_add_u32 v21, 64512, v21
    v_mfma_f32_16x16x32_bf16 v[80:83], a[208:211], v[116:119], v[80:83]
    s_add_u32 s28, s0, 104878080
    v_add_u32 v22, 129024, v20
    v_mfma_f32_16x16x32_bf16 v[80:83], a[224:227], v[120:123], v[80:83]
    ds_read_b64_tr_b16 v[98:99], v13 offset:512
    v_add_u32 v23, 129024, v21
    v_mfma_f32_16x16x32_bf16 v[80:83], a[240:243], v[124:127], v[80:83]
    s_and_b32 s4, s2, 7
    s_lshl_b32 s4, s4, 2
    v_mfma_f32_16x16x32_bf16 v[84:87], a[196:199], v[112:115], v[84:87]
    ds_read_b64_tr_b16 v[100:101], v13 offset:4096
    s_bfe_u32 s5, s2, 0x20003
    v_mfma_f32_16x16x32_bf16 v[84:87], a[212:215], v[116:119], v[84:87]
    buffer_store_dwordx4 v[72:75], v1, s[48:51], s28 offen offset:0 sc1
    s_add_u32 s4, s4, s5
    v_mfma_f32_16x16x32_bf16 v[84:87], a[228:231], v[120:123], v[84:87]
    ds_read_b64_tr_b16 v[102:103], v13 offset:4608
    s_lshr_b32 s5, s2, 5
    v_mfma_f32_16x16x32_bf16 v[84:87], a[244:247], v[124:127], v[84:87]
    s_sub_u32 s7, 15, s5
    s_lshl_b32 s7, s7, 3
    v_mfma_f32_16x16x32_bf16 v[88:91], a[200:203], v[112:115], v[88:91]
    ds_read_b64_tr_b16 v[104:105], v13 offset:8192
    s_lshl_b32 s8, s5, 3
    v_mfma_f32_16x16x32_bf16 v[88:91], a[216:219], v[116:119], v[88:91]
    s_sub_u32 s9, 7, s3
    s_add_u32 s10, s7, s3
    v_mfma_f32_16x16x32_bf16 v[88:91], a[232:235], v[120:123], v[88:91]
    ds_read_b64_tr_b16 v[106:107], v13 offset:8704
    s_add_u32 s11, s7, s9
    v_mfma_f32_16x16x32_bf16 v[88:91], a[248:251], v[124:127], v[88:91]
    s_add_u32 s12, s8, s3
    s_add_u32 s13, s8, s9
    v_mfma_f32_16x16x32_bf16 v[92:95], a[204:207], v[112:115], v[92:95]
    ds_read_b64_tr_b16 v[108:109], v13 offset:12288
    s_lshl_b32 s59, s3, 12
    v_mfma_f32_16x16x32_bf16 v[92:95], a[220:223], v[116:119], v[92:95]
    s_lshr_b32 s64, s3, 1
    s_lshl_b32 s64, s64, 18
    v_mfma_f32_16x16x32_bf16 v[92:95], a[236:239], v[120:123], v[92:95]
    ds_read_b64_tr_b16 v[110:111], v13 offset:12800
    s_and_b32 s14, s3, 1
    v_mfma_f32_16x16x32_bf16 v[92:95], a[252:255], v[124:127], v[92:95]
    s_lshl_b32 s14, s14, 7
    s_add_u32 s64, s64, s14
    s_waitcnt lgkmcnt(0)
    v_mfma_f32_16x16x32_bf16 v[64:67], a[0:3], v[96:99], 0
    ds_read_b64_tr_b16 v[112:113], v13 offset:16384
    s_lshl_b32 s14, s4, 8
    v_mfma_f32_16x16x32_bf16 v[64:67], a[16:19], v[100:103], v[64:67]
    s_add_u32 s64, s64, s14
    s_lshl_b32 s14, s11, 14
    v_mfma_f32_16x16x32_bf16 v[64:67], a[32:35], v[104:107], v[64:67]
    ds_read_b64_tr_b16 v[114:115], v13 offset:16896
    s_sub_u32 s14, s14, 2048
    v_mfma_f32_16x16x32_bf16 v[64:67], a[48:51], v[108:111], v[64:67]
    v_add_u32 v62, s14, v16
    v_add_u32 v63, s14, v17
    v_mfma_f32_16x16x32_bf16 v[68:71], a[4:7], v[96:99], 0
    ds_read_b64_tr_b16 v[116:117], v13 offset:20480
    s_lshl_b32 s14, s10, 14
    v_mfma_f32_16x16x32_bf16 v[68:71], a[20:23], v[100:103], v[68:71]
    v_add_u32 v60, s14, v16
    v_add_u32 v61, s14, v17
    v_mfma_f32_16x16x32_bf16 v[68:71], a[36:39], v[104:107], v[68:71]
    ds_read_b64_tr_b16 v[118:119], v13 offset:20992
    s_lshl_b32 s14, s13, 14
    v_mfma_f32_16x16x32_bf16 v[68:71], a[52:55], v[108:111], v[68:71]
    s_sub_u32 s14, s14, 2048
    v_add_u32 v58, s14, v16
    v_mfma_f32_16x16x32_bf16 v[72:75], a[8:11], v[96:99], 0
    ds_read_b64_tr_b16 v[120:121], v13 offset:24576
    v_add_u32 v59, s14, v17
    v_mfma_f32_16x16x32_bf16 v[72:75], a[24:27], v[100:103], v[72:75]
    v_cvt_pk_bf16_f32 v80, v80, v81
    s_lshl_b32 s14, s12, 14
    v_mfma_f32_16x16x32_bf16 v[72:75], a[40:43], v[104:107], v[72:75]
    ds_read_b64_tr_b16 v[122:123], v13 offset:25088
    v_add_u32 v56, s14, v16
    v_mfma_f32_16x16x32_bf16 v[72:75], a[56:59], v[108:111], v[72:75]
    v_add_u32 v57, s14, v17
    s_mov_b32 s88, s32
    v_mfma_f32_16x16x32_bf16 v[76:79], a[12:15], v[96:99], 0
    ds_read_b64_tr_b16 v[124:125], v13 offset:28672
    s_mov_b32 s89, s33
    v_mfma_f32_16x16x32_bf16 v[76:79], a[28:31], v[100:103], v[76:79]
    v_cvt_pk_bf16_f32 v81, v82, v83
    s_mov_b32 s90, 4194304
    v_mfma_f32_16x16x32_bf16 v[76:79], a[44:47], v[104:107], v[76:79]
    ds_read_b64_tr_b16 v[126:127], v13 offset:29184
    s_mov_b32 s91, 0x00020000
    v_mfma_f32_16x16x32_bf16 v[76:79], a[60:63], v[108:111], v[76:79]
    s_mov_b32 s84, s16
    s_mov_b32 s85, s17
    s_waitcnt lgkmcnt(0)
    v_mfma_f32_16x16x32_bf16 v[64:67], a[64:67], v[112:115], v[64:67]
    ds_read_b64_tr_b16 v[96:97], v13 offset:32768
    s_mov_b32 s86, 2097152
    v_mfma_f32_16x16x32_bf16 v[64:67], a[80:83], v[116:119], v[64:67]
    v_cvt_pk_bf16_f32 v82, v84, v85
    s_mov_b32 s87, 0x00020000
    v_mfma_f32_16x16x32_bf16 v[64:67], a[96:99], v[120:123], v[64:67]
    ds_read_b64_tr_b16 v[98:99], v13 offset:33280
    v_and_b32 v33, 15, v0
    v_mfma_f32_16x16x32_bf16 v[64:67], a[112:115], v[124:127], v[64:67]
    v_lshlrev_b32 v32, 7, v33
    v_add_u32 v32, s59, v32
    v_mfma_f32_16x16x32_bf16 v[68:71], a[68:71], v[112:115], v[68:71]
    ds_read_b64_tr_b16 v[100:101], v13 offset:36864
    v_lshrrev_b32 v33, 1, v33
    v_mfma_f32_16x16x32_bf16 v[68:71], a[84:87], v[116:119], v[68:71]
    v_cvt_pk_bf16_f32 v83, v86, v87
    v_xor_b32 v33, v33, v31
    v_mfma_f32_16x16x32_bf16 v[68:71], a[100:103], v[120:123], v[68:71]
    ds_read_b64_tr_b16 v[102:103], v13 offset:37376
    v_lshl_add_u32 v24, v33, 4, v32
    v_mfma_f32_16x16x32_bf16 v[68:71], a[116:119], v[124:127], v[68:71]
    v_xor_b32 v33, 4, v33
    v_lshl_add_u32 v29, v33, 4, v32
    v_mfma_f32_16x16x32_bf16 v[72:75], a[72:75], v[112:115], v[72:75]
    ds_read_b64_tr_b16 v[104:105], v13 offset:40960
    v_bfe_u32 v30, v0, 2, 2
    v_mfma_f32_16x16x32_bf16 v[72:75], a[88:91], v[116:119], v[72:75]
    s_add_u32 s28, s0, 104869888
    v_lshl_add_u32 v32, v31, 3, v30
    v_mfma_f32_16x16x32_bf16 v[72:75], a[104:107], v[120:123], v[72:75]
    ds_read_b64_tr_b16 v[106:107], v13 offset:41472
    v_lshlrev_b32 v32, 7, v32
    v_mfma_f32_16x16x32_bf16 v[72:75], a[120:123], v[124:127], v[72:75]
    v_and_b32 v33, 3, v0
    v_lshl_add_u32 v32, v33, 3, v32
    v_mfma_f32_16x16x32_bf16 v[76:79], a[76:79], v[112:115], v[76:79]
    ds_read_b64_tr_b16 v[108:109], v13 offset:45056
    v_bfe_u32 v33, v0, 3, 2
    v_mfma_f32_16x16x32_bf16 v[76:79], a[92:95], v[116:119], v[76:79]
    buffer_store_dwordx4 v[80:83], v1, s[48:51], s28 offen offset:1024 sc1
    v_add_u32 v32, 65536, v32
    v_mfma_f32_16x16x32_bf16 v[76:79], a[108:111], v[120:123], v[76:79]
    ds_read_b64_tr_b16 v[110:111], v13 offset:45568
    v_xor_b32 v34, 0, v33
    v_mfma_f32_16x16x32_bf16 v[76:79], a[124:127], v[124:127], v[76:79]
    v_lshl_add_u32 v25, v34, 5, v32
    v_xor_b32 v34, 1, v33
    s_waitcnt lgkmcnt(0)
    v_mfma_f32_16x16x32_bf16 v[64:67], a[128:131], v[96:99], v[64:67]
    ds_read_b64_tr_b16 v[112:113], v13 offset:49152
    v_lshl_add_u32 v26, v34, 5, v32
    v_mfma_f32_16x16x32_bf16 v[64:67], a[144:147], v[100:103], v[64:67]
    v_cvt_pk_bf16_f32 v88, v88, v89
    v_xor_b32 v34, 2, v33
    v_mfma_f32_16x16x32_bf16 v[64:67], a[160:163], v[104:107], v[64:67]
    ds_read_b64_tr_b16 v[114:115], v13 offset:49664
    v_lshl_add_u32 v27, v34, 5, v32
    v_mfma_f32_16x16x32_bf16 v[64:67], a[176:179], v[108:111], v[64:67]
    v_xor_b32 v34, 3, v33
    v_lshl_add_u32 v28, v34, 5, v32
    v_mfma_f32_16x16x32_bf16 v[68:71], a[132:135], v[96:99], v[68:71]
    ds_read_b64_tr_b16 v[116:117], v13 offset:53248
    s_mul_i32 s6, s4, 529408
    v_mfma_f32_16x16x32_bf16 v[68:71], a[148:151], v[100:103], v[68:71]
    v_cvt_pk_bf16_f32 v89, v90, v91
    s_add_u32 s56, s6, s59
    v_mfma_f32_16x16x32_bf16 v[68:71], a[164:167], v[104:107], v[68:71]
    ds_read_b64_tr_b16 v[118:119], v13 offset:53760
    s_add_u32 s56, s56, 83886080
    v_mfma_f32_16x16x32_bf16 v[68:71], a[180:183], v[108:111], v[68:71]
    s_sub_u32 s7, 16, s5
    s_mul_i32 s8, s7, 32768
    v_mfma_f32_16x16x32_bf16 v[72:75], a[136:139], v[96:99], v[72:75]
    ds_read_b64_tr_b16 v[120:121], v13 offset:57344
    s_add_u32 s57, s56, s8
    v_mfma_f32_16x16x32_bf16 v[72:75], a[152:155], v[100:103], v[72:75]
    v_cvt_pk_bf16_f32 v90, v92, v93
    s_lshl_b32 s63, s5, 1
    v_mfma_f32_16x16x32_bf16 v[72:75], a[168:171], v[104:107], v[72:75]
    ds_read_b64_tr_b16 v[122:123], v13 offset:57856
    s_lshl_b32 s8, s5, 2
    v_mfma_f32_16x16x32_bf16 v[72:75], a[184:187], v[108:111], v[72:75]
    s_sub_u32 s62, 27, s8
    s_lshl_b32 s14, s4, 12
    v_mfma_f32_16x16x32_bf16 v[76:79], a[140:143], v[96:99], v[76:79]
    ds_read_b64_tr_b16 v[124:125], v13 offset:61440
    s_add_u32 s14, s14, 53477376
    v_mfma_f32_16x16x32_bf16 v[76:79], a[156:159], v[100:103], v[76:79]
    v_cvt_pk_bf16_f32 v91, v94, v95
    s_mul_i32 s15, s10, 136192
    v_mfma_f32_16x16x32_bf16 v[76:79], a[172:175], v[104:107], v[76:79]
    ds_read_b64_tr_b16 v[126:127], v13 offset:61952
    s_add_u32 s68, s15, s14
    v_mfma_f32_16x16x32_bf16 v[76:79], a[188:191], v[108:111], v[76:79]
    s_mul_i32 s15, s11, 136192
    s_add_u32 s69, s15, s14
    s_waitcnt lgkmcnt(0)
    v_mfma_f32_16x16x32_bf16 v[64:67], a[192:195], v[112:115], v[64:67]
    ds_read_b64_tr_b16 v[96:97], v14 offset:0
    s_mul_i32 s15, s12, 136192
    v_mfma_f32_16x16x32_bf16 v[64:67], a[208:211], v[116:119], v[64:67]
    s_add_u32 s28, s0, 104878080
    s_add_u32 s70, s15, s14
    v_mfma_f32_16x16x32_bf16 v[64:67], a[224:227], v[120:123], v[64:67]
    ds_read_b64_tr_b16 v[98:99], v14 offset:512
    s_mul_i32 s15, s13, 136192
    v_mfma_f32_16x16x32_bf16 v[64:67], a[240:243], v[124:127], v[64:67]
    s_add_u32 s71, s15, s14
    s_mov_b32 s73, 0x49800000
    v_mfma_f32_16x16x32_bf16 v[68:71], a[196:199], v[112:115], v[68:71]
    ds_read_b64_tr_b16 v[100:101], v14 offset:4096
    v_and_b32 v32, 15, v0
    v_mfma_f32_16x16x32_bf16 v[68:71], a[212:215], v[116:119], v[68:71]
    buffer_store_dwordx4 v[88:91], v1, s[48:51], s28 offen offset:1024 sc1
    v_lshlrev_b32 v33, 2, v31
    v_mfma_f32_16x16x32_bf16 v[68:71], a[228:231], v[120:123], v[68:71]
    ds_read_b64_tr_b16 v[102:103], v14 offset:4608
    v_sub_u32 v33, v32, v33
    v_mfma_f32_16x16x32_bf16 v[68:71], a[244:247], v[124:127], v[68:71]
    s_lshl_b32 s7, s3, 4
    s_lshl_b32 s8, s9, 4
    v_mfma_f32_16x16x32_bf16 v[72:75], a[200:203], v[112:115], v[72:75]
    ds_read_b64_tr_b16 v[104:105], v14 offset:8192
    v_add_u32 v4, s7, v33
    v_mfma_f32_16x16x32_bf16 v[72:75], a[216:219], v[116:119], v[72:75]
    v_add_u32 v5, s8, v33
    v_cvt_f32_i32 v4, v4
    v_mfma_f32_16x16x32_bf16 v[72:75], a[232:235], v[120:123], v[72:75]
    ds_read_b64_tr_b16 v[106:107], v14 offset:8704
    v_cvt_f32_i32 v5, v5
    v_mfma_f32_16x16x32_bf16 v[72:75], a[248:251], v[124:127], v[72:75]
    v_mul_f32 v4, 0x5d800000, v4
    v_mul_f32 v5, 0x5d800000, v5
    v_mfma_f32_16x16x32_bf16 v[76:79], a[204:207], v[112:115], v[76:79]
    ds_read_b64_tr_b16 v[108:109], v14 offset:12288
    v_mov_b32 v2, v1
    v_mfma_f32_16x16x32_bf16 v[76:79], a[220:223], v[116:119], v[76:79]
    s_mov_b32 s52, s24
    s_mov_b32 s53, s25
    v_mfma_f32_16x16x32_bf16 v[76:79], a[236:239], v[120:123], v[76:79]
    ds_read_b64_tr_b16 v[110:111], v14 offset:12800
    s_mov_b32 s54, 2097152
    v_mfma_f32_16x16x32_bf16 v[76:79], a[252:255], v[124:127], v[76:79]
    s_mov_b32 s55, 0x00020000
    s_mov_b32 s80, s44
    s_waitcnt lgkmcnt(0)
    v_mfma_f32_16x16x32_bf16 v[36:39], a[0:3], v[96:99], 0
    ds_read_b64_tr_b16 v[112:113], v14 offset:16384
    s_mov_b32 s81, s45
    v_mfma_f32_16x16x32_bf16 v[36:39], a[16:19], v[100:103], v[36:39]
    s_mov_b32 s82, 256
    s_mov_b32 s83, 0x00020000
    v_mfma_f32_16x16x32_bf16 v[36:39], a[32:35], v[104:107], v[36:39]
    ds_read_b64_tr_b16 v[114:115], v14 offset:16896
    s_mov_b32 s74, s20
    v_mfma_f32_16x16x32_bf16 v[36:39], a[48:51], v[108:111], v[36:39]
    s_lshl_b32 s67, s4, 3
    s_lshl_b32 s7, s3, 28
    v_mfma_f32_16x16x32_bf16 v[40:43], a[4:7], v[96:99], 0
    ds_read_b64_tr_b16 v[116:117], v14 offset:20480
    v_mov_b32 v10, s7
    v_mfma_f32_16x16x32_bf16 v[40:43], a[20:23], v[100:103], v[40:43]
    s_cmp_eq_u32 s3, 0
    s_cselect_b64 s[18:19], -1, 0
    s_add_u32 m0, s59, 65536
    s_add_u32 s66, s64, 0
    v_mfma_f32_16x16x32_bf16 v[40:43], a[36:39], v[104:107], v[40:43]
    ds_read_b64_tr_b16 v[118:119], v14 offset:20992
    buffer_load_dwordx4 v20, s[88:91], s66 offen offset:0 lds
    v_mfma_f32_16x16x32_bf16 v[40:43], a[52:55], v[108:111], v[40:43]
    buffer_load_dwordx4 v21, s[88:91], s66 offen offset:1024 lds
    buffer_load_dwordx4 v22, s[88:91], s66 offen offset:2048 lds
    v_mfma_f32_16x16x32_bf16 v[44:47], a[8:11], v[96:99], 0
    ds_read_b64_tr_b16 v[120:121], v14 offset:24576
    buffer_load_dwordx4 v23, s[88:91], s66 offen offset:3072 lds
    v_mfma_f32_16x16x32_bf16 v[44:47], a[24:27], v[100:103], v[44:47]
    v_cvt_pk_bf16_f32 v64, v64, v65
    s_add_u32 m0, s59, 49152
    s_mov_b32 s65, 0
    v_mfma_f32_16x16x32_bf16 v[44:47], a[40:43], v[104:107], v[44:47]
    ds_read_b64_tr_b16 v[122:123], v14 offset:25088
    buffer_load_dwordx4 v56, s[84:87], s65 offen offset:0 lds
    v_mfma_f32_16x16x32_bf16 v[44:47], a[56:59], v[108:111], v[44:47]
    buffer_load_dwordx4 v57, s[84:87], s65 offen offset:1024 lds
    buffer_load_dwordx4 v58, s[84:87], s65 offen offset:2048 lds
    v_mfma_f32_16x16x32_bf16 v[48:51], a[12:15], v[96:99], 0
    ds_read_b64_tr_b16 v[124:125], v14 offset:28672
    buffer_load_dwordx4 v59, s[84:87], s65 offen offset:3072 lds
    v_mfma_f32_16x16x32_bf16 v[48:51], a[28:31], v[100:103], v[48:51]
    v_cvt_pk_bf16_f32 v65, v66, v67
    s_add_u32 m0, s59, 16384
    s_mov_b32 s65, 0
    v_mfma_f32_16x16x32_bf16 v[48:51], a[44:47], v[104:107], v[48:51]
    ds_read_b64_tr_b16 v[126:127], v14 offset:29184
    buffer_load_dwordx4 v60, s[84:87], s65 offen offset:0 lds
    v_mfma_f32_16x16x32_bf16 v[48:51], a[60:63], v[108:111], v[48:51]
    buffer_load_dwordx4 v61, s[84:87], s65 offen offset:1024 lds
    buffer_load_dwordx4 v62, s[84:87], s65 offen offset:2048 lds
    s_waitcnt lgkmcnt(0)
    v_mfma_f32_16x16x32_bf16 v[36:39], a[64:67], v[112:115], v[36:39]
    ds_read_b64_tr_b16 v[96:97], v14 offset:32768
    buffer_load_dwordx4 v63, s[84:87], s65 offen offset:3072 lds
    v_mfma_f32_16x16x32_bf16 v[36:39], a[80:83], v[116:119], v[36:39]
    v_cvt_pk_bf16_f32 v66, v68, v69
    s_add_u32 m0, s59, 81920
    s_add_u32 s66, s64, 524288
    v_mfma_f32_16x16x32_bf16 v[36:39], a[96:99], v[120:123], v[36:39]
    ds_read_b64_tr_b16 v[98:99], v14 offset:33280
    buffer_load_dwordx4 v20, s[88:91], s66 offen offset:0 lds
    v_mfma_f32_16x16x32_bf16 v[36:39], a[112:115], v[124:127], v[36:39]
    buffer_load_dwordx4 v21, s[88:91], s66 offen offset:1024 lds
    buffer_load_dwordx4 v22, s[88:91], s66 offen offset:2048 lds
    v_mfma_f32_16x16x32_bf16 v[40:43], a[68:71], v[112:115], v[40:43]
    ds_read_b64_tr_b16 v[100:101], v14 offset:36864
    buffer_load_dwordx4 v23, s[88:91], s66 offen offset:3072 lds
    v_mfma_f32_16x16x32_bf16 v[40:43], a[84:87], v[116:119], v[40:43]
    v_cvt_pk_bf16_f32 v67, v70, v71
    s_add_u32 m0, s59, 32768
    s_mov_b32 s65, 128
    v_mfma_f32_16x16x32_bf16 v[40:43], a[100:103], v[120:123], v[40:43]
    ds_read_b64_tr_b16 v[102:103], v14 offset:37376
    buffer_load_dwordx4 v56, s[84:87], s65 offen offset:0 lds
    v_mfma_f32_16x16x32_bf16 v[40:43], a[116:119], v[124:127], v[40:43]
    buffer_load_dwordx4 v57, s[84:87], s65 offen offset:1024 lds
    buffer_load_dwordx4 v58, s[84:87], s65 offen offset:2048 lds
    v_mfma_f32_16x16x32_bf16 v[44:47], a[72:75], v[112:115], v[44:47]
    ds_read_b64_tr_b16 v[104:105], v14 offset:40960
    buffer_load_dwordx4 v59, s[84:87], s65 offen offset:3072 lds
    v_mfma_f32_16x16x32_bf16 v[44:47], a[88:91], v[116:119], v[44:47]
    s_add_u32 s28, s0, 104869888
    v_mfma_f32_16x16x32_bf16 v[44:47], a[104:107], v[120:123], v[44:47]
    ds_read_b64_tr_b16 v[106:107], v14 offset:41472
    v_mfma_f32_16x16x32_bf16 v[44:47], a[120:123], v[124:127], v[44:47]
    v_mfma_f32_16x16x32_bf16 v[48:51], a[76:79], v[112:115], v[48:51]
    ds_read_b64_tr_b16 v[108:109], v14 offset:45056
    v_mfma_f32_16x16x32_bf16 v[48:51], a[92:95], v[116:119], v[48:51]
    buffer_store_dwordx4 v[64:67], v1, s[48:51], s28 offen offset:2048 sc1
    v_mfma_f32_16x16x32_bf16 v[48:51], a[108:111], v[120:123], v[48:51]
    ds_read_b64_tr_b16 v[110:111], v14 offset:45568
    v_mfma_f32_16x16x32_bf16 v[48:51], a[124:127], v[124:127], v[48:51]
    s_waitcnt lgkmcnt(0)
    v_mfma_f32_16x16x32_bf16 v[36:39], a[128:131], v[96:99], v[36:39]
    ds_read_b64_tr_b16 v[112:113], v14 offset:49152
    v_mfma_f32_16x16x32_bf16 v[36:39], a[144:147], v[100:103], v[36:39]
    v_cvt_pk_bf16_f32 v72, v72, v73
    v_mfma_f32_16x16x32_bf16 v[36:39], a[160:163], v[104:107], v[36:39]
    ds_read_b64_tr_b16 v[114:115], v14 offset:49664
    v_mfma_f32_16x16x32_bf16 v[36:39], a[176:179], v[108:111], v[36:39]
    v_mfma_f32_16x16x32_bf16 v[40:43], a[132:135], v[96:99], v[40:43]
    ds_read_b64_tr_b16 v[116:117], v14 offset:53248
    v_mfma_f32_16x16x32_bf16 v[40:43], a[148:151], v[100:103], v[40:43]
    v_cvt_pk_bf16_f32 v73, v74, v75
    v_mfma_f32_16x16x32_bf16 v[40:43], a[164:167], v[104:107], v[40:43]
    ds_read_b64_tr_b16 v[118:119], v14 offset:53760
    v_mfma_f32_16x16x32_bf16 v[40:43], a[180:183], v[108:111], v[40:43]
    v_mfma_f32_16x16x32_bf16 v[44:47], a[136:139], v[96:99], v[44:47]
    ds_read_b64_tr_b16 v[120:121], v14 offset:57344
    v_mfma_f32_16x16x32_bf16 v[44:47], a[152:155], v[100:103], v[44:47]
    v_cvt_pk_bf16_f32 v74, v76, v77
    v_mfma_f32_16x16x32_bf16 v[44:47], a[168:171], v[104:107], v[44:47]
    ds_read_b64_tr_b16 v[122:123], v14 offset:57856
    v_mfma_f32_16x16x32_bf16 v[44:47], a[184:187], v[108:111], v[44:47]
    v_mfma_f32_16x16x32_bf16 v[48:51], a[140:143], v[96:99], v[48:51]
    ds_read_b64_tr_b16 v[124:125], v14 offset:61440
    v_mfma_f32_16x16x32_bf16 v[48:51], a[156:159], v[100:103], v[48:51]
    v_cvt_pk_bf16_f32 v75, v78, v79
    v_mfma_f32_16x16x32_bf16 v[48:51], a[172:175], v[104:107], v[48:51]
    ds_read_b64_tr_b16 v[126:127], v14 offset:61952
    v_mfma_f32_16x16x32_bf16 v[48:51], a[188:191], v[108:111], v[48:51]
    s_waitcnt lgkmcnt(0)
    v_mfma_f32_16x16x32_bf16 v[36:39], a[192:195], v[112:115], v[36:39]
    v_mfma_f32_16x16x32_bf16 v[36:39], a[208:211], v[116:119], v[36:39]
    s_add_u32 s28, s0, 104878080
    v_mfma_f32_16x16x32_bf16 v[36:39], a[224:227], v[120:123], v[36:39]
    v_mfma_f32_16x16x32_bf16 v[36:39], a[240:243], v[124:127], v[36:39]
    v_mfma_f32_16x16x32_bf16 v[40:43], a[196:199], v[112:115], v[40:43]
    v_mfma_f32_16x16x32_bf16 v[40:43], a[212:215], v[116:119], v[40:43]
    buffer_store_dwordx4 v[72:75], v1, s[48:51], s28 offen offset:2048 sc1
    v_mfma_f32_16x16x32_bf16 v[40:43], a[228:231], v[120:123], v[40:43]
    v_mfma_f32_16x16x32_bf16 v[40:43], a[244:247], v[124:127], v[40:43]
    v_mfma_f32_16x16x32_bf16 v[44:47], a[200:203], v[112:115], v[44:47]
    v_mfma_f32_16x16x32_bf16 v[44:47], a[216:219], v[116:119], v[44:47]
    v_mfma_f32_16x16x32_bf16 v[44:47], a[232:235], v[120:123], v[44:47]
    v_mfma_f32_16x16x32_bf16 v[44:47], a[248:251], v[124:127], v[44:47]
    v_mfma_f32_16x16x32_bf16 v[48:51], a[204:207], v[112:115], v[48:51]
    v_mfma_f32_16x16x32_bf16 v[48:51], a[220:223], v[116:119], v[48:51]
    v_mfma_f32_16x16x32_bf16 v[48:51], a[236:239], v[120:123], v[48:51]
    v_mfma_f32_16x16x32_bf16 v[48:51], a[252:255], v[124:127], v[48:51]
    s_waitcnt vmcnt(10)
    s_barrier
    ds_read_b128 a[0:3], v24 offset:49152
    ds_read_b128 a[4:7], v24 offset:51200
    ds_read_b128 a[16:19], v29 offset:49152
    ds_read_b128 a[20:23], v29 offset:51200
    ds_read_b128 a[8:11], v24 offset:16384
    ds_read_b128 a[12:15], v24 offset:18432
    ds_read_b128 a[24:27], v29 offset:16384
    ds_read_b128 a[28:31], v29 offset:18432
    ds_read_b64_tr_b16 a[64:65], v25 offset:0
    ds_read_b64_tr_b16 a[66:67], v25 offset:512
    ds_read_b64_tr_b16 a[68:69], v26 offset:0
    ds_read_b64_tr_b16 a[70:71], v26 offset:512
    ds_read_b64_tr_b16 a[72:73], v27 offset:0
    ds_read_b64_tr_b16 a[74:75], v27 offset:512
    ds_read_b64_tr_b16 a[76:77], v28 offset:0
    ds_read_b64_tr_b16 a[78:79], v28 offset:512
    ds_read_b64_tr_b16 a[80:81], v25 offset:4096
    ds_read_b64_tr_b16 a[82:83], v25 offset:4608
    ds_read_b64_tr_b16 a[84:85], v26 offset:4096
    ds_read_b64_tr_b16 a[86:87], v26 offset:4608
    ds_read_b64_tr_b16 a[88:89], v27 offset:4096
    ds_read_b64_tr_b16 a[90:91], v27 offset:4608
    ds_read_b64_tr_b16 a[92:93], v28 offset:4096
    ds_read_b64_tr_b16 a[94:95], v28 offset:4608
    s_waitcnt lgkmcnt(0)
    v_mfma_f32_16x16x32_bf16 v[64:67], a[64:67], a[0:3], 0
    ds_read_b64_tr_b16 a[96:97], v25 offset:8192
    v_cvt_pk_bf16_f32 v36, v36, v37
    v_mfma_f32_16x16x32_bf16 v[68:71], a[68:71], a[0:3], 0
    ds_read_b64_tr_b16 a[98:99], v25 offset:8704
    v_cvt_pk_bf16_f32 v37, v38, v39
    v_mfma_f32_16x16x32_bf16 v[72:75], a[72:75], a[0:3], 0
    ds_read_b64_tr_b16 a[100:101], v26 offset:8192
    v_cvt_pk_bf16_f32 v38, v40, v41
    v_mfma_f32_16x16x32_bf16 v[76:79], a[76:79], a[0:3], 0
    ds_read_b64_tr_b16 a[102:103], v26 offset:8704
    v_cvt_pk_bf16_f32 v39, v42, v43
    v_mfma_f32_16x16x32_bf16 v[80:83], a[80:83], a[0:3], 0
    ds_read_b64_tr_b16 a[104:105], v27 offset:8192
    s_add_u32 s28, s0, 104869888
    v_mfma_f32_16x16x32_bf16 v[84:87], a[84:87], a[0:3], 0
    ds_read_b64_tr_b16 a[106:107], v27 offset:8704
    s_add_u32 m0, s59, 49152
    s_mov_b32 s65, 128
    v_mfma_f32_16x16x32_bf16 v[88:91], a[88:91], a[0:3], 0
    ds_read_b64_tr_b16 a[108:109], v28 offset:8192
    buffer_store_dwordx4 v[36:39], v1, s[48:51], s28 offen offset:3072 sc1
    v_mfma_f32_16x16x32_bf16 v[92:95], a[92:95], a[0:3], 0
    ds_read_b64_tr_b16 a[110:111], v28 offset:8704
    buffer_load_dwordx4 v60, s[84:87], s65 offen offset:0 lds
    v_mfma_f32_16x16x32_bf16 v[96:99], a[64:67], a[4:7], 0
    ds_read_b64_tr_b16 a[112:113], v25 offset:12288
    v_cvt_pk_bf16_f32 v44, v44, v45
    v_mfma_f32_16x16x32_bf16 v[100:103], a[68:71], a[4:7], 0
    ds_read_b64_tr_b16 a[114:115], v25 offset:12800
    buffer_load_dwordx4 v61, s[84:87], s65 offen offset:1024 lds
    v_mfma_f32_16x16x32_bf16 v[104:107], a[72:75], a[4:7], 0
    ds_read_b64_tr_b16 a[116:117], v26 offset:12288
    v_cvt_pk_bf16_f32 v45, v46, v47
    v_mfma_f32_16x16x32_bf16 v[108:111], a[76:79], a[4:7], 0
    ds_read_b64_tr_b16 a[118:119], v26 offset:12800
    buffer_load_dwordx4 v62, s[84:87], s65 offen offset:2048 lds
    v_mfma_f32_16x16x32_bf16 v[112:115], a[80:83], a[4:7], 0
    ds_read_b64_tr_b16 a[120:121], v27 offset:12288
    v_cvt_pk_bf16_f32 v46, v48, v49
    v_mfma_f32_16x16x32_bf16 v[116:119], a[84:87], a[4:7], 0
    ds_read_b64_tr_b16 a[122:123], v27 offset:12800
    buffer_load_dwordx4 v63, s[84:87], s65 offen offset:3072 lds
    v_mfma_f32_16x16x32_bf16 v[120:123], a[88:91], a[4:7], 0
    ds_read_b64_tr_b16 a[124:125], v28 offset:12288
    v_cvt_pk_bf16_f32 v47, v50, v51
    v_mfma_f32_16x16x32_bf16 v[124:127], a[92:95], a[4:7], 0
    ds_read_b64_tr_b16 a[126:127], v28 offset:12800
    s_add_u32 m0, s59, 16384
    s_mov_b32 s65, 256
    v_mfma_f32_16x16x32_bf16 v[128:131], a[64:67], a[8:11], 0
    buffer_load_dwordx4 v56, s[84:87], s65 offen offset:0 lds
    s_add_u32 s28, s0, 104878080
    v_mfma_f32_16x16x32_bf16 v[132:135], a[68:71], a[8:11], 0
    buffer_load_dwordx4 v57, s[84:87], s65 offen offset:1024 lds
    buffer_store_dwordx4 v[44:47], v1, s[48:51], s28 offen offset:3072 sc1
    v_mfma_f32_16x16x32_bf16 v[136:139], a[72:75], a[8:11], 0
    buffer_load_dwordx4 v58, s[84:87], s65 offen offset:2048 lds
    v_mfma_f32_16x16x32_bf16 v[140:143], a[76:79], a[8:11], 0
    buffer_load_dwordx4 v59, s[84:87], s65 offen offset:3072 lds
    v_mov_b32 v32, 0x3f803f80
    v_mfma_f32_16x16x32_bf16 v[144:147], a[80:83], a[8:11], 0
    s_add_u32 m0, s59, 98304
    s_add_u32 s66, s64, 1048576
    v_accvgpr_write_b32 a240, v32
    v_mfma_f32_16x16x32_bf16 v[148:151], a[84:87], a[8:11], 0
    buffer_load_dwordx4 v20, s[88:91], s66 offen offset:0 lds
    v_accvgpr_write_b32 a241, v32
    v_mfma_f32_16x16x32_bf16 v[152:155], a[88:91], a[8:11], 0
    buffer_load_dwordx4 v21, s[88:91], s66 offen offset:1024 lds
    v_accvgpr_write_b32 a242, v32
    v_mfma_f32_16x16x32_bf16 v[156:159], a[92:95], a[8:11], 0
    buffer_load_dwordx4 v22, s[88:91], s66 offen offset:2048 lds
    v_accvgpr_write_b32 a243, v32
    v_mfma_f32_16x16x32_bf16 v[160:163], a[64:67], a[12:15], 0
    s_waitcnt vmcnt(15)
    ds_read_b128 a[208:211], v24 offset:32768
    v_mov_b32 v32, 0
    v_mfma_f32_16x16x32_bf16 v[164:167], a[68:71], a[12:15], 0
    ds_read_b128 a[212:215], v24 offset:34816
    v_mov_b32 v33, 0
    v_mfma_f32_16x16x32_bf16 v[168:171], a[72:75], a[12:15], 0
    ds_read_b128 a[224:227], v29 offset:32768
    v_mov_b32 v34, 0
    v_mfma_f32_16x16x32_bf16 v[172:175], a[76:79], a[12:15], 0
    ds_read_b128 a[228:231], v29 offset:34816
    v_mov_b32 v35, 0
    v_mfma_f32_16x16x32_bf16 v[176:179], a[80:83], a[12:15], 0
    buffer_load_dwordx4 v23, s[88:91], s66 offen offset:3072 lds
    v_mov_b32 v36, 0
    v_mfma_f32_16x16x32_bf16 v[180:183], a[84:87], a[12:15], 0
    v_mov_b32 v37, 0
    v_mov_b32 v38, 0
    v_mfma_f32_16x16x32_bf16 v[184:187], a[88:91], a[12:15], 0
    v_mov_b32 v39, 0
    v_mov_b32 v40, 0
    v_mfma_f32_16x16x32_bf16 v[188:191], a[92:95], a[12:15], 0
    v_mov_b32 v41, 0
    v_mov_b32 v42, 0
    s_waitcnt lgkmcnt(0)
    v_mfma_f32_16x16x32_bf16 v[64:67], a[96:99], a[16:19], v[64:67]
    s_barrier
    ds_read_b64_tr_b16 a[64:65], v25 offset:16384
    v_mov_b32 v43, 0
    v_mfma_f32_16x16x32_bf16 v[68:71], a[100:103], a[16:19], v[68:71]
    ds_read_b64_tr_b16 a[66:67], v25 offset:16896
    v_mov_b32 v44, 0
    v_mfma_f32_16x16x32_bf16 v[72:75], a[104:107], a[16:19], v[72:75]
    ds_read_b64_tr_b16 a[68:69], v26 offset:16384
    v_mov_b32 v45, 0
    v_mfma_f32_16x16x32_bf16 v[76:79], a[108:111], a[16:19], v[76:79]
    ds_read_b64_tr_b16 a[70:71], v26 offset:16896
    v_mov_b32 v46, 0
    v_mfma_f32_16x16x32_bf16 v[80:83], a[112:115], a[16:19], v[80:83]
    ds_read_b64_tr_b16 a[72:73], v27 offset:16384
    v_mov_b32 v47, 0
    v_mfma_f32_16x16x32_bf16 v[84:87], a[116:119], a[16:19], v[84:87]
    ds_read_b64_tr_b16 a[74:75], v27 offset:16896
    v_mov_b32 v192, 0
    v_mfma_f32_16x16x32_bf16 v[88:91], a[120:123], a[16:19], v[88:91]
    ds_read_b64_tr_b16 a[76:77], v28 offset:16384
    v_mov_b32 v193, 0
    v_mfma_f32_16x16x32_bf16 v[92:95], a[124:127], a[16:19], v[92:95]
    ds_read_b64_tr_b16 a[78:79], v28 offset:16896
    v_mov_b32 v194, 0
    v_mfma_f32_16x16x32_bf16 v[96:99], a[96:99], a[20:23], v[96:99]
    ds_read_b64_tr_b16 a[80:81], v25 offset:20480
    v_mov_b32 v195, 0
    v_mfma_f32_16x16x32_bf16 v[100:103], a[100:103], a[20:23], v[100:103]
    ds_read_b64_tr_b16 a[82:83], v25 offset:20992
    v_mov_b32 v196, 0
    v_mfma_f32_16x16x32_bf16 v[104:107], a[104:107], a[20:23], v[104:107]
    ds_read_b64_tr_b16 a[84:85], v26 offset:20480
    v_mov_b32 v197, 0
    v_mfma_f32_16x16x32_bf16 v[108:111], a[108:111], a[20:23], v[108:111]
    ds_read_b64_tr_b16 a[86:87], v26 offset:20992
    v_mov_b32 v198, 0
    v_mfma_f32_16x16x32_bf16 v[112:115], a[112:115], a[20:23], v[112:115]
    ds_read_b64_tr_b16 a[88:89], v27 offset:20480
    v_mov_b32 v199, 0
    v_mfma_f32_16x16x32_bf16 v[116:119], a[116:119], a[20:23], v[116:119]
    ds_read_b64_tr_b16 a[90:91], v27 offset:20992
    v_mov_b32 v200, 0
    v_mfma_f32_16x16x32_bf16 v[120:123], a[120:123], a[20:23], v[120:123]
    ds_read_b64_tr_b16 a[92:93], v28 offset:20480
    v_mov_b32 v201, 0
    v_mfma_f32_16x16x32_bf16 v[124:127], a[124:127], a[20:23], v[124:127]
    ds_read_b64_tr_b16 a[94:95], v28 offset:20992
    v_mov_b32 v202, 0
    v_mfma_f32_16x16x32_bf16 v[128:131], a[96:99], a[24:27], v[128:131]
    s_add_u32 m0, s59, 32768
    s_mov_b32 s65, 256
    v_mov_b32 v203, 0
    v_mfma_f32_16x16x32_bf16 v[132:135], a[100:103], a[24:27], v[132:135]
    buffer_load_dwordx4 v60, s[84:87], s65 offen offset:0 lds
    v_mov_b32 v204, 0
    v_mfma_f32_16x16x32_bf16 v[136:139], a[104:107], a[24:27], v[136:139]
    buffer_load_dwordx4 v61, s[84:87], s65 offen offset:1024 lds
    v_mov_b32 v205, 0
    v_mfma_f32_16x16x32_bf16 v[140:143], a[108:111], a[24:27], v[140:143]
    buffer_load_dwordx4 v62, s[84:87], s65 offen offset:2048 lds
    v_mov_b32 v206, 0
    v_mfma_f32_16x16x32_bf16 v[144:147], a[112:115], a[24:27], v[144:147]
    buffer_load_dwordx4 v63, s[84:87], s65 offen offset:3072 lds
    v_mov_b32 v207, 0
    v_mfma_f32_16x16x32_bf16 v[148:151], a[116:119], a[24:27], v[148:151]
    v_mov_b32 v208, 0
    v_mov_b32 v209, 0
    v_mfma_f32_16x16x32_bf16 v[152:155], a[120:123], a[24:27], v[152:155]
    v_mov_b32 v210, 0
    v_mov_b32 v211, 0
    v_mfma_f32_16x16x32_bf16 v[156:159], a[124:127], a[24:27], v[156:159]
    v_mov_b32 v212, 0
    v_mov_b32 v213, 0
    v_mfma_f32_16x16x32_bf16 v[160:163], a[96:99], a[28:31], v[160:163]
    s_waitcnt vmcnt(13)
    ds_read_b128 a[216:219], v24 offset:49152
    v_mov_b32 v214, 0
    v_mfma_f32_16x16x32_bf16 v[164:167], a[100:103], a[28:31], v[164:167]
    ds_read_b128 a[220:223], v24 offset:51200
    v_mov_b32 v215, 0
    v_mfma_f32_16x16x32_bf16 v[168:171], a[104:107], a[28:31], v[168:171]
    ds_read_b128 a[232:235], v29 offset:49152
    v_mov_b32 v216, 0
    v_mfma_f32_16x16x32_bf16 v[172:175], a[108:111], a[28:31], v[172:175]
    ds_read_b128 a[236:239], v29 offset:51200
    v_mov_b32 v217, 0
    v_mfma_f32_16x16x32_bf16 v[176:179], a[112:115], a[28:31], v[176:179]
    v_mov_b32 v218, 0
    v_mov_b32 v219, 0
    v_mfma_f32_16x16x32_bf16 v[180:183], a[116:119], a[28:31], v[180:183]
    v_mov_b32 v220, 0
    v_mov_b32 v221, 0
    v_mfma_f32_16x16x32_bf16 v[184:187], a[120:123], a[28:31], v[184:187]
    v_mov_b32 v222, 0
    v_mov_b32 v223, 0
    v_mfma_f32_16x16x32_bf16 v[188:191], a[124:127], a[28:31], v[188:191]
    v_mov_b32 v224, 0
    v_mov_b32 v225, 0
    s_waitcnt lgkmcnt(0)
    v_mfma_f32_16x16x32_bf16 v[64:67], a[64:67], a[208:211], v[64:67]
    ds_read_b64_tr_b16 a[96:97], v25 offset:24576
    v_mov_b32 v226, 0
    v_mfma_f32_16x16x32_bf16 v[68:71], a[68:71], a[208:211], v[68:71]
    ds_read_b64_tr_b16 a[98:99], v25 offset:25088
    v_mov_b32 v227, 0
    v_mfma_f32_16x16x32_bf16 v[72:75], a[72:75], a[208:211], v[72:75]
    ds_read_b64_tr_b16 a[100:101], v26 offset:24576
    v_mov_b32 v228, 0
    v_mfma_f32_16x16x32_bf16 v[76:79], a[76:79], a[208:211], v[76:79]
    ds_read_b64_tr_b16 a[102:103], v26 offset:25088
    v_mov_b32 v229, 0
    v_mfma_f32_16x16x32_bf16 v[80:83], a[80:83], a[208:211], v[80:83]
    ds_read_b64_tr_b16 a[104:105], v27 offset:24576
    v_mov_b32 v230, 0
    v_mfma_f32_16x16x32_bf16 v[84:87], a[84:87], a[208:211], v[84:87]
    ds_read_b64_tr_b16 a[106:107], v27 offset:25088
    v_mov_b32 v231, 0
    v_mfma_f32_16x16x32_bf16 v[88:91], a[88:91], a[208:211], v[88:91]
    ds_read_b64_tr_b16 a[108:109], v28 offset:24576
    v_mov_b32 v232, 0
    v_mfma_f32_16x16x32_bf16 v[92:95], a[92:95], a[208:211], v[92:95]
    ds_read_b64_tr_b16 a[110:111], v28 offset:25088
    v_mov_b32 v233, 0
    v_mfma_f32_16x16x32_bf16 v[96:99], a[64:67], a[212:215], v[96:99]
    ds_read_b64_tr_b16 a[112:113], v25 offset:28672
    v_mov_b32 v234, 0
    v_mfma_f32_16x16x32_bf16 v[100:103], a[68:71], a[212:215], v[100:103]
    ds_read_b64_tr_b16 a[114:115], v25 offset:29184
    v_mov_b32 v235, 0
    v_mfma_f32_16x16x32_bf16 v[104:107], a[72:75], a[212:215], v[104:107]
    ds_read_b64_tr_b16 a[116:117], v26 offset:28672
    v_mov_b32 v236, 0
    v_mfma_f32_16x16x32_bf16 v[108:111], a[76:79], a[212:215], v[108:111]
    ds_read_b64_tr_b16 a[118:119], v26 offset:29184
    v_mov_b32 v237, 0
    v_mfma_f32_16x16x32_bf16 v[112:115], a[80:83], a[212:215], v[112:115]
    ds_read_b64_tr_b16 a[120:121], v27 offset:28672
    v_mov_b32 v238, 0
    v_mfma_f32_16x16x32_bf16 v[116:119], a[84:87], a[212:215], v[116:119]
    ds_read_b64_tr_b16 a[122:123], v27 offset:29184
    v_mov_b32 v239, 0
    v_mfma_f32_16x16x32_bf16 v[120:123], a[88:91], a[212:215], v[120:123]
    ds_read_b64_tr_b16 a[124:125], v28 offset:28672
    v_mov_b32 v240, 0
    v_mfma_f32_16x16x32_bf16 v[124:127], a[92:95], a[212:215], v[124:127]
    ds_read_b64_tr_b16 a[126:127], v28 offset:29184
    s_add_u32 m0, s59, 49152
    s_mov_b32 s65, 384
    v_mfma_f32_16x16x32_bf16 v[128:131], a[64:67], a[216:219], v[128:131]
    buffer_load_dwordx4 v56, s[84:87], s65 offen offset:0 lds
    v_mov_b32 v241, 0
    v_mfma_f32_16x16x32_bf16 v[132:135], a[68:71], a[216:219], v[132:135]
    buffer_load_dwordx4 v57, s[84:87], s65 offen offset:1024 lds
    v_mov_b32 v242, 0
    v_mfma_f32_16x16x32_bf16 v[136:139], a[72:75], a[216:219], v[136:139]
    buffer_load_dwordx4 v58, s[84:87], s65 offen offset:2048 lds
    v_mov_b32 v243, 0
    v_mfma_f32_16x16x32_bf16 v[140:143], a[76:79], a[216:219], v[140:143]
    buffer_load_dwordx4 v59, s[84:87], s65 offen offset:3072 lds
    v_mov_b32 v244, 0
    v_mfma_f32_16x16x32_bf16 v[144:147], a[80:83], a[216:219], v[144:147]
    s_add_u32 m0, s59, 114688
    s_add_u32 s66, s64, 1572864
    v_mov_b32 v245, 0
    v_mfma_f32_16x16x32_bf16 v[148:151], a[84:87], a[216:219], v[148:151]
    buffer_load_dwordx4 v20, s[88:91], s66 offen offset:0 lds
    v_mov_b32 v246, 0
    v_mfma_f32_16x16x32_bf16 v[152:155], a[88:91], a[216:219], v[152:155]
    buffer_load_dwordx4 v21, s[88:91], s66 offen offset:1024 lds
    v_mov_b32 v247, 0
    v_mfma_f32_16x16x32_bf16 v[156:159], a[92:95], a[216:219], v[156:159]
    buffer_load_dwordx4 v22, s[88:91], s66 offen offset:2048 lds
    v_mov_b32 v248, 0
    v_mfma_f32_16x16x32_bf16 v[160:163], a[64:67], a[220:223], v[160:163]
    s_waitcnt vmcnt(15)
    ds_read_b128 a[0:3], v24 offset:16384
    v_mov_b32 v249, 0
    v_mfma_f32_16x16x32_bf16 v[164:167], a[68:71], a[220:223], v[164:167]
    ds_read_b128 a[4:7], v24 offset:18432
    v_mov_b32 v250, 0
    v_mfma_f32_16x16x32_bf16 v[168:171], a[72:75], a[220:223], v[168:171]
    ds_read_b128 a[16:19], v29 offset:16384
    v_mov_b32 v251, 0
    v_mfma_f32_16x16x32_bf16 v[172:175], a[76:79], a[220:223], v[172:175]
    ds_read_b128 a[20:23], v29 offset:18432
    v_mov_b32 v252, 0
    v_mfma_f32_16x16x32_bf16 v[176:179], a[80:83], a[220:223], v[176:179]
    buffer_load_dwordx4 v23, s[88:91], s66 offen offset:3072 lds
    v_mov_b32 v253, 0
    v_mfma_f32_16x16x32_bf16 v[180:183], a[84:87], a[220:223], v[180:183]
    v_mov_b32 v254, 0
    v_mov_b32 v255, 0
    v_mfma_f32_16x16x32_bf16 v[184:187], a[88:91], a[220:223], v[184:187]
    v_accvgpr_write_b32 a128, 0
    v_accvgpr_write_b32 a129, 0
    v_mfma_f32_16x16x32_bf16 v[188:191], a[92:95], a[220:223], v[188:191]
    v_accvgpr_write_b32 a130, 0
    v_accvgpr_write_b32 a131, 0
    s_waitcnt vmcnt(12) lgkmcnt(0)
    v_mfma_f32_16x16x32_bf16 v[64:67], a[96:99], a[224:227], v[64:67]
    s_barrier
    ds_read_b64_tr_b16 a[64:65], v25 offset:32768
    v_accvgpr_write_b32 a132, 0
    v_mfma_f32_16x16x32_bf16 v[68:71], a[100:103], a[224:227], v[68:71]
    ds_read_b64_tr_b16 a[66:67], v25 offset:33280
    v_accvgpr_write_b32 a133, 0
    v_mfma_f32_16x16x32_bf16 v[72:75], a[104:107], a[224:227], v[72:75]
    ds_read_b64_tr_b16 a[68:69], v26 offset:32768
    v_accvgpr_write_b32 a134, 0
    v_mfma_f32_16x16x32_bf16 v[76:79], a[108:111], a[224:227], v[76:79]
    ds_read_b64_tr_b16 a[70:71], v26 offset:33280
    v_accvgpr_write_b32 a135, 0
    v_mfma_f32_16x16x32_bf16 v[80:83], a[112:115], a[224:227], v[80:83]
    ds_read_b64_tr_b16 a[72:73], v27 offset:32768
    v_accvgpr_write_b32 a136, 0
    v_mfma_f32_16x16x32_bf16 v[84:87], a[116:119], a[224:227], v[84:87]
    ds_read_b64_tr_b16 a[74:75], v27 offset:33280
    v_accvgpr_write_b32 a137, 0
    v_mfma_f32_16x16x32_bf16 v[88:91], a[120:123], a[224:227], v[88:91]
    ds_read_b64_tr_b16 a[76:77], v28 offset:32768
    v_accvgpr_write_b32 a138, 0
    v_mfma_f32_16x16x32_bf16 v[92:95], a[124:127], a[224:227], v[92:95]
    ds_read_b64_tr_b16 a[78:79], v28 offset:33280
    v_accvgpr_write_b32 a139, 0
    v_mfma_f32_16x16x32_bf16 v[96:99], a[96:99], a[228:231], v[96:99]
    ds_read_b64_tr_b16 a[80:81], v25 offset:36864
    v_accvgpr_write_b32 a140, 0
    v_mfma_f32_16x16x32_bf16 v[100:103], a[100:103], a[228:231], v[100:103]
    ds_read_b64_tr_b16 a[82:83], v25 offset:37376
    v_accvgpr_write_b32 a141, 0
    v_mfma_f32_16x16x32_bf16 v[104:107], a[104:107], a[228:231], v[104:107]
    ds_read_b64_tr_b16 a[84:85], v26 offset:36864
    v_accvgpr_write_b32 a142, 0
    v_mfma_f32_16x16x32_bf16 v[108:111], a[108:111], a[228:231], v[108:111]
    ds_read_b64_tr_b16 a[86:87], v26 offset:37376
    v_accvgpr_write_b32 a143, 0
    v_mfma_f32_16x16x32_bf16 v[112:115], a[112:115], a[228:231], v[112:115]
    ds_read_b64_tr_b16 a[88:89], v27 offset:36864
    v_accvgpr_write_b32 a144, 0
    v_mfma_f32_16x16x32_bf16 v[116:119], a[116:119], a[228:231], v[116:119]
    ds_read_b64_tr_b16 a[90:91], v27 offset:37376
    v_accvgpr_write_b32 a145, 0
    v_mfma_f32_16x16x32_bf16 v[120:123], a[120:123], a[228:231], v[120:123]
    ds_read_b64_tr_b16 a[92:93], v28 offset:36864
    v_accvgpr_write_b32 a146, 0
    v_mfma_f32_16x16x32_bf16 v[124:127], a[124:127], a[228:231], v[124:127]
    ds_read_b64_tr_b16 a[94:95], v28 offset:37376
    v_accvgpr_write_b32 a147, 0
    v_mfma_f32_16x16x32_bf16 v[128:131], a[96:99], a[232:235], v[128:131]
    v_mov_b32 v8, 1
    s_mov_b64 exec, 1
    buffer_atomic_add v8, v10, s[80:83], s72 offen sc1
    s_mov_b64 exec, -1
    v_accvgpr_write_b32 a148, 0
    v_mfma_f32_16x16x32_bf16 v[132:135], a[100:103], a[232:235], v[132:135]
    s_add_u32 m0, s59, 16384
    s_mov_b32 s65, 384
    v_accvgpr_write_b32 a149, 0
    v_mfma_f32_16x16x32_bf16 v[136:139], a[104:107], a[232:235], v[136:139]
    buffer_load_dwordx4 v60, s[84:87], s65 offen offset:0 lds
    v_accvgpr_write_b32 a150, 0
    v_mfma_f32_16x16x32_bf16 v[140:143], a[108:111], a[232:235], v[140:143]
    buffer_load_dwordx4 v61, s[84:87], s65 offen offset:1024 lds
    v_accvgpr_write_b32 a151, 0
    v_mfma_f32_16x16x32_bf16 v[144:147], a[112:115], a[232:235], v[144:147]
    buffer_load_dwordx4 v62, s[84:87], s65 offen offset:2048 lds
    v_accvgpr_write_b32 a152, 0
    v_mfma_f32_16x16x32_bf16 v[148:151], a[116:119], a[232:235], v[148:151]
    buffer_load_dwordx4 v63, s[84:87], s65 offen offset:3072 lds
    v_accvgpr_write_b32 a153, 0
    v_mfma_f32_16x16x32_bf16 v[152:155], a[120:123], a[232:235], v[152:155]
    v_accvgpr_write_b32 a154, 0
    v_accvgpr_write_b32 a155, 0
    v_mfma_f32_16x16x32_bf16 v[156:159], a[124:127], a[232:235], v[156:159]
    v_accvgpr_write_b32 a156, 0
    v_accvgpr_write_b32 a157, 0
    v_mfma_f32_16x16x32_bf16 v[160:163], a[96:99], a[236:239], v[160:163]
    s_waitcnt vmcnt(13)
    ds_read_b128 a[8:11], v24 offset:32768
    v_accvgpr_write_b32 a158, 0
    v_mfma_f32_16x16x32_bf16 v[164:167], a[100:103], a[236:239], v[164:167]
    ds_read_b128 a[12:15], v24 offset:34816
    v_accvgpr_write_b32 a159, 0
    v_mfma_f32_16x16x32_bf16 v[168:171], a[104:107], a[236:239], v[168:171]
    ds_read_b128 a[24:27], v29 offset:32768
    v_accvgpr_write_b32 a160, 0
    v_mfma_f32_16x16x32_bf16 v[172:175], a[108:111], a[236:239], v[172:175]
    ds_read_b128 a[28:31], v29 offset:34816
    v_accvgpr_write_b32 a161, 0
    v_mfma_f32_16x16x32_bf16 v[176:179], a[112:115], a[236:239], v[176:179]
    v_accvgpr_write_b32 a162, 0
    v_accvgpr_write_b32 a163, 0
    v_mfma_f32_16x16x32_bf16 v[180:183], a[116:119], a[236:239], v[180:183]
    v_accvgpr_write_b32 a164, 0
    v_accvgpr_write_b32 a165, 0
    v_mfma_f32_16x16x32_bf16 v[184:187], a[120:123], a[236:239], v[184:187]
    v_accvgpr_write_b32 a166, 0
    v_accvgpr_write_b32 a167, 0
    v_mfma_f32_16x16x32_bf16 v[188:191], a[124:127], a[236:239], v[188:191]
    v_accvgpr_write_b32 a168, 0
    v_accvgpr_write_b32 a169, 0
    s_waitcnt lgkmcnt(0)
    v_mfma_f32_16x16x32_bf16 v[64:67], a[64:67], a[0:3], v[64:67]
    ds_read_b64_tr_b16 a[96:97], v25 offset:40960
    v_accvgpr_write_b32 a170, 0
    v_mfma_f32_16x16x32_bf16 v[68:71], a[68:71], a[0:3], v[68:71]
    ds_read_b64_tr_b16 a[98:99], v25 offset:41472
    v_accvgpr_write_b32 a171, 0
    v_mfma_f32_16x16x32_bf16 v[72:75], a[72:75], a[0:3], v[72:75]
    ds_read_b64_tr_b16 a[100:101], v26 offset:40960
    v_accvgpr_write_b32 a172, 0
    v_mfma_f32_16x16x32_bf16 v[76:79], a[76:79], a[0:3], v[76:79]
    ds_read_b64_tr_b16 a[102:103], v26 offset:41472
    v_accvgpr_write_b32 a173, 0
    v_mfma_f32_16x16x32_bf16 v[80:83], a[80:83], a[0:3], v[80:83]
    ds_read_b64_tr_b16 a[104:105], v27 offset:40960
    v_accvgpr_write_b32 a174, 0
    v_mfma_f32_16x16x32_bf16 v[84:87], a[84:87], a[0:3], v[84:87]
    ds_read_b64_tr_b16 a[106:107], v27 offset:41472
    v_accvgpr_write_b32 a175, 0
    v_mfma_f32_16x16x32_bf16 v[88:91], a[88:91], a[0:3], v[88:91]
    ds_read_b64_tr_b16 a[108:109], v28 offset:40960
    v_accvgpr_write_b32 a176, 0
    v_mfma_f32_16x16x32_bf16 v[92:95], a[92:95], a[0:3], v[92:95]
    ds_read_b64_tr_b16 a[110:111], v28 offset:41472
    v_accvgpr_write_b32 a177, 0
    v_mfma_f32_16x16x32_bf16 v[96:99], a[64:67], a[4:7], v[96:99]
    ds_read_b64_tr_b16 a[112:113], v25 offset:45056
    v_accvgpr_write_b32 a178, 0
    v_mfma_f32_16x16x32_bf16 v[100:103], a[68:71], a[4:7], v[100:103]
    ds_read_b64_tr_b16 a[114:115], v25 offset:45568
    v_accvgpr_write_b32 a179, 0
    v_mfma_f32_16x16x32_bf16 v[104:107], a[72:75], a[4:7], v[104:107]
    ds_read_b64_tr_b16 a[116:117], v26 offset:45056
    v_accvgpr_write_b32 a180, 0
    v_mfma_f32_16x16x32_bf16 v[108:111], a[76:79], a[4:7], v[108:111]
    ds_read_b64_tr_b16 a[118:119], v26 offset:45568
    v_accvgpr_write_b32 a181, 0
    v_mfma_f32_16x16x32_bf16 v[112:115], a[80:83], a[4:7], v[112:115]
    ds_read_b64_tr_b16 a[120:121], v27 offset:45056
    v_accvgpr_write_b32 a182, 0
    v_mfma_f32_16x16x32_bf16 v[116:119], a[84:87], a[4:7], v[116:119]
    ds_read_b64_tr_b16 a[122:123], v27 offset:45568
    v_accvgpr_write_b32 a183, 0
    v_mfma_f32_16x16x32_bf16 v[120:123], a[88:91], a[4:7], v[120:123]
    ds_read_b64_tr_b16 a[124:125], v28 offset:45056
    v_accvgpr_write_b32 a184, 0
    v_mfma_f32_16x16x32_bf16 v[124:127], a[92:95], a[4:7], v[124:127]
    ds_read_b64_tr_b16 a[126:127], v28 offset:45568
    s_add_u32 m0, s59, 32768
    s_mov_b32 s65, 512
    v_mfma_f32_16x16x32_bf16 v[128:131], a[64:67], a[8:11], v[128:131]
    buffer_load_dwordx4 v56, s[84:87], s65 offen offset:0 lds
    v_accvgpr_write_b32 a185, 0
    v_mfma_f32_16x16x32_bf16 v[132:135], a[68:71], a[8:11], v[132:135]
    buffer_load_dwordx4 v57, s[84:87], s65 offen offset:1024 lds
    v_accvgpr_write_b32 a186, 0
    v_mfma_f32_16x16x32_bf16 v[136:139], a[72:75], a[8:11], v[136:139]
    buffer_load_dwordx4 v58, s[84:87], s65 offen offset:2048 lds
    v_accvgpr_write_b32 a187, 0
    v_mfma_f32_16x16x32_bf16 v[140:143], a[76:79], a[8:11], v[140:143]
    buffer_load_dwordx4 v59, s[84:87], s65 offen offset:3072 lds
    v_accvgpr_write_b32 a188, 0
    v_mfma_f32_16x16x32_bf16 v[144:147], a[80:83], a[8:11], v[144:147]
    s_add_u32 m0, s59, 65536
    s_add_u32 s66, s64, 2097152
    v_accvgpr_write_b32 a189, 0
    v_mfma_f32_16x16x32_bf16 v[148:151], a[84:87], a[8:11], v[148:151]
    buffer_load_dwordx4 v20, s[88:91], s66 offen offset:0 lds
    v_accvgpr_write_b32 a190, 0
    v_mfma_f32_16x16x32_bf16 v[152:155], a[88:91], a[8:11], v[152:155]
    buffer_load_dwordx4 v21, s[88:91], s66 offen offset:1024 lds
    v_accvgpr_write_b32 a191, 0
    v_mfma_f32_16x16x32_bf16 v[156:159], a[92:95], a[8:11], v[156:159]
    buffer_load_dwordx4 v22, s[88:91], s66 offen offset:2048 lds
    v_accvgpr_write_b32 a244, -1
    v_mfma_f32_16x16x32_bf16 v[160:163], a[64:67], a[12:15], v[160:163]
    s_waitcnt vmcnt(16)
    ds_read_b128 a[208:211], v24 offset:49152
    v_accvgpr_write_b32 a245, -1
    v_mfma_f32_16x16x32_bf16 v[164:167], a[68:71], a[12:15], v[164:167]
    ds_read_b128 a[212:215], v24 offset:51200
    v_accvgpr_write_b32 a246, -1
    v_mfma_f32_16x16x32_bf16 v[168:171], a[72:75], a[12:15], v[168:171]
    ds_read_b128 a[224:227], v29 offset:49152
    v_accvgpr_write_b32 a247, -1
    v_mfma_f32_16x16x32_bf16 v[172:175], a[76:79], a[12:15], v[172:175]
    ds_read_b128 a[228:231], v29 offset:51200
    v_lshrrev_b32 v30, 1, v1
    v_mfma_f32_16x16x32_bf16 v[176:179], a[80:83], a[12:15], v[176:179]
    buffer_load_dwordx4 v23, s[88:91], s66 offen offset:3072 lds
    v_add_u32 v30, 133120, v30
    v_mfma_f32_16x16x32_bf16 v[180:183], a[84:87], a[12:15], v[180:183]
    v_mfma_f32_16x16x32_bf16 v[184:187], a[88:91], a[12:15], v[184:187]
    v_mfma_f32_16x16x32_bf16 v[188:191], a[92:95], a[12:15], v[188:191]
    s_waitcnt vmcnt(13) lgkmcnt(0)
    v_mfma_f32_16x16x32_bf16 v[64:67], a[96:99], a[16:19], v[64:67]
    s_barrier
    ds_read_b64_tr_b16 a[64:65], v25 offset:49152
    v_mfma_f32_16x16x32_bf16 v[68:71], a[100:103], a[16:19], v[68:71]
    ds_read_b64_tr_b16 a[66:67], v25 offset:49664
    v_mfma_f32_16x16x32_bf16 v[72:75], a[104:107], a[16:19], v[72:75]
    ds_read_b64_tr_b16 a[68:69], v26 offset:49152
    v_mfma_f32_16x16x32_bf16 v[76:79], a[108:111], a[16:19], v[76:79]
    ds_read_b64_tr_b16 a[70:71], v26 offset:49664
    v_mfma_f32_16x16x32_bf16 v[80:83], a[112:115], a[16:19], v[80:83]
    ds_read_b64_tr_b16 a[72:73], v27 offset:49152
    v_mfma_f32_16x16x32_bf16 v[84:87], a[116:119], a[16:19], v[84:87]
    ds_read_b64_tr_b16 a[74:75], v27 offset:49664
    v_mfma_f32_16x16x32_bf16 v[88:91], a[120:123], a[16:19], v[88:91]
    ds_read_b64_tr_b16 a[76:77], v28 offset:49152
    v_mfma_f32_16x16x32_bf16 v[92:95], a[124:127], a[16:19], v[92:95]
    ds_read_b64_tr_b16 a[78:79], v28 offset:49664
    v_mfma_f32_16x16x32_bf16 v[96:99], a[96:99], a[20:23], v[96:99]
    ds_read_b64_tr_b16 a[80:81], v25 offset:53248
    v_mfma_f32_16x16x32_bf16 v[100:103], a[100:103], a[20:23], v[100:103]
    ds_read_b64_tr_b16 a[82:83], v25 offset:53760
    v_mfma_f32_16x16x32_bf16 v[104:107], a[104:107], a[20:23], v[104:107]
    ds_read_b64_tr_b16 a[84:85], v26 offset:53248
    v_mfma_f32_16x16x32_bf16 v[108:111], a[108:111], a[20:23], v[108:111]
    ds_read_b64_tr_b16 a[86:87], v26 offset:53760
    v_mfma_f32_16x16x32_bf16 v[112:115], a[112:115], a[20:23], v[112:115]
    ds_read_b64_tr_b16 a[88:89], v27 offset:53248
    v_mfma_f32_16x16x32_bf16 v[116:119], a[116:119], a[20:23], v[116:119]
    ds_read_b64_tr_b16 a[90:91], v27 offset:53760
    v_mfma_f32_16x16x32_bf16 v[120:123], a[120:123], a[20:23], v[120:123]
    ds_read_b64_tr_b16 a[92:93], v28 offset:53248
    v_mfma_f32_16x16x32_bf16 v[124:127], a[124:127], a[20:23], v[124:127]
    ds_read_b64_tr_b16 a[94:95], v28 offset:53760
    v_mfma_f32_16x16x32_bf16 v[128:131], a[96:99], a[24:27], v[128:131]
    s_add_u32 m0, s59, 49152
    s_mov_b32 s65, 512
    v_mfma_f32_16x16x32_bf16 v[132:135], a[100:103], a[24:27], v[132:135]
    buffer_load_dwordx4 v60, s[84:87], s65 offen offset:0 lds
    v_mfma_f32_16x16x32_bf16 v[136:139], a[104:107], a[24:27], v[136:139]
    buffer_load_dwordx4 v61, s[84:87], s65 offen offset:1024 lds
    v_mfma_f32_16x16x32_bf16 v[140:143], a[108:111], a[24:27], v[140:143]
    buffer_load_dwordx4 v62, s[84:87], s65 offen offset:2048 lds
    v_mfma_f32_16x16x32_bf16 v[144:147], a[112:115], a[24:27], v[144:147]
    buffer_load_dwordx4 v63, s[84:87], s65 offen offset:3072 lds
    v_mfma_f32_16x16x32_bf16 v[148:151], a[116:119], a[24:27], v[148:151]
    v_mfma_f32_16x16x32_bf16 v[152:155], a[120:123], a[24:27], v[152:155]
    v_mfma_f32_16x16x32_bf16 v[156:159], a[124:127], a[24:27], v[156:159]
    v_mfma_f32_16x16x32_bf16 v[160:163], a[96:99], a[28:31], v[160:163]
    s_waitcnt vmcnt(12)
    ds_read_b128 a[216:219], v24 offset:16384
    v_mfma_f32_16x16x32_bf16 v[164:167], a[100:103], a[28:31], v[164:167]
    ds_read_b128 a[220:223], v24 offset:18432
    v_mfma_f32_16x16x32_bf16 v[168:171], a[104:107], a[28:31], v[168:171]
    ds_read_b128 a[232:235], v29 offset:16384
    v_mfma_f32_16x16x32_bf16 v[172:175], a[108:111], a[28:31], v[172:175]
    ds_read_b128 a[236:239], v29 offset:18432
    v_mfma_f32_16x16x32_bf16 v[176:179], a[112:115], a[28:31], v[176:179]
    v_mfma_f32_16x16x32_bf16 v[180:183], a[116:119], a[28:31], v[180:183]
    v_mfma_f32_16x16x32_bf16 v[184:187], a[120:123], a[28:31], v[184:187]
    v_mfma_f32_16x16x32_bf16 v[188:191], a[124:127], a[28:31], v[188:191]
    s_waitcnt lgkmcnt(0)
    v_mfma_f32_16x16x32_bf16 v[64:67], a[64:67], a[208:211], v[64:67]
    ds_read_b64_tr_b16 a[96:97], v25 offset:57344
    v_mfma_f32_16x16x32_bf16 v[68:71], a[68:71], a[208:211], v[68:71]
    ds_read_b64_tr_b16 a[98:99], v25 offset:57856
    v_mfma_f32_16x16x32_bf16 v[72:75], a[72:75], a[208:211], v[72:75]
    ds_read_b64_tr_b16 a[100:101], v26 offset:57344
    v_mfma_f32_16x16x32_bf16 v[76:79], a[76:79], a[208:211], v[76:79]
    ds_read_b64_tr_b16 a[102:103], v26 offset:57856
    v_mfma_f32_16x16x32_bf16 v[80:83], a[80:83], a[208:211], v[80:83]
    ds_read_b64_tr_b16 a[104:105], v27 offset:57344
    v_mfma_f32_16x16x32_bf16 v[84:87], a[84:87], a[208:211], v[84:87]
    ds_read_b64_tr_b16 a[106:107], v27 offset:57856
    v_mfma_f32_16x16x32_bf16 v[88:91], a[88:91], a[208:211], v[88:91]
    ds_read_b64_tr_b16 a[108:109], v28 offset:57344
    v_mfma_f32_16x16x32_bf16 v[92:95], a[92:95], a[208:211], v[92:95]
    ds_read_b64_tr_b16 a[110:111], v28 offset:57856
    v_mfma_f32_16x16x32_bf16 v[96:99], a[64:67], a[212:215], v[96:99]
    ds_read_b64_tr_b16 a[112:113], v25 offset:61440
    v_mfma_f32_16x16x32_bf16 v[100:103], a[68:71], a[212:215], v[100:103]
    ds_read_b64_tr_b16 a[114:115], v25 offset:61952
    v_mfma_f32_16x16x32_bf16 v[104:107], a[72:75], a[212:215], v[104:107]
    ds_read_b64_tr_b16 a[116:117], v26 offset:61440
    v_mfma_f32_16x16x32_bf16 v[108:111], a[76:79], a[212:215], v[108:111]
    ds_read_b64_tr_b16 a[118:119], v26 offset:61952
    v_mfma_f32_16x16x32_bf16 v[112:115], a[80:83], a[212:215], v[112:115]
    ds_read_b64_tr_b16 a[120:121], v27 offset:61440
    v_mfma_f32_16x16x32_bf16 v[116:119], a[84:87], a[212:215], v[116:119]
    ds_read_b64_tr_b16 a[122:123], v27 offset:61952
    v_mfma_f32_16x16x32_bf16 v[120:123], a[88:91], a[212:215], v[120:123]
    ds_read_b64_tr_b16 a[124:125], v28 offset:61440
    v_mfma_f32_16x16x32_bf16 v[124:127], a[92:95], a[212:215], v[124:127]
    ds_read_b64_tr_b16 a[126:127], v28 offset:61952
    s_add_u32 m0, s59, 16384
    s_mov_b32 s65, 640
    v_mfma_f32_16x16x32_bf16 v[128:131], a[64:67], a[216:219], v[128:131]
    buffer_load_dwordx4 v56, s[84:87], s65 offen offset:0 lds
    v_mfma_f32_16x16x32_bf16 v[132:135], a[68:71], a[216:219], v[132:135]
    buffer_load_dwordx4 v57, s[84:87], s65 offen offset:1024 lds
    v_mfma_f32_16x16x32_bf16 v[136:139], a[72:75], a[216:219], v[136:139]
    buffer_load_dwordx4 v58, s[84:87], s65 offen offset:2048 lds
    v_mfma_f32_16x16x32_bf16 v[140:143], a[76:79], a[216:219], v[140:143]
    buffer_load_dwordx4 v59, s[84:87], s65 offen offset:3072 lds
    v_mfma_f32_16x16x32_bf16 v[144:147], a[80:83], a[216:219], v[144:147]
    s_add_u32 m0, s59, 81920
    s_add_u32 s66, s64, 2621440
    v_mfma_f32_16x16x32_bf16 v[148:151], a[84:87], a[216:219], v[148:151]
    buffer_load_dwordx4 v20, s[88:91], s66 offen offset:0 lds
    v_mfma_f32_16x16x32_bf16 v[152:155], a[88:91], a[216:219], v[152:155]
    buffer_load_dwordx4 v21, s[88:91], s66 offen offset:1024 lds
    v_mfma_f32_16x16x32_bf16 v[156:159], a[92:95], a[216:219], v[156:159]
    buffer_load_dwordx4 v22, s[88:91], s66 offen offset:2048 lds
    v_mfma_f32_16x16x32_bf16 v[160:163], a[64:67], a[220:223], v[160:163]
    s_waitcnt vmcnt(15)
    ds_read_b128 a[0:3], v24 offset:32768
    v_mfma_f32_16x16x32_bf16 v[164:167], a[68:71], a[220:223], v[164:167]
    ds_read_b128 a[4:7], v24 offset:34816
    v_mfma_f32_16x16x32_bf16 v[168:171], a[72:75], a[220:223], v[168:171]
    ds_read_b128 a[16:19], v29 offset:32768
    v_mfma_f32_16x16x32_bf16 v[172:175], a[76:79], a[220:223], v[172:175]
    ds_read_b128 a[20:23], v29 offset:34816
    v_mfma_f32_16x16x32_bf16 v[176:179], a[80:83], a[220:223], v[176:179]
    buffer_load_dwordx4 v23, s[88:91], s66 offen offset:3072 lds
    v_mfma_f32_16x16x32_bf16 v[180:183], a[84:87], a[220:223], v[180:183]
    v_mfma_f32_16x16x32_bf16 v[184:187], a[88:91], a[220:223], v[184:187]
    v_mfma_f32_16x16x32_bf16 v[188:191], a[92:95], a[220:223], v[188:191]
    s_waitcnt vmcnt(12) lgkmcnt(0)
    v_mfma_f32_16x16x32_bf16 v[64:67], a[96:99], a[224:227], v[64:67]
    s_barrier
    ds_read_b64_tr_b16 a[64:65], v25 offset:0
    v_mfma_f32_16x16x32_bf16 v[68:71], a[100:103], a[224:227], v[68:71]
    ds_read_b64_tr_b16 a[66:67], v25 offset:512
    v_mfma_f32_16x16x32_bf16 v[72:75], a[104:107], a[224:227], v[72:75]
    ds_read_b64_tr_b16 a[68:69], v26 offset:0
    v_mfma_f32_16x16x32_bf16 v[76:79], a[108:111], a[224:227], v[76:79]
    ds_read_b64_tr_b16 a[70:71], v26 offset:512
    v_mfma_f32_16x16x32_bf16 v[80:83], a[112:115], a[224:227], v[80:83]
    ds_read_b64_tr_b16 a[72:73], v27 offset:0
    v_mfma_f32_16x16x32_bf16 v[84:87], a[116:119], a[224:227], v[84:87]
    ds_read_b64_tr_b16 a[74:75], v27 offset:512
    v_mfma_f32_16x16x32_bf16 v[88:91], a[120:123], a[224:227], v[88:91]
    ds_read_b64_tr_b16 a[76:77], v28 offset:0
    v_mfma_f32_16x16x32_bf16 v[92:95], a[124:127], a[224:227], v[92:95]
    ds_read_b64_tr_b16 a[78:79], v28 offset:512
    v_mfma_f32_16x16x32_bf16 v[96:99], a[96:99], a[228:231], v[96:99]
    ds_read_b64_tr_b16 a[80:81], v25 offset:4096
    v_mfma_f32_16x16x32_bf16 v[100:103], a[100:103], a[228:231], v[100:103]
    ds_read_b64_tr_b16 a[82:83], v25 offset:4608
    v_mfma_f32_16x16x32_bf16 v[104:107], a[104:107], a[228:231], v[104:107]
    ds_read_b64_tr_b16 a[84:85], v26 offset:4096
    v_mfma_f32_16x16x32_bf16 v[108:111], a[108:111], a[228:231], v[108:111]
    ds_read_b64_tr_b16 a[86:87], v26 offset:4608
    v_mfma_f32_16x16x32_bf16 v[112:115], a[112:115], a[228:231], v[112:115]
    ds_read_b64_tr_b16 a[88:89], v27 offset:4096
    v_mfma_f32_16x16x32_bf16 v[116:119], a[116:119], a[228:231], v[116:119]
    ds_read_b64_tr_b16 a[90:91], v27 offset:4608
    v_mfma_f32_16x16x32_bf16 v[120:123], a[120:123], a[228:231], v[120:123]
    ds_read_b64_tr_b16 a[92:93], v28 offset:4096
    v_mfma_f32_16x16x32_bf16 v[124:127], a[124:127], a[228:231], v[124:127]
    ds_read_b64_tr_b16 a[94:95], v28 offset:4608
    v_mfma_f32_16x16x32_bf16 v[128:131], a[96:99], a[232:235], v[128:131]
    s_add_u32 m0, s59, 32768
    s_mov_b32 s65, 640
    v_mfma_f32_16x16x32_bf16 v[132:135], a[100:103], a[232:235], v[132:135]
    buffer_load_dwordx4 v60, s[84:87], s65 offen offset:0 lds
    v_mfma_f32_16x16x32_bf16 v[136:139], a[104:107], a[232:235], v[136:139]
    buffer_load_dwordx4 v61, s[84:87], s65 offen offset:1024 lds
    v_mfma_f32_16x16x32_bf16 v[140:143], a[108:111], a[232:235], v[140:143]
    buffer_load_dwordx4 v62, s[84:87], s65 offen offset:2048 lds
    v_mfma_f32_16x16x32_bf16 v[144:147], a[112:115], a[232:235], v[144:147]
    buffer_load_dwordx4 v63, s[84:87], s65 offen offset:3072 lds
    v_mfma_f32_16x16x32_bf16 v[148:151], a[116:119], a[232:235], v[148:151]
    v_mfma_f32_16x16x32_bf16 v[152:155], a[120:123], a[232:235], v[152:155]
    v_mfma_f32_16x16x32_bf16 v[156:159], a[124:127], a[232:235], v[156:159]
    v_mfma_f32_16x16x32_bf16 v[160:163], a[96:99], a[236:239], v[160:163]
    s_waitcnt vmcnt(12)
    ds_read_b128 a[8:11], v24 offset:49152
    v_mfma_f32_16x16x32_bf16 v[164:167], a[100:103], a[236:239], v[164:167]
    ds_read_b128 a[12:15], v24 offset:51200
    v_mfma_f32_16x16x32_bf16 v[168:171], a[104:107], a[236:239], v[168:171]
    ds_read_b128 a[24:27], v29 offset:49152
    v_mfma_f32_16x16x32_bf16 v[172:175], a[108:111], a[236:239], v[172:175]
    ds_read_b128 a[28:31], v29 offset:51200
    v_mfma_f32_16x16x32_bf16 v[176:179], a[112:115], a[236:239], v[176:179]
    v_mfma_f32_16x16x32_bf16 v[180:183], a[116:119], a[236:239], v[180:183]
    v_mfma_f32_16x16x32_bf16 v[184:187], a[120:123], a[236:239], v[184:187]
    v_mfma_f32_16x16x32_bf16 v[188:191], a[124:127], a[236:239], v[188:191]
    s_waitcnt lgkmcnt(0)
    v_mfma_f32_16x16x32_bf16 v[64:67], a[64:67], a[0:3], v[64:67]
    ds_read_b64_tr_b16 a[96:97], v25 offset:8192
    v_mfma_f32_16x16x32_bf16 v[68:71], a[68:71], a[0:3], v[68:71]
    ds_read_b64_tr_b16 a[98:99], v25 offset:8704
    v_mfma_f32_16x16x32_bf16 v[72:75], a[72:75], a[0:3], v[72:75]
    ds_read_b64_tr_b16 a[100:101], v26 offset:8192
    v_mfma_f32_16x16x32_bf16 v[76:79], a[76:79], a[0:3], v[76:79]
    ds_read_b64_tr_b16 a[102:103], v26 offset:8704
    v_mfma_f32_16x16x32_bf16 v[80:83], a[80:83], a[0:3], v[80:83]
    ds_read_b64_tr_b16 a[104:105], v27 offset:8192
    v_mfma_f32_16x16x32_bf16 v[84:87], a[84:87], a[0:3], v[84:87]
    ds_read_b64_tr_b16 a[106:107], v27 offset:8704
    v_mfma_f32_16x16x32_bf16 v[88:91], a[88:91], a[0:3], v[88:91]
    ds_read_b64_tr_b16 a[108:109], v28 offset:8192
    v_mfma_f32_16x16x32_bf16 v[92:95], a[92:95], a[0:3], v[92:95]
    ds_read_b64_tr_b16 a[110:111], v28 offset:8704
    v_mfma_f32_16x16x32_bf16 v[96:99], a[64:67], a[4:7], v[96:99]
    ds_read_b64_tr_b16 a[112:113], v25 offset:12288
    v_mfma_f32_16x16x32_bf16 v[100:103], a[68:71], a[4:7], v[100:103]
    ds_read_b64_tr_b16 a[114:115], v25 offset:12800
    v_mfma_f32_16x16x32_bf16 v[104:107], a[72:75], a[4:7], v[104:107]
    ds_read_b64_tr_b16 a[116:117], v26 offset:12288
    v_mfma_f32_16x16x32_bf16 v[108:111], a[76:79], a[4:7], v[108:111]
    ds_read_b64_tr_b16 a[118:119], v26 offset:12800
    v_mfma_f32_16x16x32_bf16 v[112:115], a[80:83], a[4:7], v[112:115]
    ds_read_b64_tr_b16 a[120:121], v27 offset:12288
    v_mfma_f32_16x16x32_bf16 v[116:119], a[84:87], a[4:7], v[116:119]
    ds_read_b64_tr_b16 a[122:123], v27 offset:12800
    v_mfma_f32_16x16x32_bf16 v[120:123], a[88:91], a[4:7], v[120:123]
    ds_read_b64_tr_b16 a[124:125], v28 offset:12288
    v_mfma_f32_16x16x32_bf16 v[124:127], a[92:95], a[4:7], v[124:127]
    ds_read_b64_tr_b16 a[126:127], v28 offset:12800
    s_add_u32 m0, s59, 49152
    s_mov_b32 s65, 768
    v_mfma_f32_16x16x32_bf16 v[128:131], a[64:67], a[8:11], v[128:131]
    buffer_load_dwordx4 v56, s[84:87], s65 offen offset:0 lds
    v_mfma_f32_16x16x32_bf16 v[132:135], a[68:71], a[8:11], v[132:135]
    buffer_load_dwordx4 v57, s[84:87], s65 offen offset:1024 lds
    v_mfma_f32_16x16x32_bf16 v[136:139], a[72:75], a[8:11], v[136:139]
    buffer_load_dwordx4 v58, s[84:87], s65 offen offset:2048 lds
    v_mfma_f32_16x16x32_bf16 v[140:143], a[76:79], a[8:11], v[140:143]
    buffer_load_dwordx4 v59, s[84:87], s65 offen offset:3072 lds
    v_mfma_f32_16x16x32_bf16 v[144:147], a[80:83], a[8:11], v[144:147]
    s_add_u32 m0, s59, 98304
    s_add_u32 s66, s64, 3145728
    v_mfma_f32_16x16x32_bf16 v[148:151], a[84:87], a[8:11], v[148:151]
    buffer_load_dwordx4 v20, s[88:91], s66 offen offset:0 lds
    v_mfma_f32_16x16x32_bf16 v[152:155], a[88:91], a[8:11], v[152:155]
    buffer_load_dwordx4 v21, s[88:91], s66 offen offset:1024 lds
    v_mfma_f32_16x16x32_bf16 v[156:159], a[92:95], a[8:11], v[156:159]
    buffer_load_dwordx4 v22, s[88:91], s66 offen offset:2048 lds
    v_mfma_f32_16x16x32_bf16 v[160:163], a[64:67], a[12:15], v[160:163]
    s_waitcnt vmcnt(15)
    ds_read_b128 a[208:211], v24 offset:16384
    v_mfma_f32_16x16x32_bf16 v[164:167], a[68:71], a[12:15], v[164:167]
    ds_read_b128 a[212:215], v24 offset:18432
    v_mfma_f32_16x16x32_bf16 v[168:171], a[72:75], a[12:15], v[168:171]
    ds_read_b128 a[224:227], v29 offset:16384
    v_mfma_f32_16x16x32_bf16 v[172:175], a[76:79], a[12:15], v[172:175]
    ds_read_b128 a[228:231], v29 offset:18432
    v_mfma_f32_16x16x32_bf16 v[176:179], a[80:83], a[12:15], v[176:179]
    buffer_load_dwordx4 v23, s[88:91], s66 offen offset:3072 lds
    v_mfma_f32_16x16x32_bf16 v[180:183], a[84:87], a[12:15], v[180:183]
    v_mfma_f32_16x16x32_bf16 v[184:187], a[88:91], a[12:15], v[184:187]
    v_mfma_f32_16x16x32_bf16 v[188:191], a[92:95], a[12:15], v[188:191]
    s_waitcnt vmcnt(12) lgkmcnt(0)
    v_mfma_f32_16x16x32_bf16 v[64:67], a[96:99], a[16:19], v[64:67]
    s_barrier
    ds_read_b64_tr_b16 a[64:65], v25 offset:16384
    v_mfma_f32_16x16x32_bf16 v[68:71], a[100:103], a[16:19], v[68:71]
    ds_read_b64_tr_b16 a[66:67], v25 offset:16896
    v_mfma_f32_16x16x32_bf16 v[72:75], a[104:107], a[16:19], v[72:75]
    ds_read_b64_tr_b16 a[68:69], v26 offset:16384
    v_mfma_f32_16x16x32_bf16 v[76:79], a[108:111], a[16:19], v[76:79]
    ds_read_b64_tr_b16 a[70:71], v26 offset:16896
    v_mfma_f32_16x16x32_bf16 v[80:83], a[112:115], a[16:19], v[80:83]
    ds_read_b64_tr_b16 a[72:73], v27 offset:16384
    v_mfma_f32_16x16x32_bf16 v[84:87], a[116:119], a[16:19], v[84:87]
    ds_read_b64_tr_b16 a[74:75], v27 offset:16896
    v_mfma_f32_16x16x32_bf16 v[88:91], a[120:123], a[16:19], v[88:91]
    ds_read_b64_tr_b16 a[76:77], v28 offset:16384
    v_mfma_f32_16x16x32_bf16 v[92:95], a[124:127], a[16:19], v[92:95]
    ds_read_b64_tr_b16 a[78:79], v28 offset:16896
    v_mfma_f32_16x16x32_bf16 v[96:99], a[96:99], a[20:23], v[96:99]
    ds_read_b64_tr_b16 a[80:81], v25 offset:20480
    v_mfma_f32_16x16x32_bf16 v[100:103], a[100:103], a[20:23], v[100:103]
    ds_read_b64_tr_b16 a[82:83], v25 offset:20992
    v_mfma_f32_16x16x32_bf16 v[104:107], a[104:107], a[20:23], v[104:107]
    ds_read_b64_tr_b16 a[84:85], v26 offset:20480
    v_mfma_f32_16x16x32_bf16 v[108:111], a[108:111], a[20:23], v[108:111]
    ds_read_b64_tr_b16 a[86:87], v26 offset:20992
    v_mfma_f32_16x16x32_bf16 v[112:115], a[112:115], a[20:23], v[112:115]
    ds_read_b64_tr_b16 a[88:89], v27 offset:20480
    v_mfma_f32_16x16x32_bf16 v[116:119], a[116:119], a[20:23], v[116:119]
    ds_read_b64_tr_b16 a[90:91], v27 offset:20992
    v_mfma_f32_16x16x32_bf16 v[120:123], a[120:123], a[20:23], v[120:123]
    ds_read_b64_tr_b16 a[92:93], v28 offset:20480
    v_mfma_f32_16x16x32_bf16 v[124:127], a[124:127], a[20:23], v[124:127]
    ds_read_b64_tr_b16 a[94:95], v28 offset:20992
    v_mfma_f32_16x16x32_bf16 v[128:131], a[96:99], a[24:27], v[128:131]
    s_add_u32 m0, s59, 16384
    s_mov_b32 s65, 768
    v_mfma_f32_16x16x32_bf16 v[132:135], a[100:103], a[24:27], v[132:135]
    buffer_load_dwordx4 v60, s[84:87], s65 offen offset:0 lds
    v_mfma_f32_16x16x32_bf16 v[136:139], a[104:107], a[24:27], v[136:139]
    buffer_load_dwordx4 v61, s[84:87], s65 offen offset:1024 lds
    v_mfma_f32_16x16x32_bf16 v[140:143], a[108:111], a[24:27], v[140:143]
    buffer_load_dwordx4 v62, s[84:87], s65 offen offset:2048 lds
    v_mfma_f32_16x16x32_bf16 v[144:147], a[112:115], a[24:27], v[144:147]
    buffer_load_dwordx4 v63, s[84:87], s65 offen offset:3072 lds
    v_mfma_f32_16x16x32_bf16 v[148:151], a[116:119], a[24:27], v[148:151]
    v_mfma_f32_16x16x32_bf16 v[152:155], a[120:123], a[24:27], v[152:155]
    v_mfma_f32_16x16x32_bf16 v[156:159], a[124:127], a[24:27], v[156:159]
    v_mfma_f32_16x16x32_bf16 v[160:163], a[96:99], a[28:31], v[160:163]
    s_waitcnt vmcnt(12)
    ds_read_b128 a[216:219], v24 offset:32768
    v_mfma_f32_16x16x32_bf16 v[164:167], a[100:103], a[28:31], v[164:167]
    ds_read_b128 a[220:223], v24 offset:34816
    v_mfma_f32_16x16x32_bf16 v[168:171], a[104:107], a[28:31], v[168:171]
    ds_read_b128 a[232:235], v29 offset:32768
    v_mfma_f32_16x16x32_bf16 v[172:175], a[108:111], a[28:31], v[172:175]
    ds_read_b128 a[236:239], v29 offset:34816
    v_mfma_f32_16x16x32_bf16 v[176:179], a[112:115], a[28:31], v[176:179]
    ds_write_b64 v30, v[192:193]
    v_mfma_f32_16x16x32_bf16 v[180:183], a[116:119], a[28:31], v[180:183]
    ds_write_b64 v30, v[192:193] offset:4608
    v_mfma_f32_16x16x32_bf16 v[184:187], a[120:123], a[28:31], v[184:187]
    v_mfma_f32_16x16x32_bf16 v[188:191], a[124:127], a[28:31], v[188:191]
    s_waitcnt lgkmcnt(2)
    v_mfma_f32_16x16x32_bf16 v[64:67], a[64:67], a[208:211], v[64:67]
    ds_read_b64_tr_b16 a[96:97], v25 offset:24576
    v_mfma_f32_16x16x32_bf16 v[68:71], a[68:71], a[208:211], v[68:71]
    ds_read_b64_tr_b16 a[98:99], v25 offset:25088
    v_mfma_f32_16x16x32_bf16 v[72:75], a[72:75], a[208:211], v[72:75]
    ds_read_b64_tr_b16 a[100:101], v26 offset:24576
    v_mfma_f32_16x16x32_bf16 v[76:79], a[76:79], a[208:211], v[76:79]
    ds_read_b64_tr_b16 a[102:103], v26 offset:25088
    v_mfma_f32_16x16x32_bf16 v[80:83], a[80:83], a[208:211], v[80:83]
    ds_read_b64_tr_b16 a[104:105], v27 offset:24576
    v_mfma_f32_16x16x32_bf16 v[84:87], a[84:87], a[208:211], v[84:87]
    ds_read_b64_tr_b16 a[106:107], v27 offset:25088
    v_mfma_f32_16x16x32_bf16 v[88:91], a[88:91], a[208:211], v[88:91]
    ds_read_b64_tr_b16 a[108:109], v28 offset:24576
    v_mfma_f32_16x16x32_bf16 v[92:95], a[92:95], a[208:211], v[92:95]
    ds_read_b64_tr_b16 a[110:111], v28 offset:25088
    v_mfma_f32_16x16x32_bf16 v[96:99], a[64:67], a[212:215], v[96:99]
    ds_read_b64_tr_b16 a[112:113], v25 offset:28672
    v_mfma_f32_16x16x32_bf16 v[100:103], a[68:71], a[212:215], v[100:103]
    ds_read_b64_tr_b16 a[114:115], v25 offset:29184
    v_mfma_f32_16x16x32_bf16 v[104:107], a[72:75], a[212:215], v[104:107]
    ds_read_b64_tr_b16 a[116:117], v26 offset:28672
    v_mfma_f32_16x16x32_bf16 v[108:111], a[76:79], a[212:215], v[108:111]
    ds_read_b64_tr_b16 a[118:119], v26 offset:29184
    v_mfma_f32_16x16x32_bf16 v[112:115], a[80:83], a[212:215], v[112:115]
    ds_read_b64_tr_b16 a[120:121], v27 offset:28672
    v_mfma_f32_16x16x32_bf16 v[116:119], a[84:87], a[212:215], v[116:119]
    ds_read_b64_tr_b16 a[122:123], v27 offset:29184
    v_mfma_f32_16x16x32_bf16 v[120:123], a[88:91], a[212:215], v[120:123]
    ds_read_b64_tr_b16 a[124:125], v28 offset:28672
    v_mfma_f32_16x16x32_bf16 v[124:127], a[92:95], a[212:215], v[124:127]
    ds_read_b64_tr_b16 a[126:127], v28 offset:29184
    s_add_u32 m0, s59, 32768
    s_mov_b32 s65, 896
    v_mfma_f32_16x16x32_bf16 v[128:131], a[64:67], a[216:219], v[128:131]
    buffer_load_dwordx4 v56, s[84:87], s65 offen offset:0 lds
    v_mfma_f32_16x16x32_bf16 v[132:135], a[68:71], a[216:219], v[132:135]
    buffer_load_dwordx4 v57, s[84:87], s65 offen offset:1024 lds
    v_mfma_f32_16x16x32_bf16 v[136:139], a[72:75], a[216:219], v[136:139]
    buffer_load_dwordx4 v58, s[84:87], s65 offen offset:2048 lds
    v_mfma_f32_16x16x32_bf16 v[140:143], a[76:79], a[216:219], v[140:143]
    buffer_load_dwordx4 v59, s[84:87], s65 offen offset:3072 lds
    v_mfma_f32_16x16x32_bf16 v[144:147], a[80:83], a[216:219], v[144:147]
    s_add_u32 m0, s59, 114688
    s_add_u32 s66, s64, 3670016
    v_mfma_f32_16x16x32_bf16 v[148:151], a[84:87], a[216:219], v[148:151]
    buffer_load_dwordx4 v20, s[88:91], s66 offen offset:0 lds
    v_mfma_f32_16x16x32_bf16 v[152:155], a[88:91], a[216:219], v[152:155]
    buffer_load_dwordx4 v21, s[88:91], s66 offen offset:1024 lds
    v_mfma_f32_16x16x32_bf16 v[156:159], a[92:95], a[216:219], v[156:159]
    buffer_load_dwordx4 v22, s[88:91], s66 offen offset:2048 lds
    v_mfma_f32_16x16x32_bf16 v[160:163], a[64:67], a[220:223], v[160:163]
    s_waitcnt vmcnt(15)
    ds_read_b128 a[0:3], v24 offset:49152
    v_mfma_f32_16x16x32_bf16 v[164:167], a[68:71], a[220:223], v[164:167]
    ds_read_b128 a[4:7], v24 offset:51200
    v_mfma_f32_16x16x32_bf16 v[168:171], a[72:75], a[220:223], v[168:171]
    ds_read_b128 a[16:19], v29 offset:49152
    v_mfma_f32_16x16x32_bf16 v[172:175], a[76:79], a[220:223], v[172:175]
    ds_read_b128 a[20:23], v29 offset:51200
    v_mfma_f32_16x16x32_bf16 v[176:179], a[80:83], a[220:223], v[176:179]
    buffer_load_dwordx4 v23, s[88:91], s66 offen offset:3072 lds
    v_mfma_f32_16x16x32_bf16 v[180:183], a[84:87], a[220:223], v[180:183]
    v_mfma_f32_16x16x32_bf16 v[184:187], a[88:91], a[220:223], v[184:187]
    v_mfma_f32_16x16x32_bf16 v[188:191], a[92:95], a[220:223], v[188:191]
    s_waitcnt vmcnt(12) lgkmcnt(0)
    v_mfma_f32_16x16x32_bf16 v[64:67], a[96:99], a[224:227], v[64:67]
    s_barrier
    ds_read_b64_tr_b16 a[64:65], v25 offset:32768
    v_mfma_f32_16x16x32_bf16 v[68:71], a[100:103], a[224:227], v[68:71]
    ds_read_b64_tr_b16 a[66:67], v25 offset:33280
    v_mfma_f32_16x16x32_bf16 v[72:75], a[104:107], a[224:227], v[72:75]
    ds_read_b64_tr_b16 a[68:69], v26 offset:32768
    v_mfma_f32_16x16x32_bf16 v[76:79], a[108:111], a[224:227], v[76:79]
    ds_read_b64_tr_b16 a[70:71], v26 offset:33280
    v_mfma_f32_16x16x32_bf16 v[80:83], a[112:115], a[224:227], v[80:83]
    ds_read_b64_tr_b16 a[72:73], v27 offset:32768
    v_mfma_f32_16x16x32_bf16 v[84:87], a[116:119], a[224:227], v[84:87]
    ds_read_b64_tr_b16 a[74:75], v27 offset:33280
    v_mfma_f32_16x16x32_bf16 v[88:91], a[120:123], a[224:227], v[88:91]
    ds_read_b64_tr_b16 a[76:77], v28 offset:32768
    v_mfma_f32_16x16x32_bf16 v[92:95], a[124:127], a[224:227], v[92:95]
    ds_read_b64_tr_b16 a[78:79], v28 offset:33280
    v_mfma_f32_16x16x32_bf16 v[96:99], a[96:99], a[228:231], v[96:99]
    ds_read_b64_tr_b16 a[80:81], v25 offset:36864
    v_mfma_f32_16x16x32_bf16 v[100:103], a[100:103], a[228:231], v[100:103]
    ds_read_b64_tr_b16 a[82:83], v25 offset:37376
    v_mfma_f32_16x16x32_bf16 v[104:107], a[104:107], a[228:231], v[104:107]
    ds_read_b64_tr_b16 a[84:85], v26 offset:36864
    v_mfma_f32_16x16x32_bf16 v[108:111], a[108:111], a[228:231], v[108:111]
    ds_read_b64_tr_b16 a[86:87], v26 offset:37376
    v_mfma_f32_16x16x32_bf16 v[112:115], a[112:115], a[228:231], v[112:115]
    ds_read_b64_tr_b16 a[88:89], v27 offset:36864
    v_mfma_f32_16x16x32_bf16 v[116:119], a[116:119], a[228:231], v[116:119]
    ds_read_b64_tr_b16 a[90:91], v27 offset:37376
    v_mfma_f32_16x16x32_bf16 v[120:123], a[120:123], a[228:231], v[120:123]
    ds_read_b64_tr_b16 a[92:93], v28 offset:36864
    v_mfma_f32_16x16x32_bf16 v[124:127], a[124:127], a[228:231], v[124:127]
    ds_read_b64_tr_b16 a[94:95], v28 offset:37376
    v_mfma_f32_16x16x32_bf16 v[128:131], a[96:99], a[232:235], v[128:131]
    s_add_u32 m0, s59, 49152
    s_mov_b32 s65, 896
    v_mfma_f32_16x16x32_bf16 v[132:135], a[100:103], a[232:235], v[132:135]
    buffer_load_dwordx4 v60, s[84:87], s65 offen offset:0 lds
    v_mfma_f32_16x16x32_bf16 v[136:139], a[104:107], a[232:235], v[136:139]
    buffer_load_dwordx4 v61, s[84:87], s65 offen offset:1024 lds
    v_mfma_f32_16x16x32_bf16 v[140:143], a[108:111], a[232:235], v[140:143]
    buffer_load_dwordx4 v62, s[84:87], s65 offen offset:2048 lds
    v_mfma_f32_16x16x32_bf16 v[144:147], a[112:115], a[232:235], v[144:147]
    buffer_load_dwordx4 v63, s[84:87], s65 offen offset:3072 lds
    v_mfma_f32_16x16x32_bf16 v[148:151], a[116:119], a[232:235], v[148:151]
    buffer_load_dword v9, v10, s[80:83], s67 offen sc1
    v_mfma_f32_16x16x32_bf16 v[152:155], a[120:123], a[232:235], v[152:155]
    v_mfma_f32_16x16x32_bf16 v[156:159], a[124:127], a[232:235], v[156:159]
    v_mfma_f32_16x16x32_bf16 v[160:163], a[96:99], a[236:239], v[160:163]
    s_waitcnt vmcnt(13)
    ds_read_b128 a[8:11], v24 offset:16384
    v_mfma_f32_16x16x32_bf16 v[164:167], a[100:103], a[236:239], v[164:167]
    ds_read_b128 a[12:15], v24 offset:18432
    v_mfma_f32_16x16x32_bf16 v[168:171], a[104:107], a[236:239], v[168:171]
    ds_read_b128 a[24:27], v29 offset:16384
    v_mfma_f32_16x16x32_bf16 v[172:175], a[108:111], a[236:239], v[172:175]
    ds_read_b128 a[28:31], v29 offset:18432
    v_mfma_f32_16x16x32_bf16 v[176:179], a[112:115], a[236:239], v[176:179]
    v_mfma_f32_16x16x32_bf16 v[180:183], a[116:119], a[236:239], v[180:183]
    v_mfma_f32_16x16x32_bf16 v[184:187], a[120:123], a[236:239], v[184:187]
    v_mfma_f32_16x16x32_bf16 v[188:191], a[124:127], a[236:239], v[188:191]
    s_waitcnt lgkmcnt(0)
    v_mfma_f32_16x16x32_bf16 v[64:67], a[64:67], a[0:3], v[64:67]
    ds_read_b64_tr_b16 a[96:97], v25 offset:40960
    s_mov_b32 s88, s38
    v_mfma_f32_16x16x32_bf16 v[68:71], a[68:71], a[0:3], v[68:71]
    ds_read_b64_tr_b16 a[98:99], v25 offset:41472
    s_mov_b32 s89, s39
    v_mfma_f32_16x16x32_bf16 v[72:75], a[72:75], a[0:3], v[72:75]
    ds_read_b64_tr_b16 a[100:101], v26 offset:40960
    s_mov_b32 s90, 4194304
    v_mfma_f32_16x16x32_bf16 v[76:79], a[76:79], a[0:3], v[76:79]
    ds_read_b64_tr_b16 a[102:103], v26 offset:41472
    s_mov_b32 s91, 0x00020000
    v_mfma_f32_16x16x32_bf16 v[80:83], a[80:83], a[0:3], v[80:83]
    ds_read_b64_tr_b16 a[104:105], v27 offset:40960
    v_lshrrev_b32 v11, 3, v0
    v_mfma_f32_16x16x32_bf16 v[84:87], a[84:87], a[0:3], v[84:87]
    ds_read_b64_tr_b16 a[106:107], v27 offset:41472
    v_lshlrev_b32 v11, 10, v11
    v_mfma_f32_16x16x32_bf16 v[88:91], a[88:91], a[0:3], v[88:91]
    ds_read_b64_tr_b16 a[108:109], v28 offset:40960
    v_and_b32 v12, 1, v0
    v_mfma_f32_16x16x32_bf16 v[92:95], a[92:95], a[0:3], v[92:95]
    ds_read_b64_tr_b16 a[110:111], v28 offset:41472
    v_lshl_add_u32 v11, v12, 4, v11
    v_mfma_f32_16x16x32_bf16 v[96:99], a[64:67], a[4:7], v[96:99]
    ds_read_b64_tr_b16 a[112:113], v25 offset:45056
    v_bfe_u32 v12, v0, 1, 2
    v_mfma_f32_16x16x32_bf16 v[100:103], a[68:71], a[4:7], v[100:103]
    ds_read_b64_tr_b16 a[114:115], v25 offset:45568
    v_lshrrev_b32 v13, 4, v0
    v_mfma_f32_16x16x32_bf16 v[104:107], a[72:75], a[4:7], v[104:107]
    ds_read_b64_tr_b16 a[116:117], v26 offset:45056
    v_xor_b32 v12, v12, v13
    v_mfma_f32_16x16x32_bf16 v[108:111], a[76:79], a[4:7], v[108:111]
    ds_read_b64_tr_b16 a[118:119], v26 offset:45568
    v_lshl_add_u32 v11, v12, 5, v11
    v_mfma_f32_16x16x32_bf16 v[112:115], a[80:83], a[4:7], v[112:115]
    ds_read_b64_tr_b16 a[120:121], v27 offset:45056
    s_lshr_b32 s84, s2, 1
    v_mfma_f32_16x16x32_bf16 v[116:119], a[84:87], a[4:7], v[116:119]
    ds_read_b64_tr_b16 a[122:123], v27 offset:45568
    s_lshl_b32 s85, s84, 15
    v_mfma_f32_16x16x32_bf16 v[120:123], a[88:91], a[4:7], v[120:123]
    ds_read_b64_tr_b16 a[124:125], v28 offset:45056
    s_and_b32 s86, s2, 1
    v_mfma_f32_16x16x32_bf16 v[124:127], a[92:95], a[4:7], v[124:127]
    ds_read_b64_tr_b16 a[126:127], v28 offset:45568
    s_lshl_b32 s86, s86, 2
    v_mfma_f32_16x16x32_bf16 v[128:131], a[64:67], a[8:11], v[128:131]
    s_add_u32 s86, s86, s3
    s_lshl_b32 s87, s86, 7
    v_mfma_f32_16x16x32_bf16 v[132:135], a[68:71], a[8:11], v[132:135]
    s_add_u32 s85, s85, s87
    s_lshl_b32 s87, s3, 12
    v_mfma_f32_16x16x32_bf16 v[136:139], a[72:75], a[8:11], v[136:139]
    s_add_u32 s87, s87, 147456
    s_lshl_b32 s86, s86, 19
    v_mfma_f32_16x16x32_bf16 v[140:143], a[76:79], a[8:11], v[140:143]
    s_lshl_b32 s84, s84, 11
    s_add_u32 s86, s86, s84
    v_mfma_f32_16x16x32_bf16 v[144:147], a[80:83], a[8:11], v[144:147]
    s_add_u32 s84, s86, 262144
    v_mfma_f32_16x16x32_bf16 v[148:151], a[84:87], a[8:11], v[148:151]
    v_mfma_f32_16x16x32_bf16 v[152:155], a[88:91], a[8:11], v[152:155]
    v_mfma_f32_16x16x32_bf16 v[156:159], a[92:95], a[8:11], v[156:159]
    v_mfma_f32_16x16x32_bf16 v[160:163], a[64:67], a[12:15], v[160:163]
    s_waitcnt vmcnt(9)
    ds_read_b128 a[208:211], v24 offset:32768
    v_mfma_f32_16x16x32_bf16 v[164:167], a[68:71], a[12:15], v[164:167]
    ds_read_b128 a[212:215], v24 offset:34816
    v_mfma_f32_16x16x32_bf16 v[168:171], a[72:75], a[12:15], v[168:171]
    ds_read_b128 a[224:227], v29 offset:32768
    v_mfma_f32_16x16x32_bf16 v[172:175], a[76:79], a[12:15], v[172:175]
    ds_read_b128 a[228:231], v29 offset:34816
    v_mfma_f32_16x16x32_bf16 v[176:179], a[80:83], a[12:15], v[176:179]
    v_mfma_f32_16x16x32_bf16 v[180:183], a[84:87], a[12:15], v[180:183]
    v_mfma_f32_16x16x32_bf16 v[184:187], a[88:91], a[12:15], v[184:187]
    v_mfma_f32_16x16x32_bf16 v[188:191], a[92:95], a[12:15], v[188:191]
    s_waitcnt vmcnt(5) lgkmcnt(0)
    s_waitcnt vmcnt(0)
    v_cmp_gt_u32 vcc, 8, v9
    s_and_b64 vcc, vcc, s[18:19]
    s_cbranch_scc1 GM_POLL1
GM_PB1:
    v_mfma_f32_16x16x32_bf16 v[64:67], a[96:99], a[16:19], v[64:67]
    s_barrier
    ds_read_b64_tr_b16 a[64:65], v25 offset:49152
    s_mov_b32 m0, s59
    v_mfma_f32_16x16x32_bf16 v[68:71], a[100:103], a[16:19], v[68:71]
    ds_read_b64_tr_b16 a[66:67], v25 offset:49664
    buffer_load_dwordx4 v1, s[48:51], s56 offen offset:0 sc1 lds
    v_mfma_f32_16x16x32_bf16 v[72:75], a[104:107], a[16:19], v[72:75]
    ds_read_b64_tr_b16 a[68:69], v26 offset:49152
    buffer_load_dwordx4 v1, s[48:51], s56 offen offset:1024 sc1 lds
    v_mfma_f32_16x16x32_bf16 v[76:79], a[108:111], a[16:19], v[76:79]
    ds_read_b64_tr_b16 a[70:71], v26 offset:49664
    buffer_load_dwordx4 v1, s[48:51], s56 offen offset:2048 sc1 lds
    v_mfma_f32_16x16x32_bf16 v[80:83], a[112:115], a[16:19], v[80:83]
    ds_read_b64_tr_b16 a[72:73], v27 offset:49152
    buffer_load_dwordx4 v1, s[48:51], s56 offen offset:3072 sc1 lds
    v_mfma_f32_16x16x32_bf16 v[84:87], a[116:119], a[16:19], v[84:87]
    ds_read_b64_tr_b16 a[74:75], v27 offset:49664
    s_add_u32 m0, s59, 65536
    v_mfma_f32_16x16x32_bf16 v[88:91], a[120:123], a[16:19], v[88:91]
    ds_read_b64_tr_b16 a[76:77], v28 offset:49152
    s_add_u32 s60, s56, 20979712
    v_mfma_f32_16x16x32_bf16 v[92:95], a[124:127], a[16:19], v[92:95]
    ds_read_b64_tr_b16 a[78:79], v28 offset:49664
    buffer_load_dwordx4 v1, s[48:51], s60 offen offset:0 sc1 lds
    v_mfma_f32_16x16x32_bf16 v[96:99], a[96:99], a[20:23], v[96:99]
    ds_read_b64_tr_b16 a[80:81], v25 offset:53248
    v_mfma_f32_16x16x32_bf16 v[100:103], a[100:103], a[20:23], v[100:103]
    ds_read_b64_tr_b16 a[82:83], v25 offset:53760
    buffer_load_dwordx4 v1, s[48:51], s60 offen offset:1024 sc1 lds
    v_mfma_f32_16x16x32_bf16 v[104:107], a[104:107], a[20:23], v[104:107]
    ds_read_b64_tr_b16 a[84:85], v26 offset:53248
    v_mfma_f32_16x16x32_bf16 v[108:111], a[108:111], a[20:23], v[108:111]
    ds_read_b64_tr_b16 a[86:87], v26 offset:53760
    buffer_load_dwordx4 v1, s[48:51], s60 offen offset:2048 sc1 lds
    v_mfma_f32_16x16x32_bf16 v[112:115], a[112:115], a[20:23], v[112:115]
    ds_read_b64_tr_b16 a[88:89], v27 offset:53248
    v_mfma_f32_16x16x32_bf16 v[116:119], a[116:119], a[20:23], v[116:119]
    ds_read_b64_tr_b16 a[90:91], v27 offset:53760
    buffer_load_dwordx4 v1, s[48:51], s60 offen offset:3072 sc1 lds
    v_mfma_f32_16x16x32_bf16 v[120:123], a[120:123], a[20:23], v[120:123]
    ds_read_b64_tr_b16 a[92:93], v28 offset:53248
    v_mfma_f32_16x16x32_bf16 v[124:127], a[124:127], a[20:23], v[124:127]
    ds_read_b64_tr_b16 a[94:95], v28 offset:53760
    s_add_u32 s56, s56, 16384
    v_mfma_f32_16x16x32_bf16 v[128:131], a[96:99], a[24:27], v[128:131]
    s_cmp_ge_u32 s56, s57
    s_cselect_b32 s56, 0x40000000, s56
    v_mfma_f32_16x16x32_bf16 v[132:135], a[100:103], a[24:27], v[132:135]
    s_add_u32 s59, s59, 16384
    v_mfma_f32_16x16x32_bf16 v[136:139], a[104:107], a[24:27], v[136:139]
    s_and_b32 s59, s59, 0xffff
    v_mfma_f32_16x16x32_bf16 v[140:143], a[108:111], a[24:27], v[140:143]
    s_mov_b32 m0, s59
    v_mfma_f32_16x16x32_bf16 v[144:147], a[112:115], a[24:27], v[144:147]
    v_mfma_f32_16x16x32_bf16 v[148:151], a[116:119], a[24:27], v[148:151]
    buffer_load_dwordx4 v1, s[48:51], s56 offen offset:0 sc1 lds
    v_mfma_f32_16x16x32_bf16 v[152:155], a[120:123], a[24:27], v[152:155]
    buffer_load_dwordx4 v1, s[48:51], s56 offen offset:1024 sc1 lds
    v_mfma_f32_16x16x32_bf16 v[156:159], a[124:127], a[24:27], v[156:159]
    buffer_load_dwordx4 v1, s[48:51], s56 offen offset:2048 sc1 lds
    v_mfma_f32_16x16x32_bf16 v[160:163], a[96:99], a[28:31], v[160:163]
    ds_read_b128 a[216:219], v24 offset:49152
    v_mfma_f32_16x16x32_bf16 v[164:167], a[100:103], a[28:31], v[164:167]
    ds_read_b128 a[220:223], v24 offset:51200
    v_mfma_f32_16x16x32_bf16 v[168:171], a[104:107], a[28:31], v[168:171]
    ds_read_b128 a[232:235], v29 offset:49152
    v_mfma_f32_16x16x32_bf16 v[172:175], a[108:111], a[28:31], v[172:175]
    ds_read_b128 a[236:239], v29 offset:51200
    v_mfma_f32_16x16x32_bf16 v[176:179], a[112:115], a[28:31], v[176:179]
    buffer_load_dwordx4 v1, s[48:51], s56 offen offset:3072 sc1 lds
    v_mfma_f32_16x16x32_bf16 v[180:183], a[116:119], a[28:31], v[180:183]
    v_mfma_f32_16x16x32_bf16 v[184:187], a[120:123], a[28:31], v[184:187]
    v_mfma_f32_16x16x32_bf16 v[188:191], a[124:127], a[28:31], v[188:191]
    s_waitcnt lgkmcnt(0)
    v_mfma_f32_16x16x32_bf16 v[64:67], a[64:67], a[208:211], v[64:67]
    ds_read_b64_tr_b16 a[96:97], v25 offset:57344
    v_mfma_f32_16x16x32_bf16 v[68:71], a[68:71], a[208:211], v[68:71]
    ds_read_b64_tr_b16 a[98:99], v25 offset:57856
    v_mfma_f32_16x16x32_bf16 v[72:75], a[72:75], a[208:211], v[72:75]
    ds_read_b64_tr_b16 a[100:101], v26 offset:57344
    v_mfma_f32_16x16x32_bf16 v[76:79], a[76:79], a[208:211], v[76:79]
    ds_read_b64_tr_b16 a[102:103], v26 offset:57856
    s_add_u32 m0, s59, 65536
    v_mfma_f32_16x16x32_bf16 v[80:83], a[80:83], a[208:211], v[80:83]
    ds_read_b64_tr_b16 a[104:105], v27 offset:57344
    v_mfma_f32_16x16x32_bf16 v[84:87], a[84:87], a[208:211], v[84:87]
    ds_read_b64_tr_b16 a[106:107], v27 offset:57856
    s_add_u32 s60, s56, 20979712
    v_mfma_f32_16x16x32_bf16 v[88:91], a[88:91], a[208:211], v[88:91]
    ds_read_b64_tr_b16 a[108:109], v28 offset:57344
    v_mfma_f32_16x16x32_bf16 v[92:95], a[92:95], a[208:211], v[92:95]
    ds_read_b64_tr_b16 a[110:111], v28 offset:57856
    buffer_load_dwordx4 v1, s[48:51], s60 offen offset:0 sc1 lds
    v_mfma_f32_16x16x32_bf16 v[96:99], a[64:67], a[212:215], v[96:99]
    ds_read_b64_tr_b16 a[112:113], v25 offset:61440
    v_mfma_f32_16x16x32_bf16 v[100:103], a[68:71], a[212:215], v[100:103]
    ds_read_b64_tr_b16 a[114:115], v25 offset:61952
    buffer_load_dwordx4 v1, s[48:51], s60 offen offset:1024 sc1 lds
    v_mfma_f32_16x16x32_bf16 v[104:107], a[72:75], a[212:215], v[104:107]
    ds_read_b64_tr_b16 a[116:117], v26 offset:61440
    v_mfma_f32_16x16x32_bf16 v[108:111], a[76:79], a[212:215], v[108:111]
    ds_read_b64_tr_b16 a[118:119], v26 offset:61952
    buffer_load_dwordx4 v1, s[48:51], s60 offen offset:2048 sc1 lds
    v_mfma_f32_16x16x32_bf16 v[112:115], a[80:83], a[212:215], v[112:115]
    ds_read_b64_tr_b16 a[120:121], v27 offset:61440
    v_mfma_f32_16x16x32_bf16 v[116:119], a[84:87], a[212:215], v[116:119]
    ds_read_b64_tr_b16 a[122:123], v27 offset:61952
    buffer_load_dwordx4 v1, s[48:51], s60 offen offset:3072 sc1 lds
    v_mfma_f32_16x16x32_bf16 v[120:123], a[88:91], a[212:215], v[120:123]
    ds_read_b64_tr_b16 a[124:125], v28 offset:61440
    v_mfma_f32_16x16x32_bf16 v[124:127], a[92:95], a[212:215], v[124:127]
    ds_read_b64_tr_b16 a[126:127], v28 offset:61952
    s_add_u32 s56, s56, 16384
    v_mfma_f32_16x16x32_bf16 v[128:131], a[64:67], a[216:219], v[128:131]
    s_cmp_ge_u32 s56, s57
    s_cselect_b32 s56, 0x40000000, s56
    v_mfma_f32_16x16x32_bf16 v[132:135], a[68:71], a[216:219], v[132:135]
    s_add_u32 s59, s59, 16384
    v_mfma_f32_16x16x32_bf16 v[136:139], a[72:75], a[216:219], v[136:139]
    s_and_b32 s59, s59, 0xffff
    v_mfma_f32_16x16x32_bf16 v[140:143], a[76:79], a[216:219], v[140:143]
    s_mov_b32 m0, s59
    v_mfma_f32_16x16x32_bf16 v[144:147], a[80:83], a[216:219], v[144:147]
    v_mfma_f32_16x16x32_bf16 v[148:151], a[84:87], a[216:219], v[148:151]
    buffer_load_dwordx4 v1, s[48:51], s56 offen offset:0 sc1 lds
    v_mfma_f32_16x16x32_bf16 v[152:155], a[88:91], a[216:219], v[152:155]
    buffer_load_dwordx4 v1, s[48:51], s56 offen offset:1024 sc1 lds
    v_mfma_f32_16x16x32_bf16 v[156:159], a[92:95], a[216:219], v[156:159]
    buffer_load_dwordx4 v1, s[48:51], s56 offen offset:2048 sc1 lds
    s_waitcnt lgkmcnt(0)
    v_mfma_f32_16x16x32_bf16 v[64:67], a[96:99], a[224:227], v[64:67]
    buffer_load_dwordx4 v1, s[48:51], s56 offen offset:3072 sc1 lds
    v_mfma_f32_16x16x32_bf16 v[68:71], a[100:103], a[224:227], v[68:71]
    v_mfma_f32_16x16x32_bf16 v[72:75], a[104:107], a[224:227], v[72:75]
    v_mfma_f32_16x16x32_bf16 v[76:79], a[108:111], a[224:227], v[76:79]
    v_mfma_f32_16x16x32_bf16 v[80:83], a[112:115], a[224:227], v[80:83]
    v_mfma_f32_16x16x32_bf16 v[84:87], a[116:119], a[224:227], v[84:87]
    v_mfma_f32_16x16x32_bf16 v[88:91], a[120:123], a[224:227], v[88:91]
    v_mfma_f32_16x16x32_bf16 v[92:95], a[124:127], a[224:227], v[92:95]
    v_mfma_f32_16x16x32_bf16 v[96:99], a[96:99], a[228:231], v[96:99]
    s_add_u32 m0, s59, 65536
    v_cvt_pk_bf16_f32 v64, v64, v65
    v_cvt_pk_bf16_f32 v65, v66, v67
    v_mfma_f32_16x16x32_bf16 v[100:103], a[100:103], a[228:231], v[100:103]
    s_add_u32 s60, s56, 20979712
    v_cvt_pk_bf16_f32 v66, v68, v69
    v_cvt_pk_bf16_f32 v67, v70, v71
    v_mfma_f32_16x16x32_bf16 v[104:107], a[104:107], a[228:231], v[104:107]
    buffer_load_dwordx4 v1, s[48:51], s60 offen offset:0 sc1 lds
    v_accvgpr_write_b32 a32, v64
    v_accvgpr_write_b32 a33, v65
    v_mfma_f32_16x16x32_bf16 v[108:111], a[108:111], a[228:231], v[108:111]
    buffer_load_dwordx4 v1, s[48:51], s60 offen offset:1024 sc1 lds
    v_accvgpr_write_b32 a34, v66
    v_accvgpr_write_b32 a35, v67
    v_mfma_f32_16x16x32_bf16 v[112:115], a[112:115], a[228:231], v[112:115]
    buffer_load_dwordx4 v1, s[48:51], s60 offen offset:2048 sc1 lds
    v_cvt_pk_bf16_f32 v72, v72, v73
    v_cvt_pk_bf16_f32 v73, v74, v75
    v_mfma_f32_16x16x32_bf16 v[116:119], a[116:119], a[228:231], v[116:119]
    buffer_load_dwordx4 v1, s[48:51], s60 offen offset:3072 sc1 lds
    v_cvt_pk_bf16_f32 v74, v76, v77
    v_cvt_pk_bf16_f32 v75, v78, v79
    v_mfma_f32_16x16x32_bf16 v[120:123], a[120:123], a[228:231], v[120:123]
    s_add_u32 s56, s56, 16384
    v_accvgpr_write_b32 a36, v72
    v_accvgpr_write_b32 a37, v73
    v_mfma_f32_16x16x32_bf16 v[124:127], a[124:127], a[228:231], v[124:127]
    s_cmp_ge_u32 s56, s57
    s_cselect_b32 s56, 0x40000000, s56
    v_accvgpr_write_b32 a38, v74
    v_accvgpr_write_b32 a39, v75
    v_mfma_f32_16x16x32_bf16 v[128:131], a[96:99], a[232:235], v[128:131]
    s_add_u32 s59, s59, 16384
    v_cvt_pk_bf16_f32 v80, v80, v81
    v_cvt_pk_bf16_f32 v81, v82, v83
    v_mfma_f32_16x16x32_bf16 v[132:135], a[100:103], a[232:235], v[132:135]
    s_and_b32 s59, s59, 0xffff
    v_cvt_pk_bf16_f32 v82, v84, v85
    v_cvt_pk_bf16_f32 v83, v86, v87
    v_mfma_f32_16x16x32_bf16 v[136:139], a[104:107], a[232:235], v[136:139]
    s_mov_b32 m0, s59
    v_accvgpr_write_b32 a40, v80
    v_accvgpr_write_b32 a41, v81
    v_mfma_f32_16x16x32_bf16 v[140:143], a[108:111], a[232:235], v[140:143]
    v_accvgpr_write_b32 a42, v82
    v_accvgpr_write_b32 a43, v83
    v_mfma_f32_16x16x32_bf16 v[144:147], a[112:115], a[232:235], v[144:147]
    buffer_load_dwordx4 v1, s[48:51], s56 offen offset:0 sc1 lds
    v_cvt_pk_bf16_f32 v88, v88, v89
    v_cvt_pk_bf16_f32 v89, v90, v91
    v_mfma_f32_16x16x32_bf16 v[148:151], a[116:119], a[232:235], v[148:151]
    buffer_load_dwordx4 v1, s[48:51], s56 offen offset:1024 sc1 lds
    v_cvt_pk_bf16_f32 v90, v92, v93
    v_cvt_pk_bf16_f32 v91, v94, v95
    v_mfma_f32_16x16x32_bf16 v[152:155], a[120:123], a[232:235], v[152:155]
    buffer_load_dwordx4 v1, s[48:51], s56 offen offset:2048 sc1 lds
    v_accvgpr_write_b32 a44, v88
    v_accvgpr_write_b32 a45, v89
    v_mfma_f32_16x16x32_bf16 v[156:159], a[124:127], a[232:235], v[156:159]
    buffer_load_dwordx4 v1, s[48:51], s56 offen offset:3072 sc1 lds
    v_accvgpr_write_b32 a46, v90
    v_accvgpr_write_b32 a47, v91
    v_mfma_f32_16x16x32_bf16 v[160:163], a[64:67], a[220:223], v[160:163]
    s_mov_b32 m0, s87
    v_cvt_pk_bf16_f32 v96, v96, v97
    v_cvt_pk_bf16_f32 v97, v98, v99
    v_mfma_f32_16x16x32_bf16 v[164:167], a[68:71], a[220:223], v[164:167]
    s_nop 0
    v_cvt_pk_bf16_f32 v98, v100, v101
    v_cvt_pk_bf16_f32 v99, v102, v103
    v_mfma_f32_16x16x32_bf16 v[168:171], a[72:75], a[220:223], v[168:171]
    buffer_load_dwordx4 v11, s[88:91], s85 offen offset:0 nt lds
    v_accvgpr_write_b32 a48, v96
    v_accvgpr_write_b32 a49, v97
    v_mfma_f32_16x16x32_bf16 v[172:175], a[76:79], a[220:223], v[172:175]
    s_add_u32 s85, s85, 7168
    v_accvgpr_write_b32 a50, v98
    v_accvgpr_write_b32 a51, v99
    v_mfma_f32_16x16x32_bf16 v[176:179], a[80:83], a[220:223], v[176:179]
    buffer_load_dwordx4 v11, s[88:91], s85 offen offset:1024 nt lds
    v_cvt_pk_bf16_f32 v104, v104, v105
    v_cvt_pk_bf16_f32 v105, v106, v107
    v_mfma_f32_16x16x32_bf16 v[180:183], a[84:87], a[220:223], v[180:183]
    s_add_u32 s85, s85, 7168
    v_cvt_pk_bf16_f32 v106, v108, v109
    v_cvt_pk_bf16_f32 v107, v110, v111
    v_mfma_f32_16x16x32_bf16 v[184:187], a[88:91], a[220:223], v[184:187]
    buffer_load_dwordx4 v11, s[88:91], s85 offen offset:2048 nt lds
    v_accvgpr_write_b32 a52, v104
    v_accvgpr_write_b32 a53, v105
    v_mfma_f32_16x16x32_bf16 v[188:191], a[92:95], a[220:223], v[188:191]
    s_add_u32 s85, s85, 7168
    v_accvgpr_write_b32 a54, v106
    v_accvgpr_write_b32 a55, v107
    v_mfma_f32_16x16x32_bf16 v[160:163], a[96:99], a[236:239], v[160:163]
    buffer_load_dwordx4 v11, s[88:91], s85 offen offset:3072 nt lds
    v_cvt_pk_bf16_f32 v112, v112, v113
    v_cvt_pk_bf16_f32 v113, v114, v115
    v_mfma_f32_16x16x32_bf16 v[164:167], a[100:103], a[236:239], v[164:167]
    s_add_u32 s85, s85, 7168
    v_cvt_pk_bf16_f32 v114, v116, v117
    v_cvt_pk_bf16_f32 v115, v118, v119
    v_mfma_f32_16x16x32_bf16 v[168:171], a[104:107], a[236:239], v[168:171]
    v_accvgpr_write_b32 a56, v112
    v_accvgpr_write_b32 a57, v113
    v_accvgpr_write_b32 a58, v114
    v_mfma_f32_16x16x32_bf16 v[172:175], a[108:111], a[236:239], v[172:175]
    v_accvgpr_write_b32 a59, v115
    v_cvt_pk_bf16_f32 v120, v120, v121
    v_cvt_pk_bf16_f32 v121, v122, v123
    v_mfma_f32_16x16x32_bf16 v[176:179], a[112:115], a[236:239], v[176:179]
    v_cvt_pk_bf16_f32 v122, v124, v125
    v_cvt_pk_bf16_f32 v123, v126, v127
    v_accvgpr_write_b32 a60, v120
    v_mfma_f32_16x16x32_bf16 v[180:183], a[116:119], a[236:239], v[180:183]
    v_accvgpr_write_b32 a61, v121
    v_accvgpr_write_b32 a62, v122
    v_accvgpr_write_b32 a63, v123
    v_mfma_f32_16x16x32_bf16 v[184:187], a[120:123], a[236:239], v[184:187]
    v_cvt_pk_bf16_f32 v128, v128, v129
    v_cvt_pk_bf16_f32 v129, v130, v131
    v_cvt_pk_bf16_f32 v130, v132, v133
    v_mfma_f32_16x16x32_bf16 v[188:191], a[124:127], a[236:239], v[188:191]
    v_cvt_pk_bf16_f32 v131, v134, v135
    v_accvgpr_write_b32 a0, v128
    v_accvgpr_write_b32 a1, v129
    s_waitcnt vmcnt(20)
    s_barrier
    ds_read_b128 a[64:67], v2 offset:0
    ds_read_b128 a[68:71], v2 offset:1024
    ds_read_b128 a[72:75], v2 offset:2048
    ds_read_b128 a[76:79], v2 offset:3072
    ds_read_b128 a[80:83], v2 offset:4096
    ds_read_b128 a[84:87], v2 offset:5120
    ds_read_b128 a[88:91], v2 offset:6144
    ds_read_b128 a[92:95], v2 offset:7168
    v_accvgpr_write_b32 a2, v130
    v_accvgpr_write_b32 a3, v131
    v_cvt_pk_bf16_f32 v136, v136, v137
    v_cvt_pk_bf16_f32 v137, v138, v139
    v_cvt_pk_bf16_f32 v138, v140, v141
    v_cvt_pk_bf16_f32 v139, v142, v143
    v_accvgpr_write_b32 a4, v136
    v_accvgpr_write_b32 a5, v137
    v_accvgpr_write_b32 a6, v138
    v_accvgpr_write_b32 a7, v139
    v_cvt_pk_bf16_f32 v144, v144, v145
    v_cvt_pk_bf16_f32 v145, v146, v147
    v_cvt_pk_bf16_f32 v146, v148, v149
    v_cvt_pk_bf16_f32 v147, v150, v151
    v_accvgpr_write_b32 a8, v144
    v_accvgpr_write_b32 a9, v145
    v_accvgpr_write_b32 a10, v146
    v_accvgpr_write_b32 a11, v147
    v_cvt_pk_bf16_f32 v152, v152, v153
    v_cvt_pk_bf16_f32 v153, v154, v155
    v_cvt_pk_bf16_f32 v154, v156, v157
    v_cvt_pk_bf16_f32 v155, v158, v159
    v_accvgpr_write_b32 a12, v152
    v_accvgpr_write_b32 a13, v153
    v_accvgpr_write_b32 a14, v154
    v_accvgpr_write_b32 a15, v155
    v_cvt_pk_bf16_f32 v160, v160, v161
    v_cvt_pk_bf16_f32 v161, v162, v163
    v_cvt_pk_bf16_f32 v162, v164, v165
    v_cvt_pk_bf16_f32 v163, v166, v167
    v_accvgpr_write_b32 a16, v160
    v_accvgpr_write_b32 a17, v161
    v_accvgpr_write_b32 a18, v162
    v_accvgpr_write_b32 a19, v163
    v_cvt_pk_bf16_f32 v168, v168, v169
    v_cvt_pk_bf16_f32 v169, v170, v171
    v_cvt_pk_bf16_f32 v170, v172, v173
    v_cvt_pk_bf16_f32 v171, v174, v175
    v_accvgpr_write_b32 a20, v168
    v_accvgpr_write_b32 a21, v169
    v_accvgpr_write_b32 a22, v170
    v_accvgpr_write_b32 a23, v171
    v_cvt_pk_bf16_f32 v176, v176, v177
    v_cvt_pk_bf16_f32 v177, v178, v179
    v_cvt_pk_bf16_f32 v178, v180, v181
    v_cvt_pk_bf16_f32 v179, v182, v183
    v_accvgpr_write_b32 a24, v176
    v_accvgpr_write_b32 a25, v177
    v_accvgpr_write_b32 a26, v178
    v_accvgpr_write_b32 a27, v179
    v_cvt_pk_bf16_f32 v184, v184, v185
    v_cvt_pk_bf16_f32 v185, v186, v187
    v_cvt_pk_bf16_f32 v186, v188, v189
    v_cvt_pk_bf16_f32 v187, v190, v191
    v_accvgpr_write_b32 a28, v184
    v_accvgpr_write_b32 a29, v185
    v_accvgpr_write_b32 a30, v186
    v_accvgpr_write_b32 a31, v187
    v_mov_b32 v160, 0
    s_cmp_eq_u32 s5, 0
    s_cselect_b32 s61, 0, 0x62800000
    v_add_f32 v6, s61, v4
    v_add_f32 v168, 0x5d000000, v6
    v_add_f32 v169, 0xdd000000, v6
    v_add_f32 v170, 0xddc00000, v6
    v_add_f32 v171, 0xde200000, v6
    v_add_f32 v172, 0xdf780000, v6
    v_add_f32 v173, 0xdf840000, v6
    v_add_f32 v174, 0xdf8c0000, v6
    v_add_f32 v175, 0xdf940000, v6
    v_min_f32 v168, v168, v160
    v_min_f32 v169, v169, v160
    v_min_f32 v170, v170, v160
    v_min_f32 v171, v171, v160
    v_min_f32 v172, v172, v160
    v_min_f32 v173, v173, v160
    v_min_f32 v174, v174, v160
    v_min_f32 v175, v175, v160
    s_nop 1
    s_waitcnt lgkmcnt(4)
    v_mfma_f32_16x16x32_bf16 v[48:51], a[64:67], a[0:3], 0
    s_lshl_b32 s7, s2, 13
    s_lshl_b32 s8, s3, 10
    v_mfma_f32_16x16x32_bf16 v[48:51], a[68:71], a[4:7], v[48:51]
    s_add_u32 s7, s7, s8
    s_add_u32 s8, s7, 4096
    v_mfma_f32_16x16x32_bf16 v[48:51], a[72:75], a[8:11], v[48:51]
    s_lshl_b32 s10, s2, 2
    s_load_dword s75, s[26:27], s10
    v_mfma_f32_16x16x32_bf16 v[48:51], a[76:79], a[12:15], v[48:51]
    v_subrev_u32 v7, 16, v1
    s_lshl_b32 s10, s3, 6
    v_mfma_f32_16x16x32_bf16 v[56:59], a[64:67], a[16:19], 0
    v_add_u32 v8, s10, v0
    v_cmp_eq_u32 vcc, 0, v8
    v_mfma_f32_16x16x32_bf16 v[56:59], a[68:71], a[20:23], v[56:59]
    v_add_u32 v8, s8, v7
    v_add_u32 v7, s7, v7
    v_mfma_f32_16x16x32_bf16 v[56:59], a[72:75], a[24:27], v[56:59]
    v_mov_b32 v6, 0x80000000
    v_cndmask_b32 v7, v7, v6, vcc
    v_mfma_f32_16x16x32_bf16 v[56:59], a[76:79], a[28:31], v[56:59]
    v_cndmask_b32 v8, v8, v6, vcc
    buffer_load_dwordx4 a[224:227], v7, s[52:55], 0 offen
    v_mfma_f32_16x16x32_bf16 v[64:67], a[64:67], a[32:35], v[168:171]
    buffer_load_dwordx4 a[228:231], v1, s[52:55], s7 offen
    buffer_load_dwordx4 a[232:235], v8, s[52:55], 0 offen
    v_mfma_f32_16x16x32_bf16 v[64:67], a[68:71], a[36:39], v[64:67]
    buffer_load_dwordx4 a[236:239], v1, s[52:55], s8 offen
    v_mfma_f32_16x16x32_bf16 v[64:67], a[72:75], a[40:43], v[64:67]
    v_mfma_f32_16x16x32_bf16 v[64:67], a[76:79], a[44:47], v[64:67]
    v_mfma_f32_16x16x32_bf16 v[72:75], a[64:67], a[48:51], 0
    ds_read_b128 a[64:67], v2 offset:8192
    v_mfma_f32_16x16x32_bf16 v[72:75], a[68:71], a[52:55], v[72:75]
    ds_read_b128 a[68:71], v2 offset:9216
    s_waitcnt lgkmcnt(2)
    v_mfma_f32_16x16x32_bf16 v[72:75], a[72:75], a[56:59], v[72:75]
    ds_read_b128 a[72:75], v2 offset:10240
    v_mfma_f32_16x16x32_bf16 v[72:75], a[76:79], a[60:63], v[72:75]
    ds_read_b128 a[76:79], v2 offset:11264
    v_mfma_f32_16x16x32_bf16 v[52:55], a[80:83], a[0:3], 0
    v_mfma_f32_16x16x32_bf16 v[52:55], a[84:87], a[4:7], v[52:55]
    v_mfma_f32_16x16x32_bf16 v[52:55], a[88:91], a[8:11], v[52:55]
    v_mfma_f32_16x16x32_bf16 v[52:55], a[92:95], a[12:15], v[52:55]
    v_max3_f32 v180, v48, v49, v50
    v_max_f32 v180, v180, v51
    v_max3_f32 v181, v56, v57, v58
    v_max_f32 v181, v181, v59
    v_max3_f32 v182, v64, v65, v66
    v_max_f32 v182, v182, v67
    v_max3_f32 v183, v72, v73, v74
    v_max_f32 v183, v183, v75
    v_mov_b32 v184, v180
    v_mov_b32 v185, v181
    v_mov_b32 v186, v182
    v_mov_b32 v187, v183
    v_permlane16_swap_b32 v180, v184
    v_permlane16_swap_b32 v181, v185
    v_permlane16_swap_b32 v182, v186
    v_permlane16_swap_b32 v183, v187
    v_max_f32 v180, v180, v184
    v_max_f32 v181, v181, v185
    v_max_f32 v182, v182, v186
    v_max_f32 v183, v183, v187
    v_mov_b32 v184, v180
    v_mov_b32 v185, v181
    v_mov_b32 v186, v182
    v_mov_b32 v187, v183
    v_permlane32_swap_b32 v180, v184
    v_permlane32_swap_b32 v181, v185
    v_permlane32_swap_b32 v182, v186
    v_permlane32_swap_b32 v183, v187
    v_max_f32 v180, v180, v184
    v_max_f32 v181, v181, v185
    v_max_f32 v182, v182, v186
    v_max_f32 v183, v183, v187
    v_sub_f32 v152, 0, v180
    v_sub_f32 v153, 0, v180
    v_sub_f32 v154, 0, v180
    v_sub_f32 v155, 0, v180
    v_sub_f32 v156, 0, v181
    v_sub_f32 v157, 0, v181
    v_sub_f32 v158, 0, v181
    v_mfma_f32_16x16x32_bf16 v[60:63], a[80:83], a[16:19], 0
    v_sub_f32 v159, 0, v181
    v_sub_f32 v160, 0, v182
    v_mfma_f32_16x16x32_bf16 v[60:63], a[84:87], a[20:23], v[60:63]
    v_sub_f32 v161, 0, v182
    v_sub_f32 v162, 0, v182
    v_mfma_f32_16x16x32_bf16 v[60:63], a[88:91], a[24:27], v[60:63]
    v_sub_f32 v163, 0, v182
    v_sub_f32 v164, 0, v183
    v_mfma_f32_16x16x32_bf16 v[60:63], a[92:95], a[28:31], v[60:63]
    v_sub_f32 v165, 0, v183
    v_sub_f32 v166, 0, v183
    v_mfma_f32_16x16x32_bf16 v[68:71], a[80:83], a[32:35], v[172:175]
    v_sub_f32 v167, 0, v183
    v_mfma_f32_16x16x32_bf16 v[68:71], a[84:87], a[36:39], v[68:71]
    v_mfma_f32_16x16x32_bf16 v[68:71], a[88:91], a[40:43], v[68:71]
    v_mfma_f32_16x16x32_bf16 v[68:71], a[92:95], a[44:47], v[68:71]
    v_mfma_f32_16x16x32_bf16 v[76:79], a[80:83], a[48:51], 0
    ds_read_b128 a[80:83], v2 offset:12288
    v_mfma_f32_16x16x32_bf16 v[76:79], a[84:87], a[52:55], v[76:79]
    ds_read_b128 a[84:87], v2 offset:13312
    v_mfma_f32_16x16x32_bf16 v[76:79], a[88:91], a[56:59], v[76:79]
    ds_read_b128 a[88:91], v2 offset:14336
    v_mfma_f32_16x16x32_bf16 v[76:79], a[92:95], a[60:63], v[76:79]
    ds_read_b128 a[92:95], v2 offset:15360
    s_cmp_eq_u32 s5, 0
    s_cselect_b32 s61, 0, 0x62800000
    v_add_f32 v6, s61, v4
    v_add_f32 v168, 0xdffc0000, v6
    v_add_f32 v169, 0xe0020000, v6
    v_add_f32 v170, 0xe0060000, v6
    v_add_f32 v171, 0xe00a0000, v6
    v_add_f32 v172, 0xe03e0000, v6
    v_add_f32 v173, 0xe0420000, v6
    v_add_f32 v174, 0xe0460000, v6
    v_add_f32 v175, 0xe04a0000, v6
    v_min_f32 v168, v168, v160
    v_min_f32 v169, v169, v160
    v_min_f32 v170, v170, v160
    v_min_f32 v171, v171, v160
    v_min_f32 v172, v172, v160
    v_min_f32 v173, v173, v160
    v_min_f32 v174, v174, v160
    v_min_f32 v175, v175, v160
    s_nop 1
    v_sub_f32 v48, v48, v180
    v_sub_f32 v49, v49, v180
    v_sub_f32 v50, v50, v180
    v_sub_f32 v51, v51, v180
    v_sub_f32 v52, v52, v180
    v_sub_f32 v53, v53, v180
    v_sub_f32 v54, v54, v180
    v_sub_f32 v55, v55, v180
    v_sub_f32 v56, v56, v181
    v_sub_f32 v57, v57, v181
    v_sub_f32 v58, v58, v181
    v_sub_f32 v59, v59, v181
    v_exp_f32 v112, v48
    v_exp_f32 v113, v49
    v_exp_f32 v114, v50
    v_exp_f32 v115, v51
    v_add_u32 v3, 0x10000, v2
    v_add_u32 v2, 0x4000, v2
    v_and_b32 v2, 0xffff, v2
    s_waitcnt lgkmcnt(4)
    v_mfma_f32_16x16x32_bf16 v[80:83], a[64:67], a[0:3], v[152:155]
    v_sub_f32 v60, v60, v181
    v_exp_f32 v116, v52
    v_mfma_f32_16x16x32_bf16 v[80:83], a[68:71], a[4:7], v[80:83]
    v_sub_f32 v61, v61, v181
    v_exp_f32 v117, v53
    v_mfma_f32_16x16x32_bf16 v[80:83], a[72:75], a[8:11], v[80:83]
    v_sub_f32 v62, v62, v181
    v_exp_f32 v118, v54
    v_mfma_f32_16x16x32_bf16 v[80:83], a[76:79], a[12:15], v[80:83]
    v_sub_f32 v63, v63, v181
    v_exp_f32 v119, v55
    v_mfma_f32_16x16x32_bf16 v[88:91], a[64:67], a[16:19], v[156:159]
    v_cvt_pk_bf16_f32 v120, v112, v113
    v_cvt_pk_bf16_f32 v121, v114, v115
    v_mfma_f32_16x16x32_bf16 v[88:91], a[68:71], a[20:23], v[88:91]
    v_sub_f32 v64, v64, v182
    v_exp_f32 v112, v56
    v_mfma_f32_16x16x32_bf16 v[88:91], a[72:75], a[24:27], v[88:91]
    v_sub_f32 v65, v65, v182
    v_exp_f32 v113, v57
    v_mfma_f32_16x16x32_bf16 v[88:91], a[76:79], a[28:31], v[88:91]
    v_sub_f32 v66, v66, v182
    v_exp_f32 v114, v58
    v_mfma_f32_16x16x32_bf16 v[96:99], a[64:67], a[32:35], v[168:171]
    v_sub_f32 v67, v67, v182
    v_exp_f32 v115, v59
    v_mfma_f32_16x16x32_bf16 v[96:99], a[68:71], a[36:39], v[96:99]
    v_cvt_pk_bf16_f32 v122, v116, v117
    v_cvt_pk_bf16_f32 v123, v118, v119
    v_sub_f32 v68, v68, v182
    v_exp_f32 v116, v60
    v_cvt_pk_bf16_f32 v124, v112, v113
    v_mfma_f32_16x16x32_bf16 v[16:19], a[240:243], v[120:123], v[32:35]
    v_sub_f32 v69, v69, v182
    v_exp_f32 v117, v61
    v_mfma_f32_16x16x32_bf16 v[96:99], a[72:75], a[40:43], v[96:99]
    v_sub_f32 v70, v70, v182
    v_exp_f32 v118, v62
    v_mfma_f32_16x16x32_bf16 v[96:99], a[76:79], a[44:47], v[96:99]
    v_sub_f32 v71, v71, v182
    v_exp_f32 v119, v63
    v_mfma_f32_16x16x32_bf16 v[104:107], a[64:67], a[48:51], v[164:167]
    ds_read_b128 a[64:67], v2 offset:0
    v_cvt_pk_bf16_f32 v125, v114, v115
    v_mfma_f32_16x16x32_bf16 v[104:107], a[68:71], a[52:55], v[104:107]
    s_waitcnt lgkmcnt(1)
    v_sub_f32 v72, v72, v183
    v_exp_f32 v112, v64
    v_mfma_f32_16x16x32_bf16 v[104:107], a[72:75], a[56:59], v[104:107]
    ds_read_b128 a[68:71], v2 offset:1024
    v_cvt_pk_bf16_f32 v126, v116, v117
    v_sub_f32 v73, v73, v183
    v_exp_f32 v113, v65
    v_cvt_pk_bf16_f32 v127, v118, v119
    v_mfma_f32_16x16x32_bf16 v[104:107], a[76:79], a[60:63], v[104:107]
    v_sub_f32 v74, v74, v183
    v_exp_f32 v114, v66
    v_mfma_f32_16x16x32_bf16 v[20:23], a[240:243], v[124:127], v[36:39]
    ds_read_b128 a[72:75], v2 offset:2048
    v_cvt_pk_bf16_f32 v128, v112, v113
    v_sub_f32 v75, v75, v183
    v_exp_f32 v115, v67
    v_mfma_f32_16x16x32_bf16 v[84:87], a[80:83], a[0:3], v[152:155]
    v_sub_f32 v76, v76, v183
    v_exp_f32 v116, v68
    v_mfma_f32_16x16x32_bf16 v[84:87], a[84:87], a[4:7], v[84:87]
    ds_read_b128 a[76:79], v2 offset:3072
    v_cvt_pk_bf16_f32 v129, v114, v115
    v_sub_f32 v77, v77, v183
    v_exp_f32 v117, v69
    v_mfma_f32_16x16x32_bf16 v[84:87], a[88:91], a[8:11], v[84:87]
    v_sub_f32 v78, v78, v183
    v_exp_f32 v118, v70
    v_mfma_f32_16x16x32_bf16 v[84:87], a[92:95], a[12:15], v[84:87]
    v_sub_f32 v79, v79, v183
    v_exp_f32 v119, v71
    v_mfma_f32_16x16x32_bf16 v[92:95], a[80:83], a[16:19], v[156:159]
    v_exp_f32 v112, v72
    v_mfma_f32_16x16x32_bf16 v[92:95], a[84:87], a[20:23], v[92:95]
    v_exp_f32 v113, v73
    v_mfma_f32_16x16x32_bf16 v[92:95], a[88:91], a[24:27], v[92:95]
    v_exp_f32 v114, v74
    v_mfma_f32_16x16x32_bf16 v[92:95], a[92:95], a[28:31], v[92:95]
    v_exp_f32 v115, v75
    v_mfma_f32_16x16x32_bf16 v[100:103], a[80:83], a[32:35], v[172:175]
    v_cvt_pk_bf16_f32 v130, v116, v117
    v_cvt_pk_bf16_f32 v131, v118, v119
    v_mfma_f32_16x16x32_bf16 v[100:103], a[84:87], a[36:39], v[100:103]
    v_exp_f32 v116, v76
    v_mfma_f32_16x16x32_bf16 v[24:27], a[240:243], v[128:131], v[40:43]
    v_exp_f32 v117, v77
    v_mfma_f32_16x16x32_bf16 v[100:103], a[88:91], a[40:43], v[100:103]
    v_exp_f32 v118, v78
    v_mfma_f32_16x16x32_bf16 v[100:103], a[92:95], a[44:47], v[100:103]
    v_exp_f32 v119, v79
    v_mfma_f32_16x16x32_bf16 v[108:111], a[80:83], a[48:51], v[164:167]
    ds_read_b128 a[80:83], v2 offset:4096
    v_cvt_pk_bf16_f32 v132, v112, v113
    v_exp_f32 v112, v80
    v_cvt_pk_bf16_f32 v133, v114, v115
    v_mfma_f32_16x16x32_bf16 v[108:111], a[84:87], a[52:55], v[108:111]
    v_exp_f32 v113, v81
    v_mfma_f32_16x16x32_bf16 v[108:111], a[88:91], a[56:59], v[108:111]
    ds_read_b128 a[84:87], v2 offset:5120
    v_cvt_pk_bf16_f32 v134, v116, v117
    v_exp_f32 v114, v82
    v_cvt_pk_bf16_f32 v135, v118, v119
    v_mfma_f32_16x16x32_bf16 v[108:111], a[92:95], a[60:63], v[108:111]
    v_exp_f32 v115, v83
    v_mfma_f32_16x16x32_bf16 v[28:31], a[240:243], v[132:135], v[44:47]
    ds_read_b128 a[88:91], v2 offset:6144
    ds_read_b128 a[92:95], v2 offset:7168
    s_nop 0
    s_nop 0
    s_nop 0
    s_nop 0
    s_nop 0
    s_nop 0
    v_max3_f32 v6, v16, v20, v24
    v_max_f32 v6, v6, v28
    v_cmp_lt_f32 vcc, s73, v6
    s_cbranch_vccnz K2_SLOW1
K2_BACK1:
    s_cmp_eq_u32 s5, 0
    s_cbranch_scc1 K2_LASTD0
    s_sub_u32 s63, s63, 1
.p2align 6
K2_LOOPD:
    s_waitcnt lgkmcnt(4)
    v_mfma_f32_16x16x32_bf16 v[48:51], a[64:67], a[0:3], v[152:155]
    s_waitcnt vmcnt(8)
    v_exp_f32 v116, v84
    v_mfma_f32_16x16x32_bf16 v[48:51], a[68:71], a[4:7], v[48:51]
    s_barrier
    v_cvt_pk_bf16_f32 v136, v112, v113
    v_cvt_pk_bf16_f32 v137, v114, v115
    v_mfma_f32_16x16x32_bf16 v[48:51], a[72:75], a[8:11], v[48:51]
    ds_read_b128 a[96:99], v3 offset:0
    s_add_u32 m0, s59, 65536
    v_mfma_f32_16x16x32_bf16 v[48:51], a[76:79], a[12:15], v[48:51]
    s_add_u32 s60, s56, 20979712
    v_exp_f32 v117, v85
    v_mfma_f32_16x16x32_bf16 v[56:59], a[64:67], a[16:19], v[156:159]
    ds_read_b128 a[100:103], v3 offset:1024
    v_cvt_pk_bf16_f32 v138, v116, v117
    v_mfma_f32_16x16x32_bf16 v[56:59], a[68:71], a[20:23], v[56:59]
    v_exp_f32 v118, v86
    v_mfma_f32_16x16x32_bf16 v[56:59], a[72:75], a[24:27], v[56:59]
    v_exp_f32 v119, v87
    v_mfma_f32_16x16x32_bf16 v[56:59], a[76:79], a[28:31], v[56:59]
    v_cvt_pk_bf16_f32 v139, v118, v119
    v_mfma_f32_16x16x32_bf16 v[64:67], a[64:67], a[32:35], v[160:163]
    ds_read_b128 a[104:107], v3 offset:2048
    v_mfma_f32_16x16x32_bf16 v[32:35], a[240:243], v[136:139], v[16:19]
    v_exp_f32 v112, v88
    v_mfma_f32_16x16x32_bf16 v[64:67], a[68:71], a[36:39], v[64:67]
    v_exp_f32 v113, v89
    v_mfma_f32_16x16x32_bf16 v[64:67], a[72:75], a[40:43], v[64:67]
    v_cvt_pk_bf16_f32 v140, v112, v113
    v_mfma_f32_16x16x32_bf16 v[64:67], a[76:79], a[44:47], v[64:67]
    v_exp_f32 v114, v90
    v_mfma_f32_16x16x32_bf16 v[72:75], a[64:67], a[48:51], v[164:167]
    ds_read_b128 a[108:111], v3 offset:3072
    v_mfma_f32_16x16x32_bf16 v[72:75], a[68:71], a[52:55], v[72:75]
    s_waitcnt lgkmcnt(4)
    v_exp_f32 v115, v91
    v_mfma_f32_16x16x32_bf16 v[72:75], a[72:75], a[56:59], v[72:75]
    v_cvt_pk_bf16_f32 v141, v114, v115
    v_mfma_f32_16x16x32_bf16 v[72:75], a[76:79], a[60:63], v[72:75]
    v_exp_f32 v116, v92
    v_mfma_f32_16x16x32_bf16 v[52:55], a[80:83], a[0:3], v[152:155]
    ds_read_b128 a[112:115], v3 offset:4096
    buffer_load_dwordx4 v1, s[48:51], s60 offen offset:0 sc1 lds
    v_mfma_f32_16x16x32_bf16 v[52:55], a[84:87], a[4:7], v[52:55]
    v_exp_f32 v117, v93
    v_mfma_f32_16x16x32_bf16 v[52:55], a[88:91], a[8:11], v[52:55]
    v_cvt_pk_bf16_f32 v142, v116, v117
    v_mfma_f32_16x16x32_bf16 v[52:55], a[92:95], a[12:15], v[52:55]
    v_exp_f32 v118, v94
    v_mfma_f32_16x16x32_bf16 v[60:63], a[80:83], a[16:19], v[156:159]
    ds_read_b128 a[116:119], v3 offset:5120
    buffer_load_dwordx4 v1, s[48:51], s60 offen offset:1024 sc1 lds
    v_mfma_f32_16x16x32_bf16 v[60:63], a[84:87], a[20:23], v[60:63]
    v_mfma_f32_16x16x32_bf16 v[60:63], a[88:91], a[24:27], v[60:63]
    v_exp_f32 v119, v95
    v_mfma_f32_16x16x32_bf16 v[60:63], a[92:95], a[28:31], v[60:63]
    v_cvt_pk_bf16_f32 v143, v118, v119
    v_mfma_f32_16x16x32_bf16 v[68:71], a[80:83], a[32:35], v[160:163]
    ds_read_b128 a[120:123], v3 offset:6144
    v_mfma_f32_16x16x32_bf16 v[36:39], a[240:243], v[140:143], v[20:23]
    v_exp_f32 v112, v96
    v_mfma_f32_16x16x32_bf16 v[68:71], a[84:87], a[36:39], v[68:71]
    v_exp_f32 v113, v97
    v_mfma_f32_16x16x32_bf16 v[68:71], a[88:91], a[40:43], v[68:71]
    v_cvt_pk_bf16_f32 v144, v112, v113
    v_mfma_f32_16x16x32_bf16 v[68:71], a[92:95], a[44:47], v[68:71]
    v_exp_f32 v114, v98
    v_mfma_f32_16x16x32_bf16 v[76:79], a[80:83], a[48:51], v[164:167]
    ds_read_b128 a[124:127], v3 offset:7168
    buffer_load_dwordx4 v1, s[48:51], s60 offen offset:2048 sc1 lds
    v_mfma_f32_16x16x32_bf16 v[76:79], a[84:87], a[52:55], v[76:79]
    s_waitcnt lgkmcnt(4)
    v_exp_f32 v115, v99
    v_mfma_f32_16x16x32_bf16 v[76:79], a[88:91], a[56:59], v[76:79]
    v_cvt_pk_bf16_f32 v145, v114, v115
    v_mfma_f32_16x16x32_bf16 v[76:79], a[92:95], a[60:63], v[76:79]
    v_exp_f32 v116, v100
    v_mfma_f32_16x16x32_bf16 a[128:131], a[96:99], v[120:123], a[128:131]
    ds_read_b128 a[64:67], v2 offset:8192
    v_mfma_f32_16x16x32_bf16 v[192:195], a[96:99], v[124:127], v[192:195]
    v_exp_f32 v117, v101
    v_mfma_f32_16x16x32_bf16 a[160:163], a[96:99], v[128:131], a[160:163]
    v_cvt_pk_bf16_f32 v146, v116, v117
    v_mfma_f32_16x16x32_bf16 v[224:227], a[96:99], v[132:135], v[224:227]
    v_exp_f32 v118, v102
    v_mfma_f32_16x16x32_bf16 a[132:135], a[100:103], v[120:123], a[132:135]
    ds_read_b128 a[68:71], v2 offset:9216
    buffer_load_dwordx4 v1, s[48:51], s60 offen offset:3072 sc1 lds
    v_mfma_f32_16x16x32_bf16 v[196:199], a[100:103], v[124:127], v[196:199]
    s_add_u32 s56, s56, 16384
    v_exp_f32 v119, v103
    v_mfma_f32_16x16x32_bf16 a[164:167], a[100:103], v[128:131], a[164:167]
    s_cmp_ge_u32 s56, s57
    v_cvt_pk_bf16_f32 v147, v118, v119
    v_mfma_f32_16x16x32_bf16 v[228:231], a[100:103], v[132:135], v[228:231]
    s_cselect_b32 s56, 0x40000000, s56
    v_exp_f32 v112, v104
    v_mfma_f32_16x16x32_bf16 v[40:43], a[240:243], v[144:147], v[24:27]
    v_mfma_f32_16x16x32_bf16 a[136:139], a[104:107], v[120:123], a[136:139]
    ds_read_b128 a[72:75], v2 offset:10240
    v_mfma_f32_16x16x32_bf16 v[200:203], a[104:107], v[124:127], v[200:203]
    v_exp_f32 v113, v105
    v_mfma_f32_16x16x32_bf16 a[168:171], a[104:107], v[128:131], a[168:171]
    v_cvt_pk_bf16_f32 v148, v112, v113
    v_mfma_f32_16x16x32_bf16 v[232:235], a[104:107], v[132:135], v[232:235]
    v_exp_f32 v114, v106
    v_mfma_f32_16x16x32_bf16 a[140:143], a[108:111], v[120:123], a[140:143]
    ds_read_b128 a[76:79], v2 offset:11264
    v_mfma_f32_16x16x32_bf16 v[204:207], a[108:111], v[124:127], v[204:207]
    s_waitcnt lgkmcnt(4)
    v_exp_f32 v115, v107
    v_mfma_f32_16x16x32_bf16 a[172:175], a[108:111], v[128:131], a[172:175]
    v_cvt_pk_bf16_f32 v149, v114, v115
    v_mfma_f32_16x16x32_bf16 v[236:239], a[108:111], v[132:135], v[236:239]
    v_exp_f32 v116, v108
    v_mfma_f32_16x16x32_bf16 a[144:147], a[112:115], v[120:123], a[144:147]
    ds_read_b128 a[80:83], v2 offset:12288
    v_mfma_f32_16x16x32_bf16 v[208:211], a[112:115], v[124:127], v[208:211]
    v_exp_f32 v117, v109
    v_mfma_f32_16x16x32_bf16 a[176:179], a[112:115], v[128:131], a[176:179]
    v_cvt_pk_bf16_f32 v150, v116, v117
    v_mfma_f32_16x16x32_bf16 v[240:243], a[112:115], v[132:135], v[240:243]
    v_exp_f32 v118, v110
    v_mfma_f32_16x16x32_bf16 a[148:151], a[116:119], v[120:123], a[148:151]
    ds_read_b128 a[84:87], v2 offset:13312
    v_mfma_f32_16x16x32_bf16 v[212:215], a[116:119], v[124:127], v[212:215]
    v_exp_f32 v119, v111
    v_mfma_f32_16x16x32_bf16 a[180:183], a[116:119], v[128:131], a[180:183]
    v_cvt_pk_bf16_f32 v151, v118, v119
    v_mfma_f32_16x16x32_bf16 v[244:247], a[116:119], v[132:135], v[244:247]
    v_exp_f32 v112, v48
    v_mfma_f32_16x16x32_bf16 v[44:47], a[240:243], v[148:151], v[28:31]
    v_mfma_f32_16x16x32_bf16 a[152:155], a[120:123], v[120:123], a[152:155]
    ds_read_b128 a[88:91], v2 offset:14336
    v_mfma_f32_16x16x32_bf16 v[216:219], a[120:123], v[124:127], v[216:219]
    v_exp_f32 v113, v49
    v_mfma_f32_16x16x32_bf16 a[184:187], a[120:123], v[128:131], a[184:187]
    v_exp_f32 v114, v50
    v_mfma_f32_16x16x32_bf16 v[248:251], a[120:123], v[132:135], v[248:251]
    v_mfma_f32_16x16x32_bf16 a[156:159], a[124:127], v[120:123], a[156:159]
    ds_read_b128 a[92:95], v2 offset:15360
    v_max3_f32 v6, v32, v36, v40
    v_mfma_f32_16x16x32_bf16 v[220:223], a[124:127], v[124:127], v[220:223]
    v_exp_f32 v115, v51
    v_mfma_f32_16x16x32_bf16 a[188:191], a[124:127], v[128:131], a[188:191]
    v_max_f32 v6, v6, v44
    v_cmp_lt_f32 vcc, s73, v6
    v_mfma_f32_16x16x32_bf16 v[252:255], a[124:127], v[132:135], v[252:255]
    s_cbranch_vccnz K2_SLOW2
K2_BACK2:
    s_waitcnt lgkmcnt(4)
    v_mfma_f32_16x16x32_bf16 v[80:83], a[64:67], a[0:3], v[152:155]
    ds_read_b128 a[96:99], v3 offset:8192
    v_cvt_pk_bf16_f32 v120, v112, v113
    v_mfma_f32_16x16x32_bf16 v[80:83], a[68:71], a[4:7], v[80:83]
    s_add_u32 s59, s59, 16384
    v_exp_f32 v116, v52
    v_mfma_f32_16x16x32_bf16 v[80:83], a[72:75], a[8:11], v[80:83]
    s_and_b32 s59, s59, 0xffff
    v_exp_f32 v117, v53
    v_mfma_f32_16x16x32_bf16 v[80:83], a[76:79], a[12:15], v[80:83]
    s_mov_b32 m0, s59
    v_cvt_pk_bf16_f32 v121, v114, v115
    v_cvt_pk_bf16_f32 v122, v116, v117
    v_mfma_f32_16x16x32_bf16 v[88:91], a[64:67], a[16:19], v[156:159]
    ds_read_b128 a[100:103], v3 offset:9216
    v_mfma_f32_16x16x32_bf16 v[88:91], a[68:71], a[20:23], v[88:91]
    v_exp_f32 v118, v54
    v_mfma_f32_16x16x32_bf16 v[88:91], a[72:75], a[24:27], v[88:91]
    v_exp_f32 v119, v55
    v_mfma_f32_16x16x32_bf16 v[88:91], a[76:79], a[28:31], v[88:91]
    v_cvt_pk_bf16_f32 v123, v118, v119
    v_mfma_f32_16x16x32_bf16 v[96:99], a[64:67], a[32:35], v[160:163]
    ds_read_b128 a[104:107], v3 offset:10240
    v_mfma_f32_16x16x32_bf16 v[16:19], a[240:243], v[120:123], v[32:35]
    v_exp_f32 v112, v56
    v_mfma_f32_16x16x32_bf16 v[96:99], a[68:71], a[36:39], v[96:99]
    v_exp_f32 v113, v57
    v_mfma_f32_16x16x32_bf16 v[96:99], a[72:75], a[40:43], v[96:99]
    v_cvt_pk_bf16_f32 v124, v112, v113
    v_mfma_f32_16x16x32_bf16 v[96:99], a[76:79], a[44:47], v[96:99]
    v_exp_f32 v114, v58
    v_mfma_f32_16x16x32_bf16 v[104:107], a[64:67], a[48:51], v[164:167]
    ds_read_b128 a[108:111], v3 offset:11264
    v_mfma_f32_16x16x32_bf16 v[104:107], a[68:71], a[52:55], v[104:107]
    s_waitcnt lgkmcnt(4)
    v_exp_f32 v115, v59
    v_mfma_f32_16x16x32_bf16 v[104:107], a[72:75], a[56:59], v[104:107]
    v_cvt_pk_bf16_f32 v125, v114, v115
    v_mfma_f32_16x16x32_bf16 v[104:107], a[76:79], a[60:63], v[104:107]
    v_exp_f32 v116, v60
    v_mfma_f32_16x16x32_bf16 v[84:87], a[80:83], a[0:3], v[152:155]
    ds_read_b128 a[112:115], v3 offset:12288
    v_mfma_f32_16x16x32_bf16 v[84:87], a[84:87], a[4:7], v[84:87]
    v_exp_f32 v117, v61
    v_mfma_f32_16x16x32_bf16 v[84:87], a[88:91], a[8:11], v[84:87]
    v_cvt_pk_bf16_f32 v126, v116, v117
    v_mfma_f32_16x16x32_bf16 v[84:87], a[92:95], a[12:15], v[84:87]
    v_exp_f32 v118, v62
    v_mfma_f32_16x16x32_bf16 v[92:95], a[80:83], a[16:19], v[156:159]
    ds_read_b128 a[116:119], v3 offset:13312
    v_mfma_f32_16x16x32_bf16 v[92:95], a[84:87], a[20:23], v[92:95]
    v_mfma_f32_16x16x32_bf16 v[92:95], a[88:91], a[24:27], v[92:95]
    v_exp_f32 v119, v63
    v_mfma_f32_16x16x32_bf16 v[92:95], a[92:95], a[28:31], v[92:95]
    v_cvt_pk_bf16_f32 v127, v118, v119
    v_mfma_f32_16x16x32_bf16 v[100:103], a[80:83], a[32:35], v[160:163]
    ds_read_b128 a[120:123], v3 offset:14336
    v_mfma_f32_16x16x32_bf16 v[20:23], a[240:243], v[124:127], v[36:39]
    v_exp_f32 v112, v64
    v_mfma_f32_16x16x32_bf16 v[100:103], a[84:87], a[36:39], v[100:103]
    v_exp_f32 v113, v65
    v_mfma_f32_16x16x32_bf16 v[100:103], a[88:91], a[40:43], v[100:103]
    v_cvt_pk_bf16_f32 v128, v112, v113
    v_mfma_f32_16x16x32_bf16 v[100:103], a[92:95], a[44:47], v[100:103]
    v_exp_f32 v114, v66
    v_mfma_f32_16x16x32_bf16 v[108:111], a[80:83], a[48:51], v[164:167]
    ds_read_b128 a[124:127], v3 offset:15360
    buffer_load_dwordx4 v1, s[48:51], s56 offen offset:0 sc1 lds
    v_mfma_f32_16x16x32_bf16 v[108:111], a[84:87], a[52:55], v[108:111]
    s_waitcnt lgkmcnt(4)
    v_exp_f32 v115, v67
    v_mfma_f32_16x16x32_bf16 v[108:111], a[88:91], a[56:59], v[108:111]
    v_cvt_pk_bf16_f32 v129, v114, v115
    v_add_u32 v3, 0x10000, v2
    v_mfma_f32_16x16x32_bf16 v[108:111], a[92:95], a[60:63], v[108:111]
    v_exp_f32 v116, v68
    v_mfma_f32_16x16x32_bf16 a[128:131], a[96:99], v[136:139], a[128:131]
    v_add_u32 v2, 0x4000, v2
    v_and_b32 v2, 0xffff, v2
    v_mfma_f32_16x16x32_bf16 v[192:195], a[96:99], v[140:143], v[192:195]
    ds_read_b128 a[64:67], v2 offset:0
    v_mfma_f32_16x16x32_bf16 a[160:163], a[96:99], v[144:147], a[160:163]
    v_exp_f32 v117, v69
    v_mfma_f32_16x16x32_bf16 v[224:227], a[96:99], v[148:151], v[224:227]
    v_exp_f32 v118, v70
    v_mfma_f32_16x16x32_bf16 a[132:135], a[100:103], v[136:139], a[132:135]
    ds_read_b128 a[68:71], v2 offset:1024
    buffer_load_dwordx4 v1, s[48:51], s56 offen offset:1024 sc1 lds
    v_mfma_f32_16x16x32_bf16 v[196:199], a[100:103], v[140:143], v[196:199]
    v_exp_f32 v119, v71
    v_mfma_f32_16x16x32_bf16 a[164:167], a[100:103], v[144:147], a[164:167]
    v_cvt_pk_bf16_f32 v130, v116, v117
    v_cvt_pk_bf16_f32 v131, v118, v119
    v_mfma_f32_16x16x32_bf16 v[228:231], a[100:103], v[148:151], v[228:231]
    v_exp_f32 v112, v72
    v_mfma_f32_16x16x32_bf16 v[24:27], a[240:243], v[128:131], v[40:43]
    v_mfma_f32_16x16x32_bf16 a[136:139], a[104:107], v[136:139], a[136:139]
    ds_read_b128 a[72:75], v2 offset:2048
    v_mfma_f32_16x16x32_bf16 v[200:203], a[104:107], v[140:143], v[200:203]
    v_exp_f32 v113, v73
    v_mfma_f32_16x16x32_bf16 a[168:171], a[104:107], v[144:147], a[168:171]
    v_cvt_pk_bf16_f32 v132, v112, v113
    v_mfma_f32_16x16x32_bf16 v[232:235], a[104:107], v[148:151], v[232:235]
    v_exp_f32 v114, v74
    v_mfma_f32_16x16x32_bf16 a[140:143], a[108:111], v[136:139], a[140:143]
    ds_read_b128 a[76:79], v2 offset:3072
    buffer_load_dwordx4 v1, s[48:51], s56 offen offset:2048 sc1 lds
    v_mfma_f32_16x16x32_bf16 v[204:207], a[108:111], v[140:143], v[204:207]
    s_waitcnt lgkmcnt(4)
    v_exp_f32 v115, v75
    v_mfma_f32_16x16x32_bf16 a[172:175], a[108:111], v[144:147], a[172:175]
    v_cvt_pk_bf16_f32 v133, v114, v115
    v_mfma_f32_16x16x32_bf16 v[236:239], a[108:111], v[148:151], v[236:239]
    v_exp_f32 v116, v76
    v_mfma_f32_16x16x32_bf16 a[144:147], a[112:115], v[136:139], a[144:147]
    ds_read_b128 a[80:83], v2 offset:4096
    v_mfma_f32_16x16x32_bf16 v[208:211], a[112:115], v[140:143], v[208:211]
    v_exp_f32 v117, v77
    v_mfma_f32_16x16x32_bf16 a[176:179], a[112:115], v[144:147], a[176:179]
    v_cvt_pk_bf16_f32 v134, v116, v117
    v_mfma_f32_16x16x32_bf16 v[240:243], a[112:115], v[148:151], v[240:243]
    v_exp_f32 v118, v78
    v_mfma_f32_16x16x32_bf16 a[148:151], a[116:119], v[136:139], a[148:151]
    ds_read_b128 a[84:87], v2 offset:5120
    buffer_load_dwordx4 v1, s[48:51], s56 offen offset:3072 sc1 lds
    v_mfma_f32_16x16x32_bf16 v[212:215], a[116:119], v[140:143], v[212:215]
    v_exp_f32 v119, v79
    v_mfma_f32_16x16x32_bf16 a[180:183], a[116:119], v[144:147], a[180:183]
    v_cvt_pk_bf16_f32 v135, v118, v119
    v_mfma_f32_16x16x32_bf16 v[244:247], a[116:119], v[148:151], v[244:247]
    v_exp_f32 v112, v80
    v_mfma_f32_16x16x32_bf16 v[28:31], a[240:243], v[132:135], v[44:47]
    s_sub_u32 s63, s63, 1
    v_mfma_f32_16x16x32_bf16 a[152:155], a[120:123], v[136:139], a[152:155]
    ds_read_b128 a[88:91], v2 offset:6144
    s_cmp_lg_u32 s63, 0
    v_mfma_f32_16x16x32_bf16 v[216:219], a[120:123], v[140:143], v[216:219]
    v_exp_f32 v113, v81
    v_mfma_f32_16x16x32_bf16 a[184:187], a[120:123], v[144:147], a[184:187]
    v_exp_f32 v114, v82
    v_mfma_f32_16x16x32_bf16 v[248:251], a[120:123], v[148:151], v[248:251]
    v_max3_f32 v6, v16, v20, v24
    v_max_f32 v6, v6, v28
    v_mfma_f32_16x16x32_bf16 a[156:159], a[124:127], v[136:139], a[156:159]
    ds_read_b128 a[92:95], v2 offset:7168
    v_cmp_lt_f32 vcc, s73, v6
    v_mfma_f32_16x16x32_bf16 v[220:223], a[124:127], v[140:143], v[220:223]
    v_exp_f32 v115, v83
    v_mfma_f32_16x16x32_bf16 a[188:191], a[124:127], v[144:147], a[188:191]
    v_mfma_f32_16x16x32_bf16 v[252:255], a[124:127], v[148:151], v[252:255]
    s_cbranch_vccnz K2_SLOW3
K2_BACK3:
    s_cbranch_scc1 K2_LOOPD
    v_add_f32 v168, 0x5d000000, v4
    v_add_f32 v169, 0xdd000000, v4
    v_add_f32 v170, 0xddc00000, v4
    v_add_f32 v171, 0xde200000, v4
    v_add_f32 v172, 0xdf780000, v4
    v_add_f32 v173, 0xdf840000, v4
    v_add_f32 v174, 0xdf8c0000, v4
    v_add_f32 v175, 0xdf940000, v4
    v_min_f32 v168, v168, v160
    v_min_f32 v169, v169, v160
    v_min_f32 v170, v170, v160
    v_min_f32 v171, v171, v160
    v_min_f32 v172, v172, v160
    v_min_f32 v173, v173, v160
    v_min_f32 v174, v174, v160
    v_min_f32 v175, v175, v160
    s_nop 1
    s_waitcnt lgkmcnt(4)
    v_mfma_f32_16x16x32_bf16 v[48:51], a[64:67], a[0:3], v[152:155]
    s_waitcnt vmcnt(8)
    v_exp_f32 v116, v84
    v_mfma_f32_16x16x32_bf16 v[48:51], a[68:71], a[4:7], v[48:51]
    s_barrier
    v_cvt_pk_bf16_f32 v136, v112, v113
    v_cvt_pk_bf16_f32 v137, v114, v115
    v_mfma_f32_16x16x32_bf16 v[48:51], a[72:75], a[8:11], v[48:51]
    ds_read_b128 a[96:99], v3 offset:0
    s_add_u32 m0, s59, 65536
    v_mfma_f32_16x16x32_bf16 v[48:51], a[76:79], a[12:15], v[48:51]
    s_add_u32 s60, s56, 20979712
    v_exp_f32 v117, v85
    v_mfma_f32_16x16x32_bf16 v[56:59], a[64:67], a[16:19], v[156:159]
    ds_read_b128 a[100:103], v3 offset:1024
    v_cvt_pk_bf16_f32 v138, v116, v117
    v_mfma_f32_16x16x32_bf16 v[56:59], a[68:71], a[20:23], v[56:59]
    v_exp_f32 v118, v86
    v_mfma_f32_16x16x32_bf16 v[56:59], a[72:75], a[24:27], v[56:59]
    v_exp_f32 v119, v87
    v_mfma_f32_16x16x32_bf16 v[56:59], a[76:79], a[28:31], v[56:59]
    v_cvt_pk_bf16_f32 v139, v118, v119
    v_mfma_f32_16x16x32_bf16 v[64:67], a[64:67], a[32:35], v[168:171]
    ds_read_b128 a[104:107], v3 offset:2048
    v_mfma_f32_16x16x32_bf16 v[32:35], a[240:243], v[136:139], v[16:19]
    v_exp_f32 v112, v88
    v_mfma_f32_16x16x32_bf16 v[64:67], a[68:71], a[36:39], v[64:67]
    v_exp_f32 v113, v89
    v_mfma_f32_16x16x32_bf16 v[64:67], a[72:75], a[40:43], v[64:67]
    v_cvt_pk_bf16_f32 v140, v112, v113
    v_mfma_f32_16x16x32_bf16 v[64:67], a[76:79], a[44:47], v[64:67]
    v_exp_f32 v114, v90
    v_mfma_f32_16x16x32_bf16 v[72:75], a[64:67], a[48:51], v[164:167]
    ds_read_b128 a[108:111], v3 offset:3072
    v_mfma_f32_16x16x32_bf16 v[72:75], a[68:71], a[52:55], v[72:75]
    s_waitcnt lgkmcnt(4)
    v_exp_f32 v115, v91
    v_mfma_f32_16x16x32_bf16 v[72:75], a[72:75], a[56:59], v[72:75]
    v_cvt_pk_bf16_f32 v141, v114, v115
    v_mfma_f32_16x16x32_bf16 v[72:75], a[76:79], a[60:63], v[72:75]
    v_exp_f32 v116, v92
    v_mfma_f32_16x16x32_bf16 v[52:55], a[80:83], a[0:3], v[152:155]
    ds_read_b128 a[112:115], v3 offset:4096
    buffer_load_dwordx4 v1, s[48:51], s60 offen offset:0 sc1 lds
    v_mfma_f32_16x16x32_bf16 v[52:55], a[84:87], a[4:7], v[52:55]
    v_exp_f32 v117, v93
    v_mfma_f32_16x16x32_bf16 v[52:55], a[88:91], a[8:11], v[52:55]
    v_cvt_pk_bf16_f32 v142, v116, v117
    v_mfma_f32_16x16x32_bf16 v[52:55], a[92:95], a[12:15], v[52:55]
    v_exp_f32 v118, v94
    v_mfma_f32_16x16x32_bf16 v[60:63], a[80:83], a[16:19], v[156:159]
    ds_read_b128 a[116:119], v3 offset:5120
    buffer_load_dwordx4 v1, s[48:51], s60 offen offset:1024 sc1 lds
    v_mfma_f32_16x16x32_bf16 v[60:63], a[84:87], a[20:23], v[60:63]
    v_mfma_f32_16x16x32_bf16 v[60:63], a[88:91], a[24:27], v[60:63]
    v_exp_f32 v119, v95
    v_mfma_f32_16x16x32_bf16 v[60:63], a[92:95], a[28:31], v[60:63]
    v_cvt_pk_bf16_f32 v143, v118, v119
    v_mfma_f32_16x16x32_bf16 v[68:71], a[80:83], a[32:35], v[172:175]
    ds_read_b128 a[120:123], v3 offset:6144
    v_mfma_f32_16x16x32_bf16 v[36:39], a[240:243], v[140:143], v[20:23]
    v_exp_f32 v112, v96
    v_mfma_f32_16x16x32_bf16 v[68:71], a[84:87], a[36:39], v[68:71]
    v_exp_f32 v113, v97
    v_mfma_f32_16x16x32_bf16 v[68:71], a[88:91], a[40:43], v[68:71]
    v_cvt_pk_bf16_f32 v144, v112, v113
    v_mfma_f32_16x16x32_bf16 v[68:71], a[92:95], a[44:47], v[68:71]
    v_exp_f32 v114, v98
    v_mfma_f32_16x16x32_bf16 v[76:79], a[80:83], a[48:51], v[164:167]
    ds_read_b128 a[124:127], v3 offset:7168
    buffer_load_dwordx4 v1, s[48:51], s60 offen offset:2048 sc1 lds
    v_mfma_f32_16x16x32_bf16 v[76:79], a[84:87], a[52:55], v[76:79]
    s_waitcnt lgkmcnt(4)
    v_exp_f32 v115, v99
    v_mfma_f32_16x16x32_bf16 v[76:79], a[88:91], a[56:59], v[76:79]
    v_cvt_pk_bf16_f32 v145, v114, v115
    v_mfma_f32_16x16x32_bf16 v[76:79], a[92:95], a[60:63], v[76:79]
    v_exp_f32 v116, v100
    v_mfma_f32_16x16x32_bf16 a[128:131], a[96:99], v[120:123], a[128:131]
    ds_read_b128 a[64:67], v2 offset:8192
    v_mfma_f32_16x16x32_bf16 v[192:195], a[96:99], v[124:127], v[192:195]
    v_exp_f32 v117, v101
    v_mfma_f32_16x16x32_bf16 a[160:163], a[96:99], v[128:131], a[160:163]
    v_cvt_pk_bf16_f32 v146, v116, v117
    v_mfma_f32_16x16x32_bf16 v[224:227], a[96:99], v[132:135], v[224:227]
    v_exp_f32 v118, v102
    v_mfma_f32_16x16x32_bf16 a[132:135], a[100:103], v[120:123], a[132:135]
    ds_read_b128 a[68:71], v2 offset:9216
    buffer_load_dwordx4 v1, s[48:51], s60 offen offset:3072 sc1 lds
    v_mfma_f32_16x16x32_bf16 v[196:199], a[100:103], v[124:127], v[196:199]
    s_add_u32 s56, s56, 16384
    v_exp_f32 v119, v103
    v_mfma_f32_16x16x32_bf16 a[164:167], a[100:103], v[128:131], a[164:167]
    s_cmp_ge_u32 s56, s57
    v_cvt_pk_bf16_f32 v147, v118, v119
    v_mfma_f32_16x16x32_bf16 v[228:231], a[100:103], v[132:135], v[228:231]
    s_cselect_b32 s56, 0x40000000, s56
    v_exp_f32 v112, v104
    v_mfma_f32_16x16x32_bf16 v[40:43], a[240:243], v[144:147], v[24:27]
    v_mfma_f32_16x16x32_bf16 a[136:139], a[104:107], v[120:123], a[136:139]
    ds_read_b128 a[72:75], v2 offset:10240
    v_mfma_f32_16x16x32_bf16 v[200:203], a[104:107], v[124:127], v[200:203]
    v_exp_f32 v113, v105
    v_mfma_f32_16x16x32_bf16 a[168:171], a[104:107], v[128:131], a[168:171]
    v_cvt_pk_bf16_f32 v148, v112, v113
    v_mfma_f32_16x16x32_bf16 v[232:235], a[104:107], v[132:135], v[232:235]
    v_exp_f32 v114, v106
    v_mfma_f32_16x16x32_bf16 a[140:143], a[108:111], v[120:123], a[140:143]
    ds_read_b128 a[76:79], v2 offset:11264
    v_mfma_f32_16x16x32_bf16 v[204:207], a[108:111], v[124:127], v[204:207]
    s_waitcnt lgkmcnt(4)
    v_exp_f32 v115, v107
    v_mfma_f32_16x16x32_bf16 a[172:175], a[108:111], v[128:131], a[172:175]
    v_cvt_pk_bf16_f32 v149, v114, v115
    v_mfma_f32_16x16x32_bf16 v[236:239], a[108:111], v[132:135], v[236:239]
    v_exp_f32 v116, v108
    v_mfma_f32_16x16x32_bf16 a[144:147], a[112:115], v[120:123], a[144:147]
    ds_read_b128 a[80:83], v2 offset:12288
    v_mfma_f32_16x16x32_bf16 v[208:211], a[112:115], v[124:127], v[208:211]
    v_exp_f32 v117, v109
    v_mfma_f32_16x16x32_bf16 a[176:179], a[112:115], v[128:131], a[176:179]
    v_cvt_pk_bf16_f32 v150, v116, v117
    v_mfma_f32_16x16x32_bf16 v[240:243], a[112:115], v[132:135], v[240:243]
    v_exp_f32 v118, v110
    v_mfma_f32_16x16x32_bf16 a[148:151], a[116:119], v[120:123], a[148:151]
    ds_read_b128 a[84:87], v2 offset:13312
    v_mfma_f32_16x16x32_bf16 v[212:215], a[116:119], v[124:127], v[212:215]
    v_exp_f32 v119, v111
    v_mfma_f32_16x16x32_bf16 a[180:183], a[116:119], v[128:131], a[180:183]
    v_cvt_pk_bf16_f32 v151, v118, v119
    v_mfma_f32_16x16x32_bf16 v[244:247], a[116:119], v[132:135], v[244:247]
    v_exp_f32 v112, v48
    v_mfma_f32_16x16x32_bf16 v[44:47], a[240:243], v[148:151], v[28:31]
    v_mfma_f32_16x16x32_bf16 a[152:155], a[120:123], v[120:123], a[152:155]
    ds_read_b128 a[88:91], v2 offset:14336
    v_mfma_f32_16x16x32_bf16 v[216:219], a[120:123], v[124:127], v[216:219]
    v_exp_f32 v113, v49
    v_mfma_f32_16x16x32_bf16 a[184:187], a[120:123], v[128:131], a[184:187]
    v_exp_f32 v114, v50
    v_mfma_f32_16x16x32_bf16 v[248:251], a[120:123], v[132:135], v[248:251]
    v_mfma_f32_16x16x32_bf16 a[156:159], a[124:127], v[120:123], a[156:159]
    ds_read_b128 a[92:95], v2 offset:15360
    v_max3_f32 v6, v32, v36, v40
    v_mfma_f32_16x16x32_bf16 v[220:223], a[124:127], v[124:127], v[220:223]
    v_exp_f32 v115, v51
    v_mfma_f32_16x16x32_bf16 a[188:191], a[124:127], v[128:131], a[188:191]
    v_max_f32 v6, v6, v44
    v_cmp_lt_f32 vcc, s73, v6
    v_mfma_f32_16x16x32_bf16 v[252:255], a[124:127], v[132:135], v[252:255]
    s_cbranch_vccnz K2_SLOW4
K2_BACK4:
    v_add_f32 v168, 0xdffc0000, v4
    v_add_f32 v169, 0xe0020000, v4
    v_add_f32 v170, 0xe0060000, v4
    v_add_f32 v171, 0xe00a0000, v4
    v_add_f32 v172, 0xe03e0000, v4
    v_add_f32 v173, 0xe0420000, v4
    v_add_f32 v174, 0xe0460000, v4
    v_add_f32 v175, 0xe04a0000, v4
    v_min_f32 v168, v168, v160
    v_min_f32 v169, v169, v160
    v_min_f32 v170, v170, v160
    v_min_f32 v171, v171, v160
    v_min_f32 v172, v172, v160
    v_min_f32 v173, v173, v160
    v_min_f32 v174, v174, v160
    v_min_f32 v175, v175, v160
    s_nop 1
    s_waitcnt lgkmcnt(4)
    v_mfma_f32_16x16x32_bf16 v[80:83], a[64:67], a[0:3], v[152:155]
    ds_read_b128 a[96:99], v3 offset:8192
    v_cvt_pk_bf16_f32 v120, v112, v113
    v_mfma_f32_16x16x32_bf16 v[80:83], a[68:71], a[4:7], v[80:83]
    s_add_u32 s59, s59, 16384
    v_exp_f32 v116, v52
    v_mfma_f32_16x16x32_bf16 v[80:83], a[72:75], a[8:11], v[80:83]
    s_and_b32 s59, s59, 0xffff
    v_exp_f32 v117, v53
    v_mfma_f32_16x16x32_bf16 v[80:83], a[76:79], a[12:15], v[80:83]
    s_mov_b32 m0, s59
    v_cvt_pk_bf16_f32 v121, v114, v115
    v_cvt_pk_bf16_f32 v122, v116, v117
    v_mfma_f32_16x16x32_bf16 v[88:91], a[64:67], a[16:19], v[156:159]
    ds_read_b128 a[100:103], v3 offset:9216
    v_mfma_f32_16x16x32_bf16 v[88:91], a[68:71], a[20:23], v[88:91]
    v_exp_f32 v118, v54
    v_mfma_f32_16x16x32_bf16 v[88:91], a[72:75], a[24:27], v[88:91]
    v_exp_f32 v119, v55
    v_mfma_f32_16x16x32_bf16 v[88:91], a[76:79], a[28:31], v[88:91]
    v_cvt_pk_bf16_f32 v123, v118, v119
    v_mfma_f32_16x16x32_bf16 v[96:99], a[64:67], a[32:35], v[168:171]
    ds_read_b128 a[104:107], v3 offset:10240
    v_mfma_f32_16x16x32_bf16 v[16:19], a[240:243], v[120:123], v[32:35]
    v_exp_f32 v112, v56
    v_mfma_f32_16x16x32_bf16 v[96:99], a[68:71], a[36:39], v[96:99]
    v_exp_f32 v113, v57
    v_mfma_f32_16x16x32_bf16 v[96:99], a[72:75], a[40:43], v[96:99]
    v_cvt_pk_bf16_f32 v124, v112, v113
    v_mfma_f32_16x16x32_bf16 v[96:99], a[76:79], a[44:47], v[96:99]
    v_exp_f32 v114, v58
    v_mfma_f32_16x16x32_bf16 v[104:107], a[64:67], a[48:51], v[164:167]
    ds_read_b128 a[108:111], v3 offset:11264
    v_mfma_f32_16x16x32_bf16 v[104:107], a[68:71], a[52:55], v[104:107]
    s_waitcnt lgkmcnt(4)
    v_exp_f32 v115, v59
    v_mfma_f32_16x16x32_bf16 v[104:107], a[72:75], a[56:59], v[104:107]
    v_cvt_pk_bf16_f32 v125, v114, v115
    v_mfma_f32_16x16x32_bf16 v[104:107], a[76:79], a[60:63], v[104:107]
    v_exp_f32 v116, v60
    v_mfma_f32_16x16x32_bf16 v[84:87], a[80:83], a[0:3], v[152:155]
    ds_read_b128 a[112:115], v3 offset:12288
    v_mfma_f32_16x16x32_bf16 v[84:87], a[84:87], a[4:7], v[84:87]
    v_exp_f32 v117, v61
    v_mfma_f32_16x16x32_bf16 v[84:87], a[88:91], a[8:11], v[84:87]
    v_cvt_pk_bf16_f32 v126, v116, v117
    v_mfma_f32_16x16x32_bf16 v[84:87], a[92:95], a[12:15], v[84:87]
    v_exp_f32 v118, v62
    v_mfma_f32_16x16x32_bf16 v[92:95], a[80:83], a[16:19], v[156:159]
    ds_read_b128 a[116:119], v3 offset:13312
    v_mfma_f32_16x16x32_bf16 v[92:95], a[84:87], a[20:23], v[92:95]
    v_mfma_f32_16x16x32_bf16 v[92:95], a[88:91], a[24:27], v[92:95]
    v_exp_f32 v119, v63
    v_mfma_f32_16x16x32_bf16 v[92:95], a[92:95], a[28:31], v[92:95]
    v_cvt_pk_bf16_f32 v127, v118, v119
    v_mfma_f32_16x16x32_bf16 v[100:103], a[80:83], a[32:35], v[172:175]
    ds_read_b128 a[120:123], v3 offset:14336
    v_mfma_f32_16x16x32_bf16 v[20:23], a[240:243], v[124:127], v[36:39]
    v_exp_f32 v112, v64
    v_mfma_f32_16x16x32_bf16 v[100:103], a[84:87], a[36:39], v[100:103]
    v_exp_f32 v113, v65
    v_mfma_f32_16x16x32_bf16 v[100:103], a[88:91], a[40:43], v[100:103]
    v_cvt_pk_bf16_f32 v128, v112, v113
    v_mfma_f32_16x16x32_bf16 v[100:103], a[92:95], a[44:47], v[100:103]
    v_exp_f32 v114, v66
    v_mfma_f32_16x16x32_bf16 v[108:111], a[80:83], a[48:51], v[164:167]
    ds_read_b128 a[124:127], v3 offset:15360
    buffer_load_dwordx4 v1, s[48:51], s56 offen offset:0 sc1 lds
    v_mfma_f32_16x16x32_bf16 v[108:111], a[84:87], a[52:55], v[108:111]
    s_waitcnt lgkmcnt(4)
    v_exp_f32 v115, v67
    v_mfma_f32_16x16x32_bf16 v[108:111], a[88:91], a[56:59], v[108:111]
    v_cvt_pk_bf16_f32 v129, v114, v115
    v_add_u32 v3, 0x10000, v2
    v_mfma_f32_16x16x32_bf16 v[108:111], a[92:95], a[60:63], v[108:111]
    v_exp_f32 v116, v68
    v_mfma_f32_16x16x32_bf16 a[128:131], a[96:99], v[136:139], a[128:131]
    v_add_u32 v2, 0x4000, v2
    v_and_b32 v2, 0xffff, v2
    v_mfma_f32_16x16x32_bf16 v[192:195], a[96:99], v[140:143], v[192:195]
    ds_read_b128 a[64:67], v2 offset:0
    v_mfma_f32_16x16x32_bf16 a[160:163], a[96:99], v[144:147], a[160:163]
    v_exp_f32 v117, v69
    v_mfma_f32_16x16x32_bf16 v[224:227], a[96:99], v[148:151], v[224:227]
    v_exp_f32 v118, v70
    v_mfma_f32_16x16x32_bf16 a[132:135], a[100:103], v[136:139], a[132:135]
    ds_read_b128 a[68:71], v2 offset:1024
    buffer_load_dwordx4 v1, s[48:51], s56 offen offset:1024 sc1 lds
    v_mfma_f32_16x16x32_bf16 v[196:199], a[100:103], v[140:143], v[196:199]
    v_exp_f32 v119, v71
    v_mfma_f32_16x16x32_bf16 a[164:167], a[100:103], v[144:147], a[164:167]
    v_cvt_pk_bf16_f32 v130, v116, v117
    v_cvt_pk_bf16_f32 v131, v118, v119
    v_mfma_f32_16x16x32_bf16 v[228:231], a[100:103], v[148:151], v[228:231]
    v_exp_f32 v112, v72
    v_mfma_f32_16x16x32_bf16 v[24:27], a[240:243], v[128:131], v[40:43]
    v_mfma_f32_16x16x32_bf16 a[136:139], a[104:107], v[136:139], a[136:139]
    ds_read_b128 a[72:75], v2 offset:2048
    v_mfma_f32_16x16x32_bf16 v[200:203], a[104:107], v[140:143], v[200:203]
    v_exp_f32 v113, v73
    v_mfma_f32_16x16x32_bf16 a[168:171], a[104:107], v[144:147], a[168:171]
    v_cvt_pk_bf16_f32 v132, v112, v113
    v_mfma_f32_16x16x32_bf16 v[232:235], a[104:107], v[148:151], v[232:235]
    v_exp_f32 v114, v74
    v_mfma_f32_16x16x32_bf16 a[140:143], a[108:111], v[136:139], a[140:143]
    ds_read_b128 a[76:79], v2 offset:3072
    buffer_load_dwordx4 v1, s[48:51], s56 offen offset:2048 sc1 lds
    v_mfma_f32_16x16x32_bf16 v[204:207], a[108:111], v[140:143], v[204:207]
    s_waitcnt lgkmcnt(4)
    v_exp_f32 v115, v75
    v_mfma_f32_16x16x32_bf16 a[172:175], a[108:111], v[144:147], a[172:175]
    v_cvt_pk_bf16_f32 v133, v114, v115
    v_mfma_f32_16x16x32_bf16 v[236:239], a[108:111], v[148:151], v[236:239]
    v_exp_f32 v116, v76
    v_mfma_f32_16x16x32_bf16 a[144:147], a[112:115], v[136:139], a[144:147]
    ds_read_b128 a[80:83], v2 offset:4096
    v_mfma_f32_16x16x32_bf16 v[208:211], a[112:115], v[140:143], v[208:211]
    v_exp_f32 v117, v77
    v_mfma_f32_16x16x32_bf16 a[176:179], a[112:115], v[144:147], a[176:179]
    v_cvt_pk_bf16_f32 v134, v116, v117
    v_mfma_f32_16x16x32_bf16 v[240:243], a[112:115], v[148:151], v[240:243]
    v_exp_f32 v118, v78
    v_mfma_f32_16x16x32_bf16 a[148:151], a[116:119], v[136:139], a[148:151]
    ds_read_b128 a[84:87], v2 offset:5120
    buffer_load_dwordx4 v1, s[48:51], s56 offen offset:3072 sc1 lds
    v_mfma_f32_16x16x32_bf16 v[212:215], a[116:119], v[140:143], v[212:215]
    v_exp_f32 v119, v79
    v_mfma_f32_16x16x32_bf16 a[180:183], a[116:119], v[144:147], a[180:183]
    v_cvt_pk_bf16_f32 v135, v118, v119
    v_mfma_f32_16x16x32_bf16 v[244:247], a[116:119], v[148:151], v[244:247]
    v_exp_f32 v112, v80
    v_mfma_f32_16x16x32_bf16 v[28:31], a[240:243], v[132:135], v[44:47]
    v_mfma_f32_16x16x32_bf16 a[152:155], a[120:123], v[136:139], a[152:155]
    ds_read_b128 a[88:91], v2 offset:6144
    v_mfma_f32_16x16x32_bf16 v[216:219], a[120:123], v[140:143], v[216:219]
    v_exp_f32 v113, v81
    v_mfma_f32_16x16x32_bf16 a[184:187], a[120:123], v[144:147], a[184:187]
    v_exp_f32 v114, v82
    v_mfma_f32_16x16x32_bf16 v[248:251], a[120:123], v[148:151], v[248:251]
    v_mfma_f32_16x16x32_bf16 a[156:159], a[124:127], v[136:139], a[156:159]
    ds_read_b128 a[92:95], v2 offset:7168
    v_max3_f32 v6, v16, v20, v24
    v_mfma_f32_16x16x32_bf16 v[220:223], a[124:127], v[140:143], v[220:223]
    v_exp_f32 v115, v83
    v_mfma_f32_16x16x32_bf16 a[188:191], a[124:127], v[144:147], a[188:191]
    v_max_f32 v6, v6, v28
    v_cmp_lt_f32 vcc, s73, v6
    v_mfma_f32_16x16x32_bf16 v[252:255], a[124:127], v[148:151], v[252:255]
    s_cbranch_vccnz K2_SLOW5
K2_BACK5:
K2_LASTD:
    v_and_b32 v13, 31, v0
    v_lshl_add_u32 v13, v13, 3, v10
    buffer_load_dword v14, v13, s[80:83], 0 offen sc1
    v_lshrrev_b32 v7, 2, v0
    v_lshlrev_b32 v7, 7, v7
    v_and_b32 v8, 3, v0
    v_lshl_add_u32 v7, v8, 3, v7
    v_add_u32 v7, s87, v7
    v_bfe_u32 v8, v0, 3, 2
    v_xor_b32 v9, 0, v8
    v_lshl_add_u32 v9, v9, 5, v7
    ds_read_b64_tr_b16 a[192:193], v9 offset:0
    ds_read_b64_tr_b16 a[194:195], v9 offset:2048
    v_xor_b32 v9, 1, v8
    v_lshl_add_u32 v9, v9, 5, v7
    ds_read_b64_tr_b16 a[196:197], v9 offset:0
    ds_read_b64_tr_b16 a[198:199], v9 offset:2048
    v_xor_b32 v9, 2, v8
    v_lshl_add_u32 v9, v9, 5, v7
    ds_read_b64_tr_b16 a[200:201], v9 offset:0
    ds_read_b64_tr_b16 a[202:203], v9 offset:2048
    v_xor_b32 v9, 3, v8
    v_lshl_add_u32 v9, v9, 5, v7
    ds_read_b64_tr_b16 a[204:205], v9 offset:0
    ds_read_b64_tr_b16 a[206:207], v9 offset:2048
    v_add_f32 v168, 0xe07e0000, v5
    v_add_f32 v169, 0xe0810000, v5
    v_add_f32 v170, 0xe0830000, v5
    v_add_f32 v171, 0xe0850000, v5
    v_add_f32 v172, 0xe09f0000, v5
    v_add_f32 v173, 0xe0a10000, v5
    v_add_f32 v174, 0xe0a30000, v5
    v_add_f32 v175, 0xe0a50000, v5
    v_min_f32 v168, v168, v164
    v_min_f32 v169, v169, v164
    v_min_f32 v170, v170, v164
    v_min_f32 v171, v171, v164
    v_min_f32 v172, v172, v164
    v_min_f32 v173, v173, v164
    v_min_f32 v174, v174, v164
    v_min_f32 v175, v175, v164
    s_nop 1
    s_waitcnt lgkmcnt(12)
    v_mfma_f32_16x16x32_bf16 v[48:51], a[64:67], a[0:3], v[152:155]
    s_waitcnt vmcnt(8)
    v_exp_f32 v116, v84
    v_mfma_f32_16x16x32_bf16 v[48:51], a[68:71], a[4:7], v[48:51]
    s_barrier
    v_exp_f32 v117, v85
    v_mfma_f32_16x16x32_bf16 v[48:51], a[72:75], a[8:11], v[48:51]
    ds_read_b128 a[96:99], v3 offset:0
    v_cvt_pk_bf16_f32 v136, v112, v113
    v_mfma_f32_16x16x32_bf16 v[48:51], a[76:79], a[12:15], v[48:51]
    s_waitcnt lgkmcnt(1)
    v_exp_f32 v118, v86
    v_mfma_f32_16x16x32_bf16 v[56:59], a[64:67], a[16:19], v[156:159]
    ds_read_b128 a[100:103], v3 offset:1024
    buffer_store_dwordx4 a[192:195], v1, s[48:51], s86 offen offset:0 sc1
    v_mfma_f32_16x16x32_bf16 v[56:59], a[68:71], a[20:23], v[56:59]
    v_exp_f32 v119, v87
    v_mfma_f32_16x16x32_bf16 v[56:59], a[72:75], a[24:27], v[56:59]
    ds_read_b128 a[104:107], v3 offset:2048
    buffer_store_dwordx4 a[196:199], v1, s[48:51], s86 offen offset:1024 sc1
    v_mfma_f32_16x16x32_bf16 v[56:59], a[76:79], a[28:31], v[56:59]
    v_exp_f32 v112, v88
    v_mfma_f32_16x16x32_bf16 v[72:75], a[64:67], a[48:51], v[168:171]
    v_cvt_pk_bf16_f32 v137, v114, v115
    v_cvt_pk_bf16_f32 v138, v116, v117
    v_mfma_f32_16x16x32_bf16 v[72:75], a[68:71], a[52:55], v[72:75]
    ds_read_b128 a[108:111], v3 offset:3072
    buffer_store_dwordx4 a[200:203], v1, s[48:51], s84 offen offset:0 sc1
    v_mfma_f32_16x16x32_bf16 v[72:75], a[72:75], a[56:59], v[72:75]
    v_exp_f32 v113, v89
    v_mfma_f32_16x16x32_bf16 v[72:75], a[76:79], a[60:63], v[72:75]
    v_exp_f32 v114, v90
    v_mfma_f32_16x16x32_bf16 v[52:55], a[80:83], a[0:3], v[152:155]
    ds_read_b128 a[112:115], v3 offset:4096
    buffer_store_dwordx4 a[204:207], v1, s[48:51], s84 offen offset:1024 sc1
    v_mfma_f32_16x16x32_bf16 v[52:55], a[84:87], a[4:7], v[52:55]
    s_lshr_b32 s6, s2, 6
    v_exp_f32 v115, v91
    v_mfma_f32_16x16x32_bf16 v[52:55], a[88:91], a[8:11], v[52:55]
    s_lshl_b32 s6, s6, 4
    v_exp_f32 v116, v92
    v_mfma_f32_16x16x32_bf16 v[52:55], a[92:95], a[12:15], v[52:55]
    ds_read_b128 a[116:119], v3 offset:5120
    v_cvt_pk_bf16_f32 v139, v118, v119
    v_mfma_f32_16x16x32_bf16 v[60:63], a[80:83], a[16:19], v[156:159]
    s_and_b32 s7, s2, 1
    v_exp_f32 v117, v93
    v_mfma_f32_16x16x32_bf16 v[32:35], a[240:243], v[136:139], v[16:19]
    s_lshl_b32 s7, s7, 3
    v_cvt_pk_bf16_f32 v140, v112, v113
    v_cvt_pk_bf16_f32 v141, v114, v115
    v_mfma_f32_16x16x32_bf16 v[60:63], a[84:87], a[20:23], v[60:63]
    s_add_u32 s6, s6, s7
    v_exp_f32 v118, v94
    v_mfma_f32_16x16x32_bf16 v[60:63], a[88:91], a[24:27], v[60:63]
    ds_read_b128 a[120:123], v3 offset:6144
    v_cvt_pk_bf16_f32 v142, v116, v117
    v_mfma_f32_16x16x32_bf16 v[60:63], a[92:95], a[28:31], v[60:63]
    s_bfe_u32 s7, s2, 0x30003
    v_exp_f32 v119, v95
    v_mfma_f32_16x16x32_bf16 v[76:79], a[80:83], a[48:51], v[172:175]
    s_add_u32 s6, s6, s7
    v_cvt_pk_bf16_f32 v143, v118, v119
    v_mfma_f32_16x16x32_bf16 v[76:79], a[84:87], a[52:55], v[76:79]
    ds_read_b128 a[124:127], v3 offset:7168
    s_waitcnt lgkmcnt(4)
    v_mfma_f32_16x16x32_bf16 v[36:39], a[240:243], v[140:143], v[20:23]
    s_lshl_b32 s6, s6, 2
    v_exp_f32 v112, v96
    v_mfma_f32_16x16x32_bf16 v[76:79], a[88:91], a[56:59], v[76:79]
    s_bfe_u32 s7, s2, 0x20001
    v_exp_f32 v113, v97
    v_mfma_f32_16x16x32_bf16 v[76:79], a[92:95], a[60:63], v[76:79]
    s_add_u32 s6, s6, s7
    v_exp_f32 v114, v98
    v_mfma_f32_16x16x32_bf16 a[128:131], a[96:99], v[120:123], a[128:131]
    ds_read_b128 a[64:67], v2 offset:8192
    v_cvt_pk_bf16_f32 v144, v112, v113
    v_mfma_f32_16x16x32_bf16 v[192:195], a[96:99], v[124:127], v[192:195]
    s_mul_i32 s6, s6, 49152
    v_exp_f32 v115, v99
    v_mfma_f32_16x16x32_bf16 a[160:163], a[96:99], v[128:131], a[160:163]
    s_lshl_b32 s7, s3, 12
    v_cvt_pk_bf16_f32 v145, v114, v115
    v_mfma_f32_16x16x32_bf16 v[224:227], a[96:99], v[132:135], v[224:227]
    s_add_u32 s6, s6, s7
    v_exp_f32 v116, v100
    v_mfma_f32_16x16x32_bf16 a[132:135], a[100:103], v[120:123], a[132:135]
    ds_read_b128 a[68:71], v2 offset:9216
    s_add_u32 s6, s6, 4194304
    v_mfma_f32_16x16x32_bf16 v[196:199], a[100:103], v[124:127], v[196:199]
    v_exp_f32 v117, v101
    v_mfma_f32_16x16x32_bf16 a[164:167], a[100:103], v[128:131], a[164:167]
    v_cvt_pk_bf16_f32 v146, v116, v117
    v_mfma_f32_16x16x32_bf16 v[228:231], a[100:103], v[132:135], v[228:231]
    v_exp_f32 v118, v102
    v_mfma_f32_16x16x32_bf16 a[136:139], a[104:107], v[120:123], a[136:139]
    ds_read_b128 a[72:75], v2 offset:10240
    buffer_store_dwordx4 a[244:247], v1, s[48:51], s6 offen offset:0 sc1
    v_mfma_f32_16x16x32_bf16 v[200:203], a[104:107], v[124:127], v[200:203]
    v_exp_f32 v119, v103
    v_mfma_f32_16x16x32_bf16 a[168:171], a[104:107], v[128:131], a[168:171]
    v_exp_f32 v112, v104
    v_mfma_f32_16x16x32_bf16 v[232:235], a[104:107], v[132:135], v[232:235]
    v_cvt_pk_bf16_f32 v147, v118, v119
    v_mfma_f32_16x16x32_bf16 a[140:143], a[108:111], v[120:123], a[140:143]
    ds_read_b128 a[76:79], v2 offset:11264
    buffer_store_dwordx4 a[244:247], v1, s[48:51], s6 offen offset:1024 sc1
    v_mfma_f32_16x16x32_bf16 v[40:43], a[240:243], v[144:147], v[24:27]
    v_exp_f32 v113, v105
    v_mfma_f32_16x16x32_bf16 v[204:207], a[108:111], v[124:127], v[204:207]
    s_waitcnt lgkmcnt(4)
    v_exp_f32 v114, v106
    v_mfma_f32_16x16x32_bf16 a[172:175], a[108:111], v[128:131], a[172:175]
    v_cvt_pk_bf16_f32 v148, v112, v113
    v_mfma_f32_16x16x32_bf16 v[236:239], a[108:111], v[132:135], v[236:239]
    v_exp_f32 v115, v107
    v_mfma_f32_16x16x32_bf16 a[144:147], a[112:115], v[120:123], a[144:147]
    ds_read_b128 a[80:83], v2 offset:12288
    buffer_store_dwordx4 a[244:247], v1, s[48:51], s6 offen offset:2048 sc1
    v_mfma_f32_16x16x32_bf16 v[208:211], a[112:115], v[124:127], v[208:211]
    v_exp_f32 v116, v108
    v_mfma_f32_16x16x32_bf16 a[176:179], a[112:115], v[128:131], a[176:179]
    v_cvt_pk_bf16_f32 v149, v114, v115
    v_mfma_f32_16x16x32_bf16 v[240:243], a[112:115], v[132:135], v[240:243]
    v_exp_f32 v117, v109
    v_mfma_f32_16x16x32_bf16 a[148:151], a[116:119], v[120:123], a[148:151]
    ds_read_b128 a[84:87], v2 offset:13312
    buffer_store_dwordx4 a[244:247], v1, s[48:51], s6 offen offset:3072 sc1
    v_mfma_f32_16x16x32_bf16 v[212:215], a[116:119], v[124:127], v[212:215]
    s_add_u32 m0, s59, 65536
    v_exp_f32 v118, v110
    v_mfma_f32_16x16x32_bf16 a[180:183], a[116:119], v[128:131], a[180:183]
    s_add_u32 s60, s56, 20979712
    v_exp_f32 v119, v111
    v_mfma_f32_16x16x32_bf16 v[244:247], a[116:119], v[132:135], v[244:247]
    v_cvt_pk_bf16_f32 v150, v116, v117
    v_cvt_pk_bf16_f32 v151, v118, v119
    v_mfma_f32_16x16x32_bf16 a[152:155], a[120:123], v[120:123], a[152:155]
    ds_read_b128 a[88:91], v2 offset:14336
    buffer_load_dwordx4 v1, s[48:51], s60 offen offset:0 sc1 lds
    v_mfma_f32_16x16x32_bf16 v[44:47], a[240:243], v[148:151], v[28:31]
    v_exp_f32 v112, v48
    v_mfma_f32_16x16x32_bf16 v[216:219], a[120:123], v[124:127], v[216:219]
    v_exp_f32 v113, v49
    v_mfma_f32_16x16x32_bf16 a[184:187], a[120:123], v[128:131], a[184:187]
    v_mfma_f32_16x16x32_bf16 v[248:251], a[120:123], v[132:135], v[248:251]
    v_exp_f32 v114, v50
    v_mfma_f32_16x16x32_bf16 a[156:159], a[124:127], v[120:123], a[156:159]
    ds_read_b128 a[92:95], v2 offset:15360
    buffer_load_dwordx4 v1, s[48:51], s60 offen offset:1024 sc1 lds
    v_mfma_f32_16x16x32_bf16 v[220:223], a[124:127], v[124:127], v[220:223]
    v_exp_f32 v115, v51
    v_mfma_f32_16x16x32_bf16 a[188:191], a[124:127], v[128:131], a[188:191]
    buffer_load_dwordx4 v1, s[48:51], s60 offen offset:2048 sc1 lds
    v_max3_f32 v6, v32, v36, v40
    v_mfma_f32_16x16x32_bf16 v[252:255], a[124:127], v[132:135], v[252:255]
    buffer_load_dwordx4 v1, s[48:51], s60 offen offset:3072 sc1 lds
    v_max_f32 v6, v6, v44
    s_add_u32 s56, s56, 16384
    s_cmp_ge_u32 s56, s57
    s_cselect_b32 s56, 0x40000000, s56
    v_cmp_lt_f32 vcc, s73, v6
    s_cbranch_vccnz K2_SLOW6
K2_BACK6:
    v_add_f32 v168, 0xe0bf0000, v5
    v_add_f32 v169, 0xe0c10000, v5
    v_add_f32 v170, 0xe0c30000, v5
    v_add_f32 v171, 0xe0c50000, v5
    v_add_f32 v172, 0xe0df0000, v5
    v_add_f32 v173, 0xe0e10000, v5
    v_add_f32 v174, 0xe0e30000, v5
    v_add_f32 v175, 0xe0e50000, v5
    v_min_f32 v168, v168, v164
    v_min_f32 v169, v169, v164
    v_min_f32 v170, v170, v164
    v_min_f32 v171, v171, v164
    v_min_f32 v172, v172, v164
    v_min_f32 v173, v173, v164
    v_min_f32 v174, v174, v164
    v_min_f32 v175, v175, v164
    s_nop 1
    s_waitcnt lgkmcnt(4)
    v_mfma_f32_16x16x32_bf16 v[80:83], a[64:67], a[0:3], v[152:155]
    ds_read_b128 a[96:99], v3 offset:8192
    v_cvt_pk_bf16_f32 v120, v112, v113
    v_mfma_f32_16x16x32_bf16 v[80:83], a[68:71], a[4:7], v[80:83]
    s_add_u32 s59, s59, 16384
    v_exp_f32 v116, v52
    v_mfma_f32_16x16x32_bf16 v[80:83], a[72:75], a[8:11], v[80:83]
    s_and_b32 s59, s59, 0xffff
    v_exp_f32 v117, v53
    v_mfma_f32_16x16x32_bf16 v[80:83], a[76:79], a[12:15], v[80:83]
    ds_read_b128 a[100:103], v3 offset:9216
    v_cvt_pk_bf16_f32 v121, v114, v115
    v_mfma_f32_16x16x32_bf16 v[88:91], a[64:67], a[16:19], v[156:159]
    s_mov_b32 m0, s59
    v_exp_f32 v118, v54
    v_mfma_f32_16x16x32_bf16 v[88:91], a[68:71], a[20:23], v[88:91]
    v_cvt_pk_bf16_f32 v122, v116, v117
    v_mfma_f32_16x16x32_bf16 v[88:91], a[72:75], a[24:27], v[88:91]
    ds_read_b128 a[104:107], v3 offset:10240
    v_mfma_f32_16x16x32_bf16 v[88:91], a[76:79], a[28:31], v[88:91]
    v_exp_f32 v119, v55
    v_mfma_f32_16x16x32_bf16 v[104:107], a[64:67], a[48:51], v[168:171]
    v_cvt_pk_bf16_f32 v123, v118, v119
    v_mfma_f32_16x16x32_bf16 v[104:107], a[68:71], a[52:55], v[104:107]
    ds_read_b128 a[108:111], v3 offset:11264
    s_waitcnt lgkmcnt(4)
    v_mfma_f32_16x16x32_bf16 v[16:19], a[240:243], v[120:123], v[32:35]
    v_exp_f32 v112, v56
    v_mfma_f32_16x16x32_bf16 v[104:107], a[72:75], a[56:59], v[104:107]
    v_mfma_f32_16x16x32_bf16 v[104:107], a[76:79], a[60:63], v[104:107]
    v_exp_f32 v113, v57
    v_mfma_f32_16x16x32_bf16 v[84:87], a[80:83], a[0:3], v[152:155]
    ds_read_b128 a[112:115], v3 offset:12288
    v_cvt_pk_bf16_f32 v124, v112, v113
    v_mfma_f32_16x16x32_bf16 v[84:87], a[84:87], a[4:7], v[84:87]
    v_exp_f32 v114, v58
    v_mfma_f32_16x16x32_bf16 v[84:87], a[88:91], a[8:11], v[84:87]
    v_mfma_f32_16x16x32_bf16 v[84:87], a[92:95], a[12:15], v[84:87]
    ds_read_b128 a[116:119], v3 offset:13312
    v_mfma_f32_16x16x32_bf16 v[92:95], a[80:83], a[16:19], v[156:159]
    v_exp_f32 v115, v59
    v_mfma_f32_16x16x32_bf16 v[92:95], a[84:87], a[20:23], v[92:95]
    v_cvt_pk_bf16_f32 v125, v114, v115
    v_mfma_f32_16x16x32_bf16 v[92:95], a[88:91], a[24:27], v[92:95]
    ds_read_b128 a[120:123], v3 offset:14336
    v_mfma_f32_16x16x32_bf16 v[92:95], a[92:95], a[28:31], v[92:95]
    v_exp_f32 v116, v60
    v_mfma_f32_16x16x32_bf16 v[108:111], a[80:83], a[48:51], v[172:175]
    v_exp_f32 v117, v61
    v_mfma_f32_16x16x32_bf16 v[108:111], a[84:87], a[52:55], v[108:111]
    ds_read_b128 a[124:127], v3 offset:15360
    v_cvt_pk_bf16_f32 v126, v116, v117
    v_mfma_f32_16x16x32_bf16 v[108:111], a[88:91], a[56:59], v[108:111]
    s_waitcnt lgkmcnt(4)
    v_add_u32 v3, 0x10000, v2
    v_add_u32 v2, 0x4000, v2
    v_mfma_f32_16x16x32_bf16 v[108:111], a[92:95], a[60:63], v[108:111]
    v_exp_f32 v118, v62
    v_mfma_f32_16x16x32_bf16 a[128:131], a[96:99], v[136:139], a[128:131]
    v_and_b32 v2, 0xffff, v2
    v_mfma_f32_16x16x32_bf16 v[192:195], a[96:99], v[140:143], v[192:195]
    ds_read_b128 a[64:67], v2 offset:0
    buffer_load_dwordx4 v1, s[48:51], s56 offen offset:0 sc1 lds
    v_mfma_f32_16x16x32_bf16 a[160:163], a[96:99], v[144:147], a[160:163]
    v_exp_f32 v119, v63
    v_mfma_f32_16x16x32_bf16 v[224:227], a[96:99], v[148:151], v[224:227]
    v_cvt_pk_bf16_f32 v127, v118, v119
    v_mfma_f32_16x16x32_bf16 a[132:135], a[100:103], v[136:139], a[132:135]
    ds_read_b128 a[68:71], v2 offset:1024
    v_mfma_f32_16x16x32_bf16 v[20:23], a[240:243], v[124:127], v[36:39]
    v_exp_f32 v112, v72
    v_mfma_f32_16x16x32_bf16 v[196:199], a[100:103], v[140:143], v[196:199]
    v_exp_f32 v113, v73
    v_mfma_f32_16x16x32_bf16 a[164:167], a[100:103], v[144:147], a[164:167]
    v_cvt_pk_bf16_f32 v132, v112, v113
    v_mfma_f32_16x16x32_bf16 v[228:231], a[100:103], v[148:151], v[228:231]
    v_exp_f32 v114, v74
    v_mfma_f32_16x16x32_bf16 a[136:139], a[104:107], v[136:139], a[136:139]
    ds_read_b128 a[72:75], v2 offset:2048
    buffer_load_dwordx4 v1, s[48:51], s56 offen offset:1024 sc1 lds
    v_mfma_f32_16x16x32_bf16 v[200:203], a[104:107], v[140:143], v[200:203]
    v_mfma_f32_16x16x32_bf16 a[168:171], a[104:107], v[144:147], a[168:171]
    v_exp_f32 v115, v75
    v_mfma_f32_16x16x32_bf16 v[232:235], a[104:107], v[148:151], v[232:235]
    v_cvt_pk_bf16_f32 v133, v114, v115
    v_mfma_f32_16x16x32_bf16 a[140:143], a[108:111], v[136:139], a[140:143]
    ds_read_b128 a[76:79], v2 offset:3072
    v_mfma_f32_16x16x32_bf16 v[204:207], a[108:111], v[140:143], v[204:207]
    s_waitcnt lgkmcnt(4)
    v_exp_f32 v116, v76
    v_mfma_f32_16x16x32_bf16 a[172:175], a[108:111], v[144:147], a[172:175]
    v_mfma_f32_16x16x32_bf16 v[236:239], a[108:111], v[148:151], v[236:239]
    v_exp_f32 v117, v77
    v_mfma_f32_16x16x32_bf16 a[144:147], a[112:115], v[136:139], a[144:147]
    ds_read_b128 a[80:83], v2 offset:4096
    buffer_load_dwordx4 v1, s[48:51], s56 offen offset:2048 sc1 lds
    v_mfma_f32_16x16x32_bf16 v[208:211], a[112:115], v[140:143], v[208:211]
    v_exp_f32 v118, v78
    v_mfma_f32_16x16x32_bf16 a[176:179], a[112:115], v[144:147], a[176:179]
    v_cvt_pk_bf16_f32 v134, v116, v117
    v_mfma_f32_16x16x32_bf16 v[240:243], a[112:115], v[148:151], v[240:243]
    v_exp_f32 v119, v79
    v_mfma_f32_16x16x32_bf16 a[148:151], a[116:119], v[136:139], a[148:151]
    ds_read_b128 a[84:87], v2 offset:5120
    v_cvt_pk_bf16_f32 v135, v118, v119
    v_mfma_f32_16x16x32_bf16 v[212:215], a[116:119], v[140:143], v[212:215]
    v_mfma_f32_16x16x32_bf16 a[180:183], a[116:119], v[144:147], a[180:183]
    v_exp_f32 v112, v80
    v_mfma_f32_16x16x32_bf16 v[28:31], a[240:243], v[132:135], v[44:47]
    v_mfma_f32_16x16x32_bf16 v[244:247], a[116:119], v[148:151], v[244:247]
    v_exp_f32 v113, v81
    v_mfma_f32_16x16x32_bf16 a[152:155], a[120:123], v[136:139], a[152:155]
    ds_read_b128 a[88:91], v2 offset:6144
    buffer_load_dwordx4 v1, s[48:51], s56 offen offset:3072 sc1 lds
    v_mfma_f32_16x16x32_bf16 v[216:219], a[120:123], v[140:143], v[216:219]
    v_mfma_f32_16x16x32_bf16 a[184:187], a[120:123], v[144:147], a[184:187]
    v_exp_f32 v114, v82
    v_mfma_f32_16x16x32_bf16 v[248:251], a[120:123], v[148:151], v[248:251]
    v_max3_f32 v6, v16, v20, v28
    v_cmp_lt_f32 vcc, s73, v6
    v_mfma_f32_16x16x32_bf16 a[156:159], a[124:127], v[136:139], a[156:159]
    ds_read_b128 a[92:95], v2 offset:7168
    v_mfma_f32_16x16x32_bf16 v[220:223], a[124:127], v[140:143], v[220:223]
    v_exp_f32 v115, v83
    v_mfma_f32_16x16x32_bf16 a[188:191], a[124:127], v[144:147], a[188:191]
    v_mfma_f32_16x16x32_bf16 v[252:255], a[124:127], v[148:151], v[252:255]
    s_cbranch_vccnz K2_SLOW7
K2_BACK7:
    s_waitcnt vmcnt(8)
    v_cmp_gt_u32 vcc, 8, v14
    s_and_b64 vcc, vcc, s[18:19]
    s_cbranch_scc1 GM_POLL2
GM_PB2:
    s_cmp_eq_u32 s5, 7
    s_cselect_b32 s61, 0, 0x62800000
    v_add_f32 v6, s61, v4
    v_add_f32 v168, 0x5d000000, v6
    v_add_f32 v169, 0xdd000000, v6
    v_add_f32 v170, 0xddc00000, v6
    v_add_f32 v171, 0xde200000, v6
    v_add_f32 v172, 0xdf780000, v6
    v_add_f32 v173, 0xdf840000, v6
    v_add_f32 v174, 0xdf8c0000, v6
    v_add_f32 v175, 0xdf940000, v6
    v_min_f32 v168, v168, v152
    v_min_f32 v169, v169, v152
    v_min_f32 v170, v170, v152
    v_min_f32 v171, v171, v152
    v_min_f32 v172, v172, v152
    v_min_f32 v173, v173, v152
    v_min_f32 v174, v174, v152
    v_min_f32 v175, v175, v152
    s_nop 1
    s_waitcnt lgkmcnt(4)
    v_mfma_f32_16x16x32_bf16 v[48:51], a[64:67], a[0:3], v[168:171]
    s_waitcnt vmcnt(8)
    v_exp_f32 v116, v84
    v_mfma_f32_16x16x32_bf16 v[48:51], a[68:71], a[4:7], v[48:51]
    s_barrier
    v_exp_f32 v117, v85
    v_mfma_f32_16x16x32_bf16 v[48:51], a[72:75], a[8:11], v[48:51]
    ds_read_b128 a[96:99], v3 offset:0
    v_mov_b32 v9, 1
    s_mov_b64 exec, 1
    buffer_store_dword v9, v10, s[48:51], s74 offen offset:512 sc1
    s_mov_b64 exec, -1
    v_mfma_f32_16x16x32_bf16 v[48:51], a[76:79], a[12:15], v[48:51]
    s_add_u32 m0, s59, 65536
    v_exp_f32 v118, v86
    v_mfma_f32_16x16x32_bf16 v[56:59], a[64:67], a[16:19], v[156:159]
    ds_read_b128 a[100:103], v3 offset:1024
    v_cvt_pk_bf16_f32 v136, v112, v113
    v_mfma_f32_16x16x32_bf16 v[56:59], a[68:71], a[20:23], v[56:59]
    s_waitcnt lgkmcnt(2)
    v_exp_f32 v119, v87
    v_mfma_f32_16x16x32_bf16 v[56:59], a[72:75], a[24:27], v[56:59]
    ds_read_b128 a[104:107], v3 offset:2048
    v_cvt_pk_bf16_f32 v137, v114, v115
    v_mfma_f32_16x16x32_bf16 v[56:59], a[76:79], a[28:31], v[56:59]
    s_add_u32 s60, s56, 20979712
    v_exp_f32 v112, v88
    v_mfma_f32_16x16x32_bf16 v[52:55], a[80:83], a[0:3], v[172:175]
    ds_read_b128 a[108:111], v3 offset:3072
    buffer_load_dwordx4 v1, s[48:51], s60 offen offset:0 sc1 lds
    v_mfma_f32_16x16x32_bf16 v[52:55], a[84:87], a[4:7], v[52:55]
    v_exp_f32 v113, v89
    v_mfma_f32_16x16x32_bf16 v[52:55], a[88:91], a[8:11], v[52:55]
    ds_read_b128 a[112:115], v3 offset:4096
    buffer_load_dwordx4 v1, s[48:51], s60 offen offset:1024 sc1 lds
    v_mfma_f32_16x16x32_bf16 v[52:55], a[92:95], a[12:15], v[52:55]
    v_exp_f32 v114, v90
    v_mfma_f32_16x16x32_bf16 v[60:63], a[80:83], a[16:19], v[156:159]
    ds_read_b128 a[116:119], v3 offset:5120
    buffer_load_dwordx4 v1, s[48:51], s60 offen offset:2048 sc1 lds
    v_mfma_f32_16x16x32_bf16 v[60:63], a[84:87], a[20:23], v[60:63]
    s_waitcnt lgkmcnt(2)
    v_exp_f32 v115, v91
    v_mfma_f32_16x16x32_bf16 v[60:63], a[88:91], a[24:27], v[60:63]
    ds_read_b128 a[120:123], v3 offset:6144
    buffer_load_dwordx4 v1, s[48:51], s60 offen offset:3072 sc1 lds
    v_mfma_f32_16x16x32_bf16 v[60:63], a[92:95], a[28:31], v[60:63]
    ds_read_b128 a[124:127], v3 offset:7168
    v_cvt_pk_bf16_f32 v138, v116, v117
    v_exp_f32 v116, v92
    v_cvt_pk_bf16_f32 v139, v118, v119
    v_mfma_f32_16x16x32_bf16 a[128:131], a[96:99], v[120:123], a[128:131]
    s_add_u32 s56, s56, 16384
    v_exp_f32 v117, v93
    v_mfma_f32_16x16x32_bf16 v[32:35], a[240:243], v[136:139], v[16:19]
    ds_read_b128 a[64:67], v2 offset:8192
    v_cvt_pk_bf16_f32 v140, v112, v113
    v_mfma_f32_16x16x32_bf16 v[192:195], a[96:99], v[124:127], v[192:195]
    s_cmp_ge_u32 s56, s57
    v_exp_f32 v118, v94
    v_mfma_f32_16x16x32_bf16 v[224:227], a[96:99], v[132:135], v[224:227]
    s_cselect_b32 s56, 0x40000000, s56
    v_exp_f32 v119, v95
    v_mfma_f32_16x16x32_bf16 a[132:135], a[100:103], v[120:123], a[132:135]
    ds_read_b128 a[68:71], v2 offset:9216
    v_cvt_pk_bf16_f32 v141, v114, v115
    v_mfma_f32_16x16x32_bf16 v[196:199], a[100:103], v[124:127], v[196:199]
    s_add_u32 s59, s59, 16384
    v_exp_f32 v112, v104
    v_mfma_f32_16x16x32_bf16 v[228:231], a[100:103], v[132:135], v[228:231]
    s_and_b32 s59, s59, 0xffff
    v_exp_f32 v113, v105
    v_mfma_f32_16x16x32_bf16 a[136:139], a[104:107], v[120:123], a[136:139]
    ds_read_b128 a[72:75], v2 offset:10240
    v_cvt_pk_bf16_f32 v142, v116, v117
    v_mfma_f32_16x16x32_bf16 v[200:203], a[104:107], v[124:127], v[200:203]
    s_mov_b32 m0, s59
    v_exp_f32 v114, v106
    v_mfma_f32_16x16x32_bf16 v[232:235], a[104:107], v[132:135], v[232:235]
    v_cvt_pk_bf16_f32 v143, v118, v119
    v_cvt_pk_bf16_f32 v148, v112, v113
    v_mfma_f32_16x16x32_bf16 a[140:143], a[108:111], v[120:123], a[140:143]
    ds_read_b128 a[76:79], v2 offset:11264
    s_waitcnt lgkmcnt(4)
    v_mfma_f32_16x16x32_bf16 v[36:39], a[240:243], v[140:143], v[20:23]
    v_exp_f32 v115, v107
    v_mfma_f32_16x16x32_bf16 v[204:207], a[108:111], v[124:127], v[204:207]
    v_exp_f32 v116, v108
    v_mfma_f32_16x16x32_bf16 v[236:239], a[108:111], v[132:135], v[236:239]
    v_exp_f32 v117, v109
    v_mfma_f32_16x16x32_bf16 a[144:147], a[112:115], v[120:123], a[144:147]
    ds_read_b128 a[80:83], v2 offset:12288
    buffer_load_dwordx4 v1, s[48:51], s56 offen offset:0 sc1 lds
    v_mfma_f32_16x16x32_bf16 v[208:211], a[112:115], v[124:127], v[208:211]
    v_exp_f32 v118, v110
    v_mfma_f32_16x16x32_bf16 v[240:243], a[112:115], v[132:135], v[240:243]
    v_cvt_pk_bf16_f32 v149, v114, v115
    v_cvt_pk_bf16_f32 v150, v116, v117
    v_mfma_f32_16x16x32_bf16 a[148:151], a[116:119], v[120:123], a[148:151]
    ds_read_b128 a[84:87], v2 offset:13312
    buffer_load_dwordx4 v1, s[48:51], s56 offen offset:1024 sc1 lds
    v_mfma_f32_16x16x32_bf16 v[212:215], a[116:119], v[124:127], v[212:215]
    v_exp_f32 v119, v111
    v_mfma_f32_16x16x32_bf16 v[244:247], a[116:119], v[132:135], v[244:247]
    v_exp_f32 v112, v48
    v_mfma_f32_16x16x32_bf16 a[152:155], a[120:123], v[120:123], a[152:155]
    ds_read_b128 a[88:91], v2 offset:14336
    buffer_load_dwordx4 v1, s[48:51], s56 offen offset:2048 sc1 lds
    v_mfma_f32_16x16x32_bf16 v[216:219], a[120:123], v[124:127], v[216:219]
    v_exp_f32 v113, v49
    v_mfma_f32_16x16x32_bf16 v[248:251], a[120:123], v[132:135], v[248:251]
    v_exp_f32 v114, v50
    v_mfma_f32_16x16x32_bf16 a[156:159], a[124:127], v[120:123], a[156:159]
    ds_read_b128 a[92:95], v2 offset:15360
    buffer_load_dwordx4 v1, s[48:51], s56 offen offset:3072 sc1 lds
    v_mfma_f32_16x16x32_bf16 v[220:223], a[124:127], v[124:127], v[220:223]
    v_exp_f32 v115, v51
    v_mfma_f32_16x16x32_bf16 v[252:255], a[124:127], v[132:135], v[252:255]
    v_cvt_pk_bf16_f32 v151, v118, v119
    s_nop 0
    s_nop 0
    v_mfma_f32_16x16x32_bf16 v[44:47], a[240:243], v[148:151], v[28:31]
    s_nop 0
    s_nop 0
    s_nop 0
    s_nop 0
    s_nop 0
    s_nop 0
    s_nop 0
    s_nop 0
    v_max3_f32 v6, v32, v36, v44
    v_cmp_lt_f32 vcc, s73, v6
    s_cbranch_vccnz K2_SLOW8
K2_BACK8:
    s_cmp_eq_u32 s5, 7
    s_cselect_b32 s61, 0, 0x62800000
    v_add_f32 v6, s61, v4
    v_add_f32 v168, 0xdffc0000, v6
    v_add_f32 v169, 0xe0020000, v6
    v_add_f32 v170, 0xe0060000, v6
    v_add_f32 v171, 0xe00a0000, v6
    v_add_f32 v172, 0xe03e0000, v6
    v_add_f32 v173, 0xe0420000, v6
    v_add_f32 v174, 0xe0460000, v6
    v_add_f32 v175, 0xe04a0000, v6
    v_min_f32 v168, v168, v152
    v_min_f32 v169, v169, v152
    v_min_f32 v170, v170, v152
    v_min_f32 v171, v171, v152
    v_min_f32 v172, v172, v152
    v_min_f32 v173, v173, v152
    v_min_f32 v174, v174, v152
    v_min_f32 v175, v175, v152
    s_nop 1
    s_waitcnt lgkmcnt(4)
    v_mfma_f32_16x16x32_bf16 v[80:83], a[64:67], a[0:3], v[168:171]
    ds_read_b128 a[96:99], v3 offset:8192
    v_cvt_pk_bf16_f32 v120, v112, v113
    v_rcp_f32 v11, v40
    v_mfma_f32_16x16x32_bf16 v[80:83], a[68:71], a[4:7], v[80:83]
    v_exp_f32 v116, v52
    s_nop 0
    v_accvgpr_read_b32 v176, a160
    v_mfma_f32_16x16x32_bf16 v[80:83], a[72:75], a[8:11], v[80:83]
    ds_read_b128 a[100:103], v3 offset:9216
    v_cvt_pk_bf16_f32 v121, v114, v115
    v_accvgpr_read_b32 v177, a161
    v_accvgpr_read_b32 v178, a162
    v_mfma_f32_16x16x32_bf16 v[80:83], a[76:79], a[12:15], v[80:83]
    v_exp_f32 v117, v53
    v_accvgpr_read_b32 v179, a163
    v_accvgpr_read_b32 v180, a164
    v_mfma_f32_16x16x32_bf16 v[88:91], a[64:67], a[16:19], v[156:159]
    ds_read_b128 a[104:107], v3 offset:10240
    v_cvt_pk_bf16_f32 v122, v116, v117
    v_accvgpr_read_b32 v181, a165
    v_accvgpr_read_b32 v182, a166
    v_mfma_f32_16x16x32_bf16 v[88:91], a[68:71], a[20:23], v[88:91]
    s_waitcnt lgkmcnt(3)
    v_exp_f32 v118, v54
    v_accvgpr_read_b32 v183, a167
    v_mul_f32 v176, v176, v11
    v_mfma_f32_16x16x32_bf16 v[88:91], a[72:75], a[24:27], v[88:91]
    ds_read_b128 a[108:111], v3 offset:11264
    v_mul_f32 v177, v177, v11
    v_mul_f32 v178, v178, v11
    v_mfma_f32_16x16x32_bf16 v[88:91], a[76:79], a[28:31], v[88:91]
    v_exp_f32 v119, v55
    v_mul_f32 v179, v179, v11
    v_mul_f32 v180, v180, v11
    v_mfma_f32_16x16x32_bf16 v[84:87], a[80:83], a[0:3], v[172:175]
    ds_read_b128 a[112:115], v3 offset:12288
    v_cvt_pk_bf16_f32 v123, v118, v119
    v_mul_f32 v181, v181, v11
    v_mul_f32 v182, v182, v11
    v_mfma_f32_16x16x32_bf16 v[16:19], a[240:243], v[120:123], v[32:35]
    v_mul_f32 v183, v183, v11
    v_cvt_pk_bf16_f32 v176, v176, v177
    v_mfma_f32_16x16x32_bf16 v[84:87], a[84:87], a[4:7], v[84:87]
    v_exp_f32 v112, v56
    v_cvt_pk_bf16_f32 v177, v178, v179
    v_cvt_pk_bf16_f32 v178, v180, v181
    v_mfma_f32_16x16x32_bf16 v[84:87], a[88:91], a[8:11], v[84:87]
    ds_read_b128 a[116:119], v3 offset:13312
    v_cvt_pk_bf16_f32 v179, v182, v183
    buffer_store_dwordx4 v[176:179], v1, s[48:51], s70 offen offset:0 sc1
    v_mfma_f32_16x16x32_bf16 v[84:87], a[92:95], a[12:15], v[84:87]
    v_exp_f32 v113, v57
    v_accvgpr_read_b32 v184, a168
    v_accvgpr_read_b32 v185, a169
    v_mfma_f32_16x16x32_bf16 v[92:95], a[80:83], a[16:19], v[156:159]
    ds_read_b128 a[120:123], v3 offset:14336
    v_cvt_pk_bf16_f32 v124, v112, v113
    v_accvgpr_read_b32 v186, a170
    v_accvgpr_read_b32 v187, a171
    v_mfma_f32_16x16x32_bf16 v[92:95], a[84:87], a[20:23], v[92:95]
    s_waitcnt lgkmcnt(3)
    v_accvgpr_read_b32 v188, a172
    v_accvgpr_read_b32 v189, a173
    v_mfma_f32_16x16x32_bf16 v[92:95], a[88:91], a[24:27], v[92:95]
    ds_read_b128 a[124:127], v3 offset:15360
    v_add_u32 v3, 0x10000, v2
    v_accvgpr_read_b32 v190, a174
    v_accvgpr_read_b32 v191, a175
    v_mfma_f32_16x16x32_bf16 v[92:95], a[92:95], a[28:31], v[92:95]
    v_exp_f32 v114, v58
    v_mul_f32 v184, v184, v11
    v_mul_f32 v185, v185, v11
    v_mfma_f32_16x16x32_bf16 a[128:131], a[96:99], v[136:139], a[128:131]
    v_exp_f32 v115, v59
    v_mul_f32 v186, v186, v11
    v_mul_f32 v187, v187, v11
    v_mfma_f32_16x16x32_bf16 v[192:195], a[96:99], v[140:143], v[192:195]
    v_cvt_pk_bf16_f32 v125, v114, v115
    v_add_u32 v2, 0x4000, v2
    v_mul_f32 v188, v188, v11
    v_mul_f32 v189, v189, v11
    v_mfma_f32_16x16x32_bf16 v[224:227], a[96:99], v[148:151], v[224:227]
    v_and_b32 v2, 0xffff, v2
    v_mul_f32 v190, v190, v11
    v_mul_f32 v191, v191, v11
    v_mfma_f32_16x16x32_bf16 a[132:135], a[100:103], v[136:139], a[132:135]
    ds_read_b128 a[64:67], v2 offset:0
    v_cvt_pk_bf16_f32 v184, v184, v185
    v_cvt_pk_bf16_f32 v185, v186, v187
    v_mfma_f32_16x16x32_bf16 v[196:199], a[100:103], v[140:143], v[196:199]
    v_exp_f32 v116, v60
    v_cvt_pk_bf16_f32 v186, v188, v189
    v_cvt_pk_bf16_f32 v187, v190, v191
    buffer_store_dwordx4 v[184:187], v1, s[48:51], s70 offen offset:1024 sc1
    v_mfma_f32_16x16x32_bf16 v[228:231], a[100:103], v[148:151], v[228:231]
    ds_read_b128 a[68:71], v2 offset:1024
    v_accvgpr_read_b32 v176, a176
    v_accvgpr_read_b32 v177, a177
    v_mfma_f32_16x16x32_bf16 a[136:139], a[104:107], v[136:139], a[136:139]
    v_exp_f32 v117, v61
    v_accvgpr_read_b32 v178, a178
    v_accvgpr_read_b32 v179, a179
    v_mfma_f32_16x16x32_bf16 v[200:203], a[104:107], v[140:143], v[200:203]
    ds_read_b128 a[72:75], v2 offset:2048
    v_cvt_pk_bf16_f32 v126, v116, v117
    v_accvgpr_read_b32 v180, a180
    v_accvgpr_read_b32 v181, a181
    v_mfma_f32_16x16x32_bf16 v[232:235], a[104:107], v[148:151], v[232:235]
    v_exp_f32 v118, v62
    v_accvgpr_read_b32 v182, a182
    v_accvgpr_read_b32 v183, a183
    v_mfma_f32_16x16x32_bf16 a[140:143], a[108:111], v[136:139], a[140:143]
    ds_read_b128 a[76:79], v2 offset:3072
    v_mul_f32 v176, v176, v11
    v_mul_f32 v177, v177, v11
    v_mfma_f32_16x16x32_bf16 v[204:207], a[108:111], v[140:143], v[204:207]
    s_waitcnt lgkmcnt(4)
    v_mul_f32 v178, v178, v11
    v_mul_f32 v179, v179, v11
    v_mfma_f32_16x16x32_bf16 v[236:239], a[108:111], v[148:151], v[236:239]
    v_exp_f32 v119, v63
    v_mul_f32 v180, v180, v11
    v_mul_f32 v181, v181, v11
    v_mfma_f32_16x16x32_bf16 a[144:147], a[112:115], v[136:139], a[144:147]
    ds_read_b128 a[80:83], v2 offset:4096
    v_cvt_pk_bf16_f32 v127, v118, v119
    v_mul_f32 v182, v182, v11
    v_mul_f32 v183, v183, v11
    v_mfma_f32_16x16x32_bf16 v[20:23], a[240:243], v[124:127], v[36:39]
    v_exp_f32 v112, v80
    v_cvt_pk_bf16_f32 v176, v176, v177
    v_cvt_pk_bf16_f32 v177, v178, v179
    v_mfma_f32_16x16x32_bf16 v[208:211], a[112:115], v[140:143], v[208:211]
    v_cvt_pk_bf16_f32 v178, v180, v181
    v_cvt_pk_bf16_f32 v179, v182, v183
    v_mfma_f32_16x16x32_bf16 v[240:243], a[112:115], v[148:151], v[240:243]
    buffer_store_dwordx4 v[176:179], v1, s[48:51], s70 offen offset:2048 sc1
    v_max_f32 v6, v16, v20
    v_accvgpr_read_b32 v184, a184
    v_mfma_f32_16x16x32_bf16 a[148:151], a[116:119], v[136:139], a[148:151]
    ds_read_b128 a[84:87], v2 offset:5120
    v_cmp_lt_f32 vcc, s73, v6
    v_accvgpr_read_b32 v185, a185
    v_accvgpr_read_b32 v186, a186
    v_mfma_f32_16x16x32_bf16 v[212:215], a[116:119], v[140:143], v[212:215]
    v_exp_f32 v113, v81
    v_accvgpr_read_b32 v187, a187
    v_accvgpr_read_b32 v188, a188
    v_mfma_f32_16x16x32_bf16 v[244:247], a[116:119], v[148:151], v[244:247]
    v_exp_f32 v114, v82
    v_accvgpr_read_b32 v189, a189
    v_accvgpr_read_b32 v190, a190
    v_mfma_f32_16x16x32_bf16 a[152:155], a[120:123], v[136:139], a[152:155]
    ds_read_b128 a[88:91], v2 offset:6144
    v_accvgpr_read_b32 v191, a191
    v_mul_f32 v184, v184, v11
    v_mfma_f32_16x16x32_bf16 v[216:219], a[120:123], v[140:143], v[216:219]
    v_mul_f32 v185, v185, v11
    v_mul_f32 v186, v186, v11
    v_mfma_f32_16x16x32_bf16 v[248:251], a[120:123], v[148:151], v[248:251]
    v_exp_f32 v115, v83
    v_mul_f32 v187, v187, v11
    v_mul_f32 v188, v188, v11
    v_mfma_f32_16x16x32_bf16 a[156:159], a[124:127], v[136:139], a[156:159]
    ds_read_b128 a[92:95], v2 offset:7168
    v_mul_f32 v189, v189, v11
    v_mul_f32 v190, v190, v11
    v_mfma_f32_16x16x32_bf16 v[220:223], a[124:127], v[140:143], v[220:223]
    v_mul_f32 v191, v191, v11
    v_cvt_pk_bf16_f32 v184, v184, v185
    v_mfma_f32_16x16x32_bf16 v[252:255], a[124:127], v[148:151], v[252:255]
    v_cvt_pk_bf16_f32 v185, v186, v187
    v_cvt_pk_bf16_f32 v186, v188, v189
    v_cvt_pk_bf16_f32 v187, v190, v191
    buffer_store_dwordx4 v[184:187], v1, s[48:51], s70 offen offset:3072 sc1
    s_cbranch_vccnz K2_SLOW9
K2_BACK9:
    s_lshl_b32 s7, s2, 13
    s_lshl_b32 s10, s3, 10
    s_add_u32 s7, s7, s10
    s_add_u32 s7, s7, 71303168
    s_add_u32 s8, s7, 4096
    s_add_u32 m0, s10, 133632
    s_nop 0
    buffer_load_dwordx4 v1, s[48:51], s7 offen sc1 lds
    s_add_u32 m0, s10, 138240
    s_nop 0
    buffer_load_dwordx4 v1, s[48:51], s8 offen sc1 lds
    v_rcp_f32 v11, v44
    s_nop 0
    v_mul_f32 v224, v224, v11
    v_mul_f32 v225, v225, v11
    v_mul_f32 v226, v226, v11
    v_mul_f32 v227, v227, v11
    v_mul_f32 v228, v228, v11
    v_mul_f32 v229, v229, v11
    v_mul_f32 v230, v230, v11
    v_mul_f32 v231, v231, v11
    v_cvt_pk_bf16_f32 v224, v224, v225
    v_cvt_pk_bf16_f32 v225, v226, v227
    v_cvt_pk_bf16_f32 v226, v228, v229
    v_cvt_pk_bf16_f32 v227, v230, v231
    buffer_store_dwordx4 v[224:227], v1, s[48:51], s71 offen offset:0 sc1
    v_mul_f32 v232, v232, v11
    v_mul_f32 v233, v233, v11
    v_mul_f32 v234, v234, v11
    v_mul_f32 v235, v235, v11
    v_mul_f32 v236, v236, v11
    v_mul_f32 v237, v237, v11
    v_mul_f32 v238, v238, v11
    v_mul_f32 v239, v239, v11
    v_cvt_pk_bf16_f32 v232, v232, v233
    v_cvt_pk_bf16_f32 v233, v234, v235
    v_cvt_pk_bf16_f32 v234, v236, v237
    v_cvt_pk_bf16_f32 v235, v238, v239
    buffer_store_dwordx4 v[232:235], v1, s[48:51], s71 offen offset:1024 sc1
    v_mul_f32 v240, v240, v11
    v_mul_f32 v241, v241, v11
    v_mul_f32 v242, v242, v11
    v_mul_f32 v243, v243, v11
    v_mul_f32 v244, v244, v11
    v_mul_f32 v245, v245, v11
    v_mul_f32 v246, v246, v11
    v_mul_f32 v247, v247, v11
    v_cvt_pk_bf16_f32 v240, v240, v241
    v_cvt_pk_bf16_f32 v241, v242, v243
    v_cvt_pk_bf16_f32 v242, v244, v245
    v_cvt_pk_bf16_f32 v243, v246, v247
    buffer_store_dwordx4 v[240:243], v1, s[48:51], s71 offen offset:2048 sc1
    v_mul_f32 v248, v248, v11
    v_mul_f32 v249, v249, v11
    v_mul_f32 v250, v250, v11
    v_mul_f32 v251, v251, v11
    v_mul_f32 v252, v252, v11
    v_mul_f32 v253, v253, v11
    v_mul_f32 v254, v254, v11
    v_mul_f32 v255, v255, v11
    v_cvt_pk_bf16_f32 v248, v248, v249
    v_cvt_pk_bf16_f32 v249, v250, v251
    v_cvt_pk_bf16_f32 v250, v252, v253
    v_cvt_pk_bf16_f32 v251, v254, v255
    buffer_store_dwordx4 v[248:251], v1, s[48:51], s71 offen offset:3072 sc1
    s_and_b32 s21, s2, 6
    s_lshr_b32 s6, s5, 2
    s_or_b32 s21, s21, s6
    s_and_b32 s6, s5, 3
    s_lshl_b32 s6, s6, 4
    s_or_b32 s21, s21, s6
    s_lshl_b32 s21, s21, 10
    s_and_b32 s6, s2, 1
    s_lshl_b32 s6, s6, 2
    s_add_u32 s21, s21, s6
    s_and_b32 s6, s2, 24
    s_add_u32 s21, s21, s6
    s_add_u32 s21, s21, 75563008
    v_and_b32 v163, 1, v0
    v_bfe_u32 v9, v0, 1, 2
    v_lshl_add_u32 v163, v9, 3, v163
    v_lshl_add_u32 v163, v163, 13, v10
    s_sub_u32 s63, s62, 1
    s_cmp_eq_u32 s5, 7
    s_cbranch_scc1 K2_LASTS
.p2align 6
K2_LOOPS:
    s_waitcnt lgkmcnt(4)
    v_mfma_f32_16x16x32_bf16 v[48:51], a[64:67], a[0:3], v[152:155]
    s_waitcnt vmcnt(8)
    v_exp_f32 v116, v84
    v_mfma_f32_16x16x32_bf16 v[48:51], a[68:71], a[4:7], v[48:51]
    s_barrier
    v_cvt_pk_bf16_f32 v136, v112, v113
    v_cvt_pk_bf16_f32 v137, v114, v115
    v_mfma_f32_16x16x32_bf16 v[48:51], a[72:75], a[8:11], v[48:51]
    ds_read_b128 a[96:99], v3 offset:0
    s_cmp_eq_u32 s62, s63
    v_mfma_f32_16x16x32_bf16 v[48:51], a[76:79], a[12:15], v[48:51]
    s_cbranch_scc1 K2_PUBB
K2_PUBR:
    v_exp_f32 v117, v85
    v_mfma_f32_16x16x32_bf16 v[56:59], a[64:67], a[16:19], v[156:159]
    ds_read_b128 a[100:103], v3 offset:1024
    v_cvt_pk_bf16_f32 v138, v116, v117
    v_mfma_f32_16x16x32_bf16 v[56:59], a[68:71], a[20:23], v[56:59]
    s_waitcnt lgkmcnt(2)
    v_exp_f32 v118, v86
    v_mfma_f32_16x16x32_bf16 v[56:59], a[72:75], a[24:27], v[56:59]
    ds_read_b128 a[104:107], v3 offset:2048
    s_add_u32 m0, s59, 65536
    v_mfma_f32_16x16x32_bf16 v[56:59], a[76:79], a[28:31], v[56:59]
    s_add_u32 s60, s56, 20979712
    v_exp_f32 v119, v87
    v_mfma_f32_16x16x32_bf16 v[52:55], a[80:83], a[0:3], v[152:155]
    ds_read_b128 a[108:111], v3 offset:3072
    v_cvt_pk_bf16_f32 v139, v118, v119
    v_mfma_f32_16x16x32_bf16 v[52:55], a[84:87], a[4:7], v[52:55]
    v_exp_f32 v112, v88
    v_mfma_f32_16x16x32_bf16 v[32:35], a[240:243], v[136:139], v[16:19]
    ds_read_b128 a[112:115], v3 offset:4096
    buffer_load_dwordx4 v1, s[48:51], s60 offen offset:0 sc1 lds
    v_mfma_f32_16x16x32_bf16 v[52:55], a[88:91], a[8:11], v[52:55]
    v_exp_f32 v113, v89
    v_mfma_f32_16x16x32_bf16 v[52:55], a[92:95], a[12:15], v[52:55]
    ds_read_b128 a[116:119], v3 offset:5120
    v_cvt_pk_bf16_f32 v140, v112, v113
    v_mfma_f32_16x16x32_bf16 v[60:63], a[80:83], a[16:19], v[156:159]
    v_exp_f32 v114, v90
    v_mfma_f32_16x16x32_bf16 v[60:63], a[84:87], a[20:23], v[60:63]
    ds_read_b128 a[120:123], v3 offset:6144
    buffer_load_dwordx4 v1, s[48:51], s60 offen offset:1024 sc1 lds
    v_mfma_f32_16x16x32_bf16 v[60:63], a[88:91], a[24:27], v[60:63]
    s_waitcnt lgkmcnt(3)
    v_exp_f32 v115, v91
    v_mfma_f32_16x16x32_bf16 v[60:63], a[92:95], a[28:31], v[60:63]
    ds_read_b128 a[124:127], v3 offset:7168
    buffer_load_dwordx4 v1, s[48:51], s60 offen offset:2048 sc1 lds
    v_mfma_f32_16x16x32_bf16 a[128:131], a[96:99], v[120:123], a[128:131]
    v_exp_f32 v116, v92
    v_mfma_f32_16x16x32_bf16 v[192:195], a[96:99], v[124:127], v[192:195]
    ds_read_b128 a[64:67], v2 offset:8192
    v_cvt_pk_bf16_f32 v141, v114, v115
    v_mfma_f32_16x16x32_bf16 a[132:135], a[100:103], v[120:123], a[132:135]
    v_exp_f32 v117, v93
    v_mfma_f32_16x16x32_bf16 v[196:199], a[100:103], v[124:127], v[196:199]
    ds_read_b128 a[68:71], v2 offset:9216
    buffer_load_dwordx4 v1, s[48:51], s60 offen offset:3072 sc1 lds
    v_mfma_f32_16x16x32_bf16 a[136:139], a[104:107], v[120:123], a[136:139]
    s_add_u32 s56, s56, 16384
    v_exp_f32 v118, v94
    v_mfma_f32_16x16x32_bf16 v[200:203], a[104:107], v[124:127], v[200:203]
    ds_read_b128 a[72:75], v2 offset:10240
    v_cvt_pk_bf16_f32 v142, v116, v117
    v_mfma_f32_16x16x32_bf16 a[140:143], a[108:111], v[120:123], a[140:143]
    s_waitcnt lgkmcnt(3)
    v_exp_f32 v119, v95
    v_mfma_f32_16x16x32_bf16 v[204:207], a[108:111], v[124:127], v[204:207]
    ds_read_b128 a[76:79], v2 offset:11264
    v_cvt_pk_bf16_f32 v143, v118, v119
    v_mfma_f32_16x16x32_bf16 a[144:147], a[112:115], v[120:123], a[144:147]
    s_cmp_ge_u32 s56, s57
    v_exp_f32 v112, v48
    v_mfma_f32_16x16x32_bf16 v[36:39], a[240:243], v[140:143], v[20:23]
    ds_read_b128 a[80:83], v2 offset:12288
    s_cselect_b32 s56, 0x40000000, s56
    v_mfma_f32_16x16x32_bf16 v[208:211], a[112:115], v[124:127], v[208:211]
    v_exp_f32 v113, v49
    v_mfma_f32_16x16x32_bf16 a[148:151], a[116:119], v[120:123], a[148:151]
    ds_read_b128 a[84:87], v2 offset:13312
    v_mfma_f32_16x16x32_bf16 v[212:215], a[116:119], v[124:127], v[212:215]
    v_exp_f32 v114, v50
    v_mfma_f32_16x16x32_bf16 a[152:155], a[120:123], v[120:123], a[152:155]
    ds_read_b128 a[88:91], v2 offset:14336
    v_max_f32 v6, v32, v36
    v_mfma_f32_16x16x32_bf16 v[216:219], a[120:123], v[124:127], v[216:219]
    v_exp_f32 v115, v51
    v_mfma_f32_16x16x32_bf16 a[156:159], a[124:127], v[120:123], a[156:159]
    ds_read_b128 a[92:95], v2 offset:15360
    v_cmp_lt_f32 vcc, s73, v6
    v_mfma_f32_16x16x32_bf16 v[220:223], a[124:127], v[124:127], v[220:223]
    s_cbranch_vccnz K2_SLOW10
K2_BACK10:
    s_waitcnt lgkmcnt(4)
    v_mfma_f32_16x16x32_bf16 v[80:83], a[64:67], a[0:3], v[152:155]
    ds_read_b128 a[96:99], v3 offset:8192
    v_cvt_pk_bf16_f32 v120, v112, v113
    v_mfma_f32_16x16x32_bf16 v[80:83], a[68:71], a[4:7], v[80:83]
    s_add_u32 s59, s59, 16384
    v_exp_f32 v116, v52
    v_mfma_f32_16x16x32_bf16 v[80:83], a[72:75], a[8:11], v[80:83]
    ds_read_b128 a[100:103], v3 offset:9216
    v_cvt_pk_bf16_f32 v121, v114, v115
    v_mfma_f32_16x16x32_bf16 v[80:83], a[76:79], a[12:15], v[80:83]
    s_and_b32 s59, s59, 0xffff
    v_exp_f32 v117, v53
    v_mfma_f32_16x16x32_bf16 v[88:91], a[64:67], a[16:19], v[156:159]
    ds_read_b128 a[104:107], v3 offset:10240
    v_cvt_pk_bf16_f32 v122, v116, v117
    v_mfma_f32_16x16x32_bf16 v[88:91], a[68:71], a[20:23], v[88:91]
    s_waitcnt lgkmcnt(3)
    v_exp_f32 v118, v54
    v_mfma_f32_16x16x32_bf16 v[88:91], a[72:75], a[24:27], v[88:91]
    ds_read_b128 a[108:111], v3 offset:11264
    s_mov_b32 m0, s59
    v_mfma_f32_16x16x32_bf16 v[88:91], a[76:79], a[28:31], v[88:91]
    v_exp_f32 v119, v55
    v_mfma_f32_16x16x32_bf16 v[84:87], a[80:83], a[0:3], v[152:155]
    ds_read_b128 a[112:115], v3 offset:12288
    v_cvt_pk_bf16_f32 v123, v118, v119
    v_mfma_f32_16x16x32_bf16 v[84:87], a[84:87], a[4:7], v[84:87]
    v_exp_f32 v112, v56
    v_mfma_f32_16x16x32_bf16 v[16:19], a[240:243], v[120:123], v[32:35]
    v_exp_f32 v113, v57
    v_mfma_f32_16x16x32_bf16 v[84:87], a[88:91], a[8:11], v[84:87]
    ds_read_b128 a[116:119], v3 offset:13312
    v_cvt_pk_bf16_f32 v124, v112, v113
    v_mfma_f32_16x16x32_bf16 v[84:87], a[92:95], a[12:15], v[84:87]
    v_exp_f32 v114, v58
    v_mfma_f32_16x16x32_bf16 v[92:95], a[80:83], a[16:19], v[156:159]
    ds_read_b128 a[120:123], v3 offset:14336
    buffer_load_dwordx4 v1, s[48:51], s56 offen offset:0 sc1 lds
    v_mfma_f32_16x16x32_bf16 v[92:95], a[84:87], a[20:23], v[92:95]
    s_waitcnt lgkmcnt(3)
    v_exp_f32 v115, v59
    v_mfma_f32_16x16x32_bf16 v[92:95], a[88:91], a[24:27], v[92:95]
    ds_read_b128 a[124:127], v3 offset:15360
    v_cvt_pk_bf16_f32 v125, v114, v115
    v_mfma_f32_16x16x32_bf16 v[92:95], a[92:95], a[28:31], v[92:95]
    v_exp_f32 v116, v60
    v_mfma_f32_16x16x32_bf16 a[128:131], a[96:99], v[136:139], a[128:131]
    v_add_u32 v3, 0x10000, v2
    v_add_u32 v2, 0x4000, v2
    v_mfma_f32_16x16x32_bf16 v[192:195], a[96:99], v[140:143], v[192:195]
    v_exp_f32 v117, v61
    v_mfma_f32_16x16x32_bf16 a[132:135], a[100:103], v[136:139], a[132:135]
    v_cvt_pk_bf16_f32 v126, v116, v117
    v_and_b32 v2, 0xffff, v2
    v_mfma_f32_16x16x32_bf16 v[196:199], a[100:103], v[140:143], v[196:199]
    ds_read_b128 a[64:67], v2 offset:0
    buffer_load_dwordx4 v1, s[48:51], s56 offen offset:1024 sc1 lds
    v_mfma_f32_16x16x32_bf16 a[136:139], a[104:107], v[136:139], a[136:139]
    v_exp_f32 v118, v62
    v_mfma_f32_16x16x32_bf16 v[200:203], a[104:107], v[140:143], v[200:203]
    ds_read_b128 a[68:71], v2 offset:1024
    buffer_load_dwordx4 v1, s[48:51], s56 offen offset:2048 sc1 lds
    v_mfma_f32_16x16x32_bf16 a[140:143], a[108:111], v[136:139], a[140:143]
    s_waitcnt lgkmcnt(2)
    v_exp_f32 v119, v63
    v_mfma_f32_16x16x32_bf16 v[204:207], a[108:111], v[140:143], v[204:207]
    ds_read_b128 a[72:75], v2 offset:2048
    v_cvt_pk_bf16_f32 v127, v118, v119
    v_mfma_f32_16x16x32_bf16 a[144:147], a[112:115], v[136:139], a[144:147]
    v_exp_f32 v112, v80
    v_mfma_f32_16x16x32_bf16 v[20:23], a[240:243], v[124:127], v[36:39]
    ds_read_b128 a[76:79], v2 offset:3072
    buffer_load_dwordx4 v1, s[48:51], s56 offen offset:3072 sc1 lds
    v_mfma_f32_16x16x32_bf16 v[208:211], a[112:115], v[140:143], v[208:211]
    s_sub_u32 s62, s62, 1
    v_exp_f32 v113, v81
    v_mfma_f32_16x16x32_bf16 a[148:151], a[116:119], v[136:139], a[148:151]
    ds_read_b128 a[80:83], v2 offset:4096
    s_cmp_lg_u32 s62, 0
    v_mfma_f32_16x16x32_bf16 v[212:215], a[116:119], v[140:143], v[212:215]
    v_exp_f32 v114, v82
    v_mfma_f32_16x16x32_bf16 a[152:155], a[120:123], v[136:139], a[152:155]
    ds_read_b128 a[84:87], v2 offset:5120
    v_max_f32 v6, v16, v20
    v_mfma_f32_16x16x32_bf16 v[216:219], a[120:123], v[140:143], v[216:219]
    v_exp_f32 v115, v83
    v_mfma_f32_16x16x32_bf16 a[156:159], a[124:127], v[136:139], a[156:159]
    ds_read_b128 a[88:91], v2 offset:6144
    v_cmp_lt_f32 vcc, s73, v6
    v_mfma_f32_16x16x32_bf16 v[220:223], a[124:127], v[140:143], v[220:223]
    ds_read_b128 a[92:95], v2 offset:7168
    s_cbranch_vccnz K2_SLOW11
K2_BACK11:
    s_cbranch_scc1 K2_LOOPS
    v_add_f32 v168, 0x5d000000, v4
    v_add_f32 v169, 0xdd000000, v4
    v_add_f32 v170, 0xddc00000, v4
    v_add_f32 v171, 0xde200000, v4
    v_add_f32 v172, 0xdf780000, v4
    v_add_f32 v173, 0xdf840000, v4
    v_add_f32 v174, 0xdf8c0000, v4
    v_add_f32 v175, 0xdf940000, v4
    v_min_f32 v168, v168, v152
    v_min_f32 v169, v169, v152
    v_min_f32 v170, v170, v152
    v_min_f32 v171, v171, v152
    v_min_f32 v172, v172, v152
    v_min_f32 v173, v173, v152
    v_min_f32 v174, v174, v152
    v_min_f32 v175, v175, v152
    s_nop 1
    s_waitcnt lgkmcnt(4)
    v_mfma_f32_16x16x32_bf16 v[48:51], a[64:67], a[0:3], v[168:171]
    s_waitcnt vmcnt(8)
    v_exp_f32 v116, v84
    v_mfma_f32_16x16x32_bf16 v[48:51], a[68:71], a[4:7], v[48:51]
    s_barrier
    v_cvt_pk_bf16_f32 v136, v112, v113
    v_cvt_pk_bf16_f32 v137, v114, v115
    v_mfma_f32_16x16x32_bf16 v[48:51], a[72:75], a[8:11], v[48:51]
    ds_read_b128 a[96:99], v3 offset:0
    s_add_u32 m0, s59, 65536
    v_mfma_f32_16x16x32_bf16 v[48:51], a[76:79], a[12:15], v[48:51]
    s_add_u32 s60, s56, 20979712
    v_exp_f32 v117, v85
    v_mfma_f32_16x16x32_bf16 v[56:59], a[64:67], a[16:19], v[156:159]
    ds_read_b128 a[100:103], v3 offset:1024
    v_cvt_pk_bf16_f32 v138, v116, v117
    v_mfma_f32_16x16x32_bf16 v[56:59], a[68:71], a[20:23], v[56:59]
    s_waitcnt lgkmcnt(2)
    v_exp_f32 v118, v86
    v_mfma_f32_16x16x32_bf16 v[56:59], a[72:75], a[24:27], v[56:59]
    ds_read_b128 a[104:107], v3 offset:2048
    buffer_load_dwordx4 v1, s[48:51], s60 offen offset:0 sc1 lds
    v_mfma_f32_16x16x32_bf16 v[56:59], a[76:79], a[28:31], v[56:59]
    v_exp_f32 v119, v87
    v_mfma_f32_16x16x32_bf16 v[52:55], a[80:83], a[0:3], v[172:175]
    ds_read_b128 a[108:111], v3 offset:3072
    v_cvt_pk_bf16_f32 v139, v118, v119
    v_mfma_f32_16x16x32_bf16 v[52:55], a[84:87], a[4:7], v[52:55]
    v_exp_f32 v112, v88
    v_mfma_f32_16x16x32_bf16 v[32:35], a[240:243], v[136:139], v[16:19]
    ds_read_b128 a[112:115], v3 offset:4096
    buffer_load_dwordx4 v1, s[48:51], s60 offen offset:1024 sc1 lds
    v_mfma_f32_16x16x32_bf16 v[52:55], a[88:91], a[8:11], v[52:55]
    v_exp_f32 v113, v89
    v_mfma_f32_16x16x32_bf16 v[52:55], a[92:95], a[12:15], v[52:55]
    ds_read_b128 a[116:119], v3 offset:5120
    v_cvt_pk_bf16_f32 v140, v112, v113
    v_mfma_f32_16x16x32_bf16 v[60:63], a[80:83], a[16:19], v[156:159]
    v_exp_f32 v114, v90
    v_mfma_f32_16x16x32_bf16 v[60:63], a[84:87], a[20:23], v[60:63]
    ds_read_b128 a[120:123], v3 offset:6144
    buffer_load_dwordx4 v1, s[48:51], s60 offen offset:2048 sc1 lds
    v_mfma_f32_16x16x32_bf16 v[60:63], a[88:91], a[24:27], v[60:63]
    s_waitcnt lgkmcnt(3)
    v_exp_f32 v115, v91
    v_mfma_f32_16x16x32_bf16 v[60:63], a[92:95], a[28:31], v[60:63]
    ds_read_b128 a[124:127], v3 offset:7168
    buffer_load_dwordx4 v1, s[48:51], s60 offen offset:3072 sc1 lds
    v_mfma_f32_16x16x32_bf16 a[128:131], a[96:99], v[120:123], a[128:131]
    s_add_u32 s56, s56, 16384
    v_exp_f32 v116, v92
    v_mfma_f32_16x16x32_bf16 v[192:195], a[96:99], v[124:127], v[192:195]
    ds_read_b128 a[64:67], v2 offset:8192
    v_cvt_pk_bf16_f32 v141, v114, v115
    v_mfma_f32_16x16x32_bf16 a[132:135], a[100:103], v[120:123], a[132:135]
    s_cmp_ge_u32 s56, s57
    v_exp_f32 v117, v93
    v_mfma_f32_16x16x32_bf16 v[196:199], a[100:103], v[124:127], v[196:199]
    ds_read_b128 a[68:71], v2 offset:9216
    v_cvt_pk_bf16_f32 v142, v116, v117
    v_mfma_f32_16x16x32_bf16 a[136:139], a[104:107], v[120:123], a[136:139]
    s_cselect_b32 s56, 0x40000000, s56
    v_exp_f32 v118, v94
    v_mfma_f32_16x16x32_bf16 v[200:203], a[104:107], v[124:127], v[200:203]
    ds_read_b128 a[72:75], v2 offset:10240
    s_waitcnt lgkmcnt(3)
    v_mfma_f32_16x16x32_bf16 a[140:143], a[108:111], v[120:123], a[140:143]
    v_exp_f32 v119, v95
    v_mfma_f32_16x16x32_bf16 v[204:207], a[108:111], v[124:127], v[204:207]
    ds_read_b128 a[76:79], v2 offset:11264
    v_cvt_pk_bf16_f32 v143, v118, v119
    v_mfma_f32_16x16x32_bf16 a[144:147], a[112:115], v[120:123], a[144:147]
    v_exp_f32 v112, v48
    v_mfma_f32_16x16x32_bf16 v[36:39], a[240:243], v[140:143], v[20:23]
    ds_read_b128 a[80:83], v2 offset:12288
    v_mfma_f32_16x16x32_bf16 v[208:211], a[112:115], v[124:127], v[208:211]
    v_exp_f32 v113, v49
    v_mfma_f32_16x16x32_bf16 a[148:151], a[116:119], v[120:123], a[148:151]
    ds_read_b128 a[84:87], v2 offset:13312
    v_mfma_f32_16x16x32_bf16 v[212:215], a[116:119], v[124:127], v[212:215]
    v_exp_f32 v114, v50
    v_mfma_f32_16x16x32_bf16 a[152:155], a[120:123], v[120:123], a[152:155]
    ds_read_b128 a[88:91], v2 offset:14336
    v_max_f32 v6, v32, v36
    v_mfma_f32_16x16x32_bf16 v[216:219], a[120:123], v[124:127], v[216:219]
    v_exp_f32 v115, v51
    v_mfma_f32_16x16x32_bf16 a[156:159], a[124:127], v[120:123], a[156:159]
    ds_read_b128 a[92:95], v2 offset:15360
    v_cmp_lt_f32 vcc, s73, v6
    v_mfma_f32_16x16x32_bf16 v[220:223], a[124:127], v[124:127], v[220:223]
    s_cbranch_vccnz K2_SLOW12
K2_BACK12:
    v_add_f32 v168, 0xdffc0000, v4
    v_add_f32 v169, 0xe0020000, v4
    v_add_f32 v170, 0xe0060000, v4
    v_add_f32 v171, 0xe00a0000, v4
    v_add_f32 v172, 0xe03e0000, v4
    v_add_f32 v173, 0xe0420000, v4
    v_add_f32 v174, 0xe0460000, v4
    v_add_f32 v175, 0xe04a0000, v4
    v_min_f32 v168, v168, v152
    v_min_f32 v169, v169, v152
    v_min_f32 v170, v170, v152
    v_min_f32 v171, v171, v152
    v_min_f32 v172, v172, v152
    v_min_f32 v173, v173, v152
    v_min_f32 v174, v174, v152
    v_min_f32 v175, v175, v152
    s_nop 1
    s_waitcnt lgkmcnt(4)
    v_mfma_f32_16x16x32_bf16 v[80:83], a[64:67], a[0:3], v[168:171]
    ds_read_b128 a[96:99], v3 offset:8192
    v_cvt_pk_bf16_f32 v120, v112, v113
    v_mfma_f32_16x16x32_bf16 v[80:83], a[68:71], a[4:7], v[80:83]
    s_add_u32 s59, s59, 16384
    v_exp_f32 v116, v52
    v_mfma_f32_16x16x32_bf16 v[80:83], a[72:75], a[8:11], v[80:83]
    ds_read_b128 a[100:103], v3 offset:9216
    v_cvt_pk_bf16_f32 v121, v114, v115
    v_mfma_f32_16x16x32_bf16 v[80:83], a[76:79], a[12:15], v[80:83]
    s_and_b32 s59, s59, 0xffff
    v_exp_f32 v117, v53
    v_mfma_f32_16x16x32_bf16 v[88:91], a[64:67], a[16:19], v[156:159]
    ds_read_b128 a[104:107], v3 offset:10240
    v_cvt_pk_bf16_f32 v122, v116, v117
    v_mfma_f32_16x16x32_bf16 v[88:91], a[68:71], a[20:23], v[88:91]
    s_waitcnt lgkmcnt(3)
    v_exp_f32 v118, v54
    v_mfma_f32_16x16x32_bf16 v[88:91], a[72:75], a[24:27], v[88:91]
    ds_read_b128 a[108:111], v3 offset:11264
    s_mov_b32 m0, s59
    v_mfma_f32_16x16x32_bf16 v[88:91], a[76:79], a[28:31], v[88:91]
    v_exp_f32 v119, v55
    v_mfma_f32_16x16x32_bf16 v[84:87], a[80:83], a[0:3], v[172:175]
    ds_read_b128 a[112:115], v3 offset:12288
    v_cvt_pk_bf16_f32 v123, v118, v119
    v_mfma_f32_16x16x32_bf16 v[84:87], a[84:87], a[4:7], v[84:87]
    v_exp_f32 v112, v56
    v_mfma_f32_16x16x32_bf16 v[16:19], a[240:243], v[120:123], v[32:35]
    v_exp_f32 v113, v57
    v_mfma_f32_16x16x32_bf16 v[84:87], a[88:91], a[8:11], v[84:87]
    ds_read_b128 a[116:119], v3 offset:13312
    v_cvt_pk_bf16_f32 v124, v112, v113
    v_mfma_f32_16x16x32_bf16 v[84:87], a[92:95], a[12:15], v[84:87]
    v_exp_f32 v114, v58
    v_mfma_f32_16x16x32_bf16 v[92:95], a[80:83], a[16:19], v[156:159]
    ds_read_b128 a[120:123], v3 offset:14336
    buffer_load_dwordx4 v1, s[48:51], s56 offen offset:0 sc1 lds
    v_mfma_f32_16x16x32_bf16 v[92:95], a[84:87], a[20:23], v[92:95]
    s_waitcnt lgkmcnt(3)
    v_exp_f32 v115, v59
    v_mfma_f32_16x16x32_bf16 v[92:95], a[88:91], a[24:27], v[92:95]
    ds_read_b128 a[124:127], v3 offset:15360
    v_cvt_pk_bf16_f32 v125, v114, v115
    v_mfma_f32_16x16x32_bf16 v[92:95], a[92:95], a[28:31], v[92:95]
    v_exp_f32 v116, v60
    v_mfma_f32_16x16x32_bf16 a[128:131], a[96:99], v[136:139], a[128:131]
    v_add_u32 v3, 0x10000, v2
    v_add_u32 v2, 0x4000, v2
    v_mfma_f32_16x16x32_bf16 v[192:195], a[96:99], v[140:143], v[192:195]
    v_exp_f32 v117, v61
    v_mfma_f32_16x16x32_bf16 a[132:135], a[100:103], v[136:139], a[132:135]
    v_cvt_pk_bf16_f32 v126, v116, v117
    v_and_b32 v2, 0xffff, v2
    v_mfma_f32_16x16x32_bf16 v[196:199], a[100:103], v[140:143], v[196:199]
    ds_read_b128 a[64:67], v2 offset:0
    buffer_load_dwordx4 v1, s[48:51], s56 offen offset:1024 sc1 lds
    v_mfma_f32_16x16x32_bf16 a[136:139], a[104:107], v[136:139], a[136:139]
    v_exp_f32 v118, v62
    v_mfma_f32_16x16x32_bf16 v[200:203], a[104:107], v[140:143], v[200:203]
    ds_read_b128 a[68:71], v2 offset:1024
    buffer_load_dwordx4 v1, s[48:51], s56 offen offset:2048 sc1 lds
    v_mfma_f32_16x16x32_bf16 a[140:143], a[108:111], v[136:139], a[140:143]
    s_waitcnt lgkmcnt(2)
    v_exp_f32 v119, v63
    v_mfma_f32_16x16x32_bf16 v[204:207], a[108:111], v[140:143], v[204:207]
    ds_read_b128 a[72:75], v2 offset:2048
    v_cvt_pk_bf16_f32 v127, v118, v119
    v_mfma_f32_16x16x32_bf16 a[144:147], a[112:115], v[136:139], a[144:147]
    v_exp_f32 v112, v80
    v_mfma_f32_16x16x32_bf16 v[20:23], a[240:243], v[124:127], v[36:39]
    ds_read_b128 a[76:79], v2 offset:3072
    buffer_load_dwordx4 v1, s[48:51], s56 offen offset:3072 sc1 lds
    v_mfma_f32_16x16x32_bf16 v[208:211], a[112:115], v[140:143], v[208:211]
    v_exp_f32 v113, v81
    v_mfma_f32_16x16x32_bf16 a[148:151], a[116:119], v[136:139], a[148:151]
    ds_read_b128 a[80:83], v2 offset:4096
    v_mfma_f32_16x16x32_bf16 v[212:215], a[116:119], v[140:143], v[212:215]
    v_exp_f32 v114, v82
    v_mfma_f32_16x16x32_bf16 a[152:155], a[120:123], v[136:139], a[152:155]
    ds_read_b128 a[84:87], v2 offset:5120
    v_max_f32 v6, v16, v20
    v_mfma_f32_16x16x32_bf16 v[216:219], a[120:123], v[140:143], v[216:219]
    v_exp_f32 v115, v83
    v_mfma_f32_16x16x32_bf16 a[156:159], a[124:127], v[136:139], a[156:159]
    ds_read_b128 a[88:91], v2 offset:6144
    v_cmp_lt_f32 vcc, s73, v6
    v_mfma_f32_16x16x32_bf16 v[220:223], a[124:127], v[140:143], v[220:223]
    ds_read_b128 a[92:95], v2 offset:7168
    s_cbranch_vccnz K2_SLOW13
K2_BACK13:
K2_LASTS:
    v_add_f32 v168, 0xe07e0000, v5
    v_add_f32 v169, 0xe0810000, v5
    v_add_f32 v170, 0xe0830000, v5
    v_add_f32 v171, 0xe0850000, v5
    v_add_f32 v172, 0xe09f0000, v5
    v_add_f32 v173, 0xe0a10000, v5
    v_add_f32 v174, 0xe0a30000, v5
    v_add_f32 v175, 0xe0a50000, v5
    v_min_f32 v168, v168, v156
    v_min_f32 v169, v169, v156
    v_min_f32 v170, v170, v156
    v_min_f32 v171, v171, v156
    v_min_f32 v172, v172, v156
    v_min_f32 v173, v173, v156
    v_min_f32 v174, v174, v156
    v_min_f32 v175, v175, v156
    s_nop 1
    s_waitcnt lgkmcnt(4)
    v_mfma_f32_16x16x32_bf16 v[56:59], a[64:67], a[16:19], v[168:171]
    s_waitcnt vmcnt(0)
    s_barrier
    ds_read_b128 a[96:99], v3 offset:0
    v_mov_b32 v9, 1
    s_mov_b64 exec, 255
    buffer_store_dword v9, v163, s[48:51], s21 offen offset:32 sc1
    s_mov_b64 exec, -1
    v_mfma_f32_16x16x32_bf16 v[56:59], a[68:71], a[20:23], v[56:59]
    ds_read_b128 a[100:103], v3 offset:1024
    v_cvt_pk_bf16_f32 v136, v112, v113
    v_exp_f32 v116, v84
    v_cvt_pk_bf16_f32 v137, v114, v115
    v_mfma_f32_16x16x32_bf16 v[56:59], a[72:75], a[24:27], v[56:59]
    ds_read_b128 a[104:107], v3 offset:2048
    s_waitcnt lgkmcnt(3)
    v_mfma_f32_16x16x32_bf16 v[56:59], a[76:79], a[28:31], v[56:59]
    ds_read_b128 a[108:111], v3 offset:3072
    s_bfe_u32 s26, s2, 0x20001
    v_exp_f32 v117, v85
    v_mfma_f32_16x16x32_bf16 v[60:63], a[80:83], a[16:19], v[172:175]
    ds_read_b128 a[112:115], v3 offset:4096
    v_cvt_pk_bf16_f32 v138, v116, v117
    v_exp_f32 v118, v86
    v_mfma_f32_16x16x32_bf16 v[60:63], a[84:87], a[20:23], v[60:63]
    ds_read_b128 a[116:119], v3 offset:5120
    s_waitcnt lgkmcnt(2)
    v_mfma_f32_16x16x32_bf16 v[60:63], a[88:91], a[24:27], v[60:63]
    ds_read_b128 a[120:123], v3 offset:6144
    s_and_b32 s24, s2, 1
    v_exp_f32 v119, v87
    v_mfma_f32_16x16x32_bf16 v[60:63], a[92:95], a[28:31], v[60:63]
    s_lshl_b32 s24, s24, 3
    v_exp_f32 v112, v88
    v_mfma_f32_16x16x32_bf16 a[128:131], a[96:99], v[120:123], a[128:131]
    ds_read_b128 a[124:127], v3 offset:7168
    v_cvt_pk_bf16_f32 v139, v118, v119
    v_mfma_f32_16x16x32_bf16 v[192:195], a[96:99], v[124:127], v[192:195]
    s_bfe_u32 s30, s2, 0x30003
    v_exp_f32 v113, v89
    v_mfma_f32_16x16x32_bf16 v[32:35], a[240:243], v[136:139], v[16:19]
    ds_read_b128 a[64:67], v2 offset:8192
    v_cvt_pk_bf16_f32 v140, v112, v113
    v_exp_f32 v114, v90
    v_mfma_f32_16x16x32_bf16 a[132:135], a[100:103], v[120:123], a[132:135]
    s_add_u32 s24, s24, s30
    v_exp_f32 v115, v91
    v_mfma_f32_16x16x32_bf16 v[196:199], a[100:103], v[124:127], v[196:199]
    ds_read_b128 a[68:71], v2 offset:9216
    v_cvt_pk_bf16_f32 v141, v114, v115
    v_mfma_f32_16x16x32_bf16 a[136:139], a[104:107], v[120:123], a[136:139]
    s_lshr_b32 s23, s24, 1
    v_exp_f32 v116, v92
    v_mfma_f32_16x16x32_bf16 v[200:203], a[104:107], v[124:127], v[200:203]
    ds_read_b128 a[72:75], v2 offset:10240
    s_waitcnt lgkmcnt(3)
    v_mfma_f32_16x16x32_bf16 a[140:143], a[108:111], v[120:123], a[140:143]
    s_lshl_b32 s27, s2, 10
    v_exp_f32 v117, v93
    v_mfma_f32_16x16x32_bf16 v[204:207], a[108:111], v[124:127], v[204:207]
    ds_read_b128 a[76:79], v2 offset:11264
    v_cvt_pk_bf16_f32 v142, v116, v117
    v_mfma_f32_16x16x32_bf16 a[144:147], a[112:115], v[120:123], a[144:147]
    s_add_u32 s27, s27, 75563008
    v_exp_f32 v118, v94
    v_mfma_f32_16x16x32_bf16 v[208:211], a[112:115], v[124:127], v[208:211]
    ds_read_b128 a[80:83], v2 offset:12288
    s_lshr_b32 s25, s2, 6
    v_exp_f32 v119, v95
    v_mfma_f32_16x16x32_bf16 a[148:151], a[116:119], v[120:123], a[148:151]
    s_lshl_b32 s22, s3, 12
    v_exp_f32 v112, v56
    v_mfma_f32_16x16x32_bf16 v[212:215], a[116:119], v[124:127], v[212:215]
    ds_read_b128 a[84:87], v2 offset:13312
    v_cvt_pk_bf16_f32 v143, v118, v119
    v_mfma_f32_16x16x32_bf16 a[152:155], a[120:123], v[120:123], a[152:155]
    s_mul_i32 s33, s25, 1048576
    v_exp_f32 v113, v57
    v_mfma_f32_16x16x32_bf16 v[36:39], a[240:243], v[140:143], v[20:23]
    ds_read_b128 a[88:91], v2 offset:14336
    s_mul_i32 s30, s26, 65536
    v_mfma_f32_16x16x32_bf16 v[216:219], a[120:123], v[124:127], v[216:219]
    v_exp_f32 v114, v58
    v_mfma_f32_16x16x32_bf16 a[156:159], a[124:127], v[120:123], a[156:159]
    ds_read_b128 a[92:95], v2 offset:15360
    v_lshrrev_b32 v160, 3, v0
    v_lshl_add_u32 v160, v160, 10, v10
    v_and_b32 v162, 7, v0
    v_lshl_add_u32 v160, v162, 4, v160
    v_add_u32 v160, 75530240, v160
    v_lshl_add_u32 v161, v162, 2, v10
    buffer_load_dword v162, v161, s[48:51], s27 offen offset:32 sc1
    v_mfma_f32_16x16x32_bf16 v[220:223], a[124:127], v[124:127], v[220:223]
    v_exp_f32 v115, v59
    v_max_f32 v6, v32, v36
    v_cmp_lt_f32 vcc, s73, v6
    s_cbranch_vccnz K2_SLOW14
K2_BACK14:
    v_add_f32 v168, 0xe0bf0000, v5
    v_add_f32 v169, 0xe0c10000, v5
    v_add_f32 v170, 0xe0c30000, v5
    v_add_f32 v171, 0xe0c50000, v5
    v_add_f32 v172, 0xe0df0000, v5
    v_add_f32 v173, 0xe0e10000, v5
    v_add_f32 v174, 0xe0e30000, v5
    v_add_f32 v175, 0xe0e50000, v5
    v_min_f32 v168, v168, v156
    v_min_f32 v169, v169, v156
    v_min_f32 v170, v170, v156
    v_min_f32 v171, v171, v156
    v_min_f32 v172, v172, v156
    v_min_f32 v173, v173, v156
    v_min_f32 v174, v174, v156
    v_min_f32 v175, v175, v156
    s_nop 1
    s_waitcnt lgkmcnt(4)
    v_mfma_f32_16x16x32_bf16 v[88:91], a[64:67], a[16:19], v[168:171]
    ds_read_b128 a[96:99], v3 offset:8192
    v_cvt_pk_bf16_f32 v124, v112, v113
    v_mfma_f32_16x16x32_bf16 v[88:91], a[68:71], a[20:23], v[88:91]
    ds_read_b128 a[100:103], v3 offset:9216
    v_cvt_pk_bf16_f32 v125, v114, v115
    v_mfma_f32_16x16x32_bf16 v[88:91], a[72:75], a[24:27], v[88:91]
    ds_read_b128 a[104:107], v3 offset:10240
    s_waitcnt lgkmcnt(3)
    v_mfma_f32_16x16x32_bf16 v[88:91], a[76:79], a[28:31], v[88:91]
    ds_read_b128 a[108:111], v3 offset:11264
    s_add_u32 s33, s33, s30
    v_exp_f32 v116, v60
    v_mfma_f32_16x16x32_bf16 v[92:95], a[80:83], a[16:19], v[172:175]
    ds_read_b128 a[112:115], v3 offset:12288
    s_add_u32 s33, s33, 0
    v_mfma_f32_16x16x32_bf16 v[92:95], a[84:87], a[20:23], v[92:95]
    ds_read_b128 a[116:119], v3 offset:13312
    s_waitcnt lgkmcnt(2)
    v_mfma_f32_16x16x32_bf16 v[92:95], a[88:91], a[24:27], v[92:95]
    ds_read_b128 a[120:123], v3 offset:14336
    s_lshr_b32 s30, s3, 1
    v_exp_f32 v117, v61
    v_mfma_f32_16x16x32_bf16 v[92:95], a[92:95], a[28:31], v[92:95]
    s_add_u32 s30, s30, s26
    v_exp_f32 v118, v62
    v_mfma_f32_16x16x32_bf16 a[128:131], a[96:99], v[136:139], a[128:131]
    ds_read_b128 a[124:127], v3 offset:15360
    v_cvt_pk_bf16_f32 v126, v116, v117
    v_mfma_f32_16x16x32_bf16 v[192:195], a[96:99], v[140:143], v[192:195]
    s_add_u32 s30, s30, 1
    v_exp_f32 v119, v63
    v_mfma_f32_16x16x32_bf16 a[132:135], a[100:103], v[136:139], a[132:135]
    s_and_b32 s30, s30, 3
    v_cvt_pk_bf16_f32 v127, v118, v119
    v_add_u32 v3, 0x10000, v2
    v_mfma_f32_16x16x32_bf16 v[196:199], a[100:103], v[140:143], v[196:199]
    s_mul_i32 s30, s30, 262144
    v_add_u32 v2, 0x4000, v2
    v_and_b32 v2, 0xffff, v2
    v_mfma_f32_16x16x32_bf16 v[20:23], a[240:243], v[124:127], v[36:39]
    s_add_u32 s31, s33, s30
    v_exp_f32 v112, v88
    v_mfma_f32_16x16x32_bf16 a[136:139], a[104:107], v[136:139], a[136:139]
    s_and_b32 s30, s3, 1
    v_mfma_f32_16x16x32_bf16 v[200:203], a[104:107], v[140:143], v[200:203]
    s_waitcnt lgkmcnt(0)
    v_mfma_f32_16x16x32_bf16 a[140:143], a[108:111], v[136:139], a[140:143]
    s_lshl_b32 s30, s30, 12
    v_exp_f32 v113, v89
    v_mfma_f32_16x16x32_bf16 v[204:207], a[108:111], v[140:143], v[204:207]
    s_add_u32 s31, s31, s30
    v_cmp_lt_f32 vcc, s73, v20
    v_mfma_f32_16x16x32_bf16 a[144:147], a[112:115], v[136:139], a[144:147]
    s_mul_i32 s34, s24, 544768
    v_mfma_f32_16x16x32_bf16 v[208:211], a[112:115], v[140:143], v[208:211]
    s_mul_i32 s30, s3, 136192
    v_exp_f32 v114, v90
    v_mfma_f32_16x16x32_bf16 a[148:151], a[116:119], v[136:139], a[148:151]
    s_add_u32 s34, s34, s30
    v_mfma_f32_16x16x32_bf16 v[212:215], a[116:119], v[140:143], v[212:215]
    s_lshl_b32 s30, s26, 15
    v_mfma_f32_16x16x32_bf16 a[152:155], a[120:123], v[136:139], a[152:155]
    s_add_u32 s34, s34, s30
    v_exp_f32 v115, v91
    v_mfma_f32_16x16x32_bf16 v[216:219], a[120:123], v[140:143], v[216:219]
    s_add_u32 s34, s34, 53477376
    v_mfma_f32_16x16x32_bf16 a[156:159], a[124:127], v[136:139], a[156:159]
    v_mfma_f32_16x16x32_bf16 v[220:223], a[124:127], v[140:143], v[220:223]
    s_cbranch_vccnz K2_SLOW15
K2_BACK15:
    s_waitcnt vmcnt(0)
    v_cmp_gt_u32 vcc, 1, v162
    s_and_b64 vcc, vcc, s[18:19]
    s_cbranch_scc1 GM_POLL3
GM_PB3:
    s_barrier
    ds_read_b128 a[96:99], v3 offset:0
    ds_read_b128 a[100:103], v3 offset:1024
    ds_read_b128 a[104:107], v3 offset:2048
    ds_read_b128 a[108:111], v3 offset:3072
    ds_read_b128 a[112:115], v3 offset:4096
    ds_read_b128 a[116:119], v3 offset:5120
    ds_read_b128 a[120:123], v3 offset:6144
    ds_read_b128 a[124:127], v3 offset:7168
    v_accvgpr_read_b32 v224, a224
    v_accvgpr_read_b32 v225, a225
    v_accvgpr_read_b32 v226, a226
    v_accvgpr_read_b32 v227, a227
    v_accvgpr_read_b32 v228, a228
    v_accvgpr_read_b32 v229, a229
    v_accvgpr_read_b32 v230, a230
    v_accvgpr_read_b32 v231, a231
    v_alignbit_b32 v232, v225, v224, 16
    v_alignbit_b32 v233, v226, v225, 16
    v_alignbit_b32 v234, v227, v226, 16
    v_alignbit_b32 v235, v228, v227, 16
    v_alignbit_b32 v236, v229, v228, 16
    v_alignbit_b32 v237, v230, v229, 16
    v_alignbit_b32 v238, v231, v230, 16
    v_alignbit_b32 v240, v226, v225, 16
    v_alignbit_b32 v241, v227, v226, 16
    v_alignbit_b32 v242, v228, v227, 16
    v_alignbit_b32 v243, v229, v228, 16
    v_alignbit_b32 v244, v230, v229, 16
    v_alignbit_b32 v245, v231, v230, 16
    v_mov_b32 v248, v225
    v_mov_b32 v249, v226
    v_mov_b32 v250, v227
    v_mov_b32 v251, v228
    v_mov_b32 v252, v229
    v_mov_b32 v253, v230
    s_waitcnt lgkmcnt(4)
    v_mfma_f32_16x16x32_bf16 v[192:195], a[96:99], v[124:127], v[192:195]
    v_exp_f32 v116, v92
    s_add_u32 s52, s34, 0
    v_rcp_f32 v11, v32
    s_nop 0
    v_accvgpr_read_b32 v176, a128
    v_mfma_f32_16x16x32_bf16 v[196:199], a[100:103], v[124:127], v[196:199]
    s_waitcnt lgkmcnt(0)
    v_cvt_pk_bf16_f32 v140, v112, v113
    v_cvt_pk_bf16_f32 v141, v114, v115
    v_accvgpr_read_b32 v177, a129
    v_accvgpr_read_b32 v178, a130
    v_accvgpr_read_b32 v179, a131
    buffer_load_dwordx4 a[160:163], v1, s[48:51], s52 offen offset:0 sc1
    v_accvgpr_read_b32 v180, a132
    v_accvgpr_read_b32 v181, a133
    v_mfma_f32_16x16x32_bf16 v[200:203], a[104:107], v[124:127], v[200:203]
    v_exp_f32 v117, v93
    v_accvgpr_read_b32 v182, a134
    v_accvgpr_read_b32 v183, a135
    v_mul_f32 v176, v176, v11
    v_mul_f32 v177, v177, v11
    buffer_load_dwordx4 a[164:167], v1, s[48:51], s52 offen offset:1024 sc1
    v_mfma_f32_16x16x32_bf16 v[204:207], a[108:111], v[124:127], v[204:207]
    v_cvt_pk_bf16_f32 v142, v116, v117
    v_mul_f32 v178, v178, v11
    v_mul_f32 v179, v179, v11
    v_mul_f32 v180, v180, v11
    v_mul_f32 v181, v181, v11
    v_mul_f32 v182, v182, v11
    v_mul_f32 v183, v183, v11
    v_mfma_f32_16x16x32_bf16 v[208:211], a[112:115], v[124:127], v[208:211]
    v_exp_f32 v118, v94
    buffer_load_dwordx4 a[168:171], v1, s[48:51], s52 offen offset:2048 sc1
    v_cvt_pk_bf16_f32 v176, v176, v177
    v_cvt_pk_bf16_f32 v177, v178, v179
    v_cvt_pk_bf16_f32 v178, v180, v181
    v_cvt_pk_bf16_f32 v179, v182, v183
    v_mfma_f32_16x16x32_bf16 v[212:215], a[116:119], v[124:127], v[212:215]
    buffer_store_dwordx4 v[176:179], v1, s[48:51], s68 offen offset:0 sc1
    v_accvgpr_read_b32 v184, a136
    buffer_load_dwordx4 a[172:175], v1, s[48:51], s52 offen offset:3072 sc1
    v_accvgpr_read_b32 v185, a137
    v_accvgpr_read_b32 v186, a138
    v_accvgpr_read_b32 v187, a139
    v_mfma_f32_16x16x32_bf16 v[216:219], a[120:123], v[124:127], v[216:219]
    v_exp_f32 v119, v95
    v_accvgpr_read_b32 v188, a140
    v_accvgpr_read_b32 v189, a141
    v_accvgpr_read_b32 v190, a142
    s_add_u32 s52, s34, 4096
    v_accvgpr_read_b32 v191, a143
    v_mfma_f32_16x16x32_bf16 v[220:223], a[124:127], v[124:127], v[220:223]
    v_cvt_pk_bf16_f32 v143, v118, v119
    v_mul_f32 v184, v184, v11
    v_mul_f32 v185, v185, v11
    v_mul_f32 v186, v186, v11
    v_mul_f32 v187, v187, v11
    v_mul_f32 v188, v188, v11
    buffer_load_dwordx4 a[176:179], v1, s[48:51], s52 offen offset:0 sc1
    v_mfma_f32_16x16x32_bf16 v[36:39], a[240:243], v[140:143], v[20:23]
    v_mul_f32 v189, v189, v11
    v_mul_f32 v190, v190, v11
    v_mul_f32 v191, v191, v11
    v_cvt_pk_bf16_f32 v184, v184, v185
    v_cvt_pk_bf16_f32 v185, v186, v187
    v_cvt_pk_bf16_f32 v186, v188, v189
    buffer_load_dwordx4 a[180:183], v1, s[48:51], s52 offen offset:1024 sc1
    s_nop 0
    v_cmp_lt_f32 vcc, s73, v36
    s_cbranch_vccnz K2_SLOW16
K2_BACK16:
    ds_read_b128 a[96:99], v3 offset:8192
    ds_read_b128 a[100:103], v3 offset:9216
    ds_read_b128 a[104:107], v3 offset:10240
    ds_read_b128 a[108:111], v3 offset:11264
    ds_read_b128 a[112:115], v3 offset:12288
    ds_read_b128 a[116:119], v3 offset:13312
    ds_read_b128 a[120:123], v3 offset:14336
    ds_read_b128 a[124:127], v3 offset:15360
    v_accvgpr_read_b32 v64, a232
    v_accvgpr_read_b32 v65, a233
    v_accvgpr_read_b32 v66, a234
    v_accvgpr_read_b32 v67, a235
    v_accvgpr_read_b32 v68, a236
    v_accvgpr_read_b32 v69, a237
    v_accvgpr_read_b32 v70, a238
    v_accvgpr_read_b32 v71, a239
    v_alignbit_b32 v72, v65, v64, 16
    v_alignbit_b32 v73, v66, v65, 16
    v_alignbit_b32 v74, v67, v66, 16
    v_alignbit_b32 v75, v68, v67, 16
    v_alignbit_b32 v76, v69, v68, 16
    v_alignbit_b32 v77, v70, v69, 16
    v_alignbit_b32 v78, v71, v70, 16
    v_alignbit_b32 v96, v66, v65, 16
    v_alignbit_b32 v97, v67, v66, 16
    v_alignbit_b32 v98, v68, v67, 16
    v_alignbit_b32 v99, v69, v68, 16
    v_alignbit_b32 v100, v70, v69, 16
    v_alignbit_b32 v101, v71, v70, 16
    v_mov_b32 v104, v65
    v_mov_b32 v105, v66
    v_mov_b32 v106, v67
    v_mov_b32 v107, v68
    v_mov_b32 v108, v69
    v_mov_b32 v109, v70
    buffer_load_dwordx4 v[164:167], v160, s[48:51], 0 offen offset:512 sc1
    s_waitcnt lgkmcnt(4)
    v_mfma_f32_16x16x32_bf16 v[192:195], a[96:99], v[140:143], v[192:195]
    v_cvt_pk_bf16_f32 v187, v190, v191
    buffer_store_dwordx4 v[184:187], v1, s[48:51], s68 offen offset:1024 sc1
    v_accvgpr_read_b32 v176, a144
    v_accvgpr_read_b32 v177, a145
    v_accvgpr_read_b32 v178, a146
    v_mfma_f32_16x16x32_bf16 v[196:199], a[100:103], v[140:143], v[196:199]
    s_waitcnt lgkmcnt(0)
    v_accvgpr_read_b32 v179, a147
    buffer_load_dwordx4 a[184:187], v1, s[48:51], s52 offen offset:2048 sc1
    v_accvgpr_read_b32 v180, a148
    v_accvgpr_read_b32 v181, a149
    v_accvgpr_read_b32 v182, a150
    v_accvgpr_read_b32 v183, a151
    v_mfma_f32_16x16x32_bf16 v[200:203], a[104:107], v[140:143], v[200:203]
    v_mul_f32 v176, v176, v11
    v_mul_f32 v177, v177, v11
    buffer_load_dwordx4 a[188:191], v1, s[48:51], s52 offen offset:3072 sc1
    v_mul_f32 v178, v178, v11
    v_mul_f32 v179, v179, v11
    v_mul_f32 v180, v180, v11
    v_mfma_f32_16x16x32_bf16 v[204:207], a[108:111], v[140:143], v[204:207]
    v_mul_f32 v181, v181, v11
    v_mul_f32 v182, v182, v11
    v_mul_f32 v183, v183, v11
    s_add_u32 s52, s34, 8192
    v_cvt_pk_bf16_f32 v176, v176, v177
    v_cvt_pk_bf16_f32 v177, v178, v179
    v_mfma_f32_16x16x32_bf16 v[208:211], a[112:115], v[140:143], v[208:211]
    v_cvt_pk_bf16_f32 v178, v180, v181
    v_cvt_pk_bf16_f32 v179, v182, v183
    buffer_store_dwordx4 v[176:179], v1, s[48:51], s68 offen offset:2048 sc1
    v_accvgpr_read_b32 v184, a152
    buffer_load_dwordx4 a[192:195], v1, s[48:51], s52 offen offset:0 sc1
    v_accvgpr_read_b32 v185, a153
    v_accvgpr_read_b32 v186, a154
    v_mfma_f32_16x16x32_bf16 v[212:215], a[116:119], v[140:143], v[212:215]
    v_accvgpr_read_b32 v187, a155
    v_accvgpr_read_b32 v188, a156
    v_accvgpr_read_b32 v189, a157
    v_accvgpr_read_b32 v190, a158
    buffer_load_dwordx4 a[196:199], v1, s[48:51], s52 offen offset:1024 sc1
    v_accvgpr_read_b32 v191, a159
    v_mfma_f32_16x16x32_bf16 v[216:219], a[120:123], v[140:143], v[216:219]
    v_mul_f32 v184, v184, v11
    v_mul_f32 v185, v185, v11
    v_mul_f32 v186, v186, v11
    v_mul_f32 v187, v187, v11
    v_mul_f32 v188, v188, v11
    buffer_load_dwordx4 a[200:203], v1, s[48:51], s52 offen offset:2048 sc1
    v_mfma_f32_16x16x32_bf16 v[220:223], a[124:127], v[140:143], v[220:223]
    v_mul_f32 v189, v189, v11
    v_mul_f32 v190, v190, v11
    v_mul_f32 v191, v191, v11
    v_cvt_pk_bf16_f32 v184, v184, v185
    v_cvt_pk_bf16_f32 v185, v186, v187
    v_cvt_pk_bf16_f32 v186, v188, v189
    v_cvt_pk_bf16_f32 v187, v190, v191
    buffer_store_dwordx4 v[184:187], v1, s[48:51], s68 offen offset:3072 sc1
    s_lshl_b32 s7, s3, 10
    v_add_u32 v2, s7, v1
    v_and_b32 v3, 15, v0
    v_mul_u32_u24 v3, 4160, v3
    v_mov_b32 v176, 0
    v_mov_b32 v177, 0
    v_mov_b32 v178, 0
    v_mov_b32 v179, 0
    v_rcp_f32 v11, v36
    s_nop 0
    v_mul_f32 v192, v192, v11
    buffer_load_dwordx4 a[204:207], v1, s[48:51], s52 offen offset:3072 sc1
    v_mul_f32 v193, v193, v11
    v_mul_f32 v194, v194, v11
    v_mul_f32 v195, v195, v11
    ds_write_b128 v2, v[232:235] offset:16
    v_mul_f32 v196, v196, v11
    v_mul_f32 v197, v197, v11
    v_mul_f32 v198, v198, v11
    v_mul_f32 v199, v199, v11
    v_cvt_pk_bf16_f32 v192, v192, v193
    s_add_u32 s52, s34, 12288
    v_cvt_pk_bf16_f32 v193, v194, v195
    ds_write_b128 v2, v[248:251] offset:4176
    v_cvt_pk_bf16_f32 v194, v196, v197
    v_cvt_pk_bf16_f32 v195, v198, v199
    buffer_store_dwordx4 v[192:195], v1, s[48:51], s69 offen offset:0 sc1
    v_mul_f32 v200, v200, v11
    v_mul_f32 v201, v201, v11
    v_mul_f32 v202, v202, v11
    ds_write_b128 v2, v[240:243] offset:8336
    v_mul_f32 v203, v203, v11
    buffer_load_dwordx4 a[208:211], v1, s[48:51], s52 offen offset:0 sc1
    v_mul_f32 v204, v204, v11
    v_mul_f32 v205, v205, v11
    v_mul_f32 v206, v206, v11
    v_mul_f32 v207, v207, v11
    v_cvt_pk_bf16_f32 v200, v200, v201
    ds_write_b128 v2, v[226:229] offset:12496
    v_cvt_pk_bf16_f32 v201, v202, v203
    v_cvt_pk_bf16_f32 v202, v204, v205
    v_cvt_pk_bf16_f32 v203, v206, v207
    buffer_load_dwordx4 a[212:215], v1, s[48:51], s52 offen offset:1024 sc1
    buffer_store_dwordx4 v[200:203], v1, s[48:51], s69 offen offset:1024 sc1
    v_mul_f32 v208, v208, v11
    v_mul_f32 v209, v209, v11
    ds_write_b128 v2, v[234:237] offset:16656
    v_mul_f32 v210, v210, v11
    v_mul_f32 v211, v211, v11
    v_mul_f32 v212, v212, v11
    v_mul_f32 v213, v213, v11
    v_mul_f32 v214, v214, v11
    buffer_load_dwordx4 a[216:219], v1, s[48:51], s52 offen offset:2048 sc1
    v_mul_f32 v215, v215, v11
    ds_write_b128 v2, v[250:253] offset:20816
    v_cvt_pk_bf16_f32 v208, v208, v209
    v_cvt_pk_bf16_f32 v209, v210, v211
    v_cvt_pk_bf16_f32 v210, v212, v213
    v_cvt_pk_bf16_f32 v211, v214, v215
    buffer_store_dwordx4 v[208:211], v1, s[48:51], s69 offen offset:2048 sc1
    v_mul_f32 v216, v216, v11
    ds_write_b128 v2, v[242:245] offset:24976
    v_mul_f32 v217, v217, v11
    buffer_load_dwordx4 a[220:223], v1, s[48:51], s52 offen offset:3072 sc1
    v_mul_f32 v218, v218, v11
    v_mul_f32 v219, v219, v11
    v_mul_f32 v220, v220, v11
    v_mul_f32 v221, v221, v11
    v_mul_f32 v222, v222, v11
    ds_write_b128 v2, v[228:231] offset:29136
    v_mul_f32 v223, v223, v11
    v_cvt_pk_bf16_f32 v216, v216, v217
    v_cvt_pk_bf16_f32 v217, v218, v219
    v_cvt_pk_bf16_f32 v218, v220, v221
    v_cvt_pk_bf16_f32 v219, v222, v223
    buffer_store_dwordx4 v[216:219], v1, s[48:51], s69 offen offset:3072 sc1
    ds_write_b128 v2, v[72:75] offset:33296
    s_lshr_b32 s7, s3, 1
    s_and_b32 s8, s3, 1
    ds_write_b128 v2, v[104:107] offset:37456
    v_and_b32 v4, 7, v0
    v_mul_u32_u24 v4, 4160, v4
    ds_write_b128 v2, v[96:99] offset:41616
    v_bfe_u32 v5, v0, 3, 1
    v_lshrrev_b32 v6, 4, v0
    ds_write_b128 v2, v[66:69] offset:45776
    v_add_u32 v5, v5, v6
    v_lshl_add_u32 v4, v5, 4, v4
    ds_write_b128 v2, v[74:77] offset:49936
    s_mul_i32 s9, s7, 33280
    s_lshl_b32 s10, s8, 8
    ds_write_b128 v2, v[106:109] offset:54096
    s_add_u32 s9, s9, s10
    v_add_u32 v4, s9, v4
    ds_write_b128 v2, v[98:101] offset:58256
    v_and_b32 v7, 15, v0
    v_lshlrev_b32 v5, 1, v7
    ds_write_b128 v2, v[68:71] offset:62416
    v_sub_u32 v5, v5, v6
    v_lshlrev_b32 v5, 4, v5
    ds_write_b128 v3, v[176:179]
    s_mul_i32 s9, s7, 4608
    s_add_u32 s9, s9, 133456
    s_sub_u32 s11, s9, s10
    v_add_u32 v5, s11, v5
    ds_read_b128 a[64:67], v5 offset:192
    ds_read_b128 a[68:71], v5 offset:704
    ds_read_b128 a[72:75], v5 offset:1216
    ds_read_b128 a[76:79], v5 offset:1728
    ds_read_b128 a[80:83], v5 offset:2240
    ds_read_b128 a[84:87], v5 offset:2752
    ds_read_b128 a[88:91], v5 offset:3264
    ds_read_b128 a[92:95], v5 offset:3776
    s_waitcnt vmcnt(17)
    v_min_u32 v164, v164, v165
    v_min3_u32 v164, v164, v166, v167
    v_cmp_gt_u32 vcc, 1, v164
    s_and_b64 vcc, vcc, s[18:19]
    s_cbranch_scc1 GM_POLL4
GM_PB4:
    s_waitcnt lgkmcnt(8)
    s_barrier
    ds_read_b128 a[0:3], v4 offset:0
    ds_read_b128 a[4:7], v4 offset:512
    ds_read_b128 a[8:11], v4 offset:1024
    ds_read_b128 a[12:15], v4 offset:1536
    ds_read_b128 a[16:19], v4 offset:2048
    ds_read_b128 a[20:23], v4 offset:2560
    ds_read_b128 a[24:27], v4 offset:3072
    ds_read_b128 a[28:31], v4 offset:3584
    s_waitcnt lgkmcnt(7)
    v_mfma_f32_16x16x32_bf16 v[128:131], a[0:3], a[64:67], 0
    v_lshrrev_b32 v8, 1, v6
    v_lshl_add_u32 v8, v7, 1, v8
    v_mfma_f32_16x16x32_bf16 v[132:135], a[0:3], a[68:71], 0
    ds_read_b128 a[32:35], v4 offset:64
    v_lshlrev_b32 v8, 4, v8
    s_waitcnt lgkmcnt(7)
    v_mfma_f32_16x16x32_bf16 v[132:135], a[4:7], a[64:67], v[132:135]
    v_and_b32 v9, 1, v6
    v_xor_b32 v9, 1, v9
    v_mfma_f32_16x16x32_bf16 v[136:139], a[0:3], a[72:75], 0
    ds_read_b128 a[96:99], v5 offset:128
    s_add_u32 m0, s22, 67584
    s_add_u32 s35, s31, 0
    v_mfma_f32_16x16x32_bf16 v[136:139], a[4:7], a[68:71], v[136:139]
    v_lshl_add_u32 v8, v9, 3, v8
    s_mul_i32 s9, s7, 4608
    s_waitcnt lgkmcnt(7)
    v_mfma_f32_16x16x32_bf16 v[136:139], a[8:11], a[64:67], v[136:139]
    ds_read_b128 a[36:39], v4 offset:576
    s_lshl_b32 s10, s8, 11
    v_mfma_f32_16x16x32_bf16 v[140:143], a[0:3], a[76:79], 0
    buffer_load_dwordx4 v1, s[48:51], s35 offen offset:0 sc1 lds
    s_add_u32 s9, s9, s10
    v_mfma_f32_16x16x32_bf16 v[140:143], a[4:7], a[72:75], v[140:143]
    ds_read_b128 a[100:103], v5 offset:640
    s_add_u32 s9, s9, 133632
    v_mfma_f32_16x16x32_bf16 v[140:143], a[8:11], a[68:71], v[140:143]
    v_add_u32 v8, s9, v8
    s_lshl_b32 s9, s3, 12
    s_waitcnt lgkmcnt(8)
    v_mfma_f32_16x16x32_bf16 v[140:143], a[12:15], a[64:67], v[140:143]
    ds_read_b128 a[40:43], v4 offset:1088
    buffer_load_dwordx4 v1, s[48:51], s35 offen offset:1024 sc1 lds
    v_mfma_f32_16x16x32_bf16 v[144:147], a[0:3], a[80:83], 0
    s_add_u32 s9, s9, 147456
    v_add_u32 v12, s9, v1
    v_mfma_f32_16x16x32_bf16 v[144:147], a[4:7], a[76:79], v[144:147]
    ds_read_b128 a[104:107], v5 offset:1152
    s_xor_b32 s9, s9, 4096
    v_mfma_f32_16x16x32_bf16 v[144:147], a[8:11], a[72:75], v[144:147]
    buffer_load_dwordx4 v1, s[48:51], s35 offen offset:2048 sc1 lds
    v_add_u32 v11, s9, v1
    v_mfma_f32_16x16x32_bf16 v[144:147], a[12:15], a[68:71], v[144:147]
    ds_read_b128 a[44:47], v4 offset:1600
    s_lshl_b32 s9, s75, 16
    s_waitcnt lgkmcnt(10)
    v_mfma_f32_16x16x32_bf16 v[144:147], a[16:19], a[64:67], v[144:147]
    s_and_b32 s10, s75, 0xffff0000
    s_cmp_eq_u32 s7, 0
    s_cselect_b32 s9, s9, s10
    v_mfma_f32_16x16x32_bf16 v[148:151], a[0:3], a[84:87], 0
    ds_read_b128 a[108:111], v5 offset:1664
    buffer_load_dwordx4 v1, s[48:51], s35 offen offset:3072 sc1 lds
    v_mfma_f32_16x16x32_bf16 v[148:151], a[4:7], a[80:83], v[148:151]
    s_lshl_b32 s10, s2, 13
    s_lshl_b32 s11, s7, 12
    v_mfma_f32_16x16x32_bf16 v[148:151], a[8:11], a[76:79], v[148:151]
    ds_read_b128 a[48:51], v4 offset:2112
    s_add_u32 s10, s10, s11
    v_mfma_f32_16x16x32_bf16 v[148:151], a[12:15], a[72:75], v[148:151]
    s_add_u32 m0, s22, 83968
    s_add_u32 s35, s31, 8192
    s_lshl_b32 s11, s8, 11
    v_mfma_f32_16x16x32_bf16 v[148:151], a[16:19], a[68:71], v[148:151]
    ds_read_b128 a[112:115], v5 offset:2176
    s_add_u32 s10, s10, s11
    s_waitcnt lgkmcnt(12)
    v_mfma_f32_16x16x32_bf16 v[148:151], a[20:23], a[64:67], v[148:151]
    s_add_u32 s10, s10, 73400320
    v_lshlrev_b32 v13, 5, v7
    v_mfma_f32_16x16x32_bf16 v[152:155], a[0:3], a[88:91], 0
    ds_read_b128 a[52:55], v4 offset:2624
    v_lshl_add_u32 v13, v6, 3, v13
    v_mfma_f32_16x16x32_bf16 v[152:155], a[4:7], a[84:87], v[152:155]
    buffer_load_dwordx4 v1, s[48:51], s35 offen offset:0 sc1 lds
    s_add_u32 s33, s33, s22
    v_mfma_f32_16x16x32_bf16 v[152:155], a[8:11], a[80:83], v[152:155]
    ds_read_b128 a[116:119], v5 offset:2688
    s_add_u32 s30, s26, 3
    v_mfma_f32_16x16x32_bf16 v[152:155], a[12:15], a[76:79], v[152:155]
    s_and_b32 s30, s30, 3
    s_mul_i32 s30, s30, 262144
    v_mfma_f32_16x16x32_bf16 v[152:155], a[16:19], a[72:75], v[152:155]
    ds_read_b128 a[56:59], v4 offset:3136
    buffer_load_dwordx4 v1, s[48:51], s35 offen offset:1024 sc1 lds
    v_mfma_f32_16x16x32_bf16 v[152:155], a[20:23], a[68:71], v[152:155]
    s_add_u32 s32, s33, s30
    s_mul_i32 s30, s26, 262144
    s_waitcnt lgkmcnt(14)
    v_mfma_f32_16x16x32_bf16 v[152:155], a[24:27], a[64:67], v[152:155]
    ds_read_b128 a[120:123], v5 offset:3200
    s_add_u32 s33, s33, s30
    v_mfma_f32_16x16x32_bf16 v[156:159], a[0:3], a[92:95], 0
    buffer_load_dwordx4 v1, s[48:51], s35 offen offset:2048 sc1 lds
    s_lshl_b32 s23, s23, 1
    v_mfma_f32_16x16x32_bf16 v[156:159], a[4:7], a[88:91], v[156:159]
    ds_read_b128 a[60:63], v4 offset:3648
    s_sub_u32 s23, 15, s23
    v_mfma_f32_16x16x32_bf16 v[156:159], a[8:11], a[84:87], v[156:159]
    s_mul_i32 s30, s23, 1089536
    s_add_u32 s39, s34, s30
    v_mfma_f32_16x16x32_bf16 v[156:159], a[12:15], a[80:83], v[156:159]
    ds_read_b128 a[124:127], v5 offset:3712
    buffer_load_dwordx4 v1, s[48:51], s35 offen offset:3072 sc1 lds
    v_mfma_f32_16x16x32_bf16 v[156:159], a[16:19], a[76:79], v[156:159]
    v_mov_b32 v76, v10
    v_mov_b32 v75, v161
    v_mfma_f32_16x16x32_bf16 v[156:159], a[20:23], a[72:75], v[156:159]
    v_add_u32 v66, 67584, v1
    s_mov_b32 s56, s16
    v_mfma_f32_16x16x32_bf16 v[156:159], a[24:27], a[68:71], v[156:159]
    s_add_u32 s52, s34, 16384
    s_mov_b32 s57, s17
    s_waitcnt lgkmcnt(15)
    v_mfma_f32_16x16x32_bf16 v[156:159], a[28:31], a[64:67], v[156:159]
    s_mov_b32 s58, 2097152
    s_mov_b32 s59, 0x00020000
    s_waitcnt lgkmcnt(14)
    v_mfma_f32_16x16x32_bf16 v[128:131], a[32:35], a[96:99], v[128:131]
    s_mov_b32 s60, s42
    s_mov_b32 s61, s43
    s_waitcnt lgkmcnt(12)
    v_mfma_f32_16x16x32_bf16 v[132:135], a[32:35], a[100:103], v[132:135]
    ds_read_b128 a[0:3], v4 offset:128
    buffer_load_dwordx4 a[128:131], v1, s[48:51], s52 offen offset:0 sc1
    v_mfma_f32_16x16x32_bf16 v[132:135], a[36:39], a[96:99], v[132:135]
    s_mov_b32 s62, 2097152
    s_mov_b32 s63, 0x00020000
    s_waitcnt lgkmcnt(11)
    v_mfma_f32_16x16x32_bf16 v[136:139], a[32:35], a[104:107], v[136:139]
    ds_read_b128 a[64:67], v5 offset:64
    s_lshl_b32 s86, s25, 7
    v_mfma_f32_16x16x32_bf16 v[136:139], a[36:39], a[100:103], v[136:139]
    buffer_load_dwordx4 a[132:135], v1, s[48:51], s52 offen offset:1024 sc1
    s_lshl_b32 s30, s26, 5
    v_mfma_f32_16x16x32_bf16 v[136:139], a[40:43], a[96:99], v[136:139]
    ds_read_b128 a[4:7], v4 offset:640
    s_add_u32 s86, s86, s30
    s_waitcnt lgkmcnt(11)
    v_mfma_f32_16x16x32_bf16 v[140:143], a[32:35], a[108:111], v[140:143]
    s_lshl_b32 s12, s24, 6
    s_lshl_b32 s30, s3, 4
    v_mfma_f32_16x16x32_bf16 v[140:143], a[36:39], a[104:107], v[140:143]
    s_waitcnt vmcnt(10)
    s_barrier
    v_mov_b32 v9, 1
    s_mov_b64 exec, 255
    buffer_store_dword v9, v163, s[48:51], s21 offen offset:0 sc1
    s_mov_b64 exec, -1
    v_mfma_f32_16x16x32_bf16 v[140:143], a[40:43], a[100:103], v[140:143]
    buffer_load_dwordx4 a[136:139], v1, s[48:51], s52 offen offset:2048 sc1
    s_add_u32 s12, s12, s30
    v_mfma_f32_16x16x32_bf16 v[140:143], a[44:47], a[96:99], v[140:143]
    ds_read_b128 a[68:71], v5 offset:576
    v_lshrrev_b32 v60, 3, v0
    s_waitcnt lgkmcnt(10)
    v_mfma_f32_16x16x32_bf16 v[144:147], a[32:35], a[112:115], v[144:147]
    v_lshlrev_b32 v60, 12, v60
    v_and_b32 v61, 7, v0
    v_mfma_f32_16x16x32_bf16 v[144:147], a[36:39], a[108:111], v[144:147]
    ds_read_b128 a[8:11], v4 offset:1152
    buffer_load_dwordx4 a[140:143], v1, s[48:51], s52 offen offset:3072 sc1
    v_mfma_f32_16x16x32_bf16 v[144:147], a[40:43], a[104:107], v[144:147]
    v_lshl_add_u32 v68, v61, 4, v60
    v_add_u32 v69, 31744, v68
    v_mfma_f32_16x16x32_bf16 v[144:147], a[44:47], a[100:103], v[144:147]
    ds_read_b128 a[72:75], v5 offset:1088
    s_lshl_b32 s37, s86, 12
    v_mfma_f32_16x16x32_bf16 v[144:147], a[48:51], a[96:99], v[144:147]
    s_add_u32 s52, s34, 20480
    s_lshl_b32 s30, s24, 7
    s_waitcnt lgkmcnt(10)
    v_mfma_f32_16x16x32_bf16 v[148:151], a[32:35], a[116:119], v[148:151]
    ds_read_b128 a[12:15], v4 offset:1664
    s_add_u32 s37, s37, s30
    v_mfma_f32_16x16x32_bf16 v[148:151], a[36:39], a[112:115], v[148:151]
    s_and_b32 s30, s3, 1
    s_lshl_b32 s30, s30, 16
    v_mfma_f32_16x16x32_bf16 v[148:151], a[40:43], a[108:111], v[148:151]
    ds_read_b128 a[76:79], v5 offset:1600
    buffer_load_dwordx4 a[144:147], v1, s[48:51], s52 offen offset:0 sc1
    v_mfma_f32_16x16x32_bf16 v[148:151], a[44:47], a[104:107], v[148:151]
    s_add_u32 s37, s37, s30
    s_lshr_b32 s30, s3, 1
    v_mfma_f32_16x16x32_bf16 v[148:151], a[48:51], a[100:103], v[148:151]
    ds_read_b128 a[16:19], v4 offset:2176
    s_mul_i32 s30, s30, s23
    v_mfma_f32_16x16x32_bf16 v[148:151], a[52:55], a[96:99], v[148:151]
    buffer_load_dwordx4 a[148:151], v1, s[48:51], s52 offen offset:1024 sc1
    s_lshl_b32 s30, s30, 8
    s_waitcnt lgkmcnt(11)
    v_mfma_f32_16x16x32_bf16 v[152:155], a[32:35], a[120:123], v[152:155]
    ds_read_b128 a[80:83], v5 offset:2112
    s_add_u32 s37, s37, s30
    v_mfma_f32_16x16x32_bf16 v[152:155], a[36:39], a[116:119], v[152:155]
    s_add_u32 s37, s37, 73400320
    s_lshl_b32 s38, s3, 11
    v_mfma_f32_16x16x32_bf16 v[152:155], a[40:43], a[112:115], v[152:155]
    ds_read_b128 a[20:23], v4 offset:2688
    buffer_load_dwordx4 a[152:155], v1, s[48:51], s52 offen offset:2048 sc1
    v_mfma_f32_16x16x32_bf16 v[152:155], a[44:47], a[108:111], v[152:155]
    s_add_u32 s38, s38, 155648
    v_lshrrev_b32 v60, 2, v0
    v_mfma_f32_16x16x32_bf16 v[152:155], a[48:51], a[104:107], v[152:155]
    ds_read_b128 a[84:87], v5 offset:2624
    v_and_b32 v61, 3, v0
    v_mfma_f32_16x16x32_bf16 v[152:155], a[52:55], a[100:103], v[152:155]
    buffer_load_dwordx4 a[156:159], v1, s[48:51], s52 offen offset:3072 sc1
    v_lshlrev_b32 v60, 7, v60
    v_mfma_f32_16x16x32_bf16 v[152:155], a[56:59], a[96:99], v[152:155]
    ds_read_b128 a[24:27], v4 offset:3200
    v_lshl_add_u32 v60, v61, 3, v60
    s_waitcnt lgkmcnt(13)
    v_mfma_f32_16x16x32_bf16 v[156:159], a[32:35], a[124:127], v[156:159]
    s_lshl_b32 s30, s3, 5
    s_add_u32 s30, s30, 155648
    v_mfma_f32_16x16x32_bf16 v[156:159], a[36:39], a[120:123], v[156:159]
    ds_read_b128 a[88:91], v5 offset:3136
    v_add_u32 v74, s30, v60
    v_mfma_f32_16x16x32_bf16 v[156:159], a[40:43], a[116:119], v[156:159]
    s_add_u32 m0, s22, 100352
    s_add_u32 s35, s31, 16384
    v_and_b32 v60, 15, v0
    v_mfma_f32_16x16x32_bf16 v[156:159], a[44:47], a[112:115], v[156:159]
    ds_read_b128 a[28:31], v4 offset:3712
    v_lshl_add_u32 v78, v60, 2, v76
    v_mfma_f32_16x16x32_bf16 v[156:159], a[48:51], a[108:111], v[156:159]
    v_add_u32 v60, s12, v60
    v_lshrrev_b32 v62, 4, v0
    v_mfma_f32_16x16x32_bf16 v[156:159], a[52:55], a[104:107], v[156:159]
    ds_read_b128 a[92:95], v5 offset:3648
    buffer_load_dwordx4 v1, s[48:51], s35 offen offset:0 sc1 lds
    v_mfma_f32_16x16x32_bf16 v[156:159], a[56:59], a[100:103], v[156:159]
    v_lshlrev_b32 v70, 10, v60
    v_lshl_add_u32 v70, v62, 3, v70
    v_mfma_f32_16x16x32_bf16 v[156:159], a[60:63], a[96:99], v[156:159]
    s_lshl_b32 s30, s86, 1
    v_add_u32 v70, s30, v70
    s_waitcnt lgkmcnt(14)
    v_mfma_f32_16x16x32_bf16 v[128:131], a[0:3], a[64:67], v[128:131]
    buffer_load_dwordx4 v1, s[48:51], s35 offen offset:1024 sc1 lds
    s_lshl_b32 s30, s23, 17
    s_waitcnt lgkmcnt(12)
    v_mfma_f32_16x16x32_bf16 v[132:135], a[0:3], a[68:71], v[132:135]
    ds_read_b128 a[32:35], v4 offset:192
    v_add_u32 v71, s30, v70
    v_mfma_f32_16x16x32_bf16 v[132:135], a[4:7], a[64:67], v[132:135]
    v_lshrrev_b32 v72, 3, v60
    v_lshlrev_b32 v72, 7, v72
    s_waitcnt lgkmcnt(11)
    v_mfma_f32_16x16x32_bf16 v[136:139], a[0:3], a[72:75], v[136:139]
    ds_read_b128 a[96:99], v5 offset:0
    buffer_load_dwordx4 v1, s[48:51], s35 offen offset:2048 sc1 lds
    v_mfma_f32_16x16x32_bf16 v[136:139], a[4:7], a[68:71], v[136:139]
    v_and_b32 v61, 7, v60
    v_lshl_add_u32 v72, v61, 2, v72
    v_mfma_f32_16x16x32_bf16 v[136:139], a[8:11], a[64:67], v[136:139]
    ds_read_b128 a[36:39], v4 offset:704
    v_add_u32 v72, 75497472, v72
    s_waitcnt lgkmcnt(11)
    v_mfma_f32_16x16x32_bf16 v[140:143], a[0:3], a[76:79], v[140:143]
    buffer_load_dwordx4 v1, s[48:51], s35 offen offset:3072 sc1 lds
    s_lshl_b32 s30, s23, 11
    v_mfma_f32_16x16x32_bf16 v[140:143], a[4:7], a[72:75], v[140:143]
    ds_read_b128 a[100:103], v5 offset:512
    v_add_u32 v73, s30, v72
    v_mfma_f32_16x16x32_bf16 v[140:143], a[8:11], a[68:71], v[140:143]
    buffer_load_dwordx2 v[84:85], v70, s[56:59], 0 offen offset:0
    buffer_load_dwordx2 v[86:87], v70, s[56:59], 0 offen offset:32
    v_mfma_f32_16x16x32_bf16 v[140:143], a[12:15], a[64:67], v[140:143]
    ds_read_b128 a[40:43], v4 offset:1216
    s_add_u32 m0, s22, 116736
    s_add_u32 s35, s31, 24576
    s_waitcnt lgkmcnt(11)
    v_mfma_f32_16x16x32_bf16 v[144:147], a[0:3], a[80:83], v[144:147]
    buffer_load_dword v92, v72, s[48:51], 0 offen sc1
    buffer_load_dwordx2 v[88:89], v71, s[56:59], 0 offen offset:0
    v_mfma_f32_16x16x32_bf16 v[144:147], a[4:7], a[76:79], v[144:147]
    ds_read_b128 a[104:107], v5 offset:1024
    buffer_load_dwordx2 v[90:91], v71, s[56:59], 0 offen offset:32
    v_mfma_f32_16x16x32_bf16 v[144:147], a[8:11], a[72:75], v[144:147]
    buffer_load_dword v93, v73, s[48:51], 0 offen sc1
    v_mfma_f32_16x16x32_bf16 v[144:147], a[12:15], a[68:71], v[144:147]
    ds_read_b128 a[44:47], v4 offset:1728
    buffer_load_dwordx4 v1, s[48:51], s35 offen offset:0 sc1 lds
    v_mfma_f32_16x16x32_bf16 v[144:147], a[16:19], a[64:67], v[144:147]
    s_waitcnt lgkmcnt(11)
    v_mfma_f32_16x16x32_bf16 v[148:151], a[0:3], a[84:87], v[148:151]
    ds_read_b128 a[108:111], v5 offset:1536
    v_mfma_f32_16x16x32_bf16 v[148:151], a[4:7], a[80:83], v[148:151]
    buffer_load_dwordx4 v1, s[48:51], s35 offen offset:1024 sc1 lds
    v_mfma_f32_16x16x32_bf16 v[148:151], a[8:11], a[76:79], v[148:151]
    ds_read_b128 a[48:51], v4 offset:2240
    v_mfma_f32_16x16x32_bf16 v[148:151], a[12:15], a[72:75], v[148:151]
    v_mfma_f32_16x16x32_bf16 v[148:151], a[16:19], a[68:71], v[148:151]
    ds_read_b128 a[112:115], v5 offset:2048
    buffer_load_dwordx4 v1, s[48:51], s35 offen offset:2048 sc1 lds
    v_mfma_f32_16x16x32_bf16 v[148:151], a[20:23], a[64:67], v[148:151]
    s_waitcnt lgkmcnt(12)
    v_mfma_f32_16x16x32_bf16 v[152:155], a[0:3], a[88:91], v[152:155]
    ds_read_b128 a[52:55], v4 offset:2752
    v_mfma_f32_16x16x32_bf16 v[152:155], a[4:7], a[84:87], v[152:155]
    buffer_load_dwordx4 v1, s[48:51], s35 offen offset:3072 sc1 lds
    v_mfma_f32_16x16x32_bf16 v[152:155], a[8:11], a[80:83], v[152:155]
    ds_read_b128 a[116:119], v5 offset:2560
    v_mfma_f32_16x16x32_bf16 v[152:155], a[12:15], a[76:79], v[152:155]
    v_mfma_f32_16x16x32_bf16 v[152:155], a[16:19], a[72:75], v[152:155]
    ds_read_b128 a[56:59], v4 offset:3264
    s_add_u32 s52, s34, 24576
    v_mfma_f32_16x16x32_bf16 v[152:155], a[20:23], a[68:71], v[152:155]
    v_mfma_f32_16x16x32_bf16 v[152:155], a[24:27], a[64:67], v[152:155]
    ds_read_b128 a[120:123], v5 offset:3072
    s_waitcnt lgkmcnt(14)
    v_mfma_f32_16x16x32_bf16 v[156:159], a[0:3], a[92:95], v[156:159]
    buffer_load_dwordx4 a[224:227], v1, s[48:51], s52 offen offset:0 sc1
    v_mfma_f32_16x16x32_bf16 v[156:159], a[4:7], a[88:91], v[156:159]
    ds_read_b128 a[60:63], v4 offset:3776
    v_mfma_f32_16x16x32_bf16 v[156:159], a[8:11], a[84:87], v[156:159]
    v_mfma_f32_16x16x32_bf16 v[156:159], a[12:15], a[80:83], v[156:159]
    ds_read_b128 a[124:127], v5 offset:3584
    buffer_load_dwordx4 a[228:231], v1, s[48:51], s52 offen offset:1024 sc1
    v_mfma_f32_16x16x32_bf16 v[156:159], a[16:19], a[76:79], v[156:159]
    v_mfma_f32_16x16x32_bf16 v[156:159], a[20:23], a[72:75], v[156:159]
    v_mfma_f32_16x16x32_bf16 v[156:159], a[24:27], a[68:71], v[156:159]
    v_mfma_f32_16x16x32_bf16 v[156:159], a[28:31], a[64:67], v[156:159]
    buffer_load_dwordx4 a[232:235], v1, s[48:51], s52 offen offset:2048 sc1
    s_waitcnt lgkmcnt(14)
    v_mfma_f32_16x16x32_bf16 v[128:131], a[32:35], a[96:99], v[128:131]
    s_waitcnt lgkmcnt(12)
    v_mfma_f32_16x16x32_bf16 v[132:135], a[32:35], a[100:103], v[132:135]
    ds_read_b64 v[16:17], v8 offset:0
    v_mfma_f32_16x16x32_bf16 v[132:135], a[36:39], a[96:99], v[132:135]
    buffer_load_dwordx4 a[236:239], v1, s[48:51], s52 offen offset:3072 sc1
    s_waitcnt lgkmcnt(11)
    v_mfma_f32_16x16x32_bf16 v[136:139], a[32:35], a[104:107], v[136:139]
    ds_read_b64 v[18:19], v8 offset:512
    v_mfma_f32_16x16x32_bf16 v[136:139], a[36:39], a[100:103], v[136:139]
    v_mfma_f32_16x16x32_bf16 v[136:139], a[40:43], a[96:99], v[136:139]
    ds_read_b64 v[20:21], v8 offset:1024
    s_add_u32 s52, s34, 28672
    s_waitcnt lgkmcnt(11)
    v_mfma_f32_16x16x32_bf16 v[140:143], a[32:35], a[108:111], v[140:143]
    v_mfma_f32_16x16x32_bf16 v[140:143], a[36:39], a[104:107], v[140:143]
    ds_read_b64 v[22:23], v8 offset:1536
    v_mfma_f32_16x16x32_bf16 v[140:143], a[40:43], a[100:103], v[140:143]
    buffer_load_dwordx4 a[240:243], v1, s[48:51], s52 offen offset:0 sc1
    v_mfma_f32_16x16x32_bf16 v[140:143], a[44:47], a[96:99], v[140:143]
    s_waitcnt lgkmcnt(10)
    v_mfma_f32_16x16x32_bf16 v[144:147], a[32:35], a[112:115], v[144:147]
    v_mfma_f32_16x16x32_bf16 v[144:147], a[36:39], a[108:111], v[144:147]
    buffer_load_dwordx4 a[244:247], v1, s[48:51], s52 offen offset:1024 sc1
    v_mfma_f32_16x16x32_bf16 v[144:147], a[40:43], a[104:107], v[144:147]
    v_mfma_f32_16x16x32_bf16 v[144:147], a[44:47], a[100:103], v[144:147]
    v_mfma_f32_16x16x32_bf16 v[144:147], a[48:51], a[96:99], v[144:147]
    buffer_load_dwordx4 a[248:251], v1, s[48:51], s52 offen offset:2048 sc1
    s_waitcnt lgkmcnt(8)
    v_mfma_f32_16x16x32_bf16 v[148:151], a[32:35], a[116:119], v[148:151]
    v_mfma_f32_16x16x32_bf16 v[148:151], a[36:39], a[112:115], v[148:151]
    s_waitcnt lgkmcnt(0)
    v_and_b32 v32, 0xffff0000, v17
    v_lshlrev_b32 v33, 16, v17
    v_mfma_f32_16x16x32_bf16 v[148:151], a[40:43], a[108:111], v[148:151]
    buffer_load_dwordx4 a[252:255], v1, s[48:51], s52 offen offset:3072 sc1
    v_and_b32 v34, 0xffff0000, v16
    v_mfma_f32_16x16x32_bf16 v[148:151], a[44:47], a[104:107], v[148:151]
    v_lshlrev_b32 v35, 16, v16
    v_and_b32 v36, 0xffff0000, v19
    v_mfma_f32_16x16x32_bf16 v[148:151], a[48:51], a[100:103], v[148:151]
    buffer_load_dword v94, v75, s[48:51], s27 offen sc1
    v_mfma_f32_16x16x32_bf16 v[148:151], a[52:55], a[96:99], v[148:151]
    v_lshlrev_b32 v37, 16, v19
    v_and_b32 v38, 0xffff0000, v18
    v_mfma_f32_16x16x32_bf16 v[152:155], a[32:35], a[120:123], v[152:155]
    v_lshlrev_b32 v39, 16, v18
    v_and_b32 v40, 0xffff0000, v21
    v_mfma_f32_16x16x32_bf16 v[152:155], a[36:39], a[116:119], v[152:155]
    v_lshlrev_b32 v41, 16, v21
    v_and_b32 v42, 0xffff0000, v20
    v_mfma_f32_16x16x32_bf16 v[152:155], a[40:43], a[112:115], v[152:155]
    v_lshlrev_b32 v43, 16, v20
    v_and_b32 v44, 0xffff0000, v23
    v_mfma_f32_16x16x32_bf16 v[152:155], a[44:47], a[108:111], v[152:155]
    v_lshlrev_b32 v45, 16, v23
    v_and_b32 v46, 0xffff0000, v22
    v_mfma_f32_16x16x32_bf16 v[152:155], a[48:51], a[104:107], v[152:155]
    v_lshlrev_b32 v47, 16, v22
    v_mfma_f32_16x16x32_bf16 v[152:155], a[52:55], a[100:103], v[152:155]
    v_mfma_f32_16x16x32_bf16 v[152:155], a[56:59], a[96:99], v[152:155]
    v_mfma_f32_16x16x32_bf16 v[156:159], a[32:35], a[124:127], v[156:159]
    v_mfma_f32_16x16x32_bf16 v[156:159], a[36:39], a[120:123], v[156:159]
    v_mfma_f32_16x16x32_bf16 v[156:159], a[40:43], a[116:119], v[156:159]
    v_mfma_f32_16x16x32_bf16 v[156:159], a[44:47], a[112:115], v[156:159]
    v_mfma_f32_16x16x32_bf16 v[156:159], a[48:51], a[108:111], v[156:159]
    v_mfma_f32_16x16x32_bf16 v[156:159], a[52:55], a[104:107], v[156:159]
    v_mfma_f32_16x16x32_bf16 v[156:159], a[56:59], a[100:103], v[156:159]
    v_mfma_f32_16x16x32_bf16 v[156:159], a[60:63], a[96:99], v[156:159]
    s_waitcnt vmcnt(0)
    v_cmp_gt_u32 vcc, 1, v94
    s_and_b64 vcc, vcc, s[18:19]
    s_cbranch_scc1 GM_POLL5
GM_PB5:
    s_nop 3
    s_cmp_eq_u32 s8, 0
    s_cbranch_scc0 K2_CV1
    ds_write_b128 v12, v[144:147] offset:0
    ds_write_b128 v12, v[148:151] offset:1024
    ds_write_b128 v12, v[152:155] offset:2048
    ds_write_b128 v12, v[156:159] offset:3072
    v_fma_f32 v32, s9, v32, v128
    v_fma_f32 v33, s9, v33, v129
    v_fma_f32 v34, s9, v34, v130
    v_fma_f32 v35, s9, v35, v131
    v_fma_f32 v36, s9, v36, v132
    v_fma_f32 v37, s9, v37, v133
    v_fma_f32 v38, s9, v38, v134
    v_fma_f32 v39, s9, v39, v135
    v_fma_f32 v40, s9, v40, v136
    v_fma_f32 v41, s9, v41, v137
    v_fma_f32 v42, s9, v42, v138
    v_fma_f32 v43, s9, v43, v139
    v_fma_f32 v44, s9, v44, v140
    v_fma_f32 v45, s9, v45, v141
    v_fma_f32 v46, s9, v46, v142
    v_fma_f32 v47, s9, v47, v143
    s_branch K2_CV2
K2_CV1:
    ds_write_b128 v12, v[128:131] offset:0
    ds_write_b128 v12, v[132:135] offset:1024
    ds_write_b128 v12, v[136:139] offset:2048
    ds_write_b128 v12, v[140:143] offset:3072
    v_fma_f32 v32, s9, v32, v144
    v_fma_f32 v33, s9, v33, v145
    v_fma_f32 v34, s9, v34, v146
    v_fma_f32 v35, s9, v35, v147
    v_fma_f32 v36, s9, v36, v148
    v_fma_f32 v37, s9, v37, v149
    v_fma_f32 v38, s9, v38, v150
    v_fma_f32 v39, s9, v39, v151
    v_fma_f32 v40, s9, v40, v152
    v_fma_f32 v41, s9, v41, v153
    v_fma_f32 v42, s9, v42, v154
    v_fma_f32 v43, s9, v43, v155
    v_fma_f32 v44, s9, v44, v156
    v_fma_f32 v45, s9, v45, v157
    v_fma_f32 v46, s9, v46, v158
    v_fma_f32 v47, s9, v47, v159
K2_CV2:
    s_waitcnt lgkmcnt(0)
    s_barrier
    ds_read_b128 v[16:19], v11 offset:0
    ds_read_b128 v[20:23], v11 offset:1024
    ds_read_b128 v[24:27], v11 offset:2048
    ds_read_b128 v[28:31], v11 offset:3072
    s_add_u32 s36, s39, 0
    buffer_load_dwordx4 a[0:3], v1, s[48:51], s36 offen offset:0 sc1
    buffer_load_dwordx4 a[4:7], v1, s[48:51], s36 offen offset:1024 sc1
    buffer_load_dwordx4 a[8:11], v1, s[48:51], s36 offen offset:2048 sc1
    buffer_load_dwordx4 a[12:15], v1, s[48:51], s36 offen offset:3072 sc1
    s_add_u32 s36, s39, 4096
    buffer_load_dwordx4 a[16:19], v1, s[48:51], s36 offen offset:0 sc1
    buffer_load_dwordx4 a[20:23], v1, s[48:51], s36 offen offset:1024 sc1
    buffer_load_dwordx4 a[24:27], v1, s[48:51], s36 offen offset:2048 sc1
    buffer_load_dwordx4 a[28:31], v1, s[48:51], s36 offen offset:3072 sc1
    s_add_u32 s36, s39, 8192
    buffer_load_dwordx4 a[32:35], v1, s[48:51], s36 offen offset:0 sc1
    buffer_load_dwordx4 a[36:39], v1, s[48:51], s36 offen offset:1024 sc1
    s_waitcnt lgkmcnt(0)
    v_add_f32 v32, v32, v16
    v_add_f32 v33, v33, v17
    v_add_f32 v34, v34, v18
    v_add_f32 v35, v35, v19
    v_cvt_pk_bf16_f32 v48, v32, v33
    v_cvt_pk_bf16_f32 v49, v34, v35
    buffer_store_dwordx2 v[48:49], v13, s[48:51], s10 offen offset:0 sc1
    v_add_f32 v36, v36, v20
    v_add_f32 v37, v37, v21
    v_add_f32 v38, v38, v22
    v_add_f32 v39, v39, v23
    v_cvt_pk_bf16_f32 v50, v36, v37
    v_cvt_pk_bf16_f32 v51, v38, v39
    buffer_store_dwordx2 v[50:51], v13, s[48:51], s10 offen offset:512 sc1
    v_add_f32 v40, v40, v24
    v_add_f32 v41, v41, v25
    v_add_f32 v42, v42, v26
    v_add_f32 v43, v43, v27
    v_cvt_pk_bf16_f32 v52, v40, v41
    v_cvt_pk_bf16_f32 v53, v42, v43
    buffer_store_dwordx2 v[52:53], v13, s[48:51], s10 offen offset:1024 sc1
    v_add_f32 v44, v44, v28
    v_add_f32 v45, v45, v29
    v_add_f32 v46, v46, v30
    v_add_f32 v47, v47, v31
    v_cvt_pk_bf16_f32 v54, v44, v45
    v_cvt_pk_bf16_f32 v55, v46, v47
    buffer_store_dwordx2 v[54:55], v13, s[48:51], s10 offen offset:1536 sc1
    ds_read_b128 v[96:99], v66 offset:0
    ds_read_b128 v[100:103], v66 offset:2048
    ds_read_b128 v[104:107], v66 offset:4096
    ds_read_b128 v[108:111], v66 offset:6144
    ds_read_b128 v[112:115], v66 offset:1024
    ds_read_b128 v[116:119], v66 offset:3072
    ds_read_b128 v[120:123], v66 offset:5120
    ds_read_b128 v[124:127], v66 offset:7168
    s_waitcnt vmcnt(10) lgkmcnt(4)
    v_mfma_f32_16x16x32_bf16 v[160:163], v[96:99], a[160:163], 0
    ds_read_b128 v[128:131], v66 offset:8192
    buffer_load_dwordx4 a[40:43], v1, s[48:51], s36 offen offset:2048 sc1
    v_mfma_f32_16x16x32_bf16 v[160:163], v[100:103], a[164:167], v[160:163]
    s_lshl_b32 s6, s25, 4
    s_add_u32 s6, s6, s24
    v_mfma_f32_16x16x32_bf16 v[160:163], v[104:107], a[168:171], v[160:163]
    ds_read_b128 v[132:135], v66 offset:10240
    s_mul_i32 s7, s6, 196608
    v_mfma_f32_16x16x32_bf16 v[160:163], v[108:111], a[172:175], v[160:163]
    s_add_u32 s7, s7, s22
    s_add_u32 s7, s7, 4194304
    v_mfma_f32_16x16x32_bf16 v[168:171], v[96:99], a[0:3], 0
    ds_read_b128 v[136:139], v66 offset:12288
    s_mul_i32 s8, s26, 49152
    v_mfma_f32_16x16x32_bf16 v[168:171], v[100:103], a[4:7], v[168:171]
    s_add_u32 m0, s22, 0
    s_add_u32 s35, s31, 32768
    s_add_u32 s40, s7, s8
    v_mfma_f32_16x16x32_bf16 v[168:171], v[104:107], a[8:11], v[168:171]
    ds_read_b128 v[140:143], v66 offset:14336
    v_and_b32 v60, 7, v0
    v_mfma_f32_16x16x32_bf16 v[168:171], v[108:111], a[12:15], v[168:171]
    buffer_load_dwordx4 v1, s[48:51], s35 offen offset:0 sc1 lds
    v_bfe_u32 v61, v0, 3, 1
    s_waitcnt lgkmcnt(4)
    v_mfma_f32_16x16x32_bf16 v[164:167], v[112:115], a[160:163], 0
    ds_read_b128 v[96:99], v66 offset:9216
    buffer_load_dwordx4 a[44:47], v1, s[48:51], s36 offen offset:3072 sc1
    v_mfma_f32_16x16x32_bf16 v[164:167], v[116:119], a[164:167], v[164:167]
    v_lshl_add_u32 v60, v60, 3, v61
    v_lshl_add_u32 v77, v60, 10, v76
    v_mfma_f32_16x16x32_bf16 v[164:167], v[120:123], a[168:171], v[164:167]
    ds_read_b128 v[100:103], v66 offset:11264
    s_and_b32 s6, s2, 0xc0
    v_mfma_f32_16x16x32_bf16 v[164:167], v[124:127], a[172:175], v[164:167]
    s_bfe_u32 s8, s2, 0x20004
    s_lshl_b32 s8, s8, 1
    v_mfma_f32_16x16x32_bf16 v[172:175], v[112:115], a[0:3], 0
    ds_read_b128 v[104:107], v66 offset:13312
    s_or_b32 s6, s6, s8
    v_mfma_f32_16x16x32_bf16 v[172:175], v[116:119], a[4:7], v[172:175]
    buffer_load_dwordx4 v1, s[48:51], s35 offen offset:1024 sc1 lds
    s_lshl_b32 s6, s6, 10
    v_mfma_f32_16x16x32_bf16 v[172:175], v[120:123], a[8:11], v[172:175]
    ds_read_b128 v[108:111], v66 offset:15360
    s_and_b32 s8, s2, 15
    v_mfma_f32_16x16x32_bf16 v[172:175], v[124:127], a[12:15], v[172:175]
    buffer_load_dwordx4 v1, s[48:51], s35 offen offset:2048 sc1 lds
    s_lshl_b32 s8, s8, 2
    s_waitcnt lgkmcnt(4)
    v_mfma_f32_16x16x32_bf16 v[176:179], v[128:131], a[160:163], 0
    ds_read_b128 v[112:115], v66 offset:16384
    s_add_u32 s36, s39, 12288
    v_mfma_f32_16x16x32_bf16 v[176:179], v[132:135], a[164:167], v[176:179]
    s_add_u32 s6, s6, s8
    s_add_u32 s13, s6, 75563008
    v_mfma_f32_16x16x32_bf16 v[176:179], v[136:139], a[168:171], v[176:179]
    ds_read_b128 v[116:119], v66 offset:18432
    buffer_load_dwordx4 a[48:51], v1, s[48:51], s36 offen offset:0 sc1
    v_mfma_f32_16x16x32_bf16 v[176:179], v[140:143], a[172:175], v[176:179]
    v_and_b32 v60, 3, v0
    v_min_u32 v60, 2, v60
    v_mfma_f32_16x16x32_bf16 v[184:187], v[128:131], a[0:3], 0
    ds_read_b128 v[120:123], v66 offset:20480
    s_lshl_b32 s6, s3, 7
    v_mfma_f32_16x16x32_bf16 v[184:187], v[132:135], a[4:7], v[184:187]
    buffer_load_dwordx4 v1, s[48:51], s35 offen offset:3072 sc1 lds
    v_lshl_add_u32 v79, v60, 2, s6
    v_mfma_f32_16x16x32_bf16 v[184:187], v[136:139], a[8:11], v[184:187]
    ds_read_b128 v[124:127], v66 offset:22528
    s_add_u32 s8, s26, 1
    v_mfma_f32_16x16x32_bf16 v[184:187], v[140:143], a[12:15], v[184:187]
    s_add_u32 m0, s22, 16384
    s_add_u32 s35, s31, 40960
    v_add_u32 v61, s8, v60
    s_waitcnt lgkmcnt(4)
    v_mfma_f32_16x16x32_bf16 v[180:183], v[96:99], a[160:163], 0
    ds_read_b128 v[128:131], v66 offset:17408
    buffer_load_dwordx4 a[52:55], v1, s[48:51], s36 offen offset:1024 sc1
    v_mfma_f32_16x16x32_bf16 v[180:183], v[100:103], a[164:167], v[180:183]
    v_and_b32 v61, 3, v61
    v_lshlrev_b32 v61, 11, v61
    v_mfma_f32_16x16x32_bf16 v[180:183], v[104:107], a[168:171], v[180:183]
    ds_read_b128 v[132:135], v66 offset:19456
    v_sub_u32 v60, 2, v60
    v_mfma_f32_16x16x32_bf16 v[180:183], v[108:111], a[172:175], v[180:183]
    v_lshl_add_u32 v80, v60, 2, v61
    s_mov_b64 s[14:15], -1
    v_mfma_f32_16x16x32_bf16 v[188:191], v[96:99], a[0:3], 0
    ds_read_b128 v[136:139], v66 offset:21504
    s_andn2_b32 s8, s2, 6
    v_mfma_f32_16x16x32_bf16 v[188:191], v[100:103], a[4:7], v[188:191]
    buffer_load_dwordx4 v1, s[48:51], s35 offen offset:0 sc1 lds
    s_lshl_b32 s8, s8, 10
    v_mfma_f32_16x16x32_bf16 v[188:191], v[104:107], a[8:11], v[188:191]
    ds_read_b128 v[140:143], v66 offset:23552
    s_add_u32 s8, s8, s6
    v_mfma_f32_16x16x32_bf16 v[188:191], v[108:111], a[12:15], v[188:191]
    buffer_load_dwordx4 v1, s[48:51], s35 offen offset:1024 sc1 lds
    s_add_u32 s41, s8, 75563008
    s_waitcnt vmcnt(16) lgkmcnt(4)
    v_mfma_f32_16x16x32_bf16 v[160:163], v[112:115], a[176:179], v[160:163]
    ds_read_b128 v[96:99], v66 offset:24576
    buffer_load_dwordx4 a[56:59], v1, s[48:51], s36 offen offset:2048 sc1
    v_mfma_f32_16x16x32_bf16 v[160:163], v[116:119], a[180:183], v[160:163]
    s_add_u32 s8, s26, 1
    s_and_b32 s8, s8, 3
    v_mfma_f32_16x16x32_bf16 v[160:163], v[120:123], a[184:187], v[160:163]
    ds_read_b128 v[100:103], v66 offset:26624
    s_mul_i32 s8, s8, 49152
    v_mfma_f32_16x16x32_bf16 v[160:163], v[124:127], a[188:191], v[160:163]
    s_add_u32 s8, s8, 32768
    s_add_u32 s9, s7, s8
    v_mfma_f32_16x16x32_bf16 v[168:171], v[112:115], a[16:19], v[168:171]
    ds_read_b128 v[104:107], v66 offset:28672
    s_add_u32 s8, s26, 2
    v_mfma_f32_16x16x32_bf16 v[168:171], v[116:119], a[20:23], v[168:171]
    buffer_load_dwordx4 v1, s[48:51], s35 offen offset:2048 sc1 lds
    s_and_b32 s8, s8, 3
    v_mfma_f32_16x16x32_bf16 v[168:171], v[120:123], a[24:27], v[168:171]
    ds_read_b128 v[108:111], v66 offset:30720
    s_mul_i32 s8, s8, 49152
    v_mfma_f32_16x16x32_bf16 v[168:171], v[124:127], a[28:31], v[168:171]
    buffer_load_dwordx4 v1, s[48:51], s35 offen offset:3072 sc1 lds
    s_add_u32 s8, s8, 16384
    s_waitcnt lgkmcnt(4)
    v_mfma_f32_16x16x32_bf16 v[164:167], v[128:131], a[176:179], v[164:167]
    ds_read_b128 v[112:115], v66 offset:25600
    buffer_load_dwordx4 a[60:63], v1, s[48:51], s36 offen offset:3072 sc1
    v_mfma_f32_16x16x32_bf16 v[164:167], v[132:135], a[180:183], v[164:167]
    s_add_u32 s10, s7, s8
    s_add_u32 s8, s26, 3
    v_mfma_f32_16x16x32_bf16 v[164:167], v[136:139], a[184:187], v[164:167]
    ds_read_b128 v[116:119], v66 offset:27648
    s_and_b32 s8, s8, 3
    v_mfma_f32_16x16x32_bf16 v[164:167], v[140:143], a[188:191], v[164:167]
    s_mul_i32 s8, s8, 49152
    s_add_u32 s8, s8, 0
    v_mfma_f32_16x16x32_bf16 v[172:175], v[128:131], a[16:19], v[172:175]
    ds_read_b128 v[120:123], v66 offset:29696
    s_add_u32 s11, s7, s8
    v_mfma_f32_16x16x32_bf16 v[172:175], v[132:135], a[20:23], v[172:175]
    s_add_u32 m0, s22, 32768
    s_add_u32 s35, s31, 49152
    v_mfma_f32_16x16x32_bf16 v[172:175], v[136:139], a[24:27], v[172:175]
    ds_read_b128 v[124:127], v66 offset:31744
    v_mfma_f32_16x16x32_bf16 v[172:175], v[140:143], a[28:31], v[172:175]
    buffer_load_dwordx4 v1, s[48:51], s35 offen offset:0 sc1 lds
    s_waitcnt lgkmcnt(4)
    v_mfma_f32_16x16x32_bf16 v[176:179], v[96:99], a[176:179], v[176:179]
    ds_read_b128 v[128:131], v66 offset:32768
    s_add_u32 s36, s39, 16384
    v_mfma_f32_16x16x32_bf16 v[176:179], v[100:103], a[180:183], v[176:179]
    v_mfma_f32_16x16x32_bf16 v[176:179], v[104:107], a[184:187], v[176:179]
    ds_read_b128 v[132:135], v66 offset:34816
    buffer_load_dwordx4 a[64:67], v1, s[48:51], s36 offen offset:0 sc1
    v_mfma_f32_16x16x32_bf16 v[176:179], v[108:111], a[188:191], v[176:179]
    v_mfma_f32_16x16x32_bf16 v[184:187], v[96:99], a[16:19], v[184:187]
    ds_read_b128 v[136:139], v66 offset:36864
    v_mfma_f32_16x16x32_bf16 v[184:187], v[100:103], a[20:23], v[184:187]
    buffer_load_dwordx4 v1, s[48:51], s35 offen offset:1024 sc1 lds
    v_mfma_f32_16x16x32_bf16 v[184:187], v[104:107], a[24:27], v[184:187]
    ds_read_b128 v[140:143], v66 offset:38912
    v_mfma_f32_16x16x32_bf16 v[184:187], v[108:111], a[28:31], v[184:187]
    buffer_load_dwordx4 v1, s[48:51], s35 offen offset:2048 sc1 lds
    s_waitcnt lgkmcnt(4)
    v_mfma_f32_16x16x32_bf16 v[180:183], v[112:115], a[176:179], v[180:183]
    ds_read_b128 v[96:99], v66 offset:33792
    buffer_load_dwordx4 a[68:71], v1, s[48:51], s36 offen offset:1024 sc1
    v_mfma_f32_16x16x32_bf16 v[180:183], v[116:119], a[180:183], v[180:183]
    v_mfma_f32_16x16x32_bf16 v[180:183], v[120:123], a[184:187], v[180:183]
    ds_read_b128 v[100:103], v66 offset:35840
    v_mfma_f32_16x16x32_bf16 v[180:183], v[124:127], a[188:191], v[180:183]
    v_mfma_f32_16x16x32_bf16 v[188:191], v[112:115], a[16:19], v[188:191]
    ds_read_b128 v[104:107], v66 offset:37888
    v_mfma_f32_16x16x32_bf16 v[188:191], v[116:119], a[20:23], v[188:191]
    buffer_load_dwordx4 v1, s[48:51], s35 offen offset:3072 sc1 lds
    v_mfma_f32_16x16x32_bf16 v[188:191], v[120:123], a[24:27], v[188:191]
    ds_read_b128 v[108:111], v66 offset:39936
    v_mfma_f32_16x16x32_bf16 v[188:191], v[124:127], a[28:31], v[188:191]
    s_add_u32 m0, s22, 49152
    s_add_u32 s35, s31, 57344
    s_waitcnt vmcnt(17) lgkmcnt(4)
    v_mfma_f32_16x16x32_bf16 v[160:163], v[128:131], a[192:195], v[160:163]
    ds_read_b128 v[112:115], v66 offset:40960
    buffer_load_dwordx4 a[72:75], v1, s[48:51], s36 offen offset:2048 sc1
    v_mfma_f32_16x16x32_bf16 v[160:163], v[132:135], a[196:199], v[160:163]
    v_mfma_f32_16x16x32_bf16 v[160:163], v[136:139], a[200:203], v[160:163]
    ds_read_b128 v[116:119], v66 offset:43008
    v_mfma_f32_16x16x32_bf16 v[160:163], v[140:143], a[204:207], v[160:163]
    v_mfma_f32_16x16x32_bf16 v[168:171], v[128:131], a[32:35], v[168:171]
    ds_read_b128 v[120:123], v66 offset:45056
    v_mfma_f32_16x16x32_bf16 v[168:171], v[132:135], a[36:39], v[168:171]
    buffer_load_dwordx4 v1, s[48:51], s35 offen offset:0 sc1 lds
    v_mfma_f32_16x16x32_bf16 v[168:171], v[136:139], a[40:43], v[168:171]
    ds_read_b128 v[124:127], v66 offset:47104
    v_mfma_f32_16x16x32_bf16 v[168:171], v[140:143], a[44:47], v[168:171]
    buffer_load_dwordx4 v1, s[48:51], s35 offen offset:1024 sc1 lds
    s_waitcnt lgkmcnt(4)
    v_mfma_f32_16x16x32_bf16 v[164:167], v[96:99], a[192:195], v[164:167]
    ds_read_b128 v[128:131], v66 offset:41984
    buffer_load_dwordx4 a[76:79], v1, s[48:51], s36 offen offset:3072 sc1
    v_mfma_f32_16x16x32_bf16 v[164:167], v[100:103], a[196:199], v[164:167]
    v_mfma_f32_16x16x32_bf16 v[164:167], v[104:107], a[200:203], v[164:167]
    ds_read_b128 v[132:135], v66 offset:44032
    v_mfma_f32_16x16x32_bf16 v[164:167], v[108:111], a[204:207], v[164:167]
    v_mfma_f32_16x16x32_bf16 v[172:175], v[96:99], a[32:35], v[172:175]
    ds_read_b128 v[136:139], v66 offset:46080
    v_mfma_f32_16x16x32_bf16 v[172:175], v[100:103], a[36:39], v[172:175]
    buffer_load_dwordx4 v1, s[48:51], s35 offen offset:2048 sc1 lds
    v_mfma_f32_16x16x32_bf16 v[172:175], v[104:107], a[40:43], v[172:175]
    ds_read_b128 v[140:143], v66 offset:48128
    v_mfma_f32_16x16x32_bf16 v[172:175], v[108:111], a[44:47], v[172:175]
    buffer_load_dwordx4 v1, s[48:51], s35 offen offset:3072 sc1 lds
    s_waitcnt lgkmcnt(4)
    v_mfma_f32_16x16x32_bf16 v[176:179], v[112:115], a[192:195], v[176:179]
    ds_read_b128 v[96:99], v66 offset:49152
    s_add_u32 s36, s39, 20480
    v_mfma_f32_16x16x32_bf16 v[176:179], v[116:119], a[196:199], v[176:179]
    v_mfma_f32_16x16x32_bf16 v[176:179], v[120:123], a[200:203], v[176:179]
    ds_read_b128 v[100:103], v66 offset:51200
    buffer_load_dwordx4 a[80:83], v1, s[48:51], s36 offen offset:0 sc1
    v_mfma_f32_16x16x32_bf16 v[176:179], v[124:127], a[204:207], v[176:179]
    v_mfma_f32_16x16x32_bf16 v[184:187], v[112:115], a[32:35], v[184:187]
    ds_read_b128 v[104:107], v66 offset:53248
    v_mfma_f32_16x16x32_bf16 v[184:187], v[116:119], a[36:39], v[184:187]
    v_mfma_f32_16x16x32_bf16 v[184:187], v[120:123], a[40:43], v[184:187]
    ds_read_b128 v[108:111], v66 offset:55296
    v_mfma_f32_16x16x32_bf16 v[184:187], v[124:127], a[44:47], v[184:187]
    s_waitcnt lgkmcnt(4)
    v_mfma_f32_16x16x32_bf16 v[180:183], v[128:131], a[192:195], v[180:183]
    ds_read_b128 v[112:115], v66 offset:50176
    buffer_load_dwordx4 a[84:87], v1, s[48:51], s36 offen offset:1024 sc1
    v_mfma_f32_16x16x32_bf16 v[180:183], v[132:135], a[196:199], v[180:183]
    v_mfma_f32_16x16x32_bf16 v[180:183], v[136:139], a[200:203], v[180:183]
    ds_read_b128 v[116:119], v66 offset:52224
    v_mfma_f32_16x16x32_bf16 v[180:183], v[140:143], a[204:207], v[180:183]
    v_mfma_f32_16x16x32_bf16 v[188:191], v[128:131], a[32:35], v[188:191]
    ds_read_b128 v[120:123], v66 offset:54272
    v_mfma_f32_16x16x32_bf16 v[188:191], v[132:135], a[36:39], v[188:191]
    v_mfma_f32_16x16x32_bf16 v[188:191], v[136:139], a[40:43], v[188:191]
    ds_read_b128 v[124:127], v66 offset:56320
    v_mfma_f32_16x16x32_bf16 v[188:191], v[140:143], a[44:47], v[188:191]
    s_waitcnt vmcnt(14) lgkmcnt(4)
    v_mfma_f32_16x16x32_bf16 v[160:163], v[96:99], a[208:211], v[160:163]
    ds_read_b128 v[128:131], v66 offset:57344
    buffer_load_dwordx4 a[88:91], v1, s[48:51], s36 offen offset:2048 sc1
    v_mfma_f32_16x16x32_bf16 v[160:163], v[100:103], a[212:215], v[160:163]
    v_mfma_f32_16x16x32_bf16 v[160:163], v[104:107], a[216:219], v[160:163]
    ds_read_b128 v[132:135], v66 offset:59392
    v_mfma_f32_16x16x32_bf16 v[160:163], v[108:111], a[220:223], v[160:163]
    v_mfma_f32_16x16x32_bf16 v[168:171], v[96:99], a[48:51], v[168:171]
    ds_read_b128 v[136:139], v66 offset:61440
    v_mfma_f32_16x16x32_bf16 v[168:171], v[100:103], a[52:55], v[168:171]
    v_mfma_f32_16x16x32_bf16 v[168:171], v[104:107], a[56:59], v[168:171]
    ds_read_b128 v[140:143], v66 offset:63488
    v_mfma_f32_16x16x32_bf16 v[168:171], v[108:111], a[60:63], v[168:171]
    s_waitcnt lgkmcnt(4)
    v_mfma_f32_16x16x32_bf16 v[164:167], v[112:115], a[208:211], v[164:167]
    ds_read_b128 v[96:99], v66 offset:58368
    buffer_load_dwordx4 a[92:95], v1, s[48:51], s36 offen offset:3072 sc1
    v_mfma_f32_16x16x32_bf16 v[164:167], v[116:119], a[212:215], v[164:167]
    v_mfma_f32_16x16x32_bf16 v[164:167], v[120:123], a[216:219], v[164:167]
    ds_read_b128 v[100:103], v66 offset:60416
    v_mfma_f32_16x16x32_bf16 v[164:167], v[124:127], a[220:223], v[164:167]
    v_mfma_f32_16x16x32_bf16 v[172:175], v[112:115], a[48:51], v[172:175]
    ds_read_b128 v[104:107], v66 offset:62464
    v_mfma_f32_16x16x32_bf16 v[172:175], v[116:119], a[52:55], v[172:175]
    v_mfma_f32_16x16x32_bf16 v[172:175], v[120:123], a[56:59], v[172:175]
    ds_read_b128 v[108:111], v66 offset:64512
    v_mfma_f32_16x16x32_bf16 v[172:175], v[124:127], a[60:63], v[172:175]
    s_waitcnt lgkmcnt(4)
    v_mfma_f32_16x16x32_bf16 v[176:179], v[128:131], a[208:211], v[176:179]
    s_barrier
    v_mov_b32 v94, 1
    s_mov_b64 exec, 65535
    buffer_store_dword v94, v77, s[48:51], s13 offen offset:64 sc1
    s_mov_b64 exec, -1
    ds_read_b128 v[112:115], v1 offset:0
    s_add_u32 s36, s39, 24576
    v_mfma_f32_16x16x32_bf16 v[176:179], v[132:135], a[212:215], v[176:179]
    v_mfma_f32_16x16x32_bf16 v[176:179], v[136:139], a[216:219], v[176:179]
    ds_read_b128 v[116:119], v1 offset:2048
    buffer_load_dwordx4 a[96:99], v1, s[48:51], s36 offen offset:0 sc1
    v_mfma_f32_16x16x32_bf16 v[176:179], v[140:143], a[220:223], v[176:179]
    v_mfma_f32_16x16x32_bf16 v[184:187], v[128:131], a[48:51], v[184:187]
    ds_read_b128 v[120:123], v1 offset:4096
    v_mfma_f32_16x16x32_bf16 v[184:187], v[132:135], a[52:55], v[184:187]
    s_add_u32 m0, s22, 67584
    s_add_u32 s35, s32, 0
    v_mfma_f32_16x16x32_bf16 v[184:187], v[136:139], a[56:59], v[184:187]
    ds_read_b128 v[124:127], v1 offset:6144
    v_mfma_f32_16x16x32_bf16 v[184:187], v[140:143], a[60:63], v[184:187]
    buffer_load_dwordx4 v1, s[48:51], s35 offen offset:0 sc1 lds
    s_waitcnt lgkmcnt(4)
    v_mfma_f32_16x16x32_bf16 v[180:183], v[96:99], a[208:211], v[180:183]
    ds_read_b128 v[128:131], v1 offset:1024
    buffer_load_dwordx4 a[100:103], v1, s[48:51], s36 offen offset:1024 sc1
    v_mfma_f32_16x16x32_bf16 v[180:183], v[100:103], a[212:215], v[180:183]
    v_mfma_f32_16x16x32_bf16 v[180:183], v[104:107], a[216:219], v[180:183]
    ds_read_b128 v[132:135], v1 offset:3072
    v_mfma_f32_16x16x32_bf16 v[180:183], v[108:111], a[220:223], v[180:183]
    v_mfma_f32_16x16x32_bf16 v[188:191], v[96:99], a[48:51], v[188:191]
    ds_read_b128 v[136:139], v1 offset:5120
    v_mfma_f32_16x16x32_bf16 v[188:191], v[100:103], a[52:55], v[188:191]
    buffer_load_dwordx4 v1, s[48:51], s35 offen offset:1024 sc1 lds
    v_mfma_f32_16x16x32_bf16 v[188:191], v[104:107], a[56:59], v[188:191]
    ds_read_b128 v[140:143], v1 offset:7168
    v_mfma_f32_16x16x32_bf16 v[188:191], v[108:111], a[60:63], v[188:191]
    buffer_load_dwordx4 v1, s[48:51], s35 offen offset:2048 sc1 lds
    s_waitcnt vmcnt(12) lgkmcnt(4)
    v_mfma_f32_16x16x32_bf16 v[160:163], v[112:115], a[128:131], v[160:163]
    ds_read_b128 v[96:99], v1 offset:8192
    buffer_load_dwordx4 a[104:107], v1, s[48:51], s36 offen offset:2048 sc1
    v_mfma_f32_16x16x32_bf16 v[160:163], v[116:119], a[132:135], v[160:163]
    v_mfma_f32_16x16x32_bf16 v[160:163], v[120:123], a[136:139], v[160:163]
    ds_read_b128 v[100:103], v1 offset:10240
    v_mfma_f32_16x16x32_bf16 v[160:163], v[124:127], a[140:143], v[160:163]
    v_mfma_f32_16x16x32_bf16 v[168:171], v[112:115], a[64:67], v[168:171]
    ds_read_b128 v[104:107], v1 offset:12288
    v_mfma_f32_16x16x32_bf16 v[168:171], v[116:119], a[68:71], v[168:171]
    buffer_load_dwordx4 v1, s[48:51], s35 offen offset:3072 sc1 lds
    v_mfma_f32_16x16x32_bf16 v[168:171], v[120:123], a[72:75], v[168:171]
    ds_read_b128 v[108:111], v1 offset:14336
    v_mfma_f32_16x16x32_bf16 v[168:171], v[124:127], a[76:79], v[168:171]
    s_add_u32 m0, s22, 83968
    s_add_u32 s35, s32, 16384
    s_waitcnt lgkmcnt(4)
    v_mfma_f32_16x16x32_bf16 v[164:167], v[128:131], a[128:131], v[164:167]
    ds_read_b128 v[112:115], v1 offset:9216
    buffer_load_dwordx4 a[108:111], v1, s[48:51], s36 offen offset:3072 sc1
    v_mfma_f32_16x16x32_bf16 v[164:167], v[132:135], a[132:135], v[164:167]
    v_mfma_f32_16x16x32_bf16 v[164:167], v[136:139], a[136:139], v[164:167]
    ds_read_b128 v[116:119], v1 offset:11264
    v_mfma_f32_16x16x32_bf16 v[164:167], v[140:143], a[140:143], v[164:167]
    v_mfma_f32_16x16x32_bf16 v[172:175], v[128:131], a[64:67], v[172:175]
    ds_read_b128 v[120:123], v1 offset:13312
    v_mfma_f32_16x16x32_bf16 v[172:175], v[132:135], a[68:71], v[172:175]
    buffer_load_dwordx4 v1, s[48:51], s35 offen offset:0 sc1 lds
    v_mfma_f32_16x16x32_bf16 v[172:175], v[136:139], a[72:75], v[172:175]
    ds_read_b128 v[124:127], v1 offset:15360
    v_mfma_f32_16x16x32_bf16 v[172:175], v[140:143], a[76:79], v[172:175]
    buffer_load_dwordx4 v1, s[48:51], s35 offen offset:1024 sc1 lds
    s_waitcnt lgkmcnt(4)
    v_mfma_f32_16x16x32_bf16 v[176:179], v[96:99], a[128:131], v[176:179]
    ds_read_b128 v[128:131], v1 offset:16384
    s_add_u32 s36, s39, 28672
    v_mfma_f32_16x16x32_bf16 v[176:179], v[100:103], a[132:135], v[176:179]
    v_mfma_f32_16x16x32_bf16 v[176:179], v[104:107], a[136:139], v[176:179]
    ds_read_b128 v[132:135], v1 offset:18432
    buffer_load_dwordx4 a[112:115], v1, s[48:51], s36 offen offset:0 sc1
    v_mfma_f32_16x16x32_bf16 v[176:179], v[108:111], a[140:143], v[176:179]
    v_mfma_f32_16x16x32_bf16 v[184:187], v[96:99], a[64:67], v[184:187]
    ds_read_b128 v[136:139], v1 offset:20480
    v_mfma_f32_16x16x32_bf16 v[184:187], v[100:103], a[68:71], v[184:187]
    buffer_load_dwordx4 v1, s[48:51], s35 offen offset:2048 sc1 lds
    v_mfma_f32_16x16x32_bf16 v[184:187], v[104:107], a[72:75], v[184:187]
    ds_read_b128 v[140:143], v1 offset:22528
    v_mfma_f32_16x16x32_bf16 v[184:187], v[108:111], a[76:79], v[184:187]
    buffer_load_dwordx4 v1, s[48:51], s35 offen offset:3072 sc1 lds
    s_waitcnt lgkmcnt(4)
    v_mfma_f32_16x16x32_bf16 v[180:183], v[112:115], a[128:131], v[180:183]
    ds_read_b128 v[96:99], v1 offset:17408
    buffer_load_dwordx4 a[116:119], v1, s[48:51], s36 offen offset:1024 sc1
    v_mfma_f32_16x16x32_bf16 v[180:183], v[116:119], a[132:135], v[180:183]
    v_mfma_f32_16x16x32_bf16 v[180:183], v[120:123], a[136:139], v[180:183]
    ds_read_b128 v[100:103], v1 offset:19456
    v_mfma_f32_16x16x32_bf16 v[180:183], v[124:127], a[140:143], v[180:183]
    v_mfma_f32_16x16x32_bf16 v[188:191], v[112:115], a[64:67], v[188:191]
    ds_read_b128 v[104:107], v1 offset:21504
    v_mfma_f32_16x16x32_bf16 v[188:191], v[116:119], a[68:71], v[188:191]
    v_mfma_f32_16x16x32_bf16 v[188:191], v[120:123], a[72:75], v[188:191]
    ds_read_b128 v[108:111], v1 offset:23552
    v_mfma_f32_16x16x32_bf16 v[188:191], v[124:127], a[76:79], v[188:191]
    s_waitcnt vmcnt(15) lgkmcnt(4)
    v_mfma_f32_16x16x32_bf16 v[160:163], v[128:131], a[144:147], v[160:163]
    ds_read_b128 v[112:115], v1 offset:24576
    buffer_load_dwordx4 a[120:123], v1, s[48:51], s36 offen offset:2048 sc1
    v_mfma_f32_16x16x32_bf16 v[160:163], v[132:135], a[148:151], v[160:163]
    v_mfma_f32_16x16x32_bf16 v[160:163], v[136:139], a[152:155], v[160:163]
    ds_read_b128 v[116:119], v1 offset:26624
    v_mfma_f32_16x16x32_bf16 v[160:163], v[140:143], a[156:159], v[160:163]
    v_mfma_f32_16x16x32_bf16 v[168:171], v[128:131], a[80:83], v[168:171]
    ds_read_b128 v[120:123], v1 offset:28672
    v_mfma_f32_16x16x32_bf16 v[168:171], v[132:135], a[84:87], v[168:171]
    v_mfma_f32_16x16x32_bf16 v[168:171], v[136:139], a[88:91], v[168:171]
    ds_read_b128 v[124:127], v1 offset:30720
    v_mfma_f32_16x16x32_bf16 v[168:171], v[140:143], a[92:95], v[168:171]
    s_waitcnt lgkmcnt(4)
    v_mfma_f32_16x16x32_bf16 v[164:167], v[96:99], a[144:147], v[164:167]
    ds_read_b128 v[128:131], v1 offset:25600
    buffer_load_dwordx4 a[124:127], v1, s[48:51], s36 offen offset:3072 sc1
    v_mfma_f32_16x16x32_bf16 v[164:167], v[100:103], a[148:151], v[164:167]
    v_mfma_f32_16x16x32_bf16 v[164:167], v[104:107], a[152:155], v[164:167]
    ds_read_b128 v[132:135], v1 offset:27648
    v_mfma_f32_16x16x32_bf16 v[164:167], v[108:111], a[156:159], v[164:167]
    v_mfma_f32_16x16x32_bf16 v[172:175], v[96:99], a[80:83], v[172:175]
    ds_read_b128 v[136:139], v1 offset:29696
    v_mfma_f32_16x16x32_bf16 v[172:175], v[100:103], a[84:87], v[172:175]
    v_mfma_f32_16x16x32_bf16 v[172:175], v[104:107], a[88:91], v[172:175]
    ds_read_b128 v[140:143], v1 offset:31744
    v_mfma_f32_16x16x32_bf16 v[172:175], v[108:111], a[92:95], v[172:175]
    s_waitcnt lgkmcnt(4)
    v_mfma_f32_16x16x32_bf16 v[176:179], v[112:115], a[144:147], v[176:179]
    s_barrier
    ds_read_b128 v[96:99], v1 offset:32768
    v_mfma_f32_16x16x32_bf16 v[176:179], v[116:119], a[148:151], v[176:179]
    s_add_u32 m0, s22, 100352
    s_add_u32 s35, s32, 32768
    v_mfma_f32_16x16x32_bf16 v[176:179], v[120:123], a[152:155], v[176:179]
    ds_read_b128 v[100:103], v1 offset:34816
    v_mfma_f32_16x16x32_bf16 v[176:179], v[124:127], a[156:159], v[176:179]
    buffer_load_dwordx4 v1, s[48:51], s35 offen offset:0 sc1 lds
    v_mfma_f32_16x16x32_bf16 v[184:187], v[112:115], a[80:83], v[184:187]
    ds_read_b128 v[104:107], v1 offset:36864
    v_mfma_f32_16x16x32_bf16 v[184:187], v[116:119], a[84:87], v[184:187]
    buffer_load_dwordx4 v1, s[48:51], s35 offen offset:1024 sc1 lds
    v_mfma_f32_16x16x32_bf16 v[184:187], v[120:123], a[88:91], v[184:187]
    ds_read_b128 v[108:111], v1 offset:38912
    v_mfma_f32_16x16x32_bf16 v[184:187], v[124:127], a[92:95], v[184:187]
    buffer_load_dwordx4 v1, s[48:51], s35 offen offset:2048 sc1 lds
    s_waitcnt lgkmcnt(4)
    v_mfma_f32_16x16x32_bf16 v[180:183], v[128:131], a[144:147], v[180:183]
    ds_read_b128 v[112:115], v1 offset:33792
    v_mfma_f32_16x16x32_bf16 v[180:183], v[132:135], a[148:151], v[180:183]
    buffer_load_dwordx4 v1, s[48:51], s35 offen offset:3072 sc1 lds
    v_mfma_f32_16x16x32_bf16 v[180:183], v[136:139], a[152:155], v[180:183]
    ds_read_b128 v[116:119], v1 offset:35840
    v_mfma_f32_16x16x32_bf16 v[180:183], v[140:143], a[156:159], v[180:183]
    s_add_u32 m0, s22, 116736
    s_add_u32 s35, s32, 49152
    v_mfma_f32_16x16x32_bf16 v[188:191], v[128:131], a[80:83], v[188:191]
    ds_read_b128 v[120:123], v1 offset:37888
    v_mfma_f32_16x16x32_bf16 v[188:191], v[132:135], a[84:87], v[188:191]
    buffer_load_dwordx4 v1, s[48:51], s35 offen offset:0 sc1 lds
    v_mfma_f32_16x16x32_bf16 v[188:191], v[136:139], a[88:91], v[188:191]
    ds_read_b128 v[124:127], v1 offset:39936
    v_mfma_f32_16x16x32_bf16 v[188:191], v[140:143], a[92:95], v[188:191]
    buffer_load_dwordx4 v1, s[48:51], s35 offen offset:1024 sc1 lds
    s_waitcnt vmcnt(14) lgkmcnt(4)
    v_mfma_f32_16x16x32_bf16 v[160:163], v[96:99], a[224:227], v[160:163]
    ds_read_b128 v[128:131], v1 offset:40960
    v_mfma_f32_16x16x32_bf16 v[160:163], v[100:103], a[228:231], v[160:163]
    buffer_load_dwordx4 v1, s[48:51], s35 offen offset:2048 sc1 lds
    v_mfma_f32_16x16x32_bf16 v[160:163], v[104:107], a[232:235], v[160:163]
    ds_read_b128 v[132:135], v1 offset:43008
    v_mfma_f32_16x16x32_bf16 v[160:163], v[108:111], a[236:239], v[160:163]
    buffer_load_dwordx4 v1, s[48:51], s35 offen offset:3072 sc1 lds
    v_mfma_f32_16x16x32_bf16 v[168:171], v[96:99], a[96:99], v[168:171]
    ds_read_b128 v[136:139], v1 offset:45056
    v_mfma_f32_16x16x32_bf16 v[168:171], v[100:103], a[100:103], v[168:171]
    v_mfma_f32_16x16x32_bf16 v[168:171], v[104:107], a[104:107], v[168:171]
    ds_read_b128 v[140:143], v1 offset:47104
    v_mfma_f32_16x16x32_bf16 v[168:171], v[108:111], a[108:111], v[168:171]
    s_waitcnt lgkmcnt(4)
    v_mfma_f32_16x16x32_bf16 v[164:167], v[112:115], a[224:227], v[164:167]
    ds_read_b128 v[96:99], v1 offset:41984
    v_mfma_f32_16x16x32_bf16 v[164:167], v[116:119], a[228:231], v[164:167]
    v_mfma_f32_16x16x32_bf16 v[164:167], v[120:123], a[232:235], v[164:167]
    ds_read_b128 v[100:103], v1 offset:44032
    v_mfma_f32_16x16x32_bf16 v[164:167], v[124:127], a[236:239], v[164:167]
    v_mfma_f32_16x16x32_bf16 v[172:175], v[112:115], a[96:99], v[172:175]
    ds_read_b128 v[104:107], v1 offset:46080
    v_mfma_f32_16x16x32_bf16 v[172:175], v[116:119], a[100:103], v[172:175]
    v_mfma_f32_16x16x32_bf16 v[172:175], v[120:123], a[104:107], v[172:175]
    ds_read_b128 v[108:111], v1 offset:48128
    v_mfma_f32_16x16x32_bf16 v[172:175], v[124:127], a[108:111], v[172:175]
    s_waitcnt lgkmcnt(4)
    v_mfma_f32_16x16x32_bf16 v[176:179], v[128:131], a[224:227], v[176:179]
    ds_read_b128 v[112:115], v1 offset:49152
    v_mfma_f32_16x16x32_bf16 v[176:179], v[132:135], a[228:231], v[176:179]
    v_mfma_f32_16x16x32_bf16 v[176:179], v[136:139], a[232:235], v[176:179]
    ds_read_b128 v[116:119], v1 offset:51200
    v_mfma_f32_16x16x32_bf16 v[176:179], v[140:143], a[236:239], v[176:179]
    v_mfma_f32_16x16x32_bf16 v[184:187], v[128:131], a[96:99], v[184:187]
    ds_read_b128 v[120:123], v1 offset:53248
    v_mfma_f32_16x16x32_bf16 v[184:187], v[132:135], a[100:103], v[184:187]
    v_mfma_f32_16x16x32_bf16 v[184:187], v[136:139], a[104:107], v[184:187]
    ds_read_b128 v[124:127], v1 offset:55296
    v_mfma_f32_16x16x32_bf16 v[184:187], v[140:143], a[108:111], v[184:187]
    s_waitcnt lgkmcnt(4)
    v_mfma_f32_16x16x32_bf16 v[180:183], v[96:99], a[224:227], v[180:183]
    ds_read_b128 v[128:131], v1 offset:50176
    v_mfma_f32_16x16x32_bf16 v[180:183], v[100:103], a[228:231], v[180:183]
    v_mfma_f32_16x16x32_bf16 v[180:183], v[104:107], a[232:235], v[180:183]
    ds_read_b128 v[132:135], v1 offset:52224
    v_mfma_f32_16x16x32_bf16 v[180:183], v[108:111], a[236:239], v[180:183]
    v_mfma_f32_16x16x32_bf16 v[188:191], v[96:99], a[96:99], v[188:191]
    ds_read_b128 v[136:139], v1 offset:54272
    v_mfma_f32_16x16x32_bf16 v[188:191], v[100:103], a[100:103], v[188:191]
    v_mfma_f32_16x16x32_bf16 v[188:191], v[104:107], a[104:107], v[188:191]
    ds_read_b128 v[140:143], v1 offset:56320
    v_mfma_f32_16x16x32_bf16 v[188:191], v[108:111], a[108:111], v[188:191]
    s_waitcnt vmcnt(8) lgkmcnt(4)
    v_mfma_f32_16x16x32_bf16 v[160:163], v[112:115], a[240:243], v[160:163]
    ds_read_b128 v[96:99], v1 offset:57344
    v_mfma_f32_16x16x32_bf16 v[160:163], v[116:119], a[244:247], v[160:163]
    v_mfma_f32_16x16x32_bf16 v[160:163], v[120:123], a[248:251], v[160:163]
    ds_read_b128 v[100:103], v1 offset:59392
    v_mfma_f32_16x16x32_bf16 v[160:163], v[124:127], a[252:255], v[160:163]
    v_mfma_f32_16x16x32_bf16 v[168:171], v[112:115], a[112:115], v[168:171]
    ds_read_b128 v[104:107], v1 offset:61440
    v_mfma_f32_16x16x32_bf16 v[168:171], v[116:119], a[116:119], v[168:171]
    v_mfma_f32_16x16x32_bf16 v[168:171], v[120:123], a[120:123], v[168:171]
    ds_read_b128 v[108:111], v1 offset:63488
    v_mfma_f32_16x16x32_bf16 v[168:171], v[124:127], a[124:127], v[168:171]
    s_waitcnt lgkmcnt(4)
    v_mfma_f32_16x16x32_bf16 v[164:167], v[128:131], a[240:243], v[164:167]
    ds_read_b128 v[112:115], v1 offset:58368
    v_mfma_f32_16x16x32_bf16 v[164:167], v[132:135], a[244:247], v[164:167]
    v_mfma_f32_16x16x32_bf16 v[164:167], v[136:139], a[248:251], v[164:167]
    ds_read_b128 v[116:119], v1 offset:60416
    v_mfma_f32_16x16x32_bf16 v[164:167], v[140:143], a[252:255], v[164:167]
    v_mfma_f32_16x16x32_bf16 v[172:175], v[128:131], a[112:115], v[172:175]
    ds_read_b128 v[120:123], v1 offset:62464
    v_mfma_f32_16x16x32_bf16 v[172:175], v[132:135], a[116:119], v[172:175]
    v_mfma_f32_16x16x32_bf16 v[172:175], v[136:139], a[120:123], v[172:175]
    ds_read_b128 v[124:127], v1 offset:64512
    v_mfma_f32_16x16x32_bf16 v[172:175], v[140:143], a[124:127], v[172:175]
    s_waitcnt lgkmcnt(4)
    v_mfma_f32_16x16x32_bf16 v[176:179], v[96:99], a[240:243], v[176:179]
    s_barrier
    ds_read_b128 v[128:131], v66 offset:0
    v_mfma_f32_16x16x32_bf16 v[176:179], v[100:103], a[244:247], v[176:179]
    s_add_u32 m0, s22, 0
    s_add_u32 s35, s33, 0
    v_mfma_f32_16x16x32_bf16 v[176:179], v[104:107], a[248:251], v[176:179]
    ds_read_b128 v[132:135], v66 offset:2048
    v_mfma_f32_16x16x32_bf16 v[176:179], v[108:111], a[252:255], v[176:179]
    buffer_load_dwordx4 v1, s[48:51], s35 offen offset:0 sc1 lds
    v_mfma_f32_16x16x32_bf16 v[184:187], v[96:99], a[112:115], v[184:187]
    ds_read_b128 v[136:139], v66 offset:4096
    v_mfma_f32_16x16x32_bf16 v[184:187], v[100:103], a[116:119], v[184:187]
    buffer_load_dwordx4 v1, s[48:51], s35 offen offset:1024 sc1 lds
    v_mfma_f32_16x16x32_bf16 v[184:187], v[104:107], a[120:123], v[184:187]
    ds_read_b128 v[140:143], v66 offset:6144
    v_mfma_f32_16x16x32_bf16 v[184:187], v[108:111], a[124:127], v[184:187]
    buffer_load_dwordx4 v1, s[48:51], s35 offen offset:2048 sc1 lds
    s_waitcnt lgkmcnt(4)
    v_mfma_f32_16x16x32_bf16 v[180:183], v[112:115], a[240:243], v[180:183]
    ds_read_b128 v[96:99], v66 offset:1024
    v_mfma_f32_16x16x32_bf16 v[180:183], v[116:119], a[244:247], v[180:183]
    buffer_load_dwordx4 v1, s[48:51], s35 offen offset:3072 sc1 lds
    v_mfma_f32_16x16x32_bf16 v[180:183], v[120:123], a[248:251], v[180:183]
    ds_read_b128 v[100:103], v66 offset:3072
    v_mfma_f32_16x16x32_bf16 v[180:183], v[124:127], a[252:255], v[180:183]
    s_add_u32 m0, s22, 16384
    s_add_u32 s35, s33, 16384
    v_mfma_f32_16x16x32_bf16 v[188:191], v[112:115], a[112:115], v[188:191]
    ds_read_b128 v[104:107], v66 offset:5120
    v_mfma_f32_16x16x32_bf16 v[188:191], v[116:119], a[116:119], v[188:191]
    buffer_load_dwordx4 v1, s[48:51], s35 offen offset:0 sc1 lds
    v_mfma_f32_16x16x32_bf16 v[188:191], v[120:123], a[120:123], v[188:191]
    ds_read_b128 v[108:111], v66 offset:7168
    v_mfma_f32_16x16x32_bf16 v[188:191], v[124:127], a[124:127], v[188:191]
    buffer_load_dwordx4 v1, s[48:51], s35 offen offset:1024 sc1 lds
    s_waitcnt lgkmcnt(4)
    v_mfma_f32_16x16x32_bf16 v[192:195], v[128:131], a[160:163], 0
    ds_read_b128 v[112:115], v66 offset:8192
    v_mfma_f32_16x16x32_bf16 v[192:195], v[132:135], a[164:167], v[192:195]
    buffer_load_dwordx4 v1, s[48:51], s35 offen offset:2048 sc1 lds
    v_mfma_f32_16x16x32_bf16 v[192:195], v[136:139], a[168:171], v[192:195]
    ds_read_b128 v[116:119], v66 offset:10240
    v_mfma_f32_16x16x32_bf16 v[192:195], v[140:143], a[172:175], v[192:195]
    buffer_load_dwordx4 v1, s[48:51], s35 offen offset:3072 sc1 lds
    v_mfma_f32_16x16x32_bf16 v[200:203], v[128:131], a[0:3], 0
    ds_read_b128 v[120:123], v66 offset:12288
    v_mfma_f32_16x16x32_bf16 v[200:203], v[132:135], a[4:7], v[200:203]
    buffer_load_dword v94, v78, s[48:51], s27 offen offset:64 sc1
    v_mfma_f32_16x16x32_bf16 v[200:203], v[136:139], a[8:11], v[200:203]
    ds_read_b128 v[124:127], v66 offset:14336
    v_mfma_f32_16x16x32_bf16 v[200:203], v[140:143], a[12:15], v[200:203]
    s_waitcnt lgkmcnt(4)
    v_mfma_f32_16x16x32_bf16 v[196:199], v[96:99], a[160:163], 0
    ds_read_b128 v[128:131], v66 offset:9216
    v_mfma_f32_16x16x32_bf16 v[196:199], v[100:103], a[164:167], v[196:199]
    v_mfma_f32_16x16x32_bf16 v[196:199], v[104:107], a[168:171], v[196:199]
    ds_read_b128 v[132:135], v66 offset:11264
    buffer_store_dwordx4 v[160:163], v1, s[48:51], s9 offen offset:0 sc1
    v_mfma_f32_16x16x32_bf16 v[196:199], v[108:111], a[172:175], v[196:199]
    v_mfma_f32_16x16x32_bf16 v[204:207], v[96:99], a[0:3], 0
    ds_read_b128 v[136:139], v66 offset:13312
    v_mfma_f32_16x16x32_bf16 v[204:207], v[100:103], a[4:7], v[204:207]
    v_mfma_f32_16x16x32_bf16 v[204:207], v[104:107], a[8:11], v[204:207]
    ds_read_b128 v[140:143], v66 offset:15360
    v_mfma_f32_16x16x32_bf16 v[204:207], v[108:111], a[12:15], v[204:207]
    s_waitcnt lgkmcnt(4)
    v_mfma_f32_16x16x32_bf16 v[192:195], v[112:115], a[176:179], v[192:195]
    ds_read_b128 v[96:99], v66 offset:16384
    v_mfma_f32_16x16x32_bf16 v[192:195], v[116:119], a[180:183], v[192:195]
    v_mfma_f32_16x16x32_bf16 v[192:195], v[120:123], a[184:187], v[192:195]
    ds_read_b128 v[100:103], v66 offset:18432
    buffer_store_dwordx4 v[164:167], v1, s[48:51], s9 offen offset:1024 sc1
    v_mfma_f32_16x16x32_bf16 v[192:195], v[124:127], a[188:191], v[192:195]
    v_mfma_f32_16x16x32_bf16 v[200:203], v[112:115], a[16:19], v[200:203]
    ds_read_b128 v[104:107], v66 offset:20480
    v_mfma_f32_16x16x32_bf16 v[200:203], v[116:119], a[20:23], v[200:203]
    v_mfma_f32_16x16x32_bf16 v[200:203], v[120:123], a[24:27], v[200:203]
    ds_read_b128 v[108:111], v66 offset:22528
    v_mfma_f32_16x16x32_bf16 v[200:203], v[124:127], a[28:31], v[200:203]
    s_waitcnt lgkmcnt(4)
    v_mfma_f32_16x16x32_bf16 v[196:199], v[128:131], a[176:179], v[196:199]
    ds_read_b128 v[112:115], v66 offset:17408
    v_mfma_f32_16x16x32_bf16 v[196:199], v[132:135], a[180:183], v[196:199]
    v_mfma_f32_16x16x32_bf16 v[196:199], v[136:139], a[184:187], v[196:199]
    ds_read_b128 v[116:119], v66 offset:19456
    buffer_store_dwordx4 v[168:171], v1, s[48:51], s9 offen offset:2048 sc1
    v_mfma_f32_16x16x32_bf16 v[196:199], v[140:143], a[188:191], v[196:199]
    v_mfma_f32_16x16x32_bf16 v[204:207], v[128:131], a[16:19], v[204:207]
    ds_read_b128 v[120:123], v66 offset:21504
    v_mfma_f32_16x16x32_bf16 v[204:207], v[132:135], a[20:23], v[204:207]
    v_mfma_f32_16x16x32_bf16 v[204:207], v[136:139], a[24:27], v[204:207]
    ds_read_b128 v[124:127], v66 offset:23552
    v_mfma_f32_16x16x32_bf16 v[204:207], v[140:143], a[28:31], v[204:207]
    s_waitcnt lgkmcnt(4)
    v_mfma_f32_16x16x32_bf16 v[192:195], v[96:99], a[192:195], v[192:195]
    ds_read_b128 v[128:131], v66 offset:24576
    v_mfma_f32_16x16x32_bf16 v[192:195], v[100:103], a[196:199], v[192:195]
    v_mfma_f32_16x16x32_bf16 v[192:195], v[104:107], a[200:203], v[192:195]
    ds_read_b128 v[132:135], v66 offset:26624
    buffer_store_dwordx4 v[172:175], v1, s[48:51], s9 offen offset:3072 sc1
    v_mfma_f32_16x16x32_bf16 v[192:195], v[108:111], a[204:207], v[192:195]
    v_mfma_f32_16x16x32_bf16 v[200:203], v[96:99], a[32:35], v[200:203]
    ds_read_b128 v[136:139], v66 offset:28672
    v_mfma_f32_16x16x32_bf16 v[200:203], v[100:103], a[36:39], v[200:203]
    v_mfma_f32_16x16x32_bf16 v[200:203], v[104:107], a[40:43], v[200:203]
    ds_read_b128 v[140:143], v66 offset:30720
    v_mfma_f32_16x16x32_bf16 v[200:203], v[108:111], a[44:47], v[200:203]
    s_waitcnt lgkmcnt(4)
    v_mfma_f32_16x16x32_bf16 v[196:199], v[112:115], a[192:195], v[196:199]
    ds_read_b128 v[96:99], v66 offset:25600
    v_mfma_f32_16x16x32_bf16 v[196:199], v[116:119], a[196:199], v[196:199]
    v_mfma_f32_16x16x32_bf16 v[196:199], v[120:123], a[200:203], v[196:199]
    ds_read_b128 v[100:103], v66 offset:27648
    buffer_store_dwordx4 v[176:179], v1, s[48:51], s10 offen offset:0 sc1
    v_mfma_f32_16x16x32_bf16 v[196:199], v[124:127], a[204:207], v[196:199]
    v_mfma_f32_16x16x32_bf16 v[204:207], v[112:115], a[32:35], v[204:207]
    ds_read_b128 v[104:107], v66 offset:29696
    v_mfma_f32_16x16x32_bf16 v[204:207], v[116:119], a[36:39], v[204:207]
    v_mfma_f32_16x16x32_bf16 v[204:207], v[120:123], a[40:43], v[204:207]
    ds_read_b128 v[108:111], v66 offset:31744
    v_mfma_f32_16x16x32_bf16 v[204:207], v[124:127], a[44:47], v[204:207]
    s_waitcnt vmcnt(14) lgkmcnt(4)
    s_waitcnt vmcnt(5)
    v_cmp_gt_u32 vcc, 1, v94
    s_and_b64 vcc, vcc, s[18:19]
    s_cbranch_scc1 GM_POLL6
GM_PB6:
    v_mfma_f32_16x16x32_bf16 v[192:195], v[128:131], a[208:211], v[192:195]
    s_barrier
    ds_read_b128 v[112:115], v66 offset:32768
    v_mfma_f32_16x16x32_bf16 v[192:195], v[132:135], a[212:215], v[192:195]
    s_mov_b32 m0, s38
    s_nop 0
    buffer_load_dwordx4 v68, s[48:51], s37 offen sc1 lds
    buffer_load_dwordx4 v69, s[48:51], s37 offen offset:1024 sc1 lds
    v_mfma_f32_16x16x32_bf16 v[192:195], v[136:139], a[216:219], v[192:195]
    ds_read_b128 v[116:119], v66 offset:34816
    buffer_store_dwordx4 v[180:183], v1, s[48:51], s10 offen offset:1024 sc1
    v_mfma_f32_16x16x32_bf16 v[192:195], v[140:143], a[220:223], v[192:195]
    s_add_u32 m0, s22, 32768
    s_add_u32 s35, s33, 32768
    v_mfma_f32_16x16x32_bf16 v[200:203], v[128:131], a[48:51], v[200:203]
    ds_read_b128 v[120:123], v66 offset:36864
    v_mfma_f32_16x16x32_bf16 v[200:203], v[132:135], a[52:55], v[200:203]
    buffer_load_dwordx4 v1, s[48:51], s35 offen offset:0 sc1 lds
    v_mfma_f32_16x16x32_bf16 v[200:203], v[136:139], a[56:59], v[200:203]
    ds_read_b128 v[124:127], v66 offset:38912
    v_mfma_f32_16x16x32_bf16 v[200:203], v[140:143], a[60:63], v[200:203]
    buffer_load_dwordx4 v1, s[48:51], s35 offen offset:1024 sc1 lds
    s_waitcnt lgkmcnt(4)
    v_mfma_f32_16x16x32_bf16 v[196:199], v[96:99], a[208:211], v[196:199]
    ds_read_b128 v[128:131], v66 offset:33792
    v_mfma_f32_16x16x32_bf16 v[196:199], v[100:103], a[212:215], v[196:199]
    buffer_load_dwordx4 v1, s[48:51], s35 offen offset:2048 sc1 lds
    v_mfma_f32_16x16x32_bf16 v[196:199], v[104:107], a[216:219], v[196:199]
    ds_read_b128 v[132:135], v66 offset:35840
    buffer_store_dwordx4 v[184:187], v1, s[48:51], s10 offen offset:2048 sc1
    v_mfma_f32_16x16x32_bf16 v[196:199], v[108:111], a[220:223], v[196:199]
    buffer_load_dwordx4 v1, s[48:51], s35 offen offset:3072 sc1 lds
    v_mfma_f32_16x16x32_bf16 v[204:207], v[96:99], a[48:51], v[204:207]
    ds_read_b128 v[136:139], v66 offset:37888
    v_mfma_f32_16x16x32_bf16 v[204:207], v[100:103], a[52:55], v[204:207]
    s_add_u32 m0, s22, 49152
    s_add_u32 s35, s33, 49152
    v_mfma_f32_16x16x32_bf16 v[204:207], v[104:107], a[56:59], v[204:207]
    ds_read_b128 v[140:143], v66 offset:39936
    v_mfma_f32_16x16x32_bf16 v[204:207], v[108:111], a[60:63], v[204:207]
    buffer_load_dwordx4 v1, s[48:51], s35 offen offset:0 sc1 lds
    s_waitcnt lgkmcnt(4)
    v_mfma_f32_16x16x32_bf16 v[192:195], v[112:115], a[128:131], v[192:195]
    ds_read_b128 v[96:99], v66 offset:40960
    v_mfma_f32_16x16x32_bf16 v[192:195], v[116:119], a[132:135], v[192:195]
    buffer_load_dwordx4 v1, s[48:51], s35 offen offset:1024 sc1 lds
    v_mfma_f32_16x16x32_bf16 v[192:195], v[120:123], a[136:139], v[192:195]
    ds_read_b128 v[100:103], v66 offset:43008
    buffer_store_dwordx4 v[188:191], v1, s[48:51], s10 offen offset:3072 sc1
    v_mfma_f32_16x16x32_bf16 v[192:195], v[124:127], a[140:143], v[192:195]
    buffer_load_dwordx4 v1, s[48:51], s35 offen offset:2048 sc1 lds
    v_mfma_f32_16x16x32_bf16 v[200:203], v[112:115], a[64:67], v[200:203]
    ds_read_b128 v[104:107], v66 offset:45056
    v_mfma_f32_16x16x32_bf16 v[200:203], v[116:119], a[68:71], v[200:203]
    buffer_load_dwordx4 v1, s[48:51], s35 offen offset:3072 sc1 lds
    v_mfma_f32_16x16x32_bf16 v[200:203], v[120:123], a[72:75], v[200:203]
    ds_read_b128 v[108:111], v66 offset:47104
    v_mfma_f32_16x16x32_bf16 v[200:203], v[124:127], a[76:79], v[200:203]
    s_waitcnt lgkmcnt(4)
    v_mfma_f32_16x16x32_bf16 v[196:199], v[128:131], a[128:131], v[196:199]
    ds_read_b128 v[112:115], v66 offset:41984
    v_mfma_f32_16x16x32_bf16 v[196:199], v[132:135], a[132:135], v[196:199]
    v_mfma_f32_16x16x32_bf16 v[196:199], v[136:139], a[136:139], v[196:199]
    ds_read_b128 v[116:119], v66 offset:44032
    v_mfma_f32_16x16x32_bf16 v[196:199], v[140:143], a[140:143], v[196:199]
    v_mfma_f32_16x16x32_bf16 v[204:207], v[128:131], a[64:67], v[204:207]
    ds_read_b128 v[120:123], v66 offset:46080
    v_mfma_f32_16x16x32_bf16 v[204:207], v[132:135], a[68:71], v[204:207]
    v_mfma_f32_16x16x32_bf16 v[204:207], v[136:139], a[72:75], v[204:207]
    ds_read_b128 v[124:127], v66 offset:48128
    v_mfma_f32_16x16x32_bf16 v[204:207], v[140:143], a[76:79], v[204:207]
    s_waitcnt lgkmcnt(4)
    v_mfma_f32_16x16x32_bf16 v[192:195], v[96:99], a[144:147], v[192:195]
    ds_read_b128 v[128:131], v66 offset:49152
    v_mfma_f32_16x16x32_bf16 v[192:195], v[100:103], a[148:151], v[192:195]
    v_mfma_f32_16x16x32_bf16 v[192:195], v[104:107], a[152:155], v[192:195]
    ds_read_b128 v[132:135], v66 offset:51200
    v_mfma_f32_16x16x32_bf16 v[192:195], v[108:111], a[156:159], v[192:195]
    v_mfma_f32_16x16x32_bf16 v[200:203], v[96:99], a[80:83], v[200:203]
    ds_read_b128 v[136:139], v66 offset:53248
    v_mfma_f32_16x16x32_bf16 v[200:203], v[100:103], a[84:87], v[200:203]
    v_mfma_f32_16x16x32_bf16 v[200:203], v[104:107], a[88:91], v[200:203]
    ds_read_b128 v[140:143], v66 offset:55296
    v_mfma_f32_16x16x32_bf16 v[200:203], v[108:111], a[92:95], v[200:203]
    s_waitcnt lgkmcnt(4)
    v_mfma_f32_16x16x32_bf16 v[196:199], v[112:115], a[144:147], v[196:199]
    ds_read_b128 v[96:99], v66 offset:50176
    v_mfma_f32_16x16x32_bf16 v[196:199], v[116:119], a[148:151], v[196:199]
    v_mfma_f32_16x16x32_bf16 v[196:199], v[120:123], a[152:155], v[196:199]
    ds_read_b128 v[100:103], v66 offset:52224
    v_mfma_f32_16x16x32_bf16 v[196:199], v[124:127], a[156:159], v[196:199]
    v_mfma_f32_16x16x32_bf16 v[204:207], v[112:115], a[80:83], v[204:207]
    ds_read_b128 v[104:107], v66 offset:54272
    v_mfma_f32_16x16x32_bf16 v[204:207], v[116:119], a[84:87], v[204:207]
    v_mfma_f32_16x16x32_bf16 v[204:207], v[120:123], a[88:91], v[204:207]
    ds_read_b128 v[108:111], v66 offset:56320
    v_mfma_f32_16x16x32_bf16 v[204:207], v[124:127], a[92:95], v[204:207]
    s_waitcnt lgkmcnt(4)
    v_mfma_f32_16x16x32_bf16 v[192:195], v[128:131], a[224:227], v[192:195]
    ds_read_b128 v[112:115], v66 offset:57344
    v_mfma_f32_16x16x32_bf16 v[192:195], v[132:135], a[228:231], v[192:195]
    v_mfma_f32_16x16x32_bf16 v[192:195], v[136:139], a[232:235], v[192:195]
    ds_read_b128 v[116:119], v66 offset:59392
    v_mfma_f32_16x16x32_bf16 v[192:195], v[140:143], a[236:239], v[192:195]
    v_mfma_f32_16x16x32_bf16 v[200:203], v[128:131], a[96:99], v[200:203]
    ds_read_b128 v[120:123], v66 offset:61440
    v_mfma_f32_16x16x32_bf16 v[200:203], v[132:135], a[100:103], v[200:203]
    v_mfma_f32_16x16x32_bf16 v[200:203], v[136:139], a[104:107], v[200:203]
    ds_read_b128 v[124:127], v66 offset:63488
    v_mfma_f32_16x16x32_bf16 v[200:203], v[140:143], a[108:111], v[200:203]
    s_waitcnt lgkmcnt(4)
    v_mfma_f32_16x16x32_bf16 v[196:199], v[96:99], a[224:227], v[196:199]
    ds_read_b128 v[128:131], v66 offset:58368
    v_mfma_f32_16x16x32_bf16 v[196:199], v[100:103], a[228:231], v[196:199]
    v_mfma_f32_16x16x32_bf16 v[196:199], v[104:107], a[232:235], v[196:199]
    ds_read_b128 v[132:135], v66 offset:60416
    v_mfma_f32_16x16x32_bf16 v[196:199], v[108:111], a[236:239], v[196:199]
    v_mfma_f32_16x16x32_bf16 v[204:207], v[96:99], a[96:99], v[204:207]
    ds_read_b128 v[136:139], v66 offset:62464
    v_mfma_f32_16x16x32_bf16 v[204:207], v[100:103], a[100:103], v[204:207]
    v_mfma_f32_16x16x32_bf16 v[204:207], v[104:107], a[104:107], v[204:207]
    ds_read_b128 v[140:143], v66 offset:64512
    v_mfma_f32_16x16x32_bf16 v[204:207], v[108:111], a[108:111], v[204:207]
    s_waitcnt vmcnt(11) lgkmcnt(4)
    v_mfma_f32_16x16x32_bf16 v[192:195], v[112:115], a[240:243], v[192:195]
    s_barrier
    ds_read_b128 v[96:99], v1 offset:0
    v_mfma_f32_16x16x32_bf16 v[192:195], v[116:119], a[244:247], v[192:195]
    v_mfma_f32_16x16x32_bf16 v[192:195], v[120:123], a[248:251], v[192:195]
    ds_read_b128 v[100:103], v1 offset:2048
    v_mfma_f32_16x16x32_bf16 v[192:195], v[124:127], a[252:255], v[192:195]
    v_mfma_f32_16x16x32_bf16 v[200:203], v[112:115], a[112:115], v[200:203]
    ds_read_b128 v[104:107], v1 offset:4096
    v_mfma_f32_16x16x32_bf16 v[200:203], v[116:119], a[116:119], v[200:203]
    v_mfma_f32_16x16x32_bf16 v[200:203], v[120:123], a[120:123], v[200:203]
    ds_read_b128 v[108:111], v1 offset:6144
    v_mfma_f32_16x16x32_bf16 v[200:203], v[124:127], a[124:127], v[200:203]
    s_waitcnt lgkmcnt(4)
    v_mfma_f32_16x16x32_bf16 v[196:199], v[128:131], a[240:243], v[196:199]
    ds_read_b128 v[112:115], v1 offset:1024
    ds_read_b64_tr_b16 v[16:17], v74 offset:0
    v_mfma_f32_16x16x32_bf16 v[196:199], v[132:135], a[244:247], v[196:199]
    ds_read_b64_tr_b16 v[18:19], v74 offset:2048
    ds_read_b64_tr_b16 v[20:21], v74 offset:4096
    v_mfma_f32_16x16x32_bf16 v[196:199], v[136:139], a[248:251], v[196:199]
    ds_read_b128 v[116:119], v1 offset:3072
    ds_read_b64_tr_b16 v[22:23], v74 offset:6144
    v_mfma_f32_16x16x32_bf16 v[196:199], v[140:143], a[252:255], v[196:199]
    v_sub_f32 v28, 1.0, v92
    v_sub_f32 v29, 1.0, v93
    v_mfma_f32_16x16x32_bf16 v[204:207], v[128:131], a[112:115], v[204:207]
    ds_read_b128 v[120:123], v1 offset:5120
    v_mfma_f32_16x16x32_bf16 v[204:207], v[132:135], a[116:119], v[204:207]
    v_mfma_f32_16x16x32_bf16 v[204:207], v[136:139], a[120:123], v[204:207]
    ds_read_b128 v[124:127], v1 offset:7168
    v_mfma_f32_16x16x32_bf16 v[204:207], v[140:143], a[124:127], v[204:207]
    s_waitcnt lgkmcnt(8)
    v_mfma_f32_16x16x32_bf16 v[208:211], v[96:99], a[160:163], 0
    ds_read_b128 v[128:131], v1 offset:8192
    s_waitcnt lgkmcnt(3)
    v_mfma_f32_16x16x32_bf16 v[208:211], v[100:103], a[164:167], v[208:211]
    v_lshlrev_b32 v30, 16, v84
    v_lshlrev_b32 v31, 16, v16
    v_mfma_f32_16x16x32_bf16 v[208:211], v[104:107], a[168:171], v[208:211]
    ds_read_b128 v[132:135], v1 offset:10240
    v_mul_f32 v30, v30, v31
    v_mfma_f32_16x16x32_bf16 v[208:211], v[108:111], a[172:175], v[208:211]
    v_mul_f32 v32, v30, v92
    v_and_b32 v30, 0xffff0000, v84
    v_mfma_f32_16x16x32_bf16 v[216:219], v[96:99], a[0:3], 0
    ds_read_b128 v[136:139], v1 offset:12288
    v_and_b32 v31, 0xffff0000, v16
    v_mfma_f32_16x16x32_bf16 v[216:219], v[100:103], a[4:7], v[216:219]
    v_mul_f32 v30, v30, v31
    v_mul_f32 v33, v30, v92
    v_mfma_f32_16x16x32_bf16 v[216:219], v[104:107], a[8:11], v[216:219]
    ds_read_b128 v[140:143], v1 offset:14336
    v_lshlrev_b32 v30, 16, v85
    v_mfma_f32_16x16x32_bf16 v[216:219], v[108:111], a[12:15], v[216:219]
    v_lshlrev_b32 v31, 16, v17
    v_mul_f32 v30, v30, v31
    s_waitcnt lgkmcnt(4)
    v_mfma_f32_16x16x32_bf16 v[212:215], v[112:115], a[160:163], 0
    ds_read_b128 v[96:99], v1 offset:9216
    buffer_store_dwordx4 v[192:195], v1, s[48:51], s11 offen offset:0 sc1
    v_mfma_f32_16x16x32_bf16 v[212:215], v[116:119], a[164:167], v[212:215]
    v_mul_f32 v34, v30, v92
    v_and_b32 v30, 0xffff0000, v85
    v_mfma_f32_16x16x32_bf16 v[212:215], v[120:123], a[168:171], v[212:215]
    ds_read_b128 v[100:103], v1 offset:11264
    buffer_store_dwordx4 v[196:199], v1, s[48:51], s11 offen offset:1024 sc1
    v_mfma_f32_16x16x32_bf16 v[212:215], v[124:127], a[172:175], v[212:215]
    v_and_b32 v31, 0xffff0000, v17
    v_mul_f32 v30, v30, v31
    v_mfma_f32_16x16x32_bf16 v[220:223], v[112:115], a[0:3], 0
    ds_read_b128 v[104:107], v1 offset:13312
    buffer_store_dwordx4 v[200:203], v1, s[48:51], s11 offen offset:2048 sc1
    v_mfma_f32_16x16x32_bf16 v[220:223], v[116:119], a[4:7], v[220:223]
    v_mul_f32 v35, v30, v92
    v_lshlrev_b32 v30, 16, v86
    v_mfma_f32_16x16x32_bf16 v[220:223], v[120:123], a[8:11], v[220:223]
    ds_read_b128 v[108:111], v1 offset:15360
    buffer_store_dwordx4 v[204:207], v1, s[48:51], s11 offen offset:3072 sc1
    v_mfma_f32_16x16x32_bf16 v[220:223], v[124:127], a[12:15], v[220:223]
    v_lshlrev_b32 v31, 16, v18
    v_mul_f32 v30, v30, v31
    s_waitcnt lgkmcnt(4)
    v_mfma_f32_16x16x32_bf16 v[208:211], v[128:131], a[176:179], v[208:211]
    ds_read_b128 v[112:115], v1 offset:16384
    v_mul_f32 v36, v30, v92
    v_mfma_f32_16x16x32_bf16 v[208:211], v[132:135], a[180:183], v[208:211]
    s_waitcnt vmcnt(6)
    v_mov_b32 v94, 1
    s_mov_b64 exec, 7
    buffer_store_dword v94, v80, s[48:51], s41 offen offset:128 sc1
    s_mov_b64 exec, -1
    v_mfma_f32_16x16x32_bf16 v[208:211], v[136:139], a[184:187], v[208:211]
    ds_read_b128 v[116:119], v1 offset:18432
    v_and_b32 v30, 0xffff0000, v86
    v_mfma_f32_16x16x32_bf16 v[208:211], v[140:143], a[188:191], v[208:211]
    v_and_b32 v31, 0xffff0000, v18
    v_mul_f32 v30, v30, v31
    v_mfma_f32_16x16x32_bf16 v[216:219], v[128:131], a[16:19], v[216:219]
    ds_read_b128 v[120:123], v1 offset:20480
    v_mul_f32 v37, v30, v92
    v_mfma_f32_16x16x32_bf16 v[216:219], v[132:135], a[20:23], v[216:219]
    v_lshlrev_b32 v30, 16, v87
    v_lshlrev_b32 v31, 16, v19
    v_mfma_f32_16x16x32_bf16 v[216:219], v[136:139], a[24:27], v[216:219]
    ds_read_b128 v[124:127], v1 offset:22528
    v_mul_f32 v30, v30, v31
    v_mfma_f32_16x16x32_bf16 v[216:219], v[140:143], a[28:31], v[216:219]
    v_mul_f32 v38, v30, v92
    v_and_b32 v30, 0xffff0000, v87
    s_waitcnt lgkmcnt(4)
    v_mfma_f32_16x16x32_bf16 v[212:215], v[96:99], a[176:179], v[212:215]
    ds_read_b128 v[128:131], v1 offset:17408
    v_and_b32 v31, 0xffff0000, v19
    v_mfma_f32_16x16x32_bf16 v[212:215], v[100:103], a[180:183], v[212:215]
    v_mul_f32 v30, v30, v31
    v_mul_f32 v39, v30, v92
    v_mfma_f32_16x16x32_bf16 v[212:215], v[104:107], a[184:187], v[212:215]
    ds_read_b128 v[132:135], v1 offset:19456
    v_lshlrev_b32 v30, 16, v88
    v_mfma_f32_16x16x32_bf16 v[212:215], v[108:111], a[188:191], v[212:215]
    v_lshlrev_b32 v31, 16, v20
    v_mul_f32 v30, v30, v31
    v_mfma_f32_16x16x32_bf16 v[220:223], v[96:99], a[16:19], v[220:223]
    ds_read_b128 v[136:139], v1 offset:21504
    v_mul_f32 v40, v30, v93
    v_mfma_f32_16x16x32_bf16 v[220:223], v[100:103], a[20:23], v[220:223]
    v_and_b32 v30, 0xffff0000, v88
    v_and_b32 v31, 0xffff0000, v20
    v_mfma_f32_16x16x32_bf16 v[220:223], v[104:107], a[24:27], v[220:223]
    ds_read_b128 v[140:143], v1 offset:23552
    v_mul_f32 v30, v30, v31
    v_mfma_f32_16x16x32_bf16 v[220:223], v[108:111], a[28:31], v[220:223]
    v_mul_f32 v41, v30, v93
    v_lshlrev_b32 v30, 16, v89
    s_waitcnt lgkmcnt(4)
    v_mfma_f32_16x16x32_bf16 v[208:211], v[112:115], a[192:195], v[208:211]
    ds_read_b128 v[96:99], v1 offset:24576
    v_lshlrev_b32 v31, 16, v21
    v_mfma_f32_16x16x32_bf16 v[208:211], v[116:119], a[196:199], v[208:211]
    v_mul_f32 v30, v30, v31
    v_mul_f32 v42, v30, v93
    v_mfma_f32_16x16x32_bf16 v[208:211], v[120:123], a[200:203], v[208:211]
    ds_read_b128 v[100:103], v1 offset:26624
    v_and_b32 v30, 0xffff0000, v89
    v_mfma_f32_16x16x32_bf16 v[208:211], v[124:127], a[204:207], v[208:211]
    v_and_b32 v31, 0xffff0000, v21
    v_mul_f32 v30, v30, v31
    v_mfma_f32_16x16x32_bf16 v[216:219], v[112:115], a[32:35], v[216:219]
    ds_read_b128 v[104:107], v1 offset:28672
    v_mul_f32 v43, v30, v93
    v_mfma_f32_16x16x32_bf16 v[216:219], v[116:119], a[36:39], v[216:219]
    v_lshlrev_b32 v30, 16, v90
    v_lshlrev_b32 v31, 16, v22
    v_mfma_f32_16x16x32_bf16 v[216:219], v[120:123], a[40:43], v[216:219]
    ds_read_b128 v[108:111], v1 offset:30720
    v_mul_f32 v30, v30, v31
    v_mfma_f32_16x16x32_bf16 v[216:219], v[124:127], a[44:47], v[216:219]
    v_mul_f32 v44, v30, v93
    v_and_b32 v30, 0xffff0000, v90
    s_waitcnt lgkmcnt(4)
    v_mfma_f32_16x16x32_bf16 v[212:215], v[128:131], a[192:195], v[212:215]
    ds_read_b128 v[112:115], v1 offset:25600
    v_and_b32 v31, 0xffff0000, v22
    v_mfma_f32_16x16x32_bf16 v[212:215], v[132:135], a[196:199], v[212:215]
    v_mul_f32 v30, v30, v31
    v_mul_f32 v45, v30, v93
    v_mfma_f32_16x16x32_bf16 v[212:215], v[136:139], a[200:203], v[212:215]
    ds_read_b128 v[116:119], v1 offset:27648
    v_lshlrev_b32 v30, 16, v91
    v_mfma_f32_16x16x32_bf16 v[212:215], v[140:143], a[204:207], v[212:215]
    buffer_load_dword v95, v79, s[48:51], s27 offen offset:128 sc1
    v_mfma_f32_16x16x32_bf16 v[220:223], v[128:131], a[32:35], v[220:223]
    ds_read_b128 v[120:123], v1 offset:29696
    v_lshlrev_b32 v31, 16, v23
    v_mfma_f32_16x16x32_bf16 v[220:223], v[132:135], a[36:39], v[220:223]
    v_mul_f32 v30, v30, v31
    v_mul_f32 v46, v30, v93
    v_mfma_f32_16x16x32_bf16 v[220:223], v[136:139], a[40:43], v[220:223]
    ds_read_b128 v[124:127], v1 offset:31744
    v_and_b32 v30, 0xffff0000, v91
    v_mfma_f32_16x16x32_bf16 v[220:223], v[140:143], a[44:47], v[220:223]
    v_and_b32 v31, 0xffff0000, v23
    v_mul_f32 v30, v30, v31
    s_waitcnt vmcnt(6) lgkmcnt(4)
    v_mfma_f32_16x16x32_bf16 v[208:211], v[96:99], a[208:211], v[208:211]
    s_barrier
    ds_read_b128 v[128:131], v1 offset:32768
    v_mul_f32 v47, v30, v93
    v_mfma_f32_16x16x32_bf16 v[208:211], v[100:103], a[212:215], v[208:211]
    v_mfma_f32_16x16x32_bf16 v[208:211], v[104:107], a[216:219], v[208:211]
    ds_read_b128 v[132:135], v1 offset:34816
    v_mfma_f32_16x16x32_bf16 v[208:211], v[108:111], a[220:223], v[208:211]
    v_mfma_f32_16x16x32_bf16 v[216:219], v[96:99], a[48:51], v[216:219]
    ds_read_b128 v[136:139], v1 offset:36864
    v_mfma_f32_16x16x32_bf16 v[216:219], v[100:103], a[52:55], v[216:219]
    v_mfma_f32_16x16x32_bf16 v[216:219], v[104:107], a[56:59], v[216:219]
    ds_read_b128 v[140:143], v1 offset:38912
    v_mfma_f32_16x16x32_bf16 v[216:219], v[108:111], a[60:63], v[216:219]
    s_waitcnt lgkmcnt(4)
    v_mfma_f32_16x16x32_bf16 v[212:215], v[112:115], a[208:211], v[212:215]
    ds_read_b128 v[96:99], v1 offset:33792
    v_mfma_f32_16x16x32_bf16 v[212:215], v[116:119], a[212:215], v[212:215]
    v_mfma_f32_16x16x32_bf16 v[212:215], v[120:123], a[216:219], v[212:215]
    ds_read_b128 v[100:103], v1 offset:35840
    v_mfma_f32_16x16x32_bf16 v[212:215], v[124:127], a[220:223], v[212:215]
    v_mfma_f32_16x16x32_bf16 v[220:223], v[112:115], a[48:51], v[220:223]
    ds_read_b128 v[104:107], v1 offset:37888
    v_mfma_f32_16x16x32_bf16 v[220:223], v[116:119], a[52:55], v[220:223]
    v_mfma_f32_16x16x32_bf16 v[220:223], v[120:123], a[56:59], v[220:223]
    ds_read_b128 v[108:111], v1 offset:39936
    v_mfma_f32_16x16x32_bf16 v[220:223], v[124:127], a[60:63], v[220:223]
    s_waitcnt lgkmcnt(4)
    v_mfma_f32_16x16x32_bf16 v[208:211], v[128:131], a[128:131], v[208:211]
    ds_read_b128 v[112:115], v1 offset:40960
    v_mfma_f32_16x16x32_bf16 v[208:211], v[132:135], a[132:135], v[208:211]
    v_mfma_f32_16x16x32_bf16 v[208:211], v[136:139], a[136:139], v[208:211]
    ds_read_b128 v[116:119], v1 offset:43008
    v_mfma_f32_16x16x32_bf16 v[208:211], v[140:143], a[140:143], v[208:211]
    v_mfma_f32_16x16x32_bf16 v[216:219], v[128:131], a[64:67], v[216:219]
    ds_read_b128 v[120:123], v1 offset:45056
    v_mfma_f32_16x16x32_bf16 v[216:219], v[132:135], a[68:71], v[216:219]
    v_mfma_f32_16x16x32_bf16 v[216:219], v[136:139], a[72:75], v[216:219]
    ds_read_b128 v[124:127], v1 offset:47104
    v_mfma_f32_16x16x32_bf16 v[216:219], v[140:143], a[76:79], v[216:219]
    s_waitcnt lgkmcnt(4)
    v_mfma_f32_16x16x32_bf16 v[212:215], v[96:99], a[128:131], v[212:215]
    ds_read_b128 v[128:131], v1 offset:41984
    v_mfma_f32_16x16x32_bf16 v[212:215], v[100:103], a[132:135], v[212:215]
    s_waitcnt vmcnt(0)
    v_cmp_gt_u32 vcc, 1, v95
    s_and_b64 vcc, vcc, s[14:15]
    s_cbranch_scc1 GM_POLL7
GM_PB7:
    v_mfma_f32_16x16x32_bf16 v[212:215], v[104:107], a[136:139], v[212:215]
    ds_read_b128 v[132:135], v1 offset:44032
    s_add_u32 s9, s40, 16384
    v_mfma_f32_16x16x32_bf16 v[212:215], v[108:111], a[140:143], v[212:215]
    s_add_u32 s10, s40, 32768
    v_mfma_f32_16x16x32_bf16 v[220:223], v[96:99], a[64:67], v[220:223]
    ds_read_b128 v[136:139], v1 offset:46080
    buffer_load_dwordx4 v[224:227], v1, s[48:51], s40 offen offset:0 sc1
    v_mfma_f32_16x16x32_bf16 v[220:223], v[100:103], a[68:71], v[220:223]
    buffer_load_dwordx4 v[240:243], v1, s[48:51], s9 offen offset:0 sc1
    v_mfma_f32_16x16x32_bf16 v[220:223], v[104:107], a[72:75], v[220:223]
    ds_read_b128 v[140:143], v1 offset:48128
    buffer_load_dwordx4 v[144:147], v1, s[48:51], s10 offen offset:0 sc1
    v_mfma_f32_16x16x32_bf16 v[220:223], v[108:111], a[76:79], v[220:223]
    buffer_load_dwordx4 v[228:231], v1, s[48:51], s40 offen offset:1024 sc1
    s_waitcnt lgkmcnt(4)
    v_mfma_f32_16x16x32_bf16 v[208:211], v[112:115], a[144:147], v[208:211]
    ds_read_b128 v[96:99], v1 offset:49152
    buffer_load_dwordx4 v[244:247], v1, s[48:51], s9 offen offset:1024 sc1
    v_mfma_f32_16x16x32_bf16 v[208:211], v[116:119], a[148:151], v[208:211]
    buffer_load_dwordx4 v[148:151], v1, s[48:51], s10 offen offset:1024 sc1
    v_mfma_f32_16x16x32_bf16 v[208:211], v[120:123], a[152:155], v[208:211]
    ds_read_b128 v[100:103], v1 offset:51200
    buffer_load_dwordx4 v[232:235], v1, s[48:51], s40 offen offset:2048 sc1
    v_mfma_f32_16x16x32_bf16 v[208:211], v[124:127], a[156:159], v[208:211]
    buffer_load_dwordx4 v[248:251], v1, s[48:51], s9 offen offset:2048 sc1
    v_mfma_f32_16x16x32_bf16 v[216:219], v[112:115], a[80:83], v[216:219]
    ds_read_b128 v[104:107], v1 offset:53248
    buffer_load_dwordx4 v[152:155], v1, s[48:51], s10 offen offset:2048 sc1
    v_mfma_f32_16x16x32_bf16 v[216:219], v[116:119], a[84:87], v[216:219]
    buffer_load_dwordx4 v[236:239], v1, s[48:51], s40 offen offset:3072 sc1
    v_mfma_f32_16x16x32_bf16 v[216:219], v[120:123], a[88:91], v[216:219]
    ds_read_b128 v[108:111], v1 offset:55296
    buffer_load_dwordx4 v[252:255], v1, s[48:51], s9 offen offset:3072 sc1
    v_mfma_f32_16x16x32_bf16 v[216:219], v[124:127], a[92:95], v[216:219]
    buffer_load_dwordx4 v[156:159], v1, s[48:51], s10 offen offset:3072 sc1
    s_waitcnt lgkmcnt(4)
    v_mfma_f32_16x16x32_bf16 v[212:215], v[128:131], a[144:147], v[212:215]
    ds_read_b128 v[112:115], v1 offset:50176
    v_mfma_f32_16x16x32_bf16 v[212:215], v[132:135], a[148:151], v[212:215]
    v_mfma_f32_16x16x32_bf16 v[212:215], v[136:139], a[152:155], v[212:215]
    ds_read_b128 v[116:119], v1 offset:52224
    v_mfma_f32_16x16x32_bf16 v[212:215], v[140:143], a[156:159], v[212:215]
    v_mfma_f32_16x16x32_bf16 v[220:223], v[128:131], a[80:83], v[220:223]
    ds_read_b128 v[120:123], v1 offset:54272
    v_mfma_f32_16x16x32_bf16 v[220:223], v[132:135], a[84:87], v[220:223]
    v_mfma_f32_16x16x32_bf16 v[220:223], v[136:139], a[88:91], v[220:223]
    ds_read_b128 v[124:127], v1 offset:56320
    v_mfma_f32_16x16x32_bf16 v[220:223], v[140:143], a[92:95], v[220:223]
    s_waitcnt lgkmcnt(4)
    v_mfma_f32_16x16x32_bf16 v[208:211], v[96:99], a[224:227], v[208:211]
    ds_read_b128 v[128:131], v1 offset:57344
    v_mfma_f32_16x16x32_bf16 v[208:211], v[100:103], a[228:231], v[208:211]
    v_mfma_f32_16x16x32_bf16 v[208:211], v[104:107], a[232:235], v[208:211]
    ds_read_b128 v[132:135], v1 offset:59392
    v_mfma_f32_16x16x32_bf16 v[208:211], v[108:111], a[236:239], v[208:211]
    v_mfma_f32_16x16x32_bf16 v[216:219], v[96:99], a[96:99], v[216:219]
    ds_read_b128 v[136:139], v1 offset:61440
    v_mfma_f32_16x16x32_bf16 v[216:219], v[100:103], a[100:103], v[216:219]
    v_mfma_f32_16x16x32_bf16 v[216:219], v[104:107], a[104:107], v[216:219]
    ds_read_b128 v[140:143], v1 offset:63488
    v_mfma_f32_16x16x32_bf16 v[216:219], v[108:111], a[108:111], v[216:219]
    s_waitcnt lgkmcnt(4)
    v_mfma_f32_16x16x32_bf16 v[212:215], v[112:115], a[224:227], v[212:215]
    ds_read_b128 v[96:99], v1 offset:58368
    v_mfma_f32_16x16x32_bf16 v[212:215], v[116:119], a[228:231], v[212:215]
    v_mfma_f32_16x16x32_bf16 v[212:215], v[120:123], a[232:235], v[212:215]
    ds_read_b128 v[100:103], v1 offset:60416
    v_mfma_f32_16x16x32_bf16 v[212:215], v[124:127], a[236:239], v[212:215]
    v_mfma_f32_16x16x32_bf16 v[220:223], v[112:115], a[96:99], v[220:223]
    ds_read_b128 v[104:107], v1 offset:62464
    v_mfma_f32_16x16x32_bf16 v[220:223], v[116:119], a[100:103], v[220:223]
    v_mfma_f32_16x16x32_bf16 v[220:223], v[120:123], a[104:107], v[220:223]
    ds_read_b128 v[108:111], v1 offset:64512
    v_mfma_f32_16x16x32_bf16 v[220:223], v[124:127], a[108:111], v[220:223]
    s_waitcnt lgkmcnt(4)
    v_mfma_f32_16x16x32_bf16 v[208:211], v[128:131], a[240:243], v[208:211]
    v_mfma_f32_16x16x32_bf16 v[208:211], v[132:135], a[244:247], v[208:211]
    v_mfma_f32_16x16x32_bf16 v[208:211], v[136:139], a[248:251], v[208:211]
    v_mfma_f32_16x16x32_bf16 v[208:211], v[140:143], a[252:255], v[208:211]
    v_mfma_f32_16x16x32_bf16 v[216:219], v[128:131], a[112:115], v[216:219]
    v_mfma_f32_16x16x32_bf16 v[216:219], v[132:135], a[116:119], v[216:219]
    v_mfma_f32_16x16x32_bf16 v[216:219], v[136:139], a[120:123], v[216:219]
    v_mfma_f32_16x16x32_bf16 v[216:219], v[140:143], a[124:127], v[216:219]
    s_waitcnt lgkmcnt(0)
    v_mfma_f32_16x16x32_bf16 v[212:215], v[96:99], a[240:243], v[212:215]
    v_mfma_f32_16x16x32_bf16 v[212:215], v[100:103], a[244:247], v[212:215]
    v_mfma_f32_16x16x32_bf16 v[212:215], v[104:107], a[248:251], v[212:215]
    v_mfma_f32_16x16x32_bf16 v[212:215], v[108:111], a[252:255], v[212:215]
    v_mfma_f32_16x16x32_bf16 v[220:223], v[96:99], a[112:115], v[220:223]
    v_mfma_f32_16x16x32_bf16 v[220:223], v[100:103], a[116:119], v[220:223]
    v_mfma_f32_16x16x32_bf16 v[220:223], v[104:107], a[120:123], v[220:223]
    v_mfma_f32_16x16x32_bf16 v[220:223], v[108:111], a[124:127], v[220:223]
    s_nop 7
    s_waitcnt vmcnt(0)
    v_max3_u32 v94, v224, v225, v226
    v_max3_u32 v95, v227, v228, v229
    v_max3_u32 v95, v95, v230, v231
    v_max3_u32 v94, v94, v232, v233
    v_max3_u32 v95, v95, v234, v235
    v_max3_u32 v94, v94, v236, v237
    v_max3_u32 v95, v95, v238, v239
    v_max_u32 v94, v94, v95
    v_cmp_eq_u32 vcc, -1, v94
    s_cbranch_vccnz K3_RETRY
K3_GOT:
    v_add_f32 v208, v208, v224
    v_add_f32 v240, v240, v144
    v_add_f32 v209, v209, v225
    v_add_f32 v241, v241, v145
    v_add_f32 v210, v210, v226
    v_add_f32 v242, v242, v146
    v_add_f32 v211, v211, v227
    v_add_f32 v243, v243, v147
    v_add_f32 v208, v208, v240
    v_add_f32 v209, v209, v241
    v_add_f32 v210, v210, v242
    v_add_f32 v211, v211, v243
    v_fmac_f32 v32, v208, v28
    v_fmac_f32 v33, v209, v28
    v_fmac_f32 v34, v210, v28
    v_fmac_f32 v35, v211, v28
    v_cvt_pk_bf16_f32 v50, v32, v33
    v_cvt_pk_bf16_f32 v51, v34, v35
    buffer_store_dwordx2 v[50:51], v70, s[60:63], 0 offen offset:0
    v_add_f32 v212, v212, v228
    v_add_f32 v244, v244, v148
    v_add_f32 v213, v213, v229
    v_add_f32 v245, v245, v149
    v_add_f32 v214, v214, v230
    v_add_f32 v246, v246, v150
    v_add_f32 v215, v215, v231
    v_add_f32 v247, v247, v151
    v_add_f32 v212, v212, v244
    v_add_f32 v213, v213, v245
    v_add_f32 v214, v214, v246
    v_add_f32 v215, v215, v247
    v_fmac_f32 v36, v212, v28
    v_fmac_f32 v37, v213, v28
    v_fmac_f32 v38, v214, v28
    v_fmac_f32 v39, v215, v28
    v_cvt_pk_bf16_f32 v52, v36, v37
    v_cvt_pk_bf16_f32 v53, v38, v39
    buffer_store_dwordx2 v[52:53], v70, s[60:63], 0 offen offset:32
    v_add_f32 v216, v216, v232
    v_add_f32 v248, v248, v152
    v_add_f32 v217, v217, v233
    v_add_f32 v249, v249, v153
    v_add_f32 v218, v218, v234
    v_add_f32 v250, v250, v154
    v_add_f32 v219, v219, v235
    v_add_f32 v251, v251, v155
    v_add_f32 v216, v216, v248
    v_add_f32 v217, v217, v249
    v_add_f32 v218, v218, v250
    v_add_f32 v219, v219, v251
    v_fmac_f32 v40, v216, v29
    v_fmac_f32 v41, v217, v29
    v_fmac_f32 v42, v218, v29
    v_fmac_f32 v43, v219, v29
    v_cvt_pk_bf16_f32 v54, v40, v41
    v_cvt_pk_bf16_f32 v55, v42, v43
    buffer_store_dwordx2 v[54:55], v71, s[60:63], 0 offen offset:0
    v_add_f32 v220, v220, v236
    v_add_f32 v252, v252, v156
    v_add_f32 v221, v221, v237
    v_add_f32 v253, v253, v157
    v_add_f32 v222, v222, v238
    v_add_f32 v254, v254, v158
    v_add_f32 v223, v223, v239
    v_add_f32 v255, v255, v159
    v_add_f32 v220, v220, v252
    v_add_f32 v221, v221, v253
    v_add_f32 v222, v222, v254
    v_add_f32 v223, v223, v255
    v_fmac_f32 v44, v220, v29
    v_fmac_f32 v45, v221, v29
    v_fmac_f32 v46, v222, v29
    v_fmac_f32 v47, v223, v29
    v_cvt_pk_bf16_f32 v56, v44, v45
    v_cvt_pk_bf16_f32 v57, v46, v47
    buffer_store_dwordx2 v[56:57], v71, s[60:63], 0 offen offset:32
K3_END:
    s_endpgm
GM_POLL1:
    s_mov_b32 s61, 0x40000
GM_PL1:
    buffer_load_dword v9, v10, s[80:83], s67 offen sc1
    s_waitcnt vmcnt(0)
    v_cmp_gt_u32 vcc, 8, v9
    s_cbranch_vccz GM_PB1
    s_sleep 4
    s_sub_u32 s61, s61, 1
    s_cmp_lg_u32 s61, 0
    s_cbranch_scc1 GM_PL1
    s_branch GM_PB1
K2_LASTD0:
    s_waitcnt vmcnt(4)
    s_branch K2_LASTD
GM_POLL2:
    s_mov_b32 s61, 0x40000
GM_PL2:
    buffer_load_dword v14, v13, s[80:83], 0 offen sc1
    s_waitcnt vmcnt(0)
    v_cmp_gt_u32 vcc, 8, v14
    s_cbranch_vccz GM_PB2
    s_sleep 4
    s_sub_u32 s61, s61, 1
    s_cmp_lg_u32 s61, 0
    s_cbranch_scc1 GM_PL2
    s_branch GM_PB2
K2_PUBB:
    v_mov_b32 v9, 1
    s_mov_b64 exec, 255
    buffer_store_dword v9, v163, s[48:51], s21 offen offset:32 sc1
    s_mov_b64 exec, -1
    s_branch K2_PUBR
GM_POLL3:
    s_mov_b32 s30, 0x40000
GM_PL3:
    buffer_load_dword v162, v161, s[48:51], s27 offen offset:32 sc1
    s_waitcnt vmcnt(0)
    v_cmp_gt_u32 vcc, 1, v162
    s_cbranch_vccz GM_PB3
    s_sleep 4
    s_sub_u32 s30, s30, 1
    s_cmp_lg_u32 s30, 0
    s_cbranch_scc1 GM_PL3
    s_branch GM_PB3
GM_POLL4:
    s_mov_b32 s30, 0x40000
GM_PL4:
    buffer_load_dwordx4 v[164:167], v160, s[48:51], 0 offen offset:512 sc1
    s_waitcnt vmcnt(0)
    v_min_u32 v164, v164, v165
    v_min3_u32 v164, v164, v166, v167
    v_cmp_gt_u32 vcc, 1, v164
    s_cbranch_vccz GM_PB4
    s_sleep 4
    s_sub_u32 s30, s30, 1
    s_cmp_lg_u32 s30, 0
    s_cbranch_scc1 GM_PL4
    s_branch GM_PB4
GM_POLL5:
    s_mov_b32 s30, 0x40000
GM_PL5:
    buffer_load_dword v94, v75, s[48:51], s27 offen sc1
    s_waitcnt vmcnt(0)
    v_cmp_gt_u32 vcc, 1, v94
    s_cbranch_vccz GM_PB5
    s_sleep 4
    s_sub_u32 s30, s30, 1
    s_cmp_lg_u32 s30, 0
    s_cbranch_scc1 GM_PL5
    s_branch GM_PB5
GM_POLL6:
    s_mov_b32 s30, 0x40000
GM_PL6:
    buffer_load_dword v94, v78, s[48:51], s27 offen offset:64 sc1
    s_waitcnt vmcnt(0)
    v_cmp_gt_u32 vcc, 1, v94
    s_cbranch_vccz GM_PB6
    s_sleep 4
    s_sub_u32 s30, s30, 1
    s_cmp_lg_u32 s30, 0
    s_cbranch_scc1 GM_PL6
    s_branch GM_PB6
GM_POLL7:
    s_mov_b32 s30, 0x40000
GM_PL7:
    buffer_load_dword v95, v79, s[48:51], s27 offen offset:128 sc1
    s_waitcnt vmcnt(0)
    v_cmp_gt_u32 vcc, 1, v95
    s_cbranch_vccz GM_PB7
    s_sleep 4
    s_sub_u32 s30, s30, 1
    s_cmp_lg_u32 s30, 0
    s_cbranch_scc1 GM_PL7
    s_branch GM_PB7
K3_RETRY:
    s_mov_b32 s30, 0x20000
K3_RL:
    buffer_load_dwordx4 v[224:227], v1, s[48:51], s40 offen offset:0 sc1
    buffer_load_dwordx4 v[228:231], v1, s[48:51], s40 offen offset:1024 sc1
    buffer_load_dwordx4 v[232:235], v1, s[48:51], s40 offen offset:2048 sc1
    buffer_load_dwordx4 v[236:239], v1, s[48:51], s40 offen offset:3072 sc1
    s_waitcnt vmcnt(0)
    v_max3_u32 v94, v224, v225, v226
    v_max3_u32 v95, v227, v228, v229
    v_max3_u32 v95, v95, v230, v231
    v_max3_u32 v94, v94, v232, v233
    v_max3_u32 v95, v95, v234, v235
    v_max3_u32 v94, v94, v236, v237
    v_max3_u32 v95, v95, v238, v239
    v_max_u32 v94, v94, v95
    v_cmp_eq_u32 vcc, -1, v94
    s_cbranch_vccz K3_GOT
    s_sub_u32 s30, s30, 1
    s_cmp_lg_u32 s30, 0
    s_cbranch_scc1 K3_RL
    s_branch K3_GOT
GM_HOT_END:
K2_SLOW1:
    s_nop 7
    s_nop 3
    v_log_f32 v8, v32
    v_max3_f32 v7, v48, v49, v50
    v_max3_f32 v7, v7, v51, v52
    v_max3_f32 v7, v7, v53, v54
    v_max3_f32 v7, v7, v55, 0
    v_max_f32 v7, v7, v8
    v_mov_b32 v8, v7
    s_nop 1
    v_permlane16_swap_b32 v7, v8
    v_max_f32 v7, v7, v8
    v_mov_b32 v8, v7
    s_nop 1
    v_permlane32_swap_b32 v7, v8
    v_max_f32 v7, v7, v8
    v_exp_f32 v9, -v7
    v_sub_f32 v152, v152, v7
    v_sub_f32 v153, v153, v7
    v_sub_f32 v154, v154, v7
    v_sub_f32 v155, v155, v7
    v_mul_f32 v32, v32, v9
    v_mul_f32 v33, v33, v9
    v_mul_f32 v34, v34, v9
    v_mul_f32 v35, v35, v9
    v_accvgpr_read_b32 v8, a128
    v_mul_f32 v8, v8, v9
    v_accvgpr_write_b32 a128, v8
    v_accvgpr_read_b32 v8, a129
    v_mul_f32 v8, v8, v9
    v_accvgpr_write_b32 a129, v8
    v_accvgpr_read_b32 v8, a130
    v_mul_f32 v8, v8, v9
    v_accvgpr_write_b32 a130, v8
    v_accvgpr_read_b32 v8, a131
    v_mul_f32 v8, v8, v9
    v_accvgpr_write_b32 a131, v8
    v_accvgpr_read_b32 v8, a132
    v_mul_f32 v8, v8, v9
    v_accvgpr_write_b32 a132, v8
    v_accvgpr_read_b32 v8, a133
    v_mul_f32 v8, v8, v9
    v_accvgpr_write_b32 a133, v8
    v_accvgpr_read_b32 v8, a134
    v_mul_f32 v8, v8, v9
    v_accvgpr_write_b32 a134, v8
    v_accvgpr_read_b32 v8, a135
    v_mul_f32 v8, v8, v9
    v_accvgpr_write_b32 a135, v8
    v_accvgpr_read_b32 v8, a136
    v_mul_f32 v8, v8, v9
    v_accvgpr_write_b32 a136, v8
    v_accvgpr_read_b32 v8, a137
    v_mul_f32 v8, v8, v9
    v_accvgpr_write_b32 a137, v8
    v_accvgpr_read_b32 v8, a138
    v_mul_f32 v8, v8, v9
    v_accvgpr_write_b32 a138, v8
    v_accvgpr_read_b32 v8, a139
    v_mul_f32 v8, v8, v9
    v_accvgpr_write_b32 a139, v8
    v_accvgpr_read_b32 v8, a140
    v_mul_f32 v8, v8, v9
    v_accvgpr_write_b32 a140, v8
    v_accvgpr_read_b32 v8, a141
    v_mul_f32 v8, v8, v9
    v_accvgpr_write_b32 a141, v8
    v_accvgpr_read_b32 v8, a142
    v_mul_f32 v8, v8, v9
    v_accvgpr_write_b32 a142, v8
    v_accvgpr_read_b32 v8, a143
    v_mul_f32 v8, v8, v9
    v_accvgpr_write_b32 a143, v8
    v_accvgpr_read_b32 v8, a144
    v_mul_f32 v8, v8, v9
    v_accvgpr_write_b32 a144, v8
    v_accvgpr_read_b32 v8, a145
    v_mul_f32 v8, v8, v9
    v_accvgpr_write_b32 a145, v8
    v_accvgpr_read_b32 v8, a146
    v_mul_f32 v8, v8, v9
    v_accvgpr_write_b32 a146, v8
    v_accvgpr_read_b32 v8, a147
    v_mul_f32 v8, v8, v9
    v_accvgpr_write_b32 a147, v8
    v_accvgpr_read_b32 v8, a148
    v_mul_f32 v8, v8, v9
    v_accvgpr_write_b32 a148, v8
    v_accvgpr_read_b32 v8, a149
    v_mul_f32 v8, v8, v9
    v_accvgpr_write_b32 a149, v8
    v_accvgpr_read_b32 v8, a150
    v_mul_f32 v8, v8, v9
    v_accvgpr_write_b32 a150, v8
    v_accvgpr_read_b32 v8, a151
    v_mul_f32 v8, v8, v9
    v_accvgpr_write_b32 a151, v8
    v_accvgpr_read_b32 v8, a152
    v_mul_f32 v8, v8, v9
    v_accvgpr_write_b32 a152, v8
    v_accvgpr_read_b32 v8, a153
    v_mul_f32 v8, v8, v9
    v_accvgpr_write_b32 a153, v8
    v_accvgpr_read_b32 v8, a154
    v_mul_f32 v8, v8, v9
    v_accvgpr_write_b32 a154, v8
    v_accvgpr_read_b32 v8, a155
    v_mul_f32 v8, v8, v9
    v_accvgpr_write_b32 a155, v8
    v_accvgpr_read_b32 v8, a156
    v_mul_f32 v8, v8, v9
    v_accvgpr_write_b32 a156, v8
    v_accvgpr_read_b32 v8, a157
    v_mul_f32 v8, v8, v9
    v_accvgpr_write_b32 a157, v8
    v_accvgpr_read_b32 v8, a158
    v_mul_f32 v8, v8, v9
    v_accvgpr_write_b32 a158, v8
    v_accvgpr_read_b32 v8, a159
    v_mul_f32 v8, v8, v9
    v_accvgpr_write_b32 a159, v8
    v_sub_f32 v48, v48, v7
    v_sub_f32 v80, v80, v7
    v_sub_f32 v49, v49, v7
    v_sub_f32 v81, v81, v7
    v_sub_f32 v50, v50, v7
    v_sub_f32 v82, v82, v7
    v_sub_f32 v51, v51, v7
    v_sub_f32 v83, v83, v7
    v_sub_f32 v52, v52, v7
    v_sub_f32 v84, v84, v7
    v_sub_f32 v53, v53, v7
    v_sub_f32 v85, v85, v7
    v_sub_f32 v54, v54, v7
    v_sub_f32 v86, v86, v7
    v_sub_f32 v55, v55, v7
    v_sub_f32 v87, v87, v7
    v_exp_f32 v112, v48
    v_exp_f32 v113, v49
    v_exp_f32 v114, v50
    v_exp_f32 v115, v51
    v_exp_f32 v116, v52
    v_exp_f32 v117, v53
    v_exp_f32 v118, v54
    v_exp_f32 v119, v55
    s_nop 0
    v_cvt_pk_bf16_f32 v120, v112, v113
    v_cvt_pk_bf16_f32 v121, v114, v115
    v_cvt_pk_bf16_f32 v122, v116, v117
    v_cvt_pk_bf16_f32 v123, v118, v119
    s_nop 1
    v_mfma_f32_16x16x32_bf16 v[16:19], a[240:243], v[120:123], v[32:35]
    v_log_f32 v8, v36
    v_max3_f32 v7, v56, v57, v58
    v_max3_f32 v7, v7, v59, v60
    v_max3_f32 v7, v7, v61, v62
    v_max3_f32 v7, v7, v63, 0
    v_max_f32 v7, v7, v8
    v_mov_b32 v8, v7
    s_nop 1
    v_permlane16_swap_b32 v7, v8
    v_max_f32 v7, v7, v8
    v_mov_b32 v8, v7
    s_nop 1
    v_permlane32_swap_b32 v7, v8
    v_max_f32 v7, v7, v8
    v_exp_f32 v9, -v7
    v_sub_f32 v156, v156, v7
    v_sub_f32 v157, v157, v7
    v_sub_f32 v158, v158, v7
    v_sub_f32 v159, v159, v7
    v_mul_f32 v36, v36, v9
    v_mul_f32 v37, v37, v9
    v_mul_f32 v38, v38, v9
    v_mul_f32 v39, v39, v9
    v_mul_f32 v192, v192, v9
    v_mul_f32 v193, v193, v9
    v_mul_f32 v194, v194, v9
    v_mul_f32 v195, v195, v9
    v_mul_f32 v196, v196, v9
    v_mul_f32 v197, v197, v9
    v_mul_f32 v198, v198, v9
    v_mul_f32 v199, v199, v9
    v_mul_f32 v200, v200, v9
    v_mul_f32 v201, v201, v9
    v_mul_f32 v202, v202, v9
    v_mul_f32 v203, v203, v9
    v_mul_f32 v204, v204, v9
    v_mul_f32 v205, v205, v9
    v_mul_f32 v206, v206, v9
    v_mul_f32 v207, v207, v9
    v_mul_f32 v208, v208, v9
    v_mul_f32 v209, v209, v9
    v_mul_f32 v210, v210, v9
    v_mul_f32 v211, v211, v9
    v_mul_f32 v212, v212, v9
    v_mul_f32 v213, v213, v9
    v_mul_f32 v214, v214, v9
    v_mul_f32 v215, v215, v9
    v_mul_f32 v216, v216, v9
    v_mul_f32 v217, v217, v9
    v_mul_f32 v218, v218, v9
    v_mul_f32 v219, v219, v9
    v_mul_f32 v220, v220, v9
    v_mul_f32 v221, v221, v9
    v_mul_f32 v222, v222, v9
    v_mul_f32 v223, v223, v9
    v_sub_f32 v56, v56, v7
    v_sub_f32 v88, v88, v7
    v_sub_f32 v57, v57, v7
    v_sub_f32 v89, v89, v7
    v_sub_f32 v58, v58, v7
    v_sub_f32 v90, v90, v7
    v_sub_f32 v59, v59, v7
    v_sub_f32 v91, v91, v7
    v_sub_f32 v60, v60, v7
    v_sub_f32 v92, v92, v7
    v_sub_f32 v61, v61, v7
    v_sub_f32 v93, v93, v7
    v_sub_f32 v62, v62, v7
    v_sub_f32 v94, v94, v7
    v_sub_f32 v63, v63, v7
    v_sub_f32 v95, v95, v7
    v_exp_f32 v112, v56
    v_exp_f32 v113, v57
    v_exp_f32 v114, v58
    v_exp_f32 v115, v59
    v_exp_f32 v116, v60
    v_exp_f32 v117, v61
    v_exp_f32 v118, v62
    v_exp_f32 v119, v63
    s_nop 0
    v_cvt_pk_bf16_f32 v124, v112, v113
    v_cvt_pk_bf16_f32 v125, v114, v115
    v_cvt_pk_bf16_f32 v126, v116, v117
    v_cvt_pk_bf16_f32 v127, v118, v119
    s_nop 1
    v_mfma_f32_16x16x32_bf16 v[20:23], a[240:243], v[124:127], v[36:39]
    v_log_f32 v8, v40
    v_max3_f32 v7, v64, v65, v66
    v_max3_f32 v7, v7, v67, v68
    v_max3_f32 v7, v7, v69, v70
    v_max3_f32 v7, v7, v71, 0
    v_max_f32 v7, v7, v8
    v_mov_b32 v8, v7
    s_nop 1
    v_permlane16_swap_b32 v7, v8
    v_max_f32 v7, v7, v8
    v_mov_b32 v8, v7
    s_nop 1
    v_permlane32_swap_b32 v7, v8
    v_max_f32 v7, v7, v8
    v_exp_f32 v9, -v7
    v_sub_f32 v160, v160, v7
    v_sub_f32 v161, v161, v7
    v_sub_f32 v162, v162, v7
    v_sub_f32 v163, v163, v7
    v_mul_f32 v40, v40, v9
    v_mul_f32 v41, v41, v9
    v_mul_f32 v42, v42, v9
    v_mul_f32 v43, v43, v9
    v_accvgpr_read_b32 v8, a160
    v_mul_f32 v8, v8, v9
    v_accvgpr_write_b32 a160, v8
    v_accvgpr_read_b32 v8, a161
    v_mul_f32 v8, v8, v9
    v_accvgpr_write_b32 a161, v8
    v_accvgpr_read_b32 v8, a162
    v_mul_f32 v8, v8, v9
    v_accvgpr_write_b32 a162, v8
    v_accvgpr_read_b32 v8, a163
    v_mul_f32 v8, v8, v9
    v_accvgpr_write_b32 a163, v8
    v_accvgpr_read_b32 v8, a164
    v_mul_f32 v8, v8, v9
    v_accvgpr_write_b32 a164, v8
    v_accvgpr_read_b32 v8, a165
    v_mul_f32 v8, v8, v9
    v_accvgpr_write_b32 a165, v8
    v_accvgpr_read_b32 v8, a166
    v_mul_f32 v8, v8, v9
    v_accvgpr_write_b32 a166, v8
    v_accvgpr_read_b32 v8, a167
    v_mul_f32 v8, v8, v9
    v_accvgpr_write_b32 a167, v8
    v_accvgpr_read_b32 v8, a168
    v_mul_f32 v8, v8, v9
    v_accvgpr_write_b32 a168, v8
    v_accvgpr_read_b32 v8, a169
    v_mul_f32 v8, v8, v9
    v_accvgpr_write_b32 a169, v8
    v_accvgpr_read_b32 v8, a170
    v_mul_f32 v8, v8, v9
    v_accvgpr_write_b32 a170, v8
    v_accvgpr_read_b32 v8, a171
    v_mul_f32 v8, v8, v9
    v_accvgpr_write_b32 a171, v8
    v_accvgpr_read_b32 v8, a172
    v_mul_f32 v8, v8, v9
    v_accvgpr_write_b32 a172, v8
    v_accvgpr_read_b32 v8, a173
    v_mul_f32 v8, v8, v9
    v_accvgpr_write_b32 a173, v8
    v_accvgpr_read_b32 v8, a174
    v_mul_f32 v8, v8, v9
    v_accvgpr_write_b32 a174, v8
    v_accvgpr_read_b32 v8, a175
    v_mul_f32 v8, v8, v9
    v_accvgpr_write_b32 a175, v8
    v_accvgpr_read_b32 v8, a176
    v_mul_f32 v8, v8, v9
    v_accvgpr_write_b32 a176, v8
    v_accvgpr_read_b32 v8, a177
    v_mul_f32 v8, v8, v9
    v_accvgpr_write_b32 a177, v8
    v_accvgpr_read_b32 v8, a178
    v_mul_f32 v8, v8, v9
    v_accvgpr_write_b32 a178, v8
    v_accvgpr_read_b32 v8, a179
    v_mul_f32 v8, v8, v9
    v_accvgpr_write_b32 a179, v8
    v_accvgpr_read_b32 v8, a180
    v_mul_f32 v8, v8, v9
    v_accvgpr_write_b32 a180, v8
    v_accvgpr_read_b32 v8, a181
    v_mul_f32 v8, v8, v9
    v_accvgpr_write_b32 a181, v8
    v_accvgpr_read_b32 v8, a182
    v_mul_f32 v8, v8, v9
    v_accvgpr_write_b32 a182, v8
    v_accvgpr_read_b32 v8, a183
    v_mul_f32 v8, v8, v9
    v_accvgpr_write_b32 a183, v8
    v_accvgpr_read_b32 v8, a184
    v_mul_f32 v8, v8, v9
    v_accvgpr_write_b32 a184, v8
    v_accvgpr_read_b32 v8, a185
    v_mul_f32 v8, v8, v9
    v_accvgpr_write_b32 a185, v8
    v_accvgpr_read_b32 v8, a186
    v_mul_f32 v8, v8, v9
    v_accvgpr_write_b32 a186, v8
    v_accvgpr_read_b32 v8, a187
    v_mul_f32 v8, v8, v9
    v_accvgpr_write_b32 a187, v8
    v_accvgpr_read_b32 v8, a188
    v_mul_f32 v8, v8, v9
    v_accvgpr_write_b32 a188, v8
    v_accvgpr_read_b32 v8, a189
    v_mul_f32 v8, v8, v9
    v_accvgpr_write_b32 a189, v8
    v_accvgpr_read_b32 v8, a190
    v_mul_f32 v8, v8, v9
    v_accvgpr_write_b32 a190, v8
    v_accvgpr_read_b32 v8, a191
    v_mul_f32 v8, v8, v9
    v_accvgpr_write_b32 a191, v8
    v_sub_f32 v64, v64, v7
    v_sub_f32 v96, v96, v7
    v_sub_f32 v65, v65, v7
    v_sub_f32 v97, v97, v7
    v_sub_f32 v66, v66, v7
    v_sub_f32 v98, v98, v7
    v_sub_f32 v67, v67, v7
    v_sub_f32 v99, v99, v7
    v_sub_f32 v68, v68, v7
    v_sub_f32 v100, v100, v7
    v_sub_f32 v69, v69, v7
    v_sub_f32 v101, v101, v7
    v_sub_f32 v70, v70, v7
    v_sub_f32 v102, v102, v7
    v_sub_f32 v71, v71, v7
    v_sub_f32 v103, v103, v7
    v_exp_f32 v112, v64
    v_exp_f32 v113, v65
    v_exp_f32 v114, v66
    v_exp_f32 v115, v67
    v_exp_f32 v116, v68
    v_exp_f32 v117, v69
    v_exp_f32 v118, v70
    v_exp_f32 v119, v71
    s_nop 0
    v_cvt_pk_bf16_f32 v128, v112, v113
    v_cvt_pk_bf16_f32 v129, v114, v115
    v_cvt_pk_bf16_f32 v130, v116, v117
    v_cvt_pk_bf16_f32 v131, v118, v119
    s_nop 1
    v_mfma_f32_16x16x32_bf16 v[24:27], a[240:243], v[128:131], v[40:43]
    v_log_f32 v8, v44
    v_max3_f32 v7, v72, v73, v74
    v_max3_f32 v7, v7, v75, v76
    v_max3_f32 v7, v7, v77, v78
    v_max3_f32 v7, v7, v79, 0
    v_max_f32 v7, v7, v8
    v_mov_b32 v8, v7
    s_nop 1
    v_permlane16_swap_b32 v7, v8
    v_max_f32 v7, v7, v8
    v_mov_b32 v8, v7
    s_nop 1
    v_permlane32_swap_b32 v7, v8
    v_max_f32 v7, v7, v8
    v_exp_f32 v9, -v7
    v_sub_f32 v164, v164, v7
    v_sub_f32 v165, v165, v7
    v_sub_f32 v166, v166, v7
    v_sub_f32 v167, v167, v7
    v_mul_f32 v44, v44, v9
    v_mul_f32 v45, v45, v9
    v_mul_f32 v46, v46, v9
    v_mul_f32 v47, v47, v9
    v_mul_f32 v224, v224, v9
    v_mul_f32 v225, v225, v9
    v_mul_f32 v226, v226, v9
    v_mul_f32 v227, v227, v9
    v_mul_f32 v228, v228, v9
    v_mul_f32 v229, v229, v9
    v_mul_f32 v230, v230, v9
    v_mul_f32 v231, v231, v9
    v_mul_f32 v232, v232, v9
    v_mul_f32 v233, v233, v9
    v_mul_f32 v234, v234, v9
    v_mul_f32 v235, v235, v9
    v_mul_f32 v236, v236, v9
    v_mul_f32 v237, v237, v9
    v_mul_f32 v238, v238, v9
    v_mul_f32 v239, v239, v9
    v_mul_f32 v240, v240, v9
    v_mul_f32 v241, v241, v9
    v_mul_f32 v242, v242, v9
    v_mul_f32 v243, v243, v9
    v_mul_f32 v244, v244, v9
    v_mul_f32 v245, v245, v9
    v_mul_f32 v246, v246, v9
    v_mul_f32 v247, v247, v9
    v_mul_f32 v248, v248, v9
    v_mul_f32 v249, v249, v9
    v_mul_f32 v250, v250, v9
    v_mul_f32 v251, v251, v9
    v_mul_f32 v252, v252, v9
    v_mul_f32 v253, v253, v9
    v_mul_f32 v254, v254, v9
    v_mul_f32 v255, v255, v9
    v_sub_f32 v72, v72, v7
    v_sub_f32 v104, v104, v7
    v_sub_f32 v73, v73, v7
    v_sub_f32 v105, v105, v7
    v_sub_f32 v74, v74, v7
    v_sub_f32 v106, v106, v7
    v_sub_f32 v75, v75, v7
    v_sub_f32 v107, v107, v7
    v_sub_f32 v76, v76, v7
    v_sub_f32 v108, v108, v7
    v_sub_f32 v77, v77, v7
    v_sub_f32 v109, v109, v7
    v_sub_f32 v78, v78, v7
    v_sub_f32 v110, v110, v7
    v_sub_f32 v79, v79, v7
    v_sub_f32 v111, v111, v7
    v_exp_f32 v112, v72
    v_exp_f32 v113, v73
    v_exp_f32 v114, v74
    v_exp_f32 v115, v75
    v_exp_f32 v116, v76
    v_exp_f32 v117, v77
    v_exp_f32 v118, v78
    v_exp_f32 v119, v79
    s_nop 0
    v_cvt_pk_bf16_f32 v132, v112, v113
    v_cvt_pk_bf16_f32 v133, v114, v115
    v_cvt_pk_bf16_f32 v134, v116, v117
    v_cvt_pk_bf16_f32 v135, v118, v119
    s_nop 1
    v_mfma_f32_16x16x32_bf16 v[28:31], a[240:243], v[132:135], v[44:47]
    v_exp_f32 v112, v80
    v_exp_f32 v113, v81
    v_exp_f32 v114, v82
    v_exp_f32 v115, v83
    s_nop 7
    s_branch K2_BACK1
K2_SLOW2:
    s_nop 7
    s_nop 3
    v_log_f32 v8, v16
    v_max3_f32 v7, v80, v81, v82
    v_max3_f32 v7, v7, v83, v84
    v_max3_f32 v7, v7, v85, v86
    v_max3_f32 v7, v7, v87, 0
    v_max_f32 v7, v7, v8
    v_mov_b32 v8, v7
    s_nop 1
    v_permlane16_swap_b32 v7, v8
    v_max_f32 v7, v7, v8
    v_mov_b32 v8, v7
    s_nop 1
    v_permlane32_swap_b32 v7, v8
    v_max_f32 v7, v7, v8
    v_exp_f32 v9, -v7
    v_sub_f32 v152, v152, v7
    v_sub_f32 v153, v153, v7
    v_sub_f32 v154, v154, v7
    v_sub_f32 v155, v155, v7
    v_mul_f32 v16, v16, v9
    v_mul_f32 v17, v17, v9
    v_mul_f32 v18, v18, v9
    v_mul_f32 v19, v19, v9
    v_accvgpr_read_b32 v8, a128
    v_mul_f32 v8, v8, v9
    v_accvgpr_write_b32 a128, v8
    v_accvgpr_read_b32 v8, a129
    v_mul_f32 v8, v8, v9
    v_accvgpr_write_b32 a129, v8
    v_accvgpr_read_b32 v8, a130
    v_mul_f32 v8, v8, v9
    v_accvgpr_write_b32 a130, v8
    v_accvgpr_read_b32 v8, a131
    v_mul_f32 v8, v8, v9
    v_accvgpr_write_b32 a131, v8
    v_accvgpr_read_b32 v8, a132
    v_mul_f32 v8, v8, v9
    v_accvgpr_write_b32 a132, v8
    v_accvgpr_read_b32 v8, a133
    v_mul_f32 v8, v8, v9
    v_accvgpr_write_b32 a133, v8
    v_accvgpr_read_b32 v8, a134
    v_mul_f32 v8, v8, v9
    v_accvgpr_write_b32 a134, v8
    v_accvgpr_read_b32 v8, a135
    v_mul_f32 v8, v8, v9
    v_accvgpr_write_b32 a135, v8
    v_accvgpr_read_b32 v8, a136
    v_mul_f32 v8, v8, v9
    v_accvgpr_write_b32 a136, v8
    v_accvgpr_read_b32 v8, a137
    v_mul_f32 v8, v8, v9
    v_accvgpr_write_b32 a137, v8
    v_accvgpr_read_b32 v8, a138
    v_mul_f32 v8, v8, v9
    v_accvgpr_write_b32 a138, v8
    v_accvgpr_read_b32 v8, a139
    v_mul_f32 v8, v8, v9
    v_accvgpr_write_b32 a139, v8
    v_accvgpr_read_b32 v8, a140
    v_mul_f32 v8, v8, v9
    v_accvgpr_write_b32 a140, v8
    v_accvgpr_read_b32 v8, a141
    v_mul_f32 v8, v8, v9
    v_accvgpr_write_b32 a141, v8
    v_accvgpr_read_b32 v8, a142
    v_mul_f32 v8, v8, v9
    v_accvgpr_write_b32 a142, v8
    v_accvgpr_read_b32 v8, a143
    v_mul_f32 v8, v8, v9
    v_accvgpr_write_b32 a143, v8
    v_accvgpr_read_b32 v8, a144
    v_mul_f32 v8, v8, v9
    v_accvgpr_write_b32 a144, v8
    v_accvgpr_read_b32 v8, a145
    v_mul_f32 v8, v8, v9
    v_accvgpr_write_b32 a145, v8
    v_accvgpr_read_b32 v8, a146
    v_mul_f32 v8, v8, v9
    v_accvgpr_write_b32 a146, v8
    v_accvgpr_read_b32 v8, a147
    v_mul_f32 v8, v8, v9
    v_accvgpr_write_b32 a147, v8
    v_accvgpr_read_b32 v8, a148
    v_mul_f32 v8, v8, v9
    v_accvgpr_write_b32 a148, v8
    v_accvgpr_read_b32 v8, a149
    v_mul_f32 v8, v8, v9
    v_accvgpr_write_b32 a149, v8
    v_accvgpr_read_b32 v8, a150
    v_mul_f32 v8, v8, v9
    v_accvgpr_write_b32 a150, v8
    v_accvgpr_read_b32 v8, a151
    v_mul_f32 v8, v8, v9
    v_accvgpr_write_b32 a151, v8
    v_accvgpr_read_b32 v8, a152
    v_mul_f32 v8, v8, v9
    v_accvgpr_write_b32 a152, v8
    v_accvgpr_read_b32 v8, a153
    v_mul_f32 v8, v8, v9
    v_accvgpr_write_b32 a153, v8
    v_accvgpr_read_b32 v8, a154
    v_mul_f32 v8, v8, v9
    v_accvgpr_write_b32 a154, v8
    v_accvgpr_read_b32 v8, a155
    v_mul_f32 v8, v8, v9
    v_accvgpr_write_b32 a155, v8
    v_accvgpr_read_b32 v8, a156
    v_mul_f32 v8, v8, v9
    v_accvgpr_write_b32 a156, v8
    v_accvgpr_read_b32 v8, a157
    v_mul_f32 v8, v8, v9
    v_accvgpr_write_b32 a157, v8
    v_accvgpr_read_b32 v8, a158
    v_mul_f32 v8, v8, v9
    v_accvgpr_write_b32 a158, v8
    v_accvgpr_read_b32 v8, a159
    v_mul_f32 v8, v8, v9
    v_accvgpr_write_b32 a159, v8
    v_sub_f32 v80, v80, v7
    v_sub_f32 v48, v48, v7
    v_sub_f32 v81, v81, v7
    v_sub_f32 v49, v49, v7
    v_sub_f32 v82, v82, v7
    v_sub_f32 v50, v50, v7
    v_sub_f32 v83, v83, v7
    v_sub_f32 v51, v51, v7
    v_sub_f32 v84, v84, v7
    v_sub_f32 v52, v52, v7
    v_sub_f32 v85, v85, v7
    v_sub_f32 v53, v53, v7
    v_sub_f32 v86, v86, v7
    v_sub_f32 v54, v54, v7
    v_sub_f32 v87, v87, v7
    v_sub_f32 v55, v55, v7
    v_exp_f32 v112, v80
    v_exp_f32 v113, v81
    v_exp_f32 v114, v82
    v_exp_f32 v115, v83
    v_exp_f32 v116, v84
    v_exp_f32 v117, v85
    v_exp_f32 v118, v86
    v_exp_f32 v119, v87
    s_nop 0
    v_cvt_pk_bf16_f32 v136, v112, v113
    v_cvt_pk_bf16_f32 v137, v114, v115
    v_cvt_pk_bf16_f32 v138, v116, v117
    v_cvt_pk_bf16_f32 v139, v118, v119
    s_nop 1
    v_mfma_f32_16x16x32_bf16 v[32:35], a[240:243], v[136:139], v[16:19]
    v_log_f32 v8, v20
    v_max3_f32 v7, v88, v89, v90
    v_max3_f32 v7, v7, v91, v92
    v_max3_f32 v7, v7, v93, v94
    v_max3_f32 v7, v7, v95, 0
    v_max_f32 v7, v7, v8
    v_mov_b32 v8, v7
    s_nop 1
    v_permlane16_swap_b32 v7, v8
    v_max_f32 v7, v7, v8
    v_mov_b32 v8, v7
    s_nop 1
    v_permlane32_swap_b32 v7, v8
    v_max_f32 v7, v7, v8
    v_exp_f32 v9, -v7
    v_sub_f32 v156, v156, v7
    v_sub_f32 v157, v157, v7
    v_sub_f32 v158, v158, v7
    v_sub_f32 v159, v159, v7
    v_mul_f32 v20, v20, v9
    v_mul_f32 v21, v21, v9
    v_mul_f32 v22, v22, v9
    v_mul_f32 v23, v23, v9
    v_mul_f32 v192, v192, v9
    v_mul_f32 v193, v193, v9
    v_mul_f32 v194, v194, v9
    v_mul_f32 v195, v195, v9
    v_mul_f32 v196, v196, v9
    v_mul_f32 v197, v197, v9
    v_mul_f32 v198, v198, v9
    v_mul_f32 v199, v199, v9
    v_mul_f32 v200, v200, v9
    v_mul_f32 v201, v201, v9
    v_mul_f32 v202, v202, v9
    v_mul_f32 v203, v203, v9
    v_mul_f32 v204, v204, v9
    v_mul_f32 v205, v205, v9
    v_mul_f32 v206, v206, v9
    v_mul_f32 v207, v207, v9
    v_mul_f32 v208, v208, v9
    v_mul_f32 v209, v209, v9
    v_mul_f32 v210, v210, v9
    v_mul_f32 v211, v211, v9
    v_mul_f32 v212, v212, v9
    v_mul_f32 v213, v213, v9
    v_mul_f32 v214, v214, v9
    v_mul_f32 v215, v215, v9
    v_mul_f32 v216, v216, v9
    v_mul_f32 v217, v217, v9
    v_mul_f32 v218, v218, v9
    v_mul_f32 v219, v219, v9
    v_mul_f32 v220, v220, v9
    v_mul_f32 v221, v221, v9
    v_mul_f32 v222, v222, v9
    v_mul_f32 v223, v223, v9
    v_sub_f32 v88, v88, v7
    v_sub_f32 v56, v56, v7
    v_sub_f32 v89, v89, v7
    v_sub_f32 v57, v57, v7
    v_sub_f32 v90, v90, v7
    v_sub_f32 v58, v58, v7
    v_sub_f32 v91, v91, v7
    v_sub_f32 v59, v59, v7
    v_sub_f32 v92, v92, v7
    v_sub_f32 v60, v60, v7
    v_sub_f32 v93, v93, v7
    v_sub_f32 v61, v61, v7
    v_sub_f32 v94, v94, v7
    v_sub_f32 v62, v62, v7
    v_sub_f32 v95, v95, v7
    v_sub_f32 v63, v63, v7
    v_exp_f32 v112, v88
    v_exp_f32 v113, v89
    v_exp_f32 v114, v90
    v_exp_f32 v115, v91
    v_exp_f32 v116, v92
    v_exp_f32 v117, v93
    v_exp_f32 v118, v94
    v_exp_f32 v119, v95
    s_nop 0
    v_cvt_pk_bf16_f32 v140, v112, v113
    v_cvt_pk_bf16_f32 v141, v114, v115
    v_cvt_pk_bf16_f32 v142, v116, v117
    v_cvt_pk_bf16_f32 v143, v118, v119
    s_nop 1
    v_mfma_f32_16x16x32_bf16 v[36:39], a[240:243], v[140:143], v[20:23]
    v_log_f32 v8, v24
    v_max3_f32 v7, v96, v97, v98
    v_max3_f32 v7, v7, v99, v100
    v_max3_f32 v7, v7, v101, v102
    v_max3_f32 v7, v7, v103, 0
    v_max_f32 v7, v7, v8
    v_mov_b32 v8, v7
    s_nop 1
    v_permlane16_swap_b32 v7, v8
    v_max_f32 v7, v7, v8
    v_mov_b32 v8, v7
    s_nop 1
    v_permlane32_swap_b32 v7, v8
    v_max_f32 v7, v7, v8
    v_exp_f32 v9, -v7
    v_sub_f32 v160, v160, v7
    v_sub_f32 v161, v161, v7
    v_sub_f32 v162, v162, v7
    v_sub_f32 v163, v163, v7
    v_mul_f32 v24, v24, v9
    v_mul_f32 v25, v25, v9
    v_mul_f32 v26, v26, v9
    v_mul_f32 v27, v27, v9
    v_accvgpr_read_b32 v8, a160
    v_mul_f32 v8, v8, v9
    v_accvgpr_write_b32 a160, v8
    v_accvgpr_read_b32 v8, a161
    v_mul_f32 v8, v8, v9
    v_accvgpr_write_b32 a161, v8
    v_accvgpr_read_b32 v8, a162
    v_mul_f32 v8, v8, v9
    v_accvgpr_write_b32 a162, v8
    v_accvgpr_read_b32 v8, a163
    v_mul_f32 v8, v8, v9
    v_accvgpr_write_b32 a163, v8
    v_accvgpr_read_b32 v8, a164
    v_mul_f32 v8, v8, v9
    v_accvgpr_write_b32 a164, v8
    v_accvgpr_read_b32 v8, a165
    v_mul_f32 v8, v8, v9
    v_accvgpr_write_b32 a165, v8
    v_accvgpr_read_b32 v8, a166
    v_mul_f32 v8, v8, v9
    v_accvgpr_write_b32 a166, v8
    v_accvgpr_read_b32 v8, a167
    v_mul_f32 v8, v8, v9
    v_accvgpr_write_b32 a167, v8
    v_accvgpr_read_b32 v8, a168
    v_mul_f32 v8, v8, v9
    v_accvgpr_write_b32 a168, v8
    v_accvgpr_read_b32 v8, a169
    v_mul_f32 v8, v8, v9
    v_accvgpr_write_b32 a169, v8
    v_accvgpr_read_b32 v8, a170
    v_mul_f32 v8, v8, v9
    v_accvgpr_write_b32 a170, v8
    v_accvgpr_read_b32 v8, a171
    v_mul_f32 v8, v8, v9
    v_accvgpr_write_b32 a171, v8
    v_accvgpr_read_b32 v8, a172
    v_mul_f32 v8, v8, v9
    v_accvgpr_write_b32 a172, v8
    v_accvgpr_read_b32 v8, a173
    v_mul_f32 v8, v8, v9
    v_accvgpr_write_b32 a173, v8
    v_accvgpr_read_b32 v8, a174
    v_mul_f32 v8, v8, v9
    v_accvgpr_write_b32 a174, v8
    v_accvgpr_read_b32 v8, a175
    v_mul_f32 v8, v8, v9
    v_accvgpr_write_b32 a175, v8
    v_accvgpr_read_b32 v8, a176
    v_mul_f32 v8, v8, v9
    v_accvgpr_write_b32 a176, v8
    v_accvgpr_read_b32 v8, a177
    v_mul_f32 v8, v8, v9
    v_accvgpr_write_b32 a177, v8
    v_accvgpr_read_b32 v8, a178
    v_mul_f32 v8, v8, v9
    v_accvgpr_write_b32 a178, v8
    v_accvgpr_read_b32 v8, a179
    v_mul_f32 v8, v8, v9
    v_accvgpr_write_b32 a179, v8
    v_accvgpr_read_b32 v8, a180
    v_mul_f32 v8, v8, v9
    v_accvgpr_write_b32 a180, v8
    v_accvgpr_read_b32 v8, a181
    v_mul_f32 v8, v8, v9
    v_accvgpr_write_b32 a181, v8
    v_accvgpr_read_b32 v8, a182
    v_mul_f32 v8, v8, v9
    v_accvgpr_write_b32 a182, v8
    v_accvgpr_read_b32 v8, a183
    v_mul_f32 v8, v8, v9
    v_accvgpr_write_b32 a183, v8
    v_accvgpr_read_b32 v8, a184
    v_mul_f32 v8, v8, v9
    v_accvgpr_write_b32 a184, v8
    v_accvgpr_read_b32 v8, a185
    v_mul_f32 v8, v8, v9
    v_accvgpr_write_b32 a185, v8
    v_accvgpr_read_b32 v8, a186
    v_mul_f32 v8, v8, v9
    v_accvgpr_write_b32 a186, v8
    v_accvgpr_read_b32 v8, a187
    v_mul_f32 v8, v8, v9
    v_accvgpr_write_b32 a187, v8
    v_accvgpr_read_b32 v8, a188
    v_mul_f32 v8, v8, v9
    v_accvgpr_write_b32 a188, v8
    v_accvgpr_read_b32 v8, a189
    v_mul_f32 v8, v8, v9
    v_accvgpr_write_b32 a189, v8
    v_accvgpr_read_b32 v8, a190
    v_mul_f32 v8, v8, v9
    v_accvgpr_write_b32 a190, v8
    v_accvgpr_read_b32 v8, a191
    v_mul_f32 v8, v8, v9
    v_accvgpr_write_b32 a191, v8
    v_sub_f32 v96, v96, v7
    v_sub_f32 v64, v64, v7
    v_sub_f32 v97, v97, v7
    v_sub_f32 v65, v65, v7
    v_sub_f32 v98, v98, v7
    v_sub_f32 v66, v66, v7
    v_sub_f32 v99, v99, v7
    v_sub_f32 v67, v67, v7
    v_sub_f32 v100, v100, v7
    v_sub_f32 v68, v68, v7
    v_sub_f32 v101, v101, v7
    v_sub_f32 v69, v69, v7
    v_sub_f32 v102, v102, v7
    v_sub_f32 v70, v70, v7
    v_sub_f32 v103, v103, v7
    v_sub_f32 v71, v71, v7
    v_exp_f32 v112, v96
    v_exp_f32 v113, v97
    v_exp_f32 v114, v98
    v_exp_f32 v115, v99
    v_exp_f32 v116, v100
    v_exp_f32 v117, v101
    v_exp_f32 v118, v102
    v_exp_f32 v119, v103
    s_nop 0
    v_cvt_pk_bf16_f32 v144, v112, v113
    v_cvt_pk_bf16_f32 v145, v114, v115
    v_cvt_pk_bf16_f32 v146, v116, v117
    v_cvt_pk_bf16_f32 v147, v118, v119
    s_nop 1
    v_mfma_f32_16x16x32_bf16 v[40:43], a[240:243], v[144:147], v[24:27]
    v_log_f32 v8, v28
    v_max3_f32 v7, v104, v105, v106
    v_max3_f32 v7, v7, v107, v108
    v_max3_f32 v7, v7, v109, v110
    v_max3_f32 v7, v7, v111, 0
    v_max_f32 v7, v7, v8
    v_mov_b32 v8, v7
    s_nop 1
    v_permlane16_swap_b32 v7, v8
    v_max_f32 v7, v7, v8
    v_mov_b32 v8, v7
    s_nop 1
    v_permlane32_swap_b32 v7, v8
    v_max_f32 v7, v7, v8
    v_exp_f32 v9, -v7
    v_sub_f32 v164, v164, v7
    v_sub_f32 v165, v165, v7
    v_sub_f32 v166, v166, v7
    v_sub_f32 v167, v167, v7
    v_mul_f32 v28, v28, v9
    v_mul_f32 v29, v29, v9
    v_mul_f32 v30, v30, v9
    v_mul_f32 v31, v31, v9
    v_mul_f32 v224, v224, v9
    v_mul_f32 v225, v225, v9
    v_mul_f32 v226, v226, v9
    v_mul_f32 v227, v227, v9
    v_mul_f32 v228, v228, v9
    v_mul_f32 v229, v229, v9
    v_mul_f32 v230, v230, v9
    v_mul_f32 v231, v231, v9
    v_mul_f32 v232, v232, v9
    v_mul_f32 v233, v233, v9
    v_mul_f32 v234, v234, v9
    v_mul_f32 v235, v235, v9
    v_mul_f32 v236, v236, v9
    v_mul_f32 v237, v237, v9
    v_mul_f32 v238, v238, v9
    v_mul_f32 v239, v239, v9
    v_mul_f32 v240, v240, v9
    v_mul_f32 v241, v241, v9
    v_mul_f32 v242, v242, v9
    v_mul_f32 v243, v243, v9
    v_mul_f32 v244, v244, v9
    v_mul_f32 v245, v245, v9
    v_mul_f32 v246, v246, v9
    v_mul_f32 v247, v247, v9
    v_mul_f32 v248, v248, v9
    v_mul_f32 v249, v249, v9
    v_mul_f32 v250, v250, v9
    v_mul_f32 v251, v251, v9
    v_mul_f32 v252, v252, v9
    v_mul_f32 v253, v253, v9
    v_mul_f32 v254, v254, v9
    v_mul_f32 v255, v255, v9
    v_sub_f32 v104, v104, v7
    v_sub_f32 v72, v72, v7
    v_sub_f32 v105, v105, v7
    v_sub_f32 v73, v73, v7
    v_sub_f32 v106, v106, v7
    v_sub_f32 v74, v74, v7
    v_sub_f32 v107, v107, v7
    v_sub_f32 v75, v75, v7
    v_sub_f32 v108, v108, v7
    v_sub_f32 v76, v76, v7
    v_sub_f32 v109, v109, v7
    v_sub_f32 v77, v77, v7
    v_sub_f32 v110, v110, v7
    v_sub_f32 v78, v78, v7
    v_sub_f32 v111, v111, v7
    v_sub_f32 v79, v79, v7
    v_exp_f32 v112, v104
    v_exp_f32 v113, v105
    v_exp_f32 v114, v106
    v_exp_f32 v115, v107
    v_exp_f32 v116, v108
    v_exp_f32 v117, v109
    v_exp_f32 v118, v110
    v_exp_f32 v119, v111
    s_nop 0
    v_cvt_pk_bf16_f32 v148, v112, v113
    v_cvt_pk_bf16_f32 v149, v114, v115
    v_cvt_pk_bf16_f32 v150, v116, v117
    v_cvt_pk_bf16_f32 v151, v118, v119
    s_nop 1
    v_mfma_f32_16x16x32_bf16 v[44:47], a[240:243], v[148:151], v[28:31]
    v_exp_f32 v112, v48
    v_exp_f32 v113, v49
    v_exp_f32 v114, v50
    v_exp_f32 v115, v51
    s_nop 7
    s_branch K2_BACK2
K2_SLOW3:
    s_nop 7
    s_nop 3
    v_log_f32 v8, v32
    v_max3_f32 v7, v48, v49, v50
    v_max3_f32 v7, v7, v51, v52
    v_max3_f32 v7, v7, v53, v54
    v_max3_f32 v7, v7, v55, 0
    v_max_f32 v7, v7, v8
    v_mov_b32 v8, v7
    s_nop 1
    v_permlane16_swap_b32 v7, v8
    v_max_f32 v7, v7, v8
    v_mov_b32 v8, v7
    s_nop 1
    v_permlane32_swap_b32 v7, v8
    v_max_f32 v7, v7, v8
    v_exp_f32 v9, -v7
    v_sub_f32 v152, v152, v7
    v_sub_f32 v153, v153, v7
    v_sub_f32 v154, v154, v7
    v_sub_f32 v155, v155, v7
    v_mul_f32 v32, v32, v9
    v_mul_f32 v33, v33, v9
    v_mul_f32 v34, v34, v9
    v_mul_f32 v35, v35, v9
    v_accvgpr_read_b32 v8, a128
    v_mul_f32 v8, v8, v9
    v_accvgpr_write_b32 a128, v8
    v_accvgpr_read_b32 v8, a129
    v_mul_f32 v8, v8, v9
    v_accvgpr_write_b32 a129, v8
    v_accvgpr_read_b32 v8, a130
    v_mul_f32 v8, v8, v9
    v_accvgpr_write_b32 a130, v8
    v_accvgpr_read_b32 v8, a131
    v_mul_f32 v8, v8, v9
    v_accvgpr_write_b32 a131, v8
    v_accvgpr_read_b32 v8, a132
    v_mul_f32 v8, v8, v9
    v_accvgpr_write_b32 a132, v8
    v_accvgpr_read_b32 v8, a133
    v_mul_f32 v8, v8, v9
    v_accvgpr_write_b32 a133, v8
    v_accvgpr_read_b32 v8, a134
    v_mul_f32 v8, v8, v9
    v_accvgpr_write_b32 a134, v8
    v_accvgpr_read_b32 v8, a135
    v_mul_f32 v8, v8, v9
    v_accvgpr_write_b32 a135, v8
    v_accvgpr_read_b32 v8, a136
    v_mul_f32 v8, v8, v9
    v_accvgpr_write_b32 a136, v8
    v_accvgpr_read_b32 v8, a137
    v_mul_f32 v8, v8, v9
    v_accvgpr_write_b32 a137, v8
    v_accvgpr_read_b32 v8, a138
    v_mul_f32 v8, v8, v9
    v_accvgpr_write_b32 a138, v8
    v_accvgpr_read_b32 v8, a139
    v_mul_f32 v8, v8, v9
    v_accvgpr_write_b32 a139, v8
    v_accvgpr_read_b32 v8, a140
    v_mul_f32 v8, v8, v9
    v_accvgpr_write_b32 a140, v8
    v_accvgpr_read_b32 v8, a141
    v_mul_f32 v8, v8, v9
    v_accvgpr_write_b32 a141, v8
    v_accvgpr_read_b32 v8, a142
    v_mul_f32 v8, v8, v9
    v_accvgpr_write_b32 a142, v8
    v_accvgpr_read_b32 v8, a143
    v_mul_f32 v8, v8, v9
    v_accvgpr_write_b32 a143, v8
    v_accvgpr_read_b32 v8, a144
    v_mul_f32 v8, v8, v9
    v_accvgpr_write_b32 a144, v8
    v_accvgpr_read_b32 v8, a145
    v_mul_f32 v8, v8, v9
    v_accvgpr_write_b32 a145, v8
    v_accvgpr_read_b32 v8, a146
    v_mul_f32 v8, v8, v9
    v_accvgpr_write_b32 a146, v8
    v_accvgpr_read_b32 v8, a147
    v_mul_f32 v8, v8, v9
    v_accvgpr_write_b32 a147, v8
    v_accvgpr_read_b32 v8, a148
    v_mul_f32 v8, v8, v9
    v_accvgpr_write_b32 a148, v8
    v_accvgpr_read_b32 v8, a149
    v_mul_f32 v8, v8, v9
    v_accvgpr_write_b32 a149, v8
    v_accvgpr_read_b32 v8, a150
    v_mul_f32 v8, v8, v9
    v_accvgpr_write_b32 a150, v8
    v_accvgpr_read_b32 v8, a151
    v_mul_f32 v8, v8, v9
    v_accvgpr_write_b32 a151, v8
    v_accvgpr_read_b32 v8, a152
    v_mul_f32 v8, v8, v9
    v_accvgpr_write_b32 a152, v8
    v_accvgpr_read_b32 v8, a153
    v_mul_f32 v8, v8, v9
    v_accvgpr_write_b32 a153, v8
    v_accvgpr_read_b32 v8, a154
    v_mul_f32 v8, v8, v9
    v_accvgpr_write_b32 a154, v8
    v_accvgpr_read_b32 v8, a155
    v_mul_f32 v8, v8, v9
    v_accvgpr_write_b32 a155, v8
    v_accvgpr_read_b32 v8, a156
    v_mul_f32 v8, v8, v9
    v_accvgpr_write_b32 a156, v8
    v_accvgpr_read_b32 v8, a157
    v_mul_f32 v8, v8, v9
    v_accvgpr_write_b32 a157, v8
    v_accvgpr_read_b32 v8, a158
    v_mul_f32 v8, v8, v9
    v_accvgpr_write_b32 a158, v8
    v_accvgpr_read_b32 v8, a159
    v_mul_f32 v8, v8, v9
    v_accvgpr_write_b32 a159, v8
    v_sub_f32 v48, v48, v7
    v_sub_f32 v80, v80, v7
    v_sub_f32 v49, v49, v7
    v_sub_f32 v81, v81, v7
    v_sub_f32 v50, v50, v7
    v_sub_f32 v82, v82, v7
    v_sub_f32 v51, v51, v7
    v_sub_f32 v83, v83, v7
    v_sub_f32 v52, v52, v7
    v_sub_f32 v84, v84, v7
    v_sub_f32 v53, v53, v7
    v_sub_f32 v85, v85, v7
    v_sub_f32 v54, v54, v7
    v_sub_f32 v86, v86, v7
    v_sub_f32 v55, v55, v7
    v_sub_f32 v87, v87, v7
    v_exp_f32 v112, v48
    v_exp_f32 v113, v49
    v_exp_f32 v114, v50
    v_exp_f32 v115, v51
    v_exp_f32 v116, v52
    v_exp_f32 v117, v53
    v_exp_f32 v118, v54
    v_exp_f32 v119, v55
    s_nop 0
    v_cvt_pk_bf16_f32 v120, v112, v113
    v_cvt_pk_bf16_f32 v121, v114, v115
    v_cvt_pk_bf16_f32 v122, v116, v117
    v_cvt_pk_bf16_f32 v123, v118, v119
    s_nop 1
    v_mfma_f32_16x16x32_bf16 v[16:19], a[240:243], v[120:123], v[32:35]
    v_log_f32 v8, v36
    v_max3_f32 v7, v56, v57, v58
    v_max3_f32 v7, v7, v59, v60
    v_max3_f32 v7, v7, v61, v62
    v_max3_f32 v7, v7, v63, 0
    v_max_f32 v7, v7, v8
    v_mov_b32 v8, v7
    s_nop 1
    v_permlane16_swap_b32 v7, v8
    v_max_f32 v7, v7, v8
    v_mov_b32 v8, v7
    s_nop 1
    v_permlane32_swap_b32 v7, v8
    v_max_f32 v7, v7, v8
    v_exp_f32 v9, -v7
    v_sub_f32 v156, v156, v7
    v_sub_f32 v157, v157, v7
    v_sub_f32 v158, v158, v7
    v_sub_f32 v159, v159, v7
    v_mul_f32 v36, v36, v9
    v_mul_f32 v37, v37, v9
    v_mul_f32 v38, v38, v9
    v_mul_f32 v39, v39, v9
    v_mul_f32 v192, v192, v9
    v_mul_f32 v193, v193, v9
    v_mul_f32 v194, v194, v9
    v_mul_f32 v195, v195, v9
    v_mul_f32 v196, v196, v9
    v_mul_f32 v197, v197, v9
    v_mul_f32 v198, v198, v9
    v_mul_f32 v199, v199, v9
    v_mul_f32 v200, v200, v9
    v_mul_f32 v201, v201, v9
    v_mul_f32 v202, v202, v9
    v_mul_f32 v203, v203, v9
    v_mul_f32 v204, v204, v9
    v_mul_f32 v205, v205, v9
    v_mul_f32 v206, v206, v9
    v_mul_f32 v207, v207, v9
    v_mul_f32 v208, v208, v9
    v_mul_f32 v209, v209, v9
    v_mul_f32 v210, v210, v9
    v_mul_f32 v211, v211, v9
    v_mul_f32 v212, v212, v9
    v_mul_f32 v213, v213, v9
    v_mul_f32 v214, v214, v9
    v_mul_f32 v215, v215, v9
    v_mul_f32 v216, v216, v9
    v_mul_f32 v217, v217, v9
    v_mul_f32 v218, v218, v9
    v_mul_f32 v219, v219, v9
    v_mul_f32 v220, v220, v9
    v_mul_f32 v221, v221, v9
    v_mul_f32 v222, v222, v9
    v_mul_f32 v223, v223, v9
    v_sub_f32 v56, v56, v7
    v_sub_f32 v88, v88, v7
    v_sub_f32 v57, v57, v7
    v_sub_f32 v89, v89, v7
    v_sub_f32 v58, v58, v7
    v_sub_f32 v90, v90, v7
    v_sub_f32 v59, v59, v7
    v_sub_f32 v91, v91, v7
    v_sub_f32 v60, v60, v7
    v_sub_f32 v92, v92, v7
    v_sub_f32 v61, v61, v7
    v_sub_f32 v93, v93, v7
    v_sub_f32 v62, v62, v7
    v_sub_f32 v94, v94, v7
    v_sub_f32 v63, v63, v7
    v_sub_f32 v95, v95, v7
    v_exp_f32 v112, v56
    v_exp_f32 v113, v57
    v_exp_f32 v114, v58
    v_exp_f32 v115, v59
    v_exp_f32 v116, v60
    v_exp_f32 v117, v61
    v_exp_f32 v118, v62
    v_exp_f32 v119, v63
    s_nop 0
    v_cvt_pk_bf16_f32 v124, v112, v113
    v_cvt_pk_bf16_f32 v125, v114, v115
    v_cvt_pk_bf16_f32 v126, v116, v117
    v_cvt_pk_bf16_f32 v127, v118, v119
    s_nop 1
    v_mfma_f32_16x16x32_bf16 v[20:23], a[240:243], v[124:127], v[36:39]
    v_log_f32 v8, v40
    v_max3_f32 v7, v64, v65, v66
    v_max3_f32 v7, v7, v67, v68
    v_max3_f32 v7, v7, v69, v70
    v_max3_f32 v7, v7, v71, 0
    v_max_f32 v7, v7, v8
    v_mov_b32 v8, v7
    s_nop 1
    v_permlane16_swap_b32 v7, v8
    v_max_f32 v7, v7, v8
    v_mov_b32 v8, v7
    s_nop 1
    v_permlane32_swap_b32 v7, v8
    v_max_f32 v7, v7, v8
    v_exp_f32 v9, -v7
    v_sub_f32 v160, v160, v7
    v_sub_f32 v161, v161, v7
    v_sub_f32 v162, v162, v7
    v_sub_f32 v163, v163, v7
    v_mul_f32 v40, v40, v9
    v_mul_f32 v41, v41, v9
    v_mul_f32 v42, v42, v9
    v_mul_f32 v43, v43, v9
    v_accvgpr_read_b32 v8, a160
    v_mul_f32 v8, v8, v9
    v_accvgpr_write_b32 a160, v8
    v_accvgpr_read_b32 v8, a161
    v_mul_f32 v8, v8, v9
    v_accvgpr_write_b32 a161, v8
    v_accvgpr_read_b32 v8, a162
    v_mul_f32 v8, v8, v9
    v_accvgpr_write_b32 a162, v8
    v_accvgpr_read_b32 v8, a163
    v_mul_f32 v8, v8, v9
    v_accvgpr_write_b32 a163, v8
    v_accvgpr_read_b32 v8, a164
    v_mul_f32 v8, v8, v9
    v_accvgpr_write_b32 a164, v8
    v_accvgpr_read_b32 v8, a165
    v_mul_f32 v8, v8, v9
    v_accvgpr_write_b32 a165, v8
    v_accvgpr_read_b32 v8, a166
    v_mul_f32 v8, v8, v9
    v_accvgpr_write_b32 a166, v8
    v_accvgpr_read_b32 v8, a167
    v_mul_f32 v8, v8, v9
    v_accvgpr_write_b32 a167, v8
    v_accvgpr_read_b32 v8, a168
    v_mul_f32 v8, v8, v9
    v_accvgpr_write_b32 a168, v8
    v_accvgpr_read_b32 v8, a169
    v_mul_f32 v8, v8, v9
    v_accvgpr_write_b32 a169, v8
    v_accvgpr_read_b32 v8, a170
    v_mul_f32 v8, v8, v9
    v_accvgpr_write_b32 a170, v8
    v_accvgpr_read_b32 v8, a171
    v_mul_f32 v8, v8, v9
    v_accvgpr_write_b32 a171, v8
    v_accvgpr_read_b32 v8, a172
    v_mul_f32 v8, v8, v9
    v_accvgpr_write_b32 a172, v8
    v_accvgpr_read_b32 v8, a173
    v_mul_f32 v8, v8, v9
    v_accvgpr_write_b32 a173, v8
    v_accvgpr_read_b32 v8, a174
    v_mul_f32 v8, v8, v9
    v_accvgpr_write_b32 a174, v8
    v_accvgpr_read_b32 v8, a175
    v_mul_f32 v8, v8, v9
    v_accvgpr_write_b32 a175, v8
    v_accvgpr_read_b32 v8, a176
    v_mul_f32 v8, v8, v9
    v_accvgpr_write_b32 a176, v8
    v_accvgpr_read_b32 v8, a177
    v_mul_f32 v8, v8, v9
    v_accvgpr_write_b32 a177, v8
    v_accvgpr_read_b32 v8, a178
    v_mul_f32 v8, v8, v9
    v_accvgpr_write_b32 a178, v8
    v_accvgpr_read_b32 v8, a179
    v_mul_f32 v8, v8, v9
    v_accvgpr_write_b32 a179, v8
    v_accvgpr_read_b32 v8, a180
    v_mul_f32 v8, v8, v9
    v_accvgpr_write_b32 a180, v8
    v_accvgpr_read_b32 v8, a181
    v_mul_f32 v8, v8, v9
    v_accvgpr_write_b32 a181, v8
    v_accvgpr_read_b32 v8, a182
    v_mul_f32 v8, v8, v9
    v_accvgpr_write_b32 a182, v8
    v_accvgpr_read_b32 v8, a183
    v_mul_f32 v8, v8, v9
    v_accvgpr_write_b32 a183, v8
    v_accvgpr_read_b32 v8, a184
    v_mul_f32 v8, v8, v9
    v_accvgpr_write_b32 a184, v8
    v_accvgpr_read_b32 v8, a185
    v_mul_f32 v8, v8, v9
    v_accvgpr_write_b32 a185, v8
    v_accvgpr_read_b32 v8, a186
    v_mul_f32 v8, v8, v9
    v_accvgpr_write_b32 a186, v8
    v_accvgpr_read_b32 v8, a187
    v_mul_f32 v8, v8, v9
    v_accvgpr_write_b32 a187, v8
    v_accvgpr_read_b32 v8, a188
    v_mul_f32 v8, v8, v9
    v_accvgpr_write_b32 a188, v8
    v_accvgpr_read_b32 v8, a189
    v_mul_f32 v8, v8, v9
    v_accvgpr_write_b32 a189, v8
    v_accvgpr_read_b32 v8, a190
    v_mul_f32 v8, v8, v9
    v_accvgpr_write_b32 a190, v8
    v_accvgpr_read_b32 v8, a191
    v_mul_f32 v8, v8, v9
    v_accvgpr_write_b32 a191, v8
    v_sub_f32 v64, v64, v7
    v_sub_f32 v96, v96, v7
    v_sub_f32 v65, v65, v7
    v_sub_f32 v97, v97, v7
    v_sub_f32 v66, v66, v7
    v_sub_f32 v98, v98, v7
    v_sub_f32 v67, v67, v7
    v_sub_f32 v99, v99, v7
    v_sub_f32 v68, v68, v7
    v_sub_f32 v100, v100, v7
    v_sub_f32 v69, v69, v7
    v_sub_f32 v101, v101, v7
    v_sub_f32 v70, v70, v7
    v_sub_f32 v102, v102, v7
    v_sub_f32 v71, v71, v7
    v_sub_f32 v103, v103, v7
    v_exp_f32 v112, v64
    v_exp_f32 v113, v65
    v_exp_f32 v114, v66
    v_exp_f32 v115, v67
    v_exp_f32 v116, v68
    v_exp_f32 v117, v69
    v_exp_f32 v118, v70
    v_exp_f32 v119, v71
    s_nop 0
    v_cvt_pk_bf16_f32 v128, v112, v113
    v_cvt_pk_bf16_f32 v129, v114, v115
    v_cvt_pk_bf16_f32 v130, v116, v117
    v_cvt_pk_bf16_f32 v131, v118, v119
    s_nop 1
    v_mfma_f32_16x16x32_bf16 v[24:27], a[240:243], v[128:131], v[40:43]
    v_log_f32 v8, v44
    v_max3_f32 v7, v72, v73, v74
    v_max3_f32 v7, v7, v75, v76
    v_max3_f32 v7, v7, v77, v78
    v_max3_f32 v7, v7, v79, 0
    v_max_f32 v7, v7, v8
    v_mov_b32 v8, v7
    s_nop 1
    v_permlane16_swap_b32 v7, v8
    v_max_f32 v7, v7, v8
    v_mov_b32 v8, v7
    s_nop 1
    v_permlane32_swap_b32 v7, v8
    v_max_f32 v7, v7, v8
    v_exp_f32 v9, -v7
    v_sub_f32 v164, v164, v7
    v_sub_f32 v165, v165, v7
    v_sub_f32 v166, v166, v7
    v_sub_f32 v167, v167, v7
    v_mul_f32 v44, v44, v9
    v_mul_f32 v45, v45, v9
    v_mul_f32 v46, v46, v9
    v_mul_f32 v47, v47, v9
    v_mul_f32 v224, v224, v9
    v_mul_f32 v225, v225, v9
    v_mul_f32 v226, v226, v9
    v_mul_f32 v227, v227, v9
    v_mul_f32 v228, v228, v9
    v_mul_f32 v229, v229, v9
    v_mul_f32 v230, v230, v9
    v_mul_f32 v231, v231, v9
    v_mul_f32 v232, v232, v9
    v_mul_f32 v233, v233, v9
    v_mul_f32 v234, v234, v9
    v_mul_f32 v235, v235, v9
    v_mul_f32 v236, v236, v9
    v_mul_f32 v237, v237, v9
    v_mul_f32 v238, v238, v9
    v_mul_f32 v239, v239, v9
    v_mul_f32 v240, v240, v9
    v_mul_f32 v241, v241, v9
    v_mul_f32 v242, v242, v9
    v_mul_f32 v243, v243, v9
    v_mul_f32 v244, v244, v9
    v_mul_f32 v245, v245, v9
    v_mul_f32 v246, v246, v9
    v_mul_f32 v247, v247, v9
    v_mul_f32 v248, v248, v9
    v_mul_f32 v249, v249, v9
    v_mul_f32 v250, v250, v9
    v_mul_f32 v251, v251, v9
    v_mul_f32 v252, v252, v9
    v_mul_f32 v253, v253, v9
    v_mul_f32 v254, v254, v9
    v_mul_f32 v255, v255, v9
    v_sub_f32 v72, v72, v7
    v_sub_f32 v104, v104, v7
    v_sub_f32 v73, v73, v7
    v_sub_f32 v105, v105, v7
    v_sub_f32 v74, v74, v7
    v_sub_f32 v106, v106, v7
    v_sub_f32 v75, v75, v7
    v_sub_f32 v107, v107, v7
    v_sub_f32 v76, v76, v7
    v_sub_f32 v108, v108, v7
    v_sub_f32 v77, v77, v7
    v_sub_f32 v109, v109, v7
    v_sub_f32 v78, v78, v7
    v_sub_f32 v110, v110, v7
    v_sub_f32 v79, v79, v7
    v_sub_f32 v111, v111, v7
    v_exp_f32 v112, v72
    v_exp_f32 v113, v73
    v_exp_f32 v114, v74
    v_exp_f32 v115, v75
    v_exp_f32 v116, v76
    v_exp_f32 v117, v77
    v_exp_f32 v118, v78
    v_exp_f32 v119, v79
    s_nop 0
    v_cvt_pk_bf16_f32 v132, v112, v113
    v_cvt_pk_bf16_f32 v133, v114, v115
    v_cvt_pk_bf16_f32 v134, v116, v117
    v_cvt_pk_bf16_f32 v135, v118, v119
    s_nop 1
    v_mfma_f32_16x16x32_bf16 v[28:31], a[240:243], v[132:135], v[44:47]
    v_exp_f32 v112, v80
    v_exp_f32 v113, v81
    v_exp_f32 v114, v82
    v_exp_f32 v115, v83
    s_nop 7
    s_branch K2_BACK3
K2_SLOW4:
    s_nop 7
    s_nop 3
    v_log_f32 v8, v16
    v_max3_f32 v7, v80, v81, v82
    v_max3_f32 v7, v7, v83, v84
    v_max3_f32 v7, v7, v85, v86
    v_max3_f32 v7, v7, v87, 0
    v_max_f32 v7, v7, v8
    v_mov_b32 v8, v7
    s_nop 1
    v_permlane16_swap_b32 v7, v8
    v_max_f32 v7, v7, v8
    v_mov_b32 v8, v7
    s_nop 1
    v_permlane32_swap_b32 v7, v8
    v_max_f32 v7, v7, v8
    v_exp_f32 v9, -v7
    v_sub_f32 v152, v152, v7
    v_sub_f32 v153, v153, v7
    v_sub_f32 v154, v154, v7
    v_sub_f32 v155, v155, v7
    v_mul_f32 v16, v16, v9
    v_mul_f32 v17, v17, v9
    v_mul_f32 v18, v18, v9
    v_mul_f32 v19, v19, v9
    v_accvgpr_read_b32 v8, a128
    v_mul_f32 v8, v8, v9
    v_accvgpr_write_b32 a128, v8
    v_accvgpr_read_b32 v8, a129
    v_mul_f32 v8, v8, v9
    v_accvgpr_write_b32 a129, v8
    v_accvgpr_read_b32 v8, a130
    v_mul_f32 v8, v8, v9
    v_accvgpr_write_b32 a130, v8
    v_accvgpr_read_b32 v8, a131
    v_mul_f32 v8, v8, v9
    v_accvgpr_write_b32 a131, v8
    v_accvgpr_read_b32 v8, a132
    v_mul_f32 v8, v8, v9
    v_accvgpr_write_b32 a132, v8
    v_accvgpr_read_b32 v8, a133
    v_mul_f32 v8, v8, v9
    v_accvgpr_write_b32 a133, v8
    v_accvgpr_read_b32 v8, a134
    v_mul_f32 v8, v8, v9
    v_accvgpr_write_b32 a134, v8
    v_accvgpr_read_b32 v8, a135
    v_mul_f32 v8, v8, v9
    v_accvgpr_write_b32 a135, v8
    v_accvgpr_read_b32 v8, a136
    v_mul_f32 v8, v8, v9
    v_accvgpr_write_b32 a136, v8
    v_accvgpr_read_b32 v8, a137
    v_mul_f32 v8, v8, v9
    v_accvgpr_write_b32 a137, v8
    v_accvgpr_read_b32 v8, a138
    v_mul_f32 v8, v8, v9
    v_accvgpr_write_b32 a138, v8
    v_accvgpr_read_b32 v8, a139
    v_mul_f32 v8, v8, v9
    v_accvgpr_write_b32 a139, v8
    v_accvgpr_read_b32 v8, a140
    v_mul_f32 v8, v8, v9
    v_accvgpr_write_b32 a140, v8
    v_accvgpr_read_b32 v8, a141
    v_mul_f32 v8, v8, v9
    v_accvgpr_write_b32 a141, v8
    v_accvgpr_read_b32 v8, a142
    v_mul_f32 v8, v8, v9
    v_accvgpr_write_b32 a142, v8
    v_accvgpr_read_b32 v8, a143
    v_mul_f32 v8, v8, v9
    v_accvgpr_write_b32 a143, v8
    v_accvgpr_read_b32 v8, a144
    v_mul_f32 v8, v8, v9
    v_accvgpr_write_b32 a144, v8
    v_accvgpr_read_b32 v8, a145
    v_mul_f32 v8, v8, v9
    v_accvgpr_write_b32 a145, v8
    v_accvgpr_read_b32 v8, a146
    v_mul_f32 v8, v8, v9
    v_accvgpr_write_b32 a146, v8
    v_accvgpr_read_b32 v8, a147
    v_mul_f32 v8, v8, v9
    v_accvgpr_write_b32 a147, v8
    v_accvgpr_read_b32 v8, a148
    v_mul_f32 v8, v8, v9
    v_accvgpr_write_b32 a148, v8
    v_accvgpr_read_b32 v8, a149
    v_mul_f32 v8, v8, v9
    v_accvgpr_write_b32 a149, v8
    v_accvgpr_read_b32 v8, a150
    v_mul_f32 v8, v8, v9
    v_accvgpr_write_b32 a150, v8
    v_accvgpr_read_b32 v8, a151
    v_mul_f32 v8, v8, v9
    v_accvgpr_write_b32 a151, v8
    v_accvgpr_read_b32 v8, a152
    v_mul_f32 v8, v8, v9
    v_accvgpr_write_b32 a152, v8
    v_accvgpr_read_b32 v8, a153
    v_mul_f32 v8, v8, v9
    v_accvgpr_write_b32 a153, v8
    v_accvgpr_read_b32 v8, a154
    v_mul_f32 v8, v8, v9
    v_accvgpr_write_b32 a154, v8
    v_accvgpr_read_b32 v8, a155
    v_mul_f32 v8, v8, v9
    v_accvgpr_write_b32 a155, v8
    v_accvgpr_read_b32 v8, a156
    v_mul_f32 v8, v8, v9
    v_accvgpr_write_b32 a156, v8
    v_accvgpr_read_b32 v8, a157
    v_mul_f32 v8, v8, v9
    v_accvgpr_write_b32 a157, v8
    v_accvgpr_read_b32 v8, a158
    v_mul_f32 v8, v8, v9
    v_accvgpr_write_b32 a158, v8
    v_accvgpr_read_b32 v8, a159
    v_mul_f32 v8, v8, v9
    v_accvgpr_write_b32 a159, v8
    v_sub_f32 v80, v80, v7
    v_sub_f32 v48, v48, v7
    v_sub_f32 v81, v81, v7
    v_sub_f32 v49, v49, v7
    v_sub_f32 v82, v82, v7
    v_sub_f32 v50, v50, v7
    v_sub_f32 v83, v83, v7
    v_sub_f32 v51, v51, v7
    v_sub_f32 v84, v84, v7
    v_sub_f32 v52, v52, v7
    v_sub_f32 v85, v85, v7
    v_sub_f32 v53, v53, v7
    v_sub_f32 v86, v86, v7
    v_sub_f32 v54, v54, v7
    v_sub_f32 v87, v87, v7
    v_sub_f32 v55, v55, v7
    v_exp_f32 v112, v80
    v_exp_f32 v113, v81
    v_exp_f32 v114, v82
    v_exp_f32 v115, v83
    v_exp_f32 v116, v84
    v_exp_f32 v117, v85
    v_exp_f32 v118, v86
    v_exp_f32 v119, v87
    s_nop 0
    v_cvt_pk_bf16_f32 v136, v112, v113
    v_cvt_pk_bf16_f32 v137, v114, v115
    v_cvt_pk_bf16_f32 v138, v116, v117
    v_cvt_pk_bf16_f32 v139, v118, v119
    s_nop 1
    v_mfma_f32_16x16x32_bf16 v[32:35], a[240:243], v[136:139], v[16:19]
    v_log_f32 v8, v20
    v_max3_f32 v7, v88, v89, v90
    v_max3_f32 v7, v7, v91, v92
    v_max3_f32 v7, v7, v93, v94
    v_max3_f32 v7, v7, v95, 0
    v_max_f32 v7, v7, v8
    v_mov_b32 v8, v7
    s_nop 1
    v_permlane16_swap_b32 v7, v8
    v_max_f32 v7, v7, v8
    v_mov_b32 v8, v7
    s_nop 1
    v_permlane32_swap_b32 v7, v8
    v_max_f32 v7, v7, v8
    v_exp_f32 v9, -v7
    v_sub_f32 v156, v156, v7
    v_sub_f32 v157, v157, v7
    v_sub_f32 v158, v158, v7
    v_sub_f32 v159, v159, v7
    v_mul_f32 v20, v20, v9
    v_mul_f32 v21, v21, v9
    v_mul_f32 v22, v22, v9
    v_mul_f32 v23, v23, v9
    v_mul_f32 v192, v192, v9
    v_mul_f32 v193, v193, v9
    v_mul_f32 v194, v194, v9
    v_mul_f32 v195, v195, v9
    v_mul_f32 v196, v196, v9
    v_mul_f32 v197, v197, v9
    v_mul_f32 v198, v198, v9
    v_mul_f32 v199, v199, v9
    v_mul_f32 v200, v200, v9
    v_mul_f32 v201, v201, v9
    v_mul_f32 v202, v202, v9
    v_mul_f32 v203, v203, v9
    v_mul_f32 v204, v204, v9
    v_mul_f32 v205, v205, v9
    v_mul_f32 v206, v206, v9
    v_mul_f32 v207, v207, v9
    v_mul_f32 v208, v208, v9
    v_mul_f32 v209, v209, v9
    v_mul_f32 v210, v210, v9
    v_mul_f32 v211, v211, v9
    v_mul_f32 v212, v212, v9
    v_mul_f32 v213, v213, v9
    v_mul_f32 v214, v214, v9
    v_mul_f32 v215, v215, v9
    v_mul_f32 v216, v216, v9
    v_mul_f32 v217, v217, v9
    v_mul_f32 v218, v218, v9
    v_mul_f32 v219, v219, v9
    v_mul_f32 v220, v220, v9
    v_mul_f32 v221, v221, v9
    v_mul_f32 v222, v222, v9
    v_mul_f32 v223, v223, v9
    v_sub_f32 v88, v88, v7
    v_sub_f32 v56, v56, v7
    v_sub_f32 v89, v89, v7
    v_sub_f32 v57, v57, v7
    v_sub_f32 v90, v90, v7
    v_sub_f32 v58, v58, v7
    v_sub_f32 v91, v91, v7
    v_sub_f32 v59, v59, v7
    v_sub_f32 v92, v92, v7
    v_sub_f32 v60, v60, v7
    v_sub_f32 v93, v93, v7
    v_sub_f32 v61, v61, v7
    v_sub_f32 v94, v94, v7
    v_sub_f32 v62, v62, v7
    v_sub_f32 v95, v95, v7
    v_sub_f32 v63, v63, v7
    v_exp_f32 v112, v88
    v_exp_f32 v113, v89
    v_exp_f32 v114, v90
    v_exp_f32 v115, v91
    v_exp_f32 v116, v92
    v_exp_f32 v117, v93
    v_exp_f32 v118, v94
    v_exp_f32 v119, v95
    s_nop 0
    v_cvt_pk_bf16_f32 v140, v112, v113
    v_cvt_pk_bf16_f32 v141, v114, v115
    v_cvt_pk_bf16_f32 v142, v116, v117
    v_cvt_pk_bf16_f32 v143, v118, v119
    s_nop 1
    v_mfma_f32_16x16x32_bf16 v[36:39], a[240:243], v[140:143], v[20:23]
    v_log_f32 v8, v24
    v_max3_f32 v7, v96, v97, v98
    v_max3_f32 v7, v7, v99, v100
    v_max3_f32 v7, v7, v101, v102
    v_max3_f32 v7, v7, v103, 0
    v_max_f32 v7, v7, v8
    v_mov_b32 v8, v7
    s_nop 1
    v_permlane16_swap_b32 v7, v8
    v_max_f32 v7, v7, v8
    v_mov_b32 v8, v7
    s_nop 1
    v_permlane32_swap_b32 v7, v8
    v_max_f32 v7, v7, v8
    v_exp_f32 v9, -v7
    v_sub_f32 v160, v160, v7
    v_sub_f32 v161, v161, v7
    v_sub_f32 v162, v162, v7
    v_sub_f32 v163, v163, v7
    v_mul_f32 v24, v24, v9
    v_mul_f32 v25, v25, v9
    v_mul_f32 v26, v26, v9
    v_mul_f32 v27, v27, v9
    v_accvgpr_read_b32 v8, a160
    v_mul_f32 v8, v8, v9
    v_accvgpr_write_b32 a160, v8
    v_accvgpr_read_b32 v8, a161
    v_mul_f32 v8, v8, v9
    v_accvgpr_write_b32 a161, v8
    v_accvgpr_read_b32 v8, a162
    v_mul_f32 v8, v8, v9
    v_accvgpr_write_b32 a162, v8
    v_accvgpr_read_b32 v8, a163
    v_mul_f32 v8, v8, v9
    v_accvgpr_write_b32 a163, v8
    v_accvgpr_read_b32 v8, a164
    v_mul_f32 v8, v8, v9
    v_accvgpr_write_b32 a164, v8
    v_accvgpr_read_b32 v8, a165
    v_mul_f32 v8, v8, v9
    v_accvgpr_write_b32 a165, v8
    v_accvgpr_read_b32 v8, a166
    v_mul_f32 v8, v8, v9
    v_accvgpr_write_b32 a166, v8
    v_accvgpr_read_b32 v8, a167
    v_mul_f32 v8, v8, v9
    v_accvgpr_write_b32 a167, v8
    v_accvgpr_read_b32 v8, a168
    v_mul_f32 v8, v8, v9
    v_accvgpr_write_b32 a168, v8
    v_accvgpr_read_b32 v8, a169
    v_mul_f32 v8, v8, v9
    v_accvgpr_write_b32 a169, v8
    v_accvgpr_read_b32 v8, a170
    v_mul_f32 v8, v8, v9
    v_accvgpr_write_b32 a170, v8
    v_accvgpr_read_b32 v8, a171
    v_mul_f32 v8, v8, v9
    v_accvgpr_write_b32 a171, v8
    v_accvgpr_read_b32 v8, a172
    v_mul_f32 v8, v8, v9
    v_accvgpr_write_b32 a172, v8
    v_accvgpr_read_b32 v8, a173
    v_mul_f32 v8, v8, v9
    v_accvgpr_write_b32 a173, v8
    v_accvgpr_read_b32 v8, a174
    v_mul_f32 v8, v8, v9
    v_accvgpr_write_b32 a174, v8
    v_accvgpr_read_b32 v8, a175
    v_mul_f32 v8, v8, v9
    v_accvgpr_write_b32 a175, v8
    v_accvgpr_read_b32 v8, a176
    v_mul_f32 v8, v8, v9
    v_accvgpr_write_b32 a176, v8
    v_accvgpr_read_b32 v8, a177
    v_mul_f32 v8, v8, v9
    v_accvgpr_write_b32 a177, v8
    v_accvgpr_read_b32 v8, a178
    v_mul_f32 v8, v8, v9
    v_accvgpr_write_b32 a178, v8
    v_accvgpr_read_b32 v8, a179
    v_mul_f32 v8, v8, v9
    v_accvgpr_write_b32 a179, v8
    v_accvgpr_read_b32 v8, a180
    v_mul_f32 v8, v8, v9
    v_accvgpr_write_b32 a180, v8
    v_accvgpr_read_b32 v8, a181
    v_mul_f32 v8, v8, v9
    v_accvgpr_write_b32 a181, v8
    v_accvgpr_read_b32 v8, a182
    v_mul_f32 v8, v8, v9
    v_accvgpr_write_b32 a182, v8
    v_accvgpr_read_b32 v8, a183
    v_mul_f32 v8, v8, v9
    v_accvgpr_write_b32 a183, v8
    v_accvgpr_read_b32 v8, a184
    v_mul_f32 v8, v8, v9
    v_accvgpr_write_b32 a184, v8
    v_accvgpr_read_b32 v8, a185
    v_mul_f32 v8, v8, v9
    v_accvgpr_write_b32 a185, v8
    v_accvgpr_read_b32 v8, a186
    v_mul_f32 v8, v8, v9
    v_accvgpr_write_b32 a186, v8
    v_accvgpr_read_b32 v8, a187
    v_mul_f32 v8, v8, v9
    v_accvgpr_write_b32 a187, v8
    v_accvgpr_read_b32 v8, a188
    v_mul_f32 v8, v8, v9
    v_accvgpr_write_b32 a188, v8
    v_accvgpr_read_b32 v8, a189
    v_mul_f32 v8, v8, v9
    v_accvgpr_write_b32 a189, v8
    v_accvgpr_read_b32 v8, a190
    v_mul_f32 v8, v8, v9
    v_accvgpr_write_b32 a190, v8
    v_accvgpr_read_b32 v8, a191
    v_mul_f32 v8, v8, v9
    v_accvgpr_write_b32 a191, v8
    v_sub_f32 v96, v96, v7
    v_sub_f32 v64, v64, v7
    v_sub_f32 v97, v97, v7
    v_sub_f32 v65, v65, v7
    v_sub_f32 v98, v98, v7
    v_sub_f32 v66, v66, v7
    v_sub_f32 v99, v99, v7
    v_sub_f32 v67, v67, v7
    v_sub_f32 v100, v100, v7
    v_sub_f32 v68, v68, v7
    v_sub_f32 v101, v101, v7
    v_sub_f32 v69, v69, v7
    v_sub_f32 v102, v102, v7
    v_sub_f32 v70, v70, v7
    v_sub_f32 v103, v103, v7
    v_sub_f32 v71, v71, v7
    v_exp_f32 v112, v96
    v_exp_f32 v113, v97
    v_exp_f32 v114, v98
    v_exp_f32 v115, v99
    v_exp_f32 v116, v100
    v_exp_f32 v117, v101
    v_exp_f32 v118, v102
    v_exp_f32 v119, v103
    s_nop 0
    v_cvt_pk_bf16_f32 v144, v112, v113
    v_cvt_pk_bf16_f32 v145, v114, v115
    v_cvt_pk_bf16_f32 v146, v116, v117
    v_cvt_pk_bf16_f32 v147, v118, v119
    s_nop 1
    v_mfma_f32_16x16x32_bf16 v[40:43], a[240:243], v[144:147], v[24:27]
    v_log_f32 v8, v28
    v_max3_f32 v7, v104, v105, v106
    v_max3_f32 v7, v7, v107, v108
    v_max3_f32 v7, v7, v109, v110
    v_max3_f32 v7, v7, v111, 0
    v_max_f32 v7, v7, v8
    v_mov_b32 v8, v7
    s_nop 1
    v_permlane16_swap_b32 v7, v8
    v_max_f32 v7, v7, v8
    v_mov_b32 v8, v7
    s_nop 1
    v_permlane32_swap_b32 v7, v8
    v_max_f32 v7, v7, v8
    v_exp_f32 v9, -v7
    v_sub_f32 v164, v164, v7
    v_sub_f32 v165, v165, v7
    v_sub_f32 v166, v166, v7
    v_sub_f32 v167, v167, v7
    v_mul_f32 v28, v28, v9
    v_mul_f32 v29, v29, v9
    v_mul_f32 v30, v30, v9
    v_mul_f32 v31, v31, v9
    v_mul_f32 v224, v224, v9
    v_mul_f32 v225, v225, v9
    v_mul_f32 v226, v226, v9
    v_mul_f32 v227, v227, v9
    v_mul_f32 v228, v228, v9
    v_mul_f32 v229, v229, v9
    v_mul_f32 v230, v230, v9
    v_mul_f32 v231, v231, v9
    v_mul_f32 v232, v232, v9
    v_mul_f32 v233, v233, v9
    v_mul_f32 v234, v234, v9
    v_mul_f32 v235, v235, v9
    v_mul_f32 v236, v236, v9
    v_mul_f32 v237, v237, v9
    v_mul_f32 v238, v238, v9
    v_mul_f32 v239, v239, v9
    v_mul_f32 v240, v240, v9
    v_mul_f32 v241, v241, v9
    v_mul_f32 v242, v242, v9
    v_mul_f32 v243, v243, v9
    v_mul_f32 v244, v244, v9
    v_mul_f32 v245, v245, v9
    v_mul_f32 v246, v246, v9
    v_mul_f32 v247, v247, v9
    v_mul_f32 v248, v248, v9
    v_mul_f32 v249, v249, v9
    v_mul_f32 v250, v250, v9
    v_mul_f32 v251, v251, v9
    v_mul_f32 v252, v252, v9
    v_mul_f32 v253, v253, v9
    v_mul_f32 v254, v254, v9
    v_mul_f32 v255, v255, v9
    v_sub_f32 v104, v104, v7
    v_sub_f32 v72, v72, v7
    v_sub_f32 v105, v105, v7
    v_sub_f32 v73, v73, v7
    v_sub_f32 v106, v106, v7
    v_sub_f32 v74, v74, v7
    v_sub_f32 v107, v107, v7
    v_sub_f32 v75, v75, v7
    v_sub_f32 v108, v108, v7
    v_sub_f32 v76, v76, v7
    v_sub_f32 v109, v109, v7
    v_sub_f32 v77, v77, v7
    v_sub_f32 v110, v110, v7
    v_sub_f32 v78, v78, v7
    v_sub_f32 v111, v111, v7
    v_sub_f32 v79, v79, v7
    v_exp_f32 v112, v104
    v_exp_f32 v113, v105
    v_exp_f32 v114, v106
    v_exp_f32 v115, v107
    v_exp_f32 v116, v108
    v_exp_f32 v117, v109
    v_exp_f32 v118, v110
    v_exp_f32 v119, v111
    s_nop 0
    v_cvt_pk_bf16_f32 v148, v112, v113
    v_cvt_pk_bf16_f32 v149, v114, v115
    v_cvt_pk_bf16_f32 v150, v116, v117
    v_cvt_pk_bf16_f32 v151, v118, v119
    s_nop 1
    v_mfma_f32_16x16x32_bf16 v[44:47], a[240:243], v[148:151], v[28:31]
    v_exp_f32 v112, v48
    v_exp_f32 v113, v49
    v_exp_f32 v114, v50
    v_exp_f32 v115, v51
    s_nop 7
    s_branch K2_BACK4
K2_SLOW5:
    s_nop 7
    s_nop 3
    v_log_f32 v8, v32
    v_max3_f32 v7, v48, v49, v50
    v_max3_f32 v7, v7, v51, v52
    v_max3_f32 v7, v7, v53, v54
    v_max3_f32 v7, v7, v55, 0
    v_max_f32 v7, v7, v8
    v_mov_b32 v8, v7
    s_nop 1
    v_permlane16_swap_b32 v7, v8
    v_max_f32 v7, v7, v8
    v_mov_b32 v8, v7
    s_nop 1
    v_permlane32_swap_b32 v7, v8
    v_max_f32 v7, v7, v8
    v_exp_f32 v9, -v7
    v_sub_f32 v152, v152, v7
    v_sub_f32 v153, v153, v7
    v_sub_f32 v154, v154, v7
    v_sub_f32 v155, v155, v7
    v_mul_f32 v32, v32, v9
    v_mul_f32 v33, v33, v9
    v_mul_f32 v34, v34, v9
    v_mul_f32 v35, v35, v9
    v_accvgpr_read_b32 v8, a128
    v_mul_f32 v8, v8, v9
    v_accvgpr_write_b32 a128, v8
    v_accvgpr_read_b32 v8, a129
    v_mul_f32 v8, v8, v9
    v_accvgpr_write_b32 a129, v8
    v_accvgpr_read_b32 v8, a130
    v_mul_f32 v8, v8, v9
    v_accvgpr_write_b32 a130, v8
    v_accvgpr_read_b32 v8, a131
    v_mul_f32 v8, v8, v9
    v_accvgpr_write_b32 a131, v8
    v_accvgpr_read_b32 v8, a132
    v_mul_f32 v8, v8, v9
    v_accvgpr_write_b32 a132, v8
    v_accvgpr_read_b32 v8, a133
    v_mul_f32 v8, v8, v9
    v_accvgpr_write_b32 a133, v8
    v_accvgpr_read_b32 v8, a134
    v_mul_f32 v8, v8, v9
    v_accvgpr_write_b32 a134, v8
    v_accvgpr_read_b32 v8, a135
    v_mul_f32 v8, v8, v9
    v_accvgpr_write_b32 a135, v8
    v_accvgpr_read_b32 v8, a136
    v_mul_f32 v8, v8, v9
    v_accvgpr_write_b32 a136, v8
    v_accvgpr_read_b32 v8, a137
    v_mul_f32 v8, v8, v9
    v_accvgpr_write_b32 a137, v8
    v_accvgpr_read_b32 v8, a138
    v_mul_f32 v8, v8, v9
    v_accvgpr_write_b32 a138, v8
    v_accvgpr_read_b32 v8, a139
    v_mul_f32 v8, v8, v9
    v_accvgpr_write_b32 a139, v8
    v_accvgpr_read_b32 v8, a140
    v_mul_f32 v8, v8, v9
    v_accvgpr_write_b32 a140, v8
    v_accvgpr_read_b32 v8, a141
    v_mul_f32 v8, v8, v9
    v_accvgpr_write_b32 a141, v8
    v_accvgpr_read_b32 v8, a142
    v_mul_f32 v8, v8, v9
    v_accvgpr_write_b32 a142, v8
    v_accvgpr_read_b32 v8, a143
    v_mul_f32 v8, v8, v9
    v_accvgpr_write_b32 a143, v8
    v_accvgpr_read_b32 v8, a144
    v_mul_f32 v8, v8, v9
    v_accvgpr_write_b32 a144, v8
    v_accvgpr_read_b32 v8, a145
    v_mul_f32 v8, v8, v9
    v_accvgpr_write_b32 a145, v8
    v_accvgpr_read_b32 v8, a146
    v_mul_f32 v8, v8, v9
    v_accvgpr_write_b32 a146, v8
    v_accvgpr_read_b32 v8, a147
    v_mul_f32 v8, v8, v9
    v_accvgpr_write_b32 a147, v8
    v_accvgpr_read_b32 v8, a148
    v_mul_f32 v8, v8, v9
    v_accvgpr_write_b32 a148, v8
    v_accvgpr_read_b32 v8, a149
    v_mul_f32 v8, v8, v9
    v_accvgpr_write_b32 a149, v8
    v_accvgpr_read_b32 v8, a150
    v_mul_f32 v8, v8, v9
    v_accvgpr_write_b32 a150, v8
    v_accvgpr_read_b32 v8, a151
    v_mul_f32 v8, v8, v9
    v_accvgpr_write_b32 a151, v8
    v_accvgpr_read_b32 v8, a152
    v_mul_f32 v8, v8, v9
    v_accvgpr_write_b32 a152, v8
    v_accvgpr_read_b32 v8, a153
    v_mul_f32 v8, v8, v9
    v_accvgpr_write_b32 a153, v8
    v_accvgpr_read_b32 v8, a154
    v_mul_f32 v8, v8, v9
    v_accvgpr_write_b32 a154, v8
    v_accvgpr_read_b32 v8, a155
    v_mul_f32 v8, v8, v9
    v_accvgpr_write_b32 a155, v8
    v_accvgpr_read_b32 v8, a156
    v_mul_f32 v8, v8, v9
    v_accvgpr_write_b32 a156, v8
    v_accvgpr_read_b32 v8, a157
    v_mul_f32 v8, v8, v9
    v_accvgpr_write_b32 a157, v8
    v_accvgpr_read_b32 v8, a158
    v_mul_f32 v8, v8, v9
    v_accvgpr_write_b32 a158, v8
    v_accvgpr_read_b32 v8, a159
    v_mul_f32 v8, v8, v9
    v_accvgpr_write_b32 a159, v8
    v_sub_f32 v48, v48, v7
    v_sub_f32 v80, v80, v7
    v_sub_f32 v49, v49, v7
    v_sub_f32 v81, v81, v7
    v_sub_f32 v50, v50, v7
    v_sub_f32 v82, v82, v7
    v_sub_f32 v51, v51, v7
    v_sub_f32 v83, v83, v7
    v_sub_f32 v52, v52, v7
    v_sub_f32 v84, v84, v7
    v_sub_f32 v53, v53, v7
    v_sub_f32 v85, v85, v7
    v_sub_f32 v54, v54, v7
    v_sub_f32 v86, v86, v7
    v_sub_f32 v55, v55, v7
    v_sub_f32 v87, v87, v7
    v_exp_f32 v112, v48
    v_exp_f32 v113, v49
    v_exp_f32 v114, v50
    v_exp_f32 v115, v51
    v_exp_f32 v116, v52
    v_exp_f32 v117, v53
    v_exp_f32 v118, v54
    v_exp_f32 v119, v55
    s_nop 0
    v_cvt_pk_bf16_f32 v120, v112, v113
    v_cvt_pk_bf16_f32 v121, v114, v115
    v_cvt_pk_bf16_f32 v122, v116, v117
    v_cvt_pk_bf16_f32 v123, v118, v119
    s_nop 1
    v_mfma_f32_16x16x32_bf16 v[16:19], a[240:243], v[120:123], v[32:35]
    v_log_f32 v8, v36
    v_max3_f32 v7, v56, v57, v58
    v_max3_f32 v7, v7, v59, v60
    v_max3_f32 v7, v7, v61, v62
    v_max3_f32 v7, v7, v63, 0
    v_max_f32 v7, v7, v8
    v_mov_b32 v8, v7
    s_nop 1
    v_permlane16_swap_b32 v7, v8
    v_max_f32 v7, v7, v8
    v_mov_b32 v8, v7
    s_nop 1
    v_permlane32_swap_b32 v7, v8
    v_max_f32 v7, v7, v8
    v_exp_f32 v9, -v7
    v_sub_f32 v156, v156, v7
    v_sub_f32 v157, v157, v7
    v_sub_f32 v158, v158, v7
    v_sub_f32 v159, v159, v7
    v_mul_f32 v36, v36, v9
    v_mul_f32 v37, v37, v9
    v_mul_f32 v38, v38, v9
    v_mul_f32 v39, v39, v9
    v_mul_f32 v192, v192, v9
    v_mul_f32 v193, v193, v9
    v_mul_f32 v194, v194, v9
    v_mul_f32 v195, v195, v9
    v_mul_f32 v196, v196, v9
    v_mul_f32 v197, v197, v9
    v_mul_f32 v198, v198, v9
    v_mul_f32 v199, v199, v9
    v_mul_f32 v200, v200, v9
    v_mul_f32 v201, v201, v9
    v_mul_f32 v202, v202, v9
    v_mul_f32 v203, v203, v9
    v_mul_f32 v204, v204, v9
    v_mul_f32 v205, v205, v9
    v_mul_f32 v206, v206, v9
    v_mul_f32 v207, v207, v9
    v_mul_f32 v208, v208, v9
    v_mul_f32 v209, v209, v9
    v_mul_f32 v210, v210, v9
    v_mul_f32 v211, v211, v9
    v_mul_f32 v212, v212, v9
    v_mul_f32 v213, v213, v9
    v_mul_f32 v214, v214, v9
    v_mul_f32 v215, v215, v9
    v_mul_f32 v216, v216, v9
    v_mul_f32 v217, v217, v9
    v_mul_f32 v218, v218, v9
    v_mul_f32 v219, v219, v9
    v_mul_f32 v220, v220, v9
    v_mul_f32 v221, v221, v9
    v_mul_f32 v222, v222, v9
    v_mul_f32 v223, v223, v9
    v_sub_f32 v56, v56, v7
    v_sub_f32 v88, v88, v7
    v_sub_f32 v57, v57, v7
    v_sub_f32 v89, v89, v7
    v_sub_f32 v58, v58, v7
    v_sub_f32 v90, v90, v7
    v_sub_f32 v59, v59, v7
    v_sub_f32 v91, v91, v7
    v_sub_f32 v60, v60, v7
    v_sub_f32 v92, v92, v7
    v_sub_f32 v61, v61, v7
    v_sub_f32 v93, v93, v7
    v_sub_f32 v62, v62, v7
    v_sub_f32 v94, v94, v7
    v_sub_f32 v63, v63, v7
    v_sub_f32 v95, v95, v7
    v_exp_f32 v112, v56
    v_exp_f32 v113, v57
    v_exp_f32 v114, v58
    v_exp_f32 v115, v59
    v_exp_f32 v116, v60
    v_exp_f32 v117, v61
    v_exp_f32 v118, v62
    v_exp_f32 v119, v63
    s_nop 0
    v_cvt_pk_bf16_f32 v124, v112, v113
    v_cvt_pk_bf16_f32 v125, v114, v115
    v_cvt_pk_bf16_f32 v126, v116, v117
    v_cvt_pk_bf16_f32 v127, v118, v119
    s_nop 1
    v_mfma_f32_16x16x32_bf16 v[20:23], a[240:243], v[124:127], v[36:39]
    v_log_f32 v8, v40
    v_max3_f32 v7, v64, v65, v66
    v_max3_f32 v7, v7, v67, v68
    v_max3_f32 v7, v7, v69, v70
    v_max3_f32 v7, v7, v71, 0
    v_max_f32 v7, v7, v8
    v_mov_b32 v8, v7
    s_nop 1
    v_permlane16_swap_b32 v7, v8
    v_max_f32 v7, v7, v8
    v_mov_b32 v8, v7
    s_nop 1
    v_permlane32_swap_b32 v7, v8
    v_max_f32 v7, v7, v8
    v_exp_f32 v9, -v7
    v_sub_f32 v160, v160, v7
    v_sub_f32 v161, v161, v7
    v_sub_f32 v162, v162, v7
    v_sub_f32 v163, v163, v7
    v_mul_f32 v40, v40, v9
    v_mul_f32 v41, v41, v9
    v_mul_f32 v42, v42, v9
    v_mul_f32 v43, v43, v9
    v_accvgpr_read_b32 v8, a160
    v_mul_f32 v8, v8, v9
    v_accvgpr_write_b32 a160, v8
    v_accvgpr_read_b32 v8, a161
    v_mul_f32 v8, v8, v9
    v_accvgpr_write_b32 a161, v8
    v_accvgpr_read_b32 v8, a162
    v_mul_f32 v8, v8, v9
    v_accvgpr_write_b32 a162, v8
    v_accvgpr_read_b32 v8, a163
    v_mul_f32 v8, v8, v9
    v_accvgpr_write_b32 a163, v8
    v_accvgpr_read_b32 v8, a164
    v_mul_f32 v8, v8, v9
    v_accvgpr_write_b32 a164, v8
    v_accvgpr_read_b32 v8, a165
    v_mul_f32 v8, v8, v9
    v_accvgpr_write_b32 a165, v8
    v_accvgpr_read_b32 v8, a166
    v_mul_f32 v8, v8, v9
    v_accvgpr_write_b32 a166, v8
    v_accvgpr_read_b32 v8, a167
    v_mul_f32 v8, v8, v9
    v_accvgpr_write_b32 a167, v8
    v_accvgpr_read_b32 v8, a168
    v_mul_f32 v8, v8, v9
    v_accvgpr_write_b32 a168, v8
    v_accvgpr_read_b32 v8, a169
    v_mul_f32 v8, v8, v9
    v_accvgpr_write_b32 a169, v8
    v_accvgpr_read_b32 v8, a170
    v_mul_f32 v8, v8, v9
    v_accvgpr_write_b32 a170, v8
    v_accvgpr_read_b32 v8, a171
    v_mul_f32 v8, v8, v9
    v_accvgpr_write_b32 a171, v8
    v_accvgpr_read_b32 v8, a172
    v_mul_f32 v8, v8, v9
    v_accvgpr_write_b32 a172, v8
    v_accvgpr_read_b32 v8, a173
    v_mul_f32 v8, v8, v9
    v_accvgpr_write_b32 a173, v8
    v_accvgpr_read_b32 v8, a174
    v_mul_f32 v8, v8, v9
    v_accvgpr_write_b32 a174, v8
    v_accvgpr_read_b32 v8, a175
    v_mul_f32 v8, v8, v9
    v_accvgpr_write_b32 a175, v8
    v_accvgpr_read_b32 v8, a176
    v_mul_f32 v8, v8, v9
    v_accvgpr_write_b32 a176, v8
    v_accvgpr_read_b32 v8, a177
    v_mul_f32 v8, v8, v9
    v_accvgpr_write_b32 a177, v8
    v_accvgpr_read_b32 v8, a178
    v_mul_f32 v8, v8, v9
    v_accvgpr_write_b32 a178, v8
    v_accvgpr_read_b32 v8, a179
    v_mul_f32 v8, v8, v9
    v_accvgpr_write_b32 a179, v8
    v_accvgpr_read_b32 v8, a180
    v_mul_f32 v8, v8, v9
    v_accvgpr_write_b32 a180, v8
    v_accvgpr_read_b32 v8, a181
    v_mul_f32 v8, v8, v9
    v_accvgpr_write_b32 a181, v8
    v_accvgpr_read_b32 v8, a182
    v_mul_f32 v8, v8, v9
    v_accvgpr_write_b32 a182, v8
    v_accvgpr_read_b32 v8, a183
    v_mul_f32 v8, v8, v9
    v_accvgpr_write_b32 a183, v8
    v_accvgpr_read_b32 v8, a184
    v_mul_f32 v8, v8, v9
    v_accvgpr_write_b32 a184, v8
    v_accvgpr_read_b32 v8, a185
    v_mul_f32 v8, v8, v9
    v_accvgpr_write_b32 a185, v8
    v_accvgpr_read_b32 v8, a186
    v_mul_f32 v8, v8, v9
    v_accvgpr_write_b32 a186, v8
    v_accvgpr_read_b32 v8, a187
    v_mul_f32 v8, v8, v9
    v_accvgpr_write_b32 a187, v8
    v_accvgpr_read_b32 v8, a188
    v_mul_f32 v8, v8, v9
    v_accvgpr_write_b32 a188, v8
    v_accvgpr_read_b32 v8, a189
    v_mul_f32 v8, v8, v9
    v_accvgpr_write_b32 a189, v8
    v_accvgpr_read_b32 v8, a190
    v_mul_f32 v8, v8, v9
    v_accvgpr_write_b32 a190, v8
    v_accvgpr_read_b32 v8, a191
    v_mul_f32 v8, v8, v9
    v_accvgpr_write_b32 a191, v8
    v_sub_f32 v64, v64, v7
    v_sub_f32 v96, v96, v7
    v_sub_f32 v65, v65, v7
    v_sub_f32 v97, v97, v7
    v_sub_f32 v66, v66, v7
    v_sub_f32 v98, v98, v7
    v_sub_f32 v67, v67, v7
    v_sub_f32 v99, v99, v7
    v_sub_f32 v68, v68, v7
    v_sub_f32 v100, v100, v7
    v_sub_f32 v69, v69, v7
    v_sub_f32 v101, v101, v7
    v_sub_f32 v70, v70, v7
    v_sub_f32 v102, v102, v7
    v_sub_f32 v71, v71, v7
    v_sub_f32 v103, v103, v7
    v_exp_f32 v112, v64
    v_exp_f32 v113, v65
    v_exp_f32 v114, v66
    v_exp_f32 v115, v67
    v_exp_f32 v116, v68
    v_exp_f32 v117, v69
    v_exp_f32 v118, v70
    v_exp_f32 v119, v71
    s_nop 0
    v_cvt_pk_bf16_f32 v128, v112, v113
    v_cvt_pk_bf16_f32 v129, v114, v115
    v_cvt_pk_bf16_f32 v130, v116, v117
    v_cvt_pk_bf16_f32 v131, v118, v119
    s_nop 1
    v_mfma_f32_16x16x32_bf16 v[24:27], a[240:243], v[128:131], v[40:43]
    v_log_f32 v8, v44
    v_max3_f32 v7, v72, v73, v74
    v_max3_f32 v7, v7, v75, v76
    v_max3_f32 v7, v7, v77, v78
    v_max3_f32 v7, v7, v79, 0
    v_max_f32 v7, v7, v8
    v_mov_b32 v8, v7
    s_nop 1
    v_permlane16_swap_b32 v7, v8
    v_max_f32 v7, v7, v8
    v_mov_b32 v8, v7
    s_nop 1
    v_permlane32_swap_b32 v7, v8
    v_max_f32 v7, v7, v8
    v_exp_f32 v9, -v7
    v_sub_f32 v164, v164, v7
    v_sub_f32 v165, v165, v7
    v_sub_f32 v166, v166, v7
    v_sub_f32 v167, v167, v7
    v_mul_f32 v44, v44, v9
    v_mul_f32 v45, v45, v9
    v_mul_f32 v46, v46, v9
    v_mul_f32 v47, v47, v9
    v_mul_f32 v224, v224, v9
    v_mul_f32 v225, v225, v9
    v_mul_f32 v226, v226, v9
    v_mul_f32 v227, v227, v9
    v_mul_f32 v228, v228, v9
    v_mul_f32 v229, v229, v9
    v_mul_f32 v230, v230, v9
    v_mul_f32 v231, v231, v9
    v_mul_f32 v232, v232, v9
    v_mul_f32 v233, v233, v9
    v_mul_f32 v234, v234, v9
    v_mul_f32 v235, v235, v9
    v_mul_f32 v236, v236, v9
    v_mul_f32 v237, v237, v9
    v_mul_f32 v238, v238, v9
    v_mul_f32 v239, v239, v9
    v_mul_f32 v240, v240, v9
    v_mul_f32 v241, v241, v9
    v_mul_f32 v242, v242, v9
    v_mul_f32 v243, v243, v9
    v_mul_f32 v244, v244, v9
    v_mul_f32 v245, v245, v9
    v_mul_f32 v246, v246, v9
    v_mul_f32 v247, v247, v9
    v_mul_f32 v248, v248, v9
    v_mul_f32 v249, v249, v9
    v_mul_f32 v250, v250, v9
    v_mul_f32 v251, v251, v9
    v_mul_f32 v252, v252, v9
    v_mul_f32 v253, v253, v9
    v_mul_f32 v254, v254, v9
    v_mul_f32 v255, v255, v9
    v_sub_f32 v72, v72, v7
    v_sub_f32 v104, v104, v7
    v_sub_f32 v73, v73, v7
    v_sub_f32 v105, v105, v7
    v_sub_f32 v74, v74, v7
    v_sub_f32 v106, v106, v7
    v_sub_f32 v75, v75, v7
    v_sub_f32 v107, v107, v7
    v_sub_f32 v76, v76, v7
    v_sub_f32 v108, v108, v7
    v_sub_f32 v77, v77, v7
    v_sub_f32 v109, v109, v7
    v_sub_f32 v78, v78, v7
    v_sub_f32 v110, v110, v7
    v_sub_f32 v79, v79, v7
    v_sub_f32 v111, v111, v7
    v_exp_f32 v112, v72
    v_exp_f32 v113, v73
    v_exp_f32 v114, v74
    v_exp_f32 v115, v75
    v_exp_f32 v116, v76
    v_exp_f32 v117, v77
    v_exp_f32 v118, v78
    v_exp_f32 v119, v79
    s_nop 0
    v_cvt_pk_bf16_f32 v132, v112, v113
    v_cvt_pk_bf16_f32 v133, v114, v115
    v_cvt_pk_bf16_f32 v134, v116, v117
    v_cvt_pk_bf16_f32 v135, v118, v119
    s_nop 1
    v_mfma_f32_16x16x32_bf16 v[28:31], a[240:243], v[132:135], v[44:47]
    v_exp_f32 v112, v80
    v_exp_f32 v113, v81
    v_exp_f32 v114, v82
    v_exp_f32 v115, v83
    s_nop 7
    s_branch K2_BACK5
K2_SLOW6:
    s_nop 7
    s_nop 3
    v_log_f32 v8, v16
    v_max3_f32 v7, v80, v81, v82
    v_max3_f32 v7, v7, v83, v84
    v_max3_f32 v7, v7, v85, v86
    v_max3_f32 v7, v7, v87, 0
    v_max_f32 v7, v7, v8
    v_mov_b32 v8, v7
    s_nop 1
    v_permlane16_swap_b32 v7, v8
    v_max_f32 v7, v7, v8
    v_mov_b32 v8, v7
    s_nop 1
    v_permlane32_swap_b32 v7, v8
    v_max_f32 v7, v7, v8
    v_exp_f32 v9, -v7
    v_sub_f32 v152, v152, v7
    v_sub_f32 v153, v153, v7
    v_sub_f32 v154, v154, v7
    v_sub_f32 v155, v155, v7
    v_mul_f32 v16, v16, v9
    v_mul_f32 v17, v17, v9
    v_mul_f32 v18, v18, v9
    v_mul_f32 v19, v19, v9
    v_accvgpr_read_b32 v8, a128
    v_mul_f32 v8, v8, v9
    v_accvgpr_write_b32 a128, v8
    v_accvgpr_read_b32 v8, a129
    v_mul_f32 v8, v8, v9
    v_accvgpr_write_b32 a129, v8
    v_accvgpr_read_b32 v8, a130
    v_mul_f32 v8, v8, v9
    v_accvgpr_write_b32 a130, v8
    v_accvgpr_read_b32 v8, a131
    v_mul_f32 v8, v8, v9
    v_accvgpr_write_b32 a131, v8
    v_accvgpr_read_b32 v8, a132
    v_mul_f32 v8, v8, v9
    v_accvgpr_write_b32 a132, v8
    v_accvgpr_read_b32 v8, a133
    v_mul_f32 v8, v8, v9
    v_accvgpr_write_b32 a133, v8
    v_accvgpr_read_b32 v8, a134
    v_mul_f32 v8, v8, v9
    v_accvgpr_write_b32 a134, v8
    v_accvgpr_read_b32 v8, a135
    v_mul_f32 v8, v8, v9
    v_accvgpr_write_b32 a135, v8
    v_accvgpr_read_b32 v8, a136
    v_mul_f32 v8, v8, v9
    v_accvgpr_write_b32 a136, v8
    v_accvgpr_read_b32 v8, a137
    v_mul_f32 v8, v8, v9
    v_accvgpr_write_b32 a137, v8
    v_accvgpr_read_b32 v8, a138
    v_mul_f32 v8, v8, v9
    v_accvgpr_write_b32 a138, v8
    v_accvgpr_read_b32 v8, a139
    v_mul_f32 v8, v8, v9
    v_accvgpr_write_b32 a139, v8
    v_accvgpr_read_b32 v8, a140
    v_mul_f32 v8, v8, v9
    v_accvgpr_write_b32 a140, v8
    v_accvgpr_read_b32 v8, a141
    v_mul_f32 v8, v8, v9
    v_accvgpr_write_b32 a141, v8
    v_accvgpr_read_b32 v8, a142
    v_mul_f32 v8, v8, v9
    v_accvgpr_write_b32 a142, v8
    v_accvgpr_read_b32 v8, a143
    v_mul_f32 v8, v8, v9
    v_accvgpr_write_b32 a143, v8
    v_accvgpr_read_b32 v8, a144
    v_mul_f32 v8, v8, v9
    v_accvgpr_write_b32 a144, v8
    v_accvgpr_read_b32 v8, a145
    v_mul_f32 v8, v8, v9
    v_accvgpr_write_b32 a145, v8
    v_accvgpr_read_b32 v8, a146
    v_mul_f32 v8, v8, v9
    v_accvgpr_write_b32 a146, v8
    v_accvgpr_read_b32 v8, a147
    v_mul_f32 v8, v8, v9
    v_accvgpr_write_b32 a147, v8
    v_accvgpr_read_b32 v8, a148
    v_mul_f32 v8, v8, v9
    v_accvgpr_write_b32 a148, v8
    v_accvgpr_read_b32 v8, a149
    v_mul_f32 v8, v8, v9
    v_accvgpr_write_b32 a149, v8
    v_accvgpr_read_b32 v8, a150
    v_mul_f32 v8, v8, v9
    v_accvgpr_write_b32 a150, v8
    v_accvgpr_read_b32 v8, a151
    v_mul_f32 v8, v8, v9
    v_accvgpr_write_b32 a151, v8
    v_accvgpr_read_b32 v8, a152
    v_mul_f32 v8, v8, v9
    v_accvgpr_write_b32 a152, v8
    v_accvgpr_read_b32 v8, a153
    v_mul_f32 v8, v8, v9
    v_accvgpr_write_b32 a153, v8
    v_accvgpr_read_b32 v8, a154
    v_mul_f32 v8, v8, v9
    v_accvgpr_write_b32 a154, v8
    v_accvgpr_read_b32 v8, a155
    v_mul_f32 v8, v8, v9
    v_accvgpr_write_b32 a155, v8
    v_accvgpr_read_b32 v8, a156
    v_mul_f32 v8, v8, v9
    v_accvgpr_write_b32 a156, v8
    v_accvgpr_read_b32 v8, a157
    v_mul_f32 v8, v8, v9
    v_accvgpr_write_b32 a157, v8
    v_accvgpr_read_b32 v8, a158
    v_mul_f32 v8, v8, v9
    v_accvgpr_write_b32 a158, v8
    v_accvgpr_read_b32 v8, a159
    v_mul_f32 v8, v8, v9
    v_accvgpr_write_b32 a159, v8
    v_sub_f32 v80, v80, v7
    v_sub_f32 v48, v48, v7
    v_sub_f32 v81, v81, v7
    v_sub_f32 v49, v49, v7
    v_sub_f32 v82, v82, v7
    v_sub_f32 v50, v50, v7
    v_sub_f32 v83, v83, v7
    v_sub_f32 v51, v51, v7
    v_sub_f32 v84, v84, v7
    v_sub_f32 v52, v52, v7
    v_sub_f32 v85, v85, v7
    v_sub_f32 v53, v53, v7
    v_sub_f32 v86, v86, v7
    v_sub_f32 v54, v54, v7
    v_sub_f32 v87, v87, v7
    v_sub_f32 v55, v55, v7
    v_exp_f32 v112, v80
    v_exp_f32 v113, v81
    v_exp_f32 v114, v82
    v_exp_f32 v115, v83
    v_exp_f32 v116, v84
    v_exp_f32 v117, v85
    v_exp_f32 v118, v86
    v_exp_f32 v119, v87
    s_nop 0
    v_cvt_pk_bf16_f32 v136, v112, v113
    v_cvt_pk_bf16_f32 v137, v114, v115
    v_cvt_pk_bf16_f32 v138, v116, v117
    v_cvt_pk_bf16_f32 v139, v118, v119
    s_nop 1
    v_mfma_f32_16x16x32_bf16 v[32:35], a[240:243], v[136:139], v[16:19]
    v_log_f32 v8, v20
    v_max3_f32 v7, v88, v89, v90
    v_max3_f32 v7, v7, v91, v92
    v_max3_f32 v7, v7, v93, v94
    v_max3_f32 v7, v7, v95, 0
    v_max_f32 v7, v7, v8
    v_mov_b32 v8, v7
    s_nop 1
    v_permlane16_swap_b32 v7, v8
    v_max_f32 v7, v7, v8
    v_mov_b32 v8, v7
    s_nop 1
    v_permlane32_swap_b32 v7, v8
    v_max_f32 v7, v7, v8
    v_exp_f32 v9, -v7
    v_sub_f32 v156, v156, v7
    v_sub_f32 v157, v157, v7
    v_sub_f32 v158, v158, v7
    v_sub_f32 v159, v159, v7
    v_mul_f32 v20, v20, v9
    v_mul_f32 v21, v21, v9
    v_mul_f32 v22, v22, v9
    v_mul_f32 v23, v23, v9
    v_mul_f32 v192, v192, v9
    v_mul_f32 v193, v193, v9
    v_mul_f32 v194, v194, v9
    v_mul_f32 v195, v195, v9
    v_mul_f32 v196, v196, v9
    v_mul_f32 v197, v197, v9
    v_mul_f32 v198, v198, v9
    v_mul_f32 v199, v199, v9
    v_mul_f32 v200, v200, v9
    v_mul_f32 v201, v201, v9
    v_mul_f32 v202, v202, v9
    v_mul_f32 v203, v203, v9
    v_mul_f32 v204, v204, v9
    v_mul_f32 v205, v205, v9
    v_mul_f32 v206, v206, v9
    v_mul_f32 v207, v207, v9
    v_mul_f32 v208, v208, v9
    v_mul_f32 v209, v209, v9
    v_mul_f32 v210, v210, v9
    v_mul_f32 v211, v211, v9
    v_mul_f32 v212, v212, v9
    v_mul_f32 v213, v213, v9
    v_mul_f32 v214, v214, v9
    v_mul_f32 v215, v215, v9
    v_mul_f32 v216, v216, v9
    v_mul_f32 v217, v217, v9
    v_mul_f32 v218, v218, v9
    v_mul_f32 v219, v219, v9
    v_mul_f32 v220, v220, v9
    v_mul_f32 v221, v221, v9
    v_mul_f32 v222, v222, v9
    v_mul_f32 v223, v223, v9
    v_sub_f32 v88, v88, v7
    v_sub_f32 v56, v56, v7
    v_sub_f32 v89, v89, v7
    v_sub_f32 v57, v57, v7
    v_sub_f32 v90, v90, v7
    v_sub_f32 v58, v58, v7
    v_sub_f32 v91, v91, v7
    v_sub_f32 v59, v59, v7
    v_sub_f32 v92, v92, v7
    v_sub_f32 v60, v60, v7
    v_sub_f32 v93, v93, v7
    v_sub_f32 v61, v61, v7
    v_sub_f32 v94, v94, v7
    v_sub_f32 v62, v62, v7
    v_sub_f32 v95, v95, v7
    v_sub_f32 v63, v63, v7
    v_exp_f32 v112, v88
    v_exp_f32 v113, v89
    v_exp_f32 v114, v90
    v_exp_f32 v115, v91
    v_exp_f32 v116, v92
    v_exp_f32 v117, v93
    v_exp_f32 v118, v94
    v_exp_f32 v119, v95
    s_nop 0
    v_cvt_pk_bf16_f32 v140, v112, v113
    v_cvt_pk_bf16_f32 v141, v114, v115
    v_cvt_pk_bf16_f32 v142, v116, v117
    v_cvt_pk_bf16_f32 v143, v118, v119
    s_nop 1
    v_mfma_f32_16x16x32_bf16 v[36:39], a[240:243], v[140:143], v[20:23]
    v_log_f32 v8, v24
    v_max3_f32 v7, v96, v97, v98
    v_max3_f32 v7, v7, v99, v100
    v_max3_f32 v7, v7, v101, v102
    v_max3_f32 v7, v7, v103, 0
    v_max_f32 v7, v7, v8
    v_mov_b32 v8, v7
    s_nop 1
    v_permlane16_swap_b32 v7, v8
    v_max_f32 v7, v7, v8
    v_mov_b32 v8, v7
    s_nop 1
    v_permlane32_swap_b32 v7, v8
    v_max_f32 v7, v7, v8
    v_exp_f32 v9, -v7
    v_sub_f32 v160, v160, v7
    v_sub_f32 v161, v161, v7
    v_sub_f32 v162, v162, v7
    v_sub_f32 v163, v163, v7
    v_mul_f32 v24, v24, v9
    v_mul_f32 v25, v25, v9
    v_mul_f32 v26, v26, v9
    v_mul_f32 v27, v27, v9
    v_accvgpr_read_b32 v8, a160
    v_mul_f32 v8, v8, v9
    v_accvgpr_write_b32 a160, v8
    v_accvgpr_read_b32 v8, a161
    v_mul_f32 v8, v8, v9
    v_accvgpr_write_b32 a161, v8
    v_accvgpr_read_b32 v8, a162
    v_mul_f32 v8, v8, v9
    v_accvgpr_write_b32 a162, v8
    v_accvgpr_read_b32 v8, a163
    v_mul_f32 v8, v8, v9
    v_accvgpr_write_b32 a163, v8
    v_accvgpr_read_b32 v8, a164
    v_mul_f32 v8, v8, v9
    v_accvgpr_write_b32 a164, v8
    v_accvgpr_read_b32 v8, a165
    v_mul_f32 v8, v8, v9
    v_accvgpr_write_b32 a165, v8
    v_accvgpr_read_b32 v8, a166
    v_mul_f32 v8, v8, v9
    v_accvgpr_write_b32 a166, v8
    v_accvgpr_read_b32 v8, a167
    v_mul_f32 v8, v8, v9
    v_accvgpr_write_b32 a167, v8
    v_accvgpr_read_b32 v8, a168
    v_mul_f32 v8, v8, v9
    v_accvgpr_write_b32 a168, v8
    v_accvgpr_read_b32 v8, a169
    v_mul_f32 v8, v8, v9
    v_accvgpr_write_b32 a169, v8
    v_accvgpr_read_b32 v8, a170
    v_mul_f32 v8, v8, v9
    v_accvgpr_write_b32 a170, v8
    v_accvgpr_read_b32 v8, a171
    v_mul_f32 v8, v8, v9
    v_accvgpr_write_b32 a171, v8
    v_accvgpr_read_b32 v8, a172
    v_mul_f32 v8, v8, v9
    v_accvgpr_write_b32 a172, v8
    v_accvgpr_read_b32 v8, a173
    v_mul_f32 v8, v8, v9
    v_accvgpr_write_b32 a173, v8
    v_accvgpr_read_b32 v8, a174
    v_mul_f32 v8, v8, v9
    v_accvgpr_write_b32 a174, v8
    v_accvgpr_read_b32 v8, a175
    v_mul_f32 v8, v8, v9
    v_accvgpr_write_b32 a175, v8
    v_accvgpr_read_b32 v8, a176
    v_mul_f32 v8, v8, v9
    v_accvgpr_write_b32 a176, v8
    v_accvgpr_read_b32 v8, a177
    v_mul_f32 v8, v8, v9
    v_accvgpr_write_b32 a177, v8
    v_accvgpr_read_b32 v8, a178
    v_mul_f32 v8, v8, v9
    v_accvgpr_write_b32 a178, v8
    v_accvgpr_read_b32 v8, a179
    v_mul_f32 v8, v8, v9
    v_accvgpr_write_b32 a179, v8
    v_accvgpr_read_b32 v8, a180
    v_mul_f32 v8, v8, v9
    v_accvgpr_write_b32 a180, v8
    v_accvgpr_read_b32 v8, a181
    v_mul_f32 v8, v8, v9
    v_accvgpr_write_b32 a181, v8
    v_accvgpr_read_b32 v8, a182
    v_mul_f32 v8, v8, v9
    v_accvgpr_write_b32 a182, v8
    v_accvgpr_read_b32 v8, a183
    v_mul_f32 v8, v8, v9
    v_accvgpr_write_b32 a183, v8
    v_accvgpr_read_b32 v8, a184
    v_mul_f32 v8, v8, v9
    v_accvgpr_write_b32 a184, v8
    v_accvgpr_read_b32 v8, a185
    v_mul_f32 v8, v8, v9
    v_accvgpr_write_b32 a185, v8
    v_accvgpr_read_b32 v8, a186
    v_mul_f32 v8, v8, v9
    v_accvgpr_write_b32 a186, v8
    v_accvgpr_read_b32 v8, a187
    v_mul_f32 v8, v8, v9
    v_accvgpr_write_b32 a187, v8
    v_accvgpr_read_b32 v8, a188
    v_mul_f32 v8, v8, v9
    v_accvgpr_write_b32 a188, v8
    v_accvgpr_read_b32 v8, a189
    v_mul_f32 v8, v8, v9
    v_accvgpr_write_b32 a189, v8
    v_accvgpr_read_b32 v8, a190
    v_mul_f32 v8, v8, v9
    v_accvgpr_write_b32 a190, v8
    v_accvgpr_read_b32 v8, a191
    v_mul_f32 v8, v8, v9
    v_accvgpr_write_b32 a191, v8
    v_sub_f32 v96, v96, v7
    v_sub_f32 v64, v64, v7
    v_sub_f32 v97, v97, v7
    v_sub_f32 v65, v65, v7
    v_sub_f32 v98, v98, v7
    v_sub_f32 v66, v66, v7
    v_sub_f32 v99, v99, v7
    v_sub_f32 v67, v67, v7
    v_sub_f32 v100, v100, v7
    v_sub_f32 v68, v68, v7
    v_sub_f32 v101, v101, v7
    v_sub_f32 v69, v69, v7
    v_sub_f32 v102, v102, v7
    v_sub_f32 v70, v70, v7
    v_sub_f32 v103, v103, v7
    v_sub_f32 v71, v71, v7
    v_exp_f32 v112, v96
    v_exp_f32 v113, v97
    v_exp_f32 v114, v98
    v_exp_f32 v115, v99
    v_exp_f32 v116, v100
    v_exp_f32 v117, v101
    v_exp_f32 v118, v102
    v_exp_f32 v119, v103
    s_nop 0
    v_cvt_pk_bf16_f32 v144, v112, v113
    v_cvt_pk_bf16_f32 v145, v114, v115
    v_cvt_pk_bf16_f32 v146, v116, v117
    v_cvt_pk_bf16_f32 v147, v118, v119
    s_nop 1
    v_mfma_f32_16x16x32_bf16 v[40:43], a[240:243], v[144:147], v[24:27]
    v_log_f32 v8, v28
    v_max3_f32 v7, v104, v105, v106
    v_max3_f32 v7, v7, v107, v108
    v_max3_f32 v7, v7, v109, v110
    v_max3_f32 v7, v7, v111, 0
    v_max_f32 v7, v7, v8
    v_mov_b32 v8, v7
    s_nop 1
    v_permlane16_swap_b32 v7, v8
    v_max_f32 v7, v7, v8
    v_mov_b32 v8, v7
    s_nop 1
    v_permlane32_swap_b32 v7, v8
    v_max_f32 v7, v7, v8
    v_exp_f32 v9, -v7
    v_sub_f32 v164, v164, v7
    v_sub_f32 v165, v165, v7
    v_sub_f32 v166, v166, v7
    v_sub_f32 v167, v167, v7
    v_mul_f32 v28, v28, v9
    v_mul_f32 v29, v29, v9
    v_mul_f32 v30, v30, v9
    v_mul_f32 v31, v31, v9
    v_mul_f32 v224, v224, v9
    v_mul_f32 v225, v225, v9
    v_mul_f32 v226, v226, v9
    v_mul_f32 v227, v227, v9
    v_mul_f32 v228, v228, v9
    v_mul_f32 v229, v229, v9
    v_mul_f32 v230, v230, v9
    v_mul_f32 v231, v231, v9
    v_mul_f32 v232, v232, v9
    v_mul_f32 v233, v233, v9
    v_mul_f32 v234, v234, v9
    v_mul_f32 v235, v235, v9
    v_mul_f32 v236, v236, v9
    v_mul_f32 v237, v237, v9
    v_mul_f32 v238, v238, v9
    v_mul_f32 v239, v239, v9
    v_mul_f32 v240, v240, v9
    v_mul_f32 v241, v241, v9
    v_mul_f32 v242, v242, v9
    v_mul_f32 v243, v243, v9
    v_mul_f32 v244, v244, v9
    v_mul_f32 v245, v245, v9
    v_mul_f32 v246, v246, v9
    v_mul_f32 v247, v247, v9
    v_mul_f32 v248, v248, v9
    v_mul_f32 v249, v249, v9
    v_mul_f32 v250, v250, v9
    v_mul_f32 v251, v251, v9
    v_mul_f32 v252, v252, v9
    v_mul_f32 v253, v253, v9
    v_mul_f32 v254, v254, v9
    v_mul_f32 v255, v255, v9
    v_sub_f32 v104, v104, v7
    v_sub_f32 v72, v72, v7
    v_sub_f32 v105, v105, v7
    v_sub_f32 v73, v73, v7
    v_sub_f32 v106, v106, v7
    v_sub_f32 v74, v74, v7
    v_sub_f32 v107, v107, v7
    v_sub_f32 v75, v75, v7
    v_sub_f32 v108, v108, v7
    v_sub_f32 v76, v76, v7
    v_sub_f32 v109, v109, v7
    v_sub_f32 v77, v77, v7
    v_sub_f32 v110, v110, v7
    v_sub_f32 v78, v78, v7
    v_sub_f32 v111, v111, v7
    v_sub_f32 v79, v79, v7
    v_exp_f32 v112, v104
    v_exp_f32 v113, v105
    v_exp_f32 v114, v106
    v_exp_f32 v115, v107
    v_exp_f32 v116, v108
    v_exp_f32 v117, v109
    v_exp_f32 v118, v110
    v_exp_f32 v119, v111
    s_nop 0
    v_cvt_pk_bf16_f32 v148, v112, v113
    v_cvt_pk_bf16_f32 v149, v114, v115
    v_cvt_pk_bf16_f32 v150, v116, v117
    v_cvt_pk_bf16_f32 v151, v118, v119
    s_nop 1
    v_mfma_f32_16x16x32_bf16 v[44:47], a[240:243], v[148:151], v[28:31]
    v_exp_f32 v112, v48
    v_exp_f32 v113, v49
    v_exp_f32 v114, v50
    v_exp_f32 v115, v51
    s_nop 7
    s_branch K2_BACK6
K2_SLOW7:
    s_nop 7
    s_nop 3
    v_log_f32 v8, v32
    v_max3_f32 v7, v48, v49, v50
    v_max3_f32 v7, v7, v51, v52
    v_max3_f32 v7, v7, v53, v54
    v_max3_f32 v7, v7, v55, 0
    v_max_f32 v7, v7, v8
    v_mov_b32 v8, v7
    s_nop 1
    v_permlane16_swap_b32 v7, v8
    v_max_f32 v7, v7, v8
    v_mov_b32 v8, v7
    s_nop 1
    v_permlane32_swap_b32 v7, v8
    v_max_f32 v7, v7, v8
    v_exp_f32 v9, -v7
    v_sub_f32 v152, v152, v7
    v_sub_f32 v153, v153, v7
    v_sub_f32 v154, v154, v7
    v_sub_f32 v155, v155, v7
    v_mul_f32 v32, v32, v9
    v_mul_f32 v33, v33, v9
    v_mul_f32 v34, v34, v9
    v_mul_f32 v35, v35, v9
    v_accvgpr_read_b32 v8, a128
    v_mul_f32 v8, v8, v9
    v_accvgpr_write_b32 a128, v8
    v_accvgpr_read_b32 v8, a129
    v_mul_f32 v8, v8, v9
    v_accvgpr_write_b32 a129, v8
    v_accvgpr_read_b32 v8, a130
    v_mul_f32 v8, v8, v9
    v_accvgpr_write_b32 a130, v8
    v_accvgpr_read_b32 v8, a131
    v_mul_f32 v8, v8, v9
    v_accvgpr_write_b32 a131, v8
    v_accvgpr_read_b32 v8, a132
    v_mul_f32 v8, v8, v9
    v_accvgpr_write_b32 a132, v8
    v_accvgpr_read_b32 v8, a133
    v_mul_f32 v8, v8, v9
    v_accvgpr_write_b32 a133, v8
    v_accvgpr_read_b32 v8, a134
    v_mul_f32 v8, v8, v9
    v_accvgpr_write_b32 a134, v8
    v_accvgpr_read_b32 v8, a135
    v_mul_f32 v8, v8, v9
    v_accvgpr_write_b32 a135, v8
    v_accvgpr_read_b32 v8, a136
    v_mul_f32 v8, v8, v9
    v_accvgpr_write_b32 a136, v8
    v_accvgpr_read_b32 v8, a137
    v_mul_f32 v8, v8, v9
    v_accvgpr_write_b32 a137, v8
    v_accvgpr_read_b32 v8, a138
    v_mul_f32 v8, v8, v9
    v_accvgpr_write_b32 a138, v8
    v_accvgpr_read_b32 v8, a139
    v_mul_f32 v8, v8, v9
    v_accvgpr_write_b32 a139, v8
    v_accvgpr_read_b32 v8, a140
    v_mul_f32 v8, v8, v9
    v_accvgpr_write_b32 a140, v8
    v_accvgpr_read_b32 v8, a141
    v_mul_f32 v8, v8, v9
    v_accvgpr_write_b32 a141, v8
    v_accvgpr_read_b32 v8, a142
    v_mul_f32 v8, v8, v9
    v_accvgpr_write_b32 a142, v8
    v_accvgpr_read_b32 v8, a143
    v_mul_f32 v8, v8, v9
    v_accvgpr_write_b32 a143, v8
    v_accvgpr_read_b32 v8, a144
    v_mul_f32 v8, v8, v9
    v_accvgpr_write_b32 a144, v8
    v_accvgpr_read_b32 v8, a145
    v_mul_f32 v8, v8, v9
    v_accvgpr_write_b32 a145, v8
    v_accvgpr_read_b32 v8, a146
    v_mul_f32 v8, v8, v9
    v_accvgpr_write_b32 a146, v8
    v_accvgpr_read_b32 v8, a147
    v_mul_f32 v8, v8, v9
    v_accvgpr_write_b32 a147, v8
    v_accvgpr_read_b32 v8, a148
    v_mul_f32 v8, v8, v9
    v_accvgpr_write_b32 a148, v8
    v_accvgpr_read_b32 v8, a149
    v_mul_f32 v8, v8, v9
    v_accvgpr_write_b32 a149, v8
    v_accvgpr_read_b32 v8, a150
    v_mul_f32 v8, v8, v9
    v_accvgpr_write_b32 a150, v8
    v_accvgpr_read_b32 v8, a151
    v_mul_f32 v8, v8, v9
    v_accvgpr_write_b32 a151, v8
    v_accvgpr_read_b32 v8, a152
    v_mul_f32 v8, v8, v9
    v_accvgpr_write_b32 a152, v8
    v_accvgpr_read_b32 v8, a153
    v_mul_f32 v8, v8, v9
    v_accvgpr_write_b32 a153, v8
    v_accvgpr_read_b32 v8, a154
    v_mul_f32 v8, v8, v9
    v_accvgpr_write_b32 a154, v8
    v_accvgpr_read_b32 v8, a155
    v_mul_f32 v8, v8, v9
    v_accvgpr_write_b32 a155, v8
    v_accvgpr_read_b32 v8, a156
    v_mul_f32 v8, v8, v9
    v_accvgpr_write_b32 a156, v8
    v_accvgpr_read_b32 v8, a157
    v_mul_f32 v8, v8, v9
    v_accvgpr_write_b32 a157, v8
    v_accvgpr_read_b32 v8, a158
    v_mul_f32 v8, v8, v9
    v_accvgpr_write_b32 a158, v8
    v_accvgpr_read_b32 v8, a159
    v_mul_f32 v8, v8, v9
    v_accvgpr_write_b32 a159, v8
    v_sub_f32 v48, v48, v7
    v_sub_f32 v80, v80, v7
    v_sub_f32 v49, v49, v7
    v_sub_f32 v81, v81, v7
    v_sub_f32 v50, v50, v7
    v_sub_f32 v82, v82, v7
    v_sub_f32 v51, v51, v7
    v_sub_f32 v83, v83, v7
    v_sub_f32 v52, v52, v7
    v_sub_f32 v84, v84, v7
    v_sub_f32 v53, v53, v7
    v_sub_f32 v85, v85, v7
    v_sub_f32 v54, v54, v7
    v_sub_f32 v86, v86, v7
    v_sub_f32 v55, v55, v7
    v_sub_f32 v87, v87, v7
    v_exp_f32 v112, v48
    v_exp_f32 v113, v49
    v_exp_f32 v114, v50
    v_exp_f32 v115, v51
    v_exp_f32 v116, v52
    v_exp_f32 v117, v53
    v_exp_f32 v118, v54
    v_exp_f32 v119, v55
    s_nop 0
    v_cvt_pk_bf16_f32 v120, v112, v113
    v_cvt_pk_bf16_f32 v121, v114, v115
    v_cvt_pk_bf16_f32 v122, v116, v117
    v_cvt_pk_bf16_f32 v123, v118, v119
    s_nop 1
    v_mfma_f32_16x16x32_bf16 v[16:19], a[240:243], v[120:123], v[32:35]
    v_log_f32 v8, v36
    v_max3_f32 v7, v56, v57, v58
    v_max3_f32 v7, v7, v59, v60
    v_max3_f32 v7, v7, v61, v62
    v_max3_f32 v7, v7, v63, 0
    v_max_f32 v7, v7, v8
    v_mov_b32 v8, v7
    s_nop 1
    v_permlane16_swap_b32 v7, v8
    v_max_f32 v7, v7, v8
    v_mov_b32 v8, v7
    s_nop 1
    v_permlane32_swap_b32 v7, v8
    v_max_f32 v7, v7, v8
    v_exp_f32 v9, -v7
    v_sub_f32 v156, v156, v7
    v_sub_f32 v157, v157, v7
    v_sub_f32 v158, v158, v7
    v_sub_f32 v159, v159, v7
    v_mul_f32 v36, v36, v9
    v_mul_f32 v37, v37, v9
    v_mul_f32 v38, v38, v9
    v_mul_f32 v39, v39, v9
    v_mul_f32 v192, v192, v9
    v_mul_f32 v193, v193, v9
    v_mul_f32 v194, v194, v9
    v_mul_f32 v195, v195, v9
    v_mul_f32 v196, v196, v9
    v_mul_f32 v197, v197, v9
    v_mul_f32 v198, v198, v9
    v_mul_f32 v199, v199, v9
    v_mul_f32 v200, v200, v9
    v_mul_f32 v201, v201, v9
    v_mul_f32 v202, v202, v9
    v_mul_f32 v203, v203, v9
    v_mul_f32 v204, v204, v9
    v_mul_f32 v205, v205, v9
    v_mul_f32 v206, v206, v9
    v_mul_f32 v207, v207, v9
    v_mul_f32 v208, v208, v9
    v_mul_f32 v209, v209, v9
    v_mul_f32 v210, v210, v9
    v_mul_f32 v211, v211, v9
    v_mul_f32 v212, v212, v9
    v_mul_f32 v213, v213, v9
    v_mul_f32 v214, v214, v9
    v_mul_f32 v215, v215, v9
    v_mul_f32 v216, v216, v9
    v_mul_f32 v217, v217, v9
    v_mul_f32 v218, v218, v9
    v_mul_f32 v219, v219, v9
    v_mul_f32 v220, v220, v9
    v_mul_f32 v221, v221, v9
    v_mul_f32 v222, v222, v9
    v_mul_f32 v223, v223, v9
    v_sub_f32 v56, v56, v7
    v_sub_f32 v88, v88, v7
    v_sub_f32 v57, v57, v7
    v_sub_f32 v89, v89, v7
    v_sub_f32 v58, v58, v7
    v_sub_f32 v90, v90, v7
    v_sub_f32 v59, v59, v7
    v_sub_f32 v91, v91, v7
    v_sub_f32 v60, v60, v7
    v_sub_f32 v92, v92, v7
    v_sub_f32 v61, v61, v7
    v_sub_f32 v93, v93, v7
    v_sub_f32 v62, v62, v7
    v_sub_f32 v94, v94, v7
    v_sub_f32 v63, v63, v7
    v_sub_f32 v95, v95, v7
    v_exp_f32 v112, v56
    v_exp_f32 v113, v57
    v_exp_f32 v114, v58
    v_exp_f32 v115, v59
    v_exp_f32 v116, v60
    v_exp_f32 v117, v61
    v_exp_f32 v118, v62
    v_exp_f32 v119, v63
    s_nop 0
    v_cvt_pk_bf16_f32 v124, v112, v113
    v_cvt_pk_bf16_f32 v125, v114, v115
    v_cvt_pk_bf16_f32 v126, v116, v117
    v_cvt_pk_bf16_f32 v127, v118, v119
    s_nop 1
    v_mfma_f32_16x16x32_bf16 v[20:23], a[240:243], v[124:127], v[36:39]
    v_log_f32 v8, v44
    v_max3_f32 v7, v72, v73, v74
    v_max3_f32 v7, v7, v75, v76
    v_max3_f32 v7, v7, v77, v78
    v_max3_f32 v7, v7, v79, 0
    v_max_f32 v7, v7, v8
    v_mov_b32 v8, v7
    s_nop 1
    v_permlane16_swap_b32 v7, v8
    v_max_f32 v7, v7, v8
    v_mov_b32 v8, v7
    s_nop 1
    v_permlane32_swap_b32 v7, v8
    v_max_f32 v7, v7, v8
    v_exp_f32 v9, -v7
    v_sub_f32 v164, v164, v7
    v_sub_f32 v165, v165, v7
    v_sub_f32 v166, v166, v7
    v_sub_f32 v167, v167, v7
    v_mul_f32 v44, v44, v9
    v_mul_f32 v45, v45, v9
    v_mul_f32 v46, v46, v9
    v_mul_f32 v47, v47, v9
    v_mul_f32 v224, v224, v9
    v_mul_f32 v225, v225, v9
    v_mul_f32 v226, v226, v9
    v_mul_f32 v227, v227, v9
    v_mul_f32 v228, v228, v9
    v_mul_f32 v229, v229, v9
    v_mul_f32 v230, v230, v9
    v_mul_f32 v231, v231, v9
    v_mul_f32 v232, v232, v9
    v_mul_f32 v233, v233, v9
    v_mul_f32 v234, v234, v9
    v_mul_f32 v235, v235, v9
    v_mul_f32 v236, v236, v9
    v_mul_f32 v237, v237, v9
    v_mul_f32 v238, v238, v9
    v_mul_f32 v239, v239, v9
    v_mul_f32 v240, v240, v9
    v_mul_f32 v241, v241, v9
    v_mul_f32 v242, v242, v9
    v_mul_f32 v243, v243, v9
    v_mul_f32 v244, v244, v9
    v_mul_f32 v245, v245, v9
    v_mul_f32 v246, v246, v9
    v_mul_f32 v247, v247, v9
    v_mul_f32 v248, v248, v9
    v_mul_f32 v249, v249, v9
    v_mul_f32 v250, v250, v9
    v_mul_f32 v251, v251, v9
    v_mul_f32 v252, v252, v9
    v_mul_f32 v253, v253, v9
    v_mul_f32 v254, v254, v9
    v_mul_f32 v255, v255, v9
    v_sub_f32 v72, v72, v7
    v_sub_f32 v104, v104, v7
    v_sub_f32 v73, v73, v7
    v_sub_f32 v105, v105, v7
    v_sub_f32 v74, v74, v7
    v_sub_f32 v106, v106, v7
    v_sub_f32 v75, v75, v7
    v_sub_f32 v107, v107, v7
    v_sub_f32 v76, v76, v7
    v_sub_f32 v108, v108, v7
    v_sub_f32 v77, v77, v7
    v_sub_f32 v109, v109, v7
    v_sub_f32 v78, v78, v7
    v_sub_f32 v110, v110, v7
    v_sub_f32 v79, v79, v7
    v_sub_f32 v111, v111, v7
    v_exp_f32 v112, v72
    v_exp_f32 v113, v73
    v_exp_f32 v114, v74
    v_exp_f32 v115, v75
    v_exp_f32 v116, v76
    v_exp_f32 v117, v77
    v_exp_f32 v118, v78
    v_exp_f32 v119, v79
    s_nop 0
    v_cvt_pk_bf16_f32 v132, v112, v113
    v_cvt_pk_bf16_f32 v133, v114, v115
    v_cvt_pk_bf16_f32 v134, v116, v117
    v_cvt_pk_bf16_f32 v135, v118, v119
    s_nop 1
    v_mfma_f32_16x16x32_bf16 v[28:31], a[240:243], v[132:135], v[44:47]
    v_exp_f32 v112, v80
    v_exp_f32 v113, v81
    v_exp_f32 v114, v82
    v_exp_f32 v115, v83
    s_nop 7
    s_branch K2_BACK7
K2_SLOW8:
    s_nop 7
    s_nop 3
    v_log_f32 v8, v16
    v_max3_f32 v7, v80, v81, v82
    v_max3_f32 v7, v7, v83, v84
    v_max3_f32 v7, v7, v85, v86
    v_max3_f32 v7, v7, v87, 0
    v_max_f32 v7, v7, v8
    v_mov_b32 v8, v7
    s_nop 1
    v_permlane16_swap_b32 v7, v8
    v_max_f32 v7, v7, v8
    v_mov_b32 v8, v7
    s_nop 1
    v_permlane32_swap_b32 v7, v8
    v_max_f32 v7, v7, v8
    v_exp_f32 v9, -v7
    v_sub_f32 v152, v152, v7
    v_sub_f32 v153, v153, v7
    v_sub_f32 v154, v154, v7
    v_sub_f32 v155, v155, v7
    v_mul_f32 v16, v16, v9
    v_mul_f32 v17, v17, v9
    v_mul_f32 v18, v18, v9
    v_mul_f32 v19, v19, v9
    v_accvgpr_read_b32 v8, a128
    v_mul_f32 v8, v8, v9
    v_accvgpr_write_b32 a128, v8
    v_accvgpr_read_b32 v8, a129
    v_mul_f32 v8, v8, v9
    v_accvgpr_write_b32 a129, v8
    v_accvgpr_read_b32 v8, a130
    v_mul_f32 v8, v8, v9
    v_accvgpr_write_b32 a130, v8
    v_accvgpr_read_b32 v8, a131
    v_mul_f32 v8, v8, v9
    v_accvgpr_write_b32 a131, v8
    v_accvgpr_read_b32 v8, a132
    v_mul_f32 v8, v8, v9
    v_accvgpr_write_b32 a132, v8
    v_accvgpr_read_b32 v8, a133
    v_mul_f32 v8, v8, v9
    v_accvgpr_write_b32 a133, v8
    v_accvgpr_read_b32 v8, a134
    v_mul_f32 v8, v8, v9
    v_accvgpr_write_b32 a134, v8
    v_accvgpr_read_b32 v8, a135
    v_mul_f32 v8, v8, v9
    v_accvgpr_write_b32 a135, v8
    v_accvgpr_read_b32 v8, a136
    v_mul_f32 v8, v8, v9
    v_accvgpr_write_b32 a136, v8
    v_accvgpr_read_b32 v8, a137
    v_mul_f32 v8, v8, v9
    v_accvgpr_write_b32 a137, v8
    v_accvgpr_read_b32 v8, a138
    v_mul_f32 v8, v8, v9
    v_accvgpr_write_b32 a138, v8
    v_accvgpr_read_b32 v8, a139
    v_mul_f32 v8, v8, v9
    v_accvgpr_write_b32 a139, v8
    v_accvgpr_read_b32 v8, a140
    v_mul_f32 v8, v8, v9
    v_accvgpr_write_b32 a140, v8
    v_accvgpr_read_b32 v8, a141
    v_mul_f32 v8, v8, v9
    v_accvgpr_write_b32 a141, v8
    v_accvgpr_read_b32 v8, a142
    v_mul_f32 v8, v8, v9
    v_accvgpr_write_b32 a142, v8
    v_accvgpr_read_b32 v8, a143
    v_mul_f32 v8, v8, v9
    v_accvgpr_write_b32 a143, v8
    v_accvgpr_read_b32 v8, a144
    v_mul_f32 v8, v8, v9
    v_accvgpr_write_b32 a144, v8
    v_accvgpr_read_b32 v8, a145
    v_mul_f32 v8, v8, v9
    v_accvgpr_write_b32 a145, v8
    v_accvgpr_read_b32 v8, a146
    v_mul_f32 v8, v8, v9
    v_accvgpr_write_b32 a146, v8
    v_accvgpr_read_b32 v8, a147
    v_mul_f32 v8, v8, v9
    v_accvgpr_write_b32 a147, v8
    v_accvgpr_read_b32 v8, a148
    v_mul_f32 v8, v8, v9
    v_accvgpr_write_b32 a148, v8
    v_accvgpr_read_b32 v8, a149
    v_mul_f32 v8, v8, v9
    v_accvgpr_write_b32 a149, v8
    v_accvgpr_read_b32 v8, a150
    v_mul_f32 v8, v8, v9
    v_accvgpr_write_b32 a150, v8
    v_accvgpr_read_b32 v8, a151
    v_mul_f32 v8, v8, v9
    v_accvgpr_write_b32 a151, v8
    v_accvgpr_read_b32 v8, a152
    v_mul_f32 v8, v8, v9
    v_accvgpr_write_b32 a152, v8
    v_accvgpr_read_b32 v8, a153
    v_mul_f32 v8, v8, v9
    v_accvgpr_write_b32 a153, v8
    v_accvgpr_read_b32 v8, a154
    v_mul_f32 v8, v8, v9
    v_accvgpr_write_b32 a154, v8
    v_accvgpr_read_b32 v8, a155
    v_mul_f32 v8, v8, v9
    v_accvgpr_write_b32 a155, v8
    v_accvgpr_read_b32 v8, a156
    v_mul_f32 v8, v8, v9
    v_accvgpr_write_b32 a156, v8
    v_accvgpr_read_b32 v8, a157
    v_mul_f32 v8, v8, v9
    v_accvgpr_write_b32 a157, v8
    v_accvgpr_read_b32 v8, a158
    v_mul_f32 v8, v8, v9
    v_accvgpr_write_b32 a158, v8
    v_accvgpr_read_b32 v8, a159
    v_mul_f32 v8, v8, v9
    v_accvgpr_write_b32 a159, v8
    v_sub_f32 v80, v80, v7
    v_sub_f32 v48, v48, v7
    v_sub_f32 v81, v81, v7
    v_sub_f32 v49, v49, v7
    v_sub_f32 v82, v82, v7
    v_sub_f32 v50, v50, v7
    v_sub_f32 v83, v83, v7
    v_sub_f32 v51, v51, v7
    v_sub_f32 v84, v84, v7
    v_sub_f32 v52, v52, v7
    v_sub_f32 v85, v85, v7
    v_sub_f32 v53, v53, v7
    v_sub_f32 v86, v86, v7
    v_sub_f32 v54, v54, v7
    v_sub_f32 v87, v87, v7
    v_sub_f32 v55, v55, v7
    v_exp_f32 v112, v80
    v_exp_f32 v113, v81
    v_exp_f32 v114, v82
    v_exp_f32 v115, v83
    v_exp_f32 v116, v84
    v_exp_f32 v117, v85
    v_exp_f32 v118, v86
    v_exp_f32 v119, v87
    s_nop 0
    v_cvt_pk_bf16_f32 v136, v112, v113
    v_cvt_pk_bf16_f32 v137, v114, v115
    v_cvt_pk_bf16_f32 v138, v116, v117
    v_cvt_pk_bf16_f32 v139, v118, v119
    s_nop 1
    v_mfma_f32_16x16x32_bf16 v[32:35], a[240:243], v[136:139], v[16:19]
    v_log_f32 v8, v20
    v_max3_f32 v7, v88, v89, v90
    v_max3_f32 v7, v7, v91, v92
    v_max3_f32 v7, v7, v93, v94
    v_max3_f32 v7, v7, v95, 0
    v_max_f32 v7, v7, v8
    v_mov_b32 v8, v7
    s_nop 1
    v_permlane16_swap_b32 v7, v8
    v_max_f32 v7, v7, v8
    v_mov_b32 v8, v7
    s_nop 1
    v_permlane32_swap_b32 v7, v8
    v_max_f32 v7, v7, v8
    v_exp_f32 v9, -v7
    v_sub_f32 v156, v156, v7
    v_sub_f32 v157, v157, v7
    v_sub_f32 v158, v158, v7
    v_sub_f32 v159, v159, v7
    v_mul_f32 v20, v20, v9
    v_mul_f32 v21, v21, v9
    v_mul_f32 v22, v22, v9
    v_mul_f32 v23, v23, v9
    v_mul_f32 v192, v192, v9
    v_mul_f32 v193, v193, v9
    v_mul_f32 v194, v194, v9
    v_mul_f32 v195, v195, v9
    v_mul_f32 v196, v196, v9
    v_mul_f32 v197, v197, v9
    v_mul_f32 v198, v198, v9
    v_mul_f32 v199, v199, v9
    v_mul_f32 v200, v200, v9
    v_mul_f32 v201, v201, v9
    v_mul_f32 v202, v202, v9
    v_mul_f32 v203, v203, v9
    v_mul_f32 v204, v204, v9
    v_mul_f32 v205, v205, v9
    v_mul_f32 v206, v206, v9
    v_mul_f32 v207, v207, v9
    v_mul_f32 v208, v208, v9
    v_mul_f32 v209, v209, v9
    v_mul_f32 v210, v210, v9
    v_mul_f32 v211, v211, v9
    v_mul_f32 v212, v212, v9
    v_mul_f32 v213, v213, v9
    v_mul_f32 v214, v214, v9
    v_mul_f32 v215, v215, v9
    v_mul_f32 v216, v216, v9
    v_mul_f32 v217, v217, v9
    v_mul_f32 v218, v218, v9
    v_mul_f32 v219, v219, v9
    v_mul_f32 v220, v220, v9
    v_mul_f32 v221, v221, v9
    v_mul_f32 v222, v222, v9
    v_mul_f32 v223, v223, v9
    v_sub_f32 v88, v88, v7
    v_sub_f32 v56, v56, v7
    v_sub_f32 v89, v89, v7
    v_sub_f32 v57, v57, v7
    v_sub_f32 v90, v90, v7
    v_sub_f32 v58, v58, v7
    v_sub_f32 v91, v91, v7
    v_sub_f32 v59, v59, v7
    v_sub_f32 v92, v92, v7
    v_sub_f32 v60, v60, v7
    v_sub_f32 v93, v93, v7
    v_sub_f32 v61, v61, v7
    v_sub_f32 v94, v94, v7
    v_sub_f32 v62, v62, v7
    v_sub_f32 v95, v95, v7
    v_sub_f32 v63, v63, v7
    v_exp_f32 v112, v88
    v_exp_f32 v113, v89
    v_exp_f32 v114, v90
    v_exp_f32 v115, v91
    v_exp_f32 v116, v92
    v_exp_f32 v117, v93
    v_exp_f32 v118, v94
    v_exp_f32 v119, v95
    s_nop 0
    v_cvt_pk_bf16_f32 v140, v112, v113
    v_cvt_pk_bf16_f32 v141, v114, v115
    v_cvt_pk_bf16_f32 v142, v116, v117
    v_cvt_pk_bf16_f32 v143, v118, v119
    s_nop 1
    v_mfma_f32_16x16x32_bf16 v[36:39], a[240:243], v[140:143], v[20:23]
    v_log_f32 v8, v28
    v_max3_f32 v7, v104, v105, v106
    v_max3_f32 v7, v7, v107, v108
    v_max3_f32 v7, v7, v109, v110
    v_max3_f32 v7, v7, v111, 0
    v_max_f32 v7, v7, v8
    v_mov_b32 v8, v7
    s_nop 1
    v_permlane16_swap_b32 v7, v8
    v_max_f32 v7, v7, v8
    v_mov_b32 v8, v7
    s_nop 1
    v_permlane32_swap_b32 v7, v8
    v_max_f32 v7, v7, v8
    v_exp_f32 v9, -v7
    v_sub_f32 v164, v164, v7
    v_sub_f32 v165, v165, v7
    v_sub_f32 v166, v166, v7
    v_sub_f32 v167, v167, v7
    v_mul_f32 v28, v28, v9
    v_mul_f32 v29, v29, v9
    v_mul_f32 v30, v30, v9
    v_mul_f32 v31, v31, v9
    v_mul_f32 v224, v224, v9
    v_mul_f32 v225, v225, v9
    v_mul_f32 v226, v226, v9
    v_mul_f32 v227, v227, v9
    v_mul_f32 v228, v228, v9
    v_mul_f32 v229, v229, v9
    v_mul_f32 v230, v230, v9
    v_mul_f32 v231, v231, v9
    v_mul_f32 v232, v232, v9
    v_mul_f32 v233, v233, v9
    v_mul_f32 v234, v234, v9
    v_mul_f32 v235, v235, v9
    v_mul_f32 v236, v236, v9
    v_mul_f32 v237, v237, v9
    v_mul_f32 v238, v238, v9
    v_mul_f32 v239, v239, v9
    v_mul_f32 v240, v240, v9
    v_mul_f32 v241, v241, v9
    v_mul_f32 v242, v242, v9
    v_mul_f32 v243, v243, v9
    v_mul_f32 v244, v244, v9
    v_mul_f32 v245, v245, v9
    v_mul_f32 v246, v246, v9
    v_mul_f32 v247, v247, v9
    v_mul_f32 v248, v248, v9
    v_mul_f32 v249, v249, v9
    v_mul_f32 v250, v250, v9
    v_mul_f32 v251, v251, v9
    v_mul_f32 v252, v252, v9
    v_mul_f32 v253, v253, v9
    v_mul_f32 v254, v254, v9
    v_mul_f32 v255, v255, v9
    v_sub_f32 v104, v104, v7
    v_sub_f32 v72, v72, v7
    v_sub_f32 v105, v105, v7
    v_sub_f32 v73, v73, v7
    v_sub_f32 v106, v106, v7
    v_sub_f32 v74, v74, v7
    v_sub_f32 v107, v107, v7
    v_sub_f32 v75, v75, v7
    v_sub_f32 v108, v108, v7
    v_sub_f32 v76, v76, v7
    v_sub_f32 v109, v109, v7
    v_sub_f32 v77, v77, v7
    v_sub_f32 v110, v110, v7
    v_sub_f32 v78, v78, v7
    v_sub_f32 v111, v111, v7
    v_sub_f32 v79, v79, v7
    v_exp_f32 v112, v104
    v_exp_f32 v113, v105
    v_exp_f32 v114, v106
    v_exp_f32 v115, v107
    v_exp_f32 v116, v108
    v_exp_f32 v117, v109
    v_exp_f32 v118, v110
    v_exp_f32 v119, v111
    s_nop 0
    v_cvt_pk_bf16_f32 v148, v112, v113
    v_cvt_pk_bf16_f32 v149, v114, v115
    v_cvt_pk_bf16_f32 v150, v116, v117
    v_cvt_pk_bf16_f32 v151, v118, v119
    s_nop 1
    v_mfma_f32_16x16x32_bf16 v[44:47], a[240:243], v[148:151], v[28:31]
    v_exp_f32 v112, v48
    v_exp_f32 v113, v49
    v_exp_f32 v114, v50
    v_exp_f32 v115, v51
    s_nop 7
    s_branch K2_BACK8
K2_SLOW9:
    s_nop 7
    s_nop 3
    v_log_f32 v8, v32
    v_max3_f32 v7, v48, v49, v50
    v_max3_f32 v7, v7, v51, v52
    v_max3_f32 v7, v7, v53, v54
    v_max3_f32 v7, v7, v55, 0
    v_max_f32 v7, v7, v8
    v_mov_b32 v8, v7
    s_nop 1
    v_permlane16_swap_b32 v7, v8
    v_max_f32 v7, v7, v8
    v_mov_b32 v8, v7
    s_nop 1
    v_permlane32_swap_b32 v7, v8
    v_max_f32 v7, v7, v8
    v_exp_f32 v9, -v7
    v_sub_f32 v152, v152, v7
    v_sub_f32 v153, v153, v7
    v_sub_f32 v154, v154, v7
    v_sub_f32 v155, v155, v7
    v_mul_f32 v32, v32, v9
    v_mul_f32 v33, v33, v9
    v_mul_f32 v34, v34, v9
    v_mul_f32 v35, v35, v9
    v_accvgpr_read_b32 v8, a128
    v_mul_f32 v8, v8, v9
    v_accvgpr_write_b32 a128, v8
    v_accvgpr_read_b32 v8, a129
    v_mul_f32 v8, v8, v9
    v_accvgpr_write_b32 a129, v8
    v_accvgpr_read_b32 v8, a130
    v_mul_f32 v8, v8, v9
    v_accvgpr_write_b32 a130, v8
    v_accvgpr_read_b32 v8, a131
    v_mul_f32 v8, v8, v9
    v_accvgpr_write_b32 a131, v8
    v_accvgpr_read_b32 v8, a132
    v_mul_f32 v8, v8, v9
    v_accvgpr_write_b32 a132, v8
    v_accvgpr_read_b32 v8, a133
    v_mul_f32 v8, v8, v9
    v_accvgpr_write_b32 a133, v8
    v_accvgpr_read_b32 v8, a134
    v_mul_f32 v8, v8, v9
    v_accvgpr_write_b32 a134, v8
    v_accvgpr_read_b32 v8, a135
    v_mul_f32 v8, v8, v9
    v_accvgpr_write_b32 a135, v8
    v_accvgpr_read_b32 v8, a136
    v_mul_f32 v8, v8, v9
    v_accvgpr_write_b32 a136, v8
    v_accvgpr_read_b32 v8, a137
    v_mul_f32 v8, v8, v9
    v_accvgpr_write_b32 a137, v8
    v_accvgpr_read_b32 v8, a138
    v_mul_f32 v8, v8, v9
    v_accvgpr_write_b32 a138, v8
    v_accvgpr_read_b32 v8, a139
    v_mul_f32 v8, v8, v9
    v_accvgpr_write_b32 a139, v8
    v_accvgpr_read_b32 v8, a140
    v_mul_f32 v8, v8, v9
    v_accvgpr_write_b32 a140, v8
    v_accvgpr_read_b32 v8, a141
    v_mul_f32 v8, v8, v9
    v_accvgpr_write_b32 a141, v8
    v_accvgpr_read_b32 v8, a142
    v_mul_f32 v8, v8, v9
    v_accvgpr_write_b32 a142, v8
    v_accvgpr_read_b32 v8, a143
    v_mul_f32 v8, v8, v9
    v_accvgpr_write_b32 a143, v8
    v_accvgpr_read_b32 v8, a144
    v_mul_f32 v8, v8, v9
    v_accvgpr_write_b32 a144, v8
    v_accvgpr_read_b32 v8, a145
    v_mul_f32 v8, v8, v9
    v_accvgpr_write_b32 a145, v8
    v_accvgpr_read_b32 v8, a146
    v_mul_f32 v8, v8, v9
    v_accvgpr_write_b32 a146, v8
    v_accvgpr_read_b32 v8, a147
    v_mul_f32 v8, v8, v9
    v_accvgpr_write_b32 a147, v8
    v_accvgpr_read_b32 v8, a148
    v_mul_f32 v8, v8, v9
    v_accvgpr_write_b32 a148, v8
    v_accvgpr_read_b32 v8, a149
    v_mul_f32 v8, v8, v9
    v_accvgpr_write_b32 a149, v8
    v_accvgpr_read_b32 v8, a150
    v_mul_f32 v8, v8, v9
    v_accvgpr_write_b32 a150, v8
    v_accvgpr_read_b32 v8, a151
    v_mul_f32 v8, v8, v9
    v_accvgpr_write_b32 a151, v8
    v_accvgpr_read_b32 v8, a152
    v_mul_f32 v8, v8, v9
    v_accvgpr_write_b32 a152, v8
    v_accvgpr_read_b32 v8, a153
    v_mul_f32 v8, v8, v9
    v_accvgpr_write_b32 a153, v8
    v_accvgpr_read_b32 v8, a154
    v_mul_f32 v8, v8, v9
    v_accvgpr_write_b32 a154, v8
    v_accvgpr_read_b32 v8, a155
    v_mul_f32 v8, v8, v9
    v_accvgpr_write_b32 a155, v8
    v_accvgpr_read_b32 v8, a156
    v_mul_f32 v8, v8, v9
    v_accvgpr_write_b32 a156, v8
    v_accvgpr_read_b32 v8, a157
    v_mul_f32 v8, v8, v9
    v_accvgpr_write_b32 a157, v8
    v_accvgpr_read_b32 v8, a158
    v_mul_f32 v8, v8, v9
    v_accvgpr_write_b32 a158, v8
    v_accvgpr_read_b32 v8, a159
    v_mul_f32 v8, v8, v9
    v_accvgpr_write_b32 a159, v8
    v_sub_f32 v48, v48, v7
    v_sub_f32 v80, v80, v7
    v_sub_f32 v49, v49, v7
    v_sub_f32 v81, v81, v7
    v_sub_f32 v50, v50, v7
    v_sub_f32 v82, v82, v7
    v_sub_f32 v51, v51, v7
    v_sub_f32 v83, v83, v7
    v_sub_f32 v52, v52, v7
    v_sub_f32 v84, v84, v7
    v_sub_f32 v53, v53, v7
    v_sub_f32 v85, v85, v7
    v_sub_f32 v54, v54, v7
    v_sub_f32 v86, v86, v7
    v_sub_f32 v55, v55, v7
    v_sub_f32 v87, v87, v7
    v_exp_f32 v112, v48
    v_exp_f32 v113, v49
    v_exp_f32 v114, v50
    v_exp_f32 v115, v51
    v_exp_f32 v116, v52
    v_exp_f32 v117, v53
    v_exp_f32 v118, v54
    v_exp_f32 v119, v55
    s_nop 0
    v_cvt_pk_bf16_f32 v120, v112, v113
    v_cvt_pk_bf16_f32 v121, v114, v115
    v_cvt_pk_bf16_f32 v122, v116, v117
    v_cvt_pk_bf16_f32 v123, v118, v119
    s_nop 1
    v_mfma_f32_16x16x32_bf16 v[16:19], a[240:243], v[120:123], v[32:35]
    v_log_f32 v8, v36
    v_max3_f32 v7, v56, v57, v58
    v_max3_f32 v7, v7, v59, v60
    v_max3_f32 v7, v7, v61, v62
    v_max3_f32 v7, v7, v63, 0
    v_max_f32 v7, v7, v8
    v_mov_b32 v8, v7
    s_nop 1
    v_permlane16_swap_b32 v7, v8
    v_max_f32 v7, v7, v8
    v_mov_b32 v8, v7
    s_nop 1
    v_permlane32_swap_b32 v7, v8
    v_max_f32 v7, v7, v8
    v_exp_f32 v9, -v7
    v_sub_f32 v156, v156, v7
    v_sub_f32 v157, v157, v7
    v_sub_f32 v158, v158, v7
    v_sub_f32 v159, v159, v7
    v_mul_f32 v36, v36, v9
    v_mul_f32 v37, v37, v9
    v_mul_f32 v38, v38, v9
    v_mul_f32 v39, v39, v9
    v_mul_f32 v192, v192, v9
    v_mul_f32 v193, v193, v9
    v_mul_f32 v194, v194, v9
    v_mul_f32 v195, v195, v9
    v_mul_f32 v196, v196, v9
    v_mul_f32 v197, v197, v9
    v_mul_f32 v198, v198, v9
    v_mul_f32 v199, v199, v9
    v_mul_f32 v200, v200, v9
    v_mul_f32 v201, v201, v9
    v_mul_f32 v202, v202, v9
    v_mul_f32 v203, v203, v9
    v_mul_f32 v204, v204, v9
    v_mul_f32 v205, v205, v9
    v_mul_f32 v206, v206, v9
    v_mul_f32 v207, v207, v9
    v_mul_f32 v208, v208, v9
    v_mul_f32 v209, v209, v9
    v_mul_f32 v210, v210, v9
    v_mul_f32 v211, v211, v9
    v_mul_f32 v212, v212, v9
    v_mul_f32 v213, v213, v9
    v_mul_f32 v214, v214, v9
    v_mul_f32 v215, v215, v9
    v_mul_f32 v216, v216, v9
    v_mul_f32 v217, v217, v9
    v_mul_f32 v218, v218, v9
    v_mul_f32 v219, v219, v9
    v_mul_f32 v220, v220, v9
    v_mul_f32 v221, v221, v9
    v_mul_f32 v222, v222, v9
    v_mul_f32 v223, v223, v9
    v_sub_f32 v56, v56, v7
    v_sub_f32 v88, v88, v7
    v_sub_f32 v57, v57, v7
    v_sub_f32 v89, v89, v7
    v_sub_f32 v58, v58, v7
    v_sub_f32 v90, v90, v7
    v_sub_f32 v59, v59, v7
    v_sub_f32 v91, v91, v7
    v_sub_f32 v60, v60, v7
    v_sub_f32 v92, v92, v7
    v_sub_f32 v61, v61, v7
    v_sub_f32 v93, v93, v7
    v_sub_f32 v62, v62, v7
    v_sub_f32 v94, v94, v7
    v_sub_f32 v63, v63, v7
    v_sub_f32 v95, v95, v7
    v_exp_f32 v112, v56
    v_exp_f32 v113, v57
    v_exp_f32 v114, v58
    v_exp_f32 v115, v59
    v_exp_f32 v116, v60
    v_exp_f32 v117, v61
    v_exp_f32 v118, v62
    v_exp_f32 v119, v63
    s_nop 0
    v_cvt_pk_bf16_f32 v124, v112, v113
    v_cvt_pk_bf16_f32 v125, v114, v115
    v_cvt_pk_bf16_f32 v126, v116, v117
    v_cvt_pk_bf16_f32 v127, v118, v119
    s_nop 1
    v_mfma_f32_16x16x32_bf16 v[20:23], a[240:243], v[124:127], v[36:39]
    v_exp_f32 v112, v80
    v_exp_f32 v113, v81
    v_exp_f32 v114, v82
    v_exp_f32 v115, v83
    s_nop 7
    s_branch K2_BACK9
K2_SLOW10:
    s_nop 7
    s_nop 3
    v_log_f32 v8, v16
    v_max3_f32 v7, v80, v81, v82
    v_max3_f32 v7, v7, v83, v84
    v_max3_f32 v7, v7, v85, v86
    v_max3_f32 v7, v7, v87, 0
    v_max_f32 v7, v7, v8
    v_mov_b32 v8, v7
    s_nop 1
    v_permlane16_swap_b32 v7, v8
    v_max_f32 v7, v7, v8
    v_mov_b32 v8, v7
    s_nop 1
    v_permlane32_swap_b32 v7, v8
    v_max_f32 v7, v7, v8
    v_exp_f32 v9, -v7
    v_sub_f32 v152, v152, v7
    v_sub_f32 v153, v153, v7
    v_sub_f32 v154, v154, v7
    v_sub_f32 v155, v155, v7
    v_mul_f32 v16, v16, v9
    v_mul_f32 v17, v17, v9
    v_mul_f32 v18, v18, v9
    v_mul_f32 v19, v19, v9
    v_accvgpr_read_b32 v8, a128
    v_mul_f32 v8, v8, v9
    v_accvgpr_write_b32 a128, v8
    v_accvgpr_read_b32 v8, a129
    v_mul_f32 v8, v8, v9
    v_accvgpr_write_b32 a129, v8
    v_accvgpr_read_b32 v8, a130
    v_mul_f32 v8, v8, v9
    v_accvgpr_write_b32 a130, v8
    v_accvgpr_read_b32 v8, a131
    v_mul_f32 v8, v8, v9
    v_accvgpr_write_b32 a131, v8
    v_accvgpr_read_b32 v8, a132
    v_mul_f32 v8, v8, v9
    v_accvgpr_write_b32 a132, v8
    v_accvgpr_read_b32 v8, a133
    v_mul_f32 v8, v8, v9
    v_accvgpr_write_b32 a133, v8
    v_accvgpr_read_b32 v8, a134
    v_mul_f32 v8, v8, v9
    v_accvgpr_write_b32 a134, v8
    v_accvgpr_read_b32 v8, a135
    v_mul_f32 v8, v8, v9
    v_accvgpr_write_b32 a135, v8
    v_accvgpr_read_b32 v8, a136
    v_mul_f32 v8, v8, v9
    v_accvgpr_write_b32 a136, v8
    v_accvgpr_read_b32 v8, a137
    v_mul_f32 v8, v8, v9
    v_accvgpr_write_b32 a137, v8
    v_accvgpr_read_b32 v8, a138
    v_mul_f32 v8, v8, v9
    v_accvgpr_write_b32 a138, v8
    v_accvgpr_read_b32 v8, a139
    v_mul_f32 v8, v8, v9
    v_accvgpr_write_b32 a139, v8
    v_accvgpr_read_b32 v8, a140
    v_mul_f32 v8, v8, v9
    v_accvgpr_write_b32 a140, v8
    v_accvgpr_read_b32 v8, a141
    v_mul_f32 v8, v8, v9
    v_accvgpr_write_b32 a141, v8
    v_accvgpr_read_b32 v8, a142
    v_mul_f32 v8, v8, v9
    v_accvgpr_write_b32 a142, v8
    v_accvgpr_read_b32 v8, a143
    v_mul_f32 v8, v8, v9
    v_accvgpr_write_b32 a143, v8
    v_accvgpr_read_b32 v8, a144
    v_mul_f32 v8, v8, v9
    v_accvgpr_write_b32 a144, v8
    v_accvgpr_read_b32 v8, a145
    v_mul_f32 v8, v8, v9
    v_accvgpr_write_b32 a145, v8
    v_accvgpr_read_b32 v8, a146
    v_mul_f32 v8, v8, v9
    v_accvgpr_write_b32 a146, v8
    v_accvgpr_read_b32 v8, a147
    v_mul_f32 v8, v8, v9
    v_accvgpr_write_b32 a147, v8
    v_accvgpr_read_b32 v8, a148
    v_mul_f32 v8, v8, v9
    v_accvgpr_write_b32 a148, v8
    v_accvgpr_read_b32 v8, a149
    v_mul_f32 v8, v8, v9
    v_accvgpr_write_b32 a149, v8
    v_accvgpr_read_b32 v8, a150
    v_mul_f32 v8, v8, v9
    v_accvgpr_write_b32 a150, v8
    v_accvgpr_read_b32 v8, a151
    v_mul_f32 v8, v8, v9
    v_accvgpr_write_b32 a151, v8
    v_accvgpr_read_b32 v8, a152
    v_mul_f32 v8, v8, v9
    v_accvgpr_write_b32 a152, v8
    v_accvgpr_read_b32 v8, a153
    v_mul_f32 v8, v8, v9
    v_accvgpr_write_b32 a153, v8
    v_accvgpr_read_b32 v8, a154
    v_mul_f32 v8, v8, v9
    v_accvgpr_write_b32 a154, v8
    v_accvgpr_read_b32 v8, a155
    v_mul_f32 v8, v8, v9
    v_accvgpr_write_b32 a155, v8
    v_accvgpr_read_b32 v8, a156
    v_mul_f32 v8, v8, v9
    v_accvgpr_write_b32 a156, v8
    v_accvgpr_read_b32 v8, a157
    v_mul_f32 v8, v8, v9
    v_accvgpr_write_b32 a157, v8
    v_accvgpr_read_b32 v8, a158
    v_mul_f32 v8, v8, v9
    v_accvgpr_write_b32 a158, v8
    v_accvgpr_read_b32 v8, a159
    v_mul_f32 v8, v8, v9
    v_accvgpr_write_b32 a159, v8
    v_sub_f32 v80, v80, v7
    v_sub_f32 v48, v48, v7
    v_sub_f32 v81, v81, v7
    v_sub_f32 v49, v49, v7
    v_sub_f32 v82, v82, v7
    v_sub_f32 v50, v50, v7
    v_sub_f32 v83, v83, v7
    v_sub_f32 v51, v51, v7
    v_sub_f32 v84, v84, v7
    v_sub_f32 v52, v52, v7
    v_sub_f32 v85, v85, v7
    v_sub_f32 v53, v53, v7
    v_sub_f32 v86, v86, v7
    v_sub_f32 v54, v54, v7
    v_sub_f32 v87, v87, v7
    v_sub_f32 v55, v55, v7
    v_exp_f32 v112, v80
    v_exp_f32 v113, v81
    v_exp_f32 v114, v82
    v_exp_f32 v115, v83
    v_exp_f32 v116, v84
    v_exp_f32 v117, v85
    v_exp_f32 v118, v86
    v_exp_f32 v119, v87
    s_nop 0
    v_cvt_pk_bf16_f32 v136, v112, v113
    v_cvt_pk_bf16_f32 v137, v114, v115
    v_cvt_pk_bf16_f32 v138, v116, v117
    v_cvt_pk_bf16_f32 v139, v118, v119
    s_nop 1
    v_mfma_f32_16x16x32_bf16 v[32:35], a[240:243], v[136:139], v[16:19]
    v_log_f32 v8, v20
    v_max3_f32 v7, v88, v89, v90
    v_max3_f32 v7, v7, v91, v92
    v_max3_f32 v7, v7, v93, v94
    v_max3_f32 v7, v7, v95, 0
    v_max_f32 v7, v7, v8
    v_mov_b32 v8, v7
    s_nop 1
    v_permlane16_swap_b32 v7, v8
    v_max_f32 v7, v7, v8
    v_mov_b32 v8, v7
    s_nop 1
    v_permlane32_swap_b32 v7, v8
    v_max_f32 v7, v7, v8
    v_exp_f32 v9, -v7
    v_sub_f32 v156, v156, v7
    v_sub_f32 v157, v157, v7
    v_sub_f32 v158, v158, v7
    v_sub_f32 v159, v159, v7
    v_mul_f32 v20, v20, v9
    v_mul_f32 v21, v21, v9
    v_mul_f32 v22, v22, v9
    v_mul_f32 v23, v23, v9
    v_mul_f32 v192, v192, v9
    v_mul_f32 v193, v193, v9
    v_mul_f32 v194, v194, v9
    v_mul_f32 v195, v195, v9
    v_mul_f32 v196, v196, v9
    v_mul_f32 v197, v197, v9
    v_mul_f32 v198, v198, v9
    v_mul_f32 v199, v199, v9
    v_mul_f32 v200, v200, v9
    v_mul_f32 v201, v201, v9
    v_mul_f32 v202, v202, v9
    v_mul_f32 v203, v203, v9
    v_mul_f32 v204, v204, v9
    v_mul_f32 v205, v205, v9
    v_mul_f32 v206, v206, v9
    v_mul_f32 v207, v207, v9
    v_mul_f32 v208, v208, v9
    v_mul_f32 v209, v209, v9
    v_mul_f32 v210, v210, v9
    v_mul_f32 v211, v211, v9
    v_mul_f32 v212, v212, v9
    v_mul_f32 v213, v213, v9
    v_mul_f32 v214, v214, v9
    v_mul_f32 v215, v215, v9
    v_mul_f32 v216, v216, v9
    v_mul_f32 v217, v217, v9
    v_mul_f32 v218, v218, v9
    v_mul_f32 v219, v219, v9
    v_mul_f32 v220, v220, v9
    v_mul_f32 v221, v221, v9
    v_mul_f32 v222, v222, v9
    v_mul_f32 v223, v223, v9
    v_sub_f32 v88, v88, v7
    v_sub_f32 v56, v56, v7
    v_sub_f32 v89, v89, v7
    v_sub_f32 v57, v57, v7
    v_sub_f32 v90, v90, v7
    v_sub_f32 v58, v58, v7
    v_sub_f32 v91, v91, v7
    v_sub_f32 v59, v59, v7
    v_sub_f32 v92, v92, v7
    v_sub_f32 v60, v60, v7
    v_sub_f32 v93, v93, v7
    v_sub_f32 v61, v61, v7
    v_sub_f32 v94, v94, v7
    v_sub_f32 v62, v62, v7
    v_sub_f32 v95, v95, v7
    v_sub_f32 v63, v63, v7
    v_exp_f32 v112, v88
    v_exp_f32 v113, v89
    v_exp_f32 v114, v90
    v_exp_f32 v115, v91
    v_exp_f32 v116, v92
    v_exp_f32 v117, v93
    v_exp_f32 v118, v94
    v_exp_f32 v119, v95
    s_nop 0
    v_cvt_pk_bf16_f32 v140, v112, v113
    v_cvt_pk_bf16_f32 v141, v114, v115
    v_cvt_pk_bf16_f32 v142, v116, v117
    v_cvt_pk_bf16_f32 v143, v118, v119
    s_nop 1
    v_mfma_f32_16x16x32_bf16 v[36:39], a[240:243], v[140:143], v[20:23]
    v_exp_f32 v112, v48
    v_exp_f32 v113, v49
    v_exp_f32 v114, v50
    v_exp_f32 v115, v51
    s_nop 7
    s_branch K2_BACK10
K2_SLOW11:
    s_nop 7
    s_nop 3
    v_log_f32 v8, v32
    v_max3_f32 v7, v48, v49, v50
    v_max3_f32 v7, v7, v51, v52
    v_max3_f32 v7, v7, v53, v54
    v_max3_f32 v7, v7, v55, 0
    v_max_f32 v7, v7, v8
    v_mov_b32 v8, v7
    s_nop 1
    v_permlane16_swap_b32 v7, v8
    v_max_f32 v7, v7, v8
    v_mov_b32 v8, v7
    s_nop 1
    v_permlane32_swap_b32 v7, v8
    v_max_f32 v7, v7, v8
    v_exp_f32 v9, -v7
    v_sub_f32 v152, v152, v7
    v_sub_f32 v153, v153, v7
    v_sub_f32 v154, v154, v7
    v_sub_f32 v155, v155, v7
    v_mul_f32 v32, v32, v9
    v_mul_f32 v33, v33, v9
    v_mul_f32 v34, v34, v9
    v_mul_f32 v35, v35, v9
    v_accvgpr_read_b32 v8, a128
    v_mul_f32 v8, v8, v9
    v_accvgpr_write_b32 a128, v8
    v_accvgpr_read_b32 v8, a129
    v_mul_f32 v8, v8, v9
    v_accvgpr_write_b32 a129, v8
    v_accvgpr_read_b32 v8, a130
    v_mul_f32 v8, v8, v9
    v_accvgpr_write_b32 a130, v8
    v_accvgpr_read_b32 v8, a131
    v_mul_f32 v8, v8, v9
    v_accvgpr_write_b32 a131, v8
    v_accvgpr_read_b32 v8, a132
    v_mul_f32 v8, v8, v9
    v_accvgpr_write_b32 a132, v8
    v_accvgpr_read_b32 v8, a133
    v_mul_f32 v8, v8, v9
    v_accvgpr_write_b32 a133, v8
    v_accvgpr_read_b32 v8, a134
    v_mul_f32 v8, v8, v9
    v_accvgpr_write_b32 a134, v8
    v_accvgpr_read_b32 v8, a135
    v_mul_f32 v8, v8, v9
    v_accvgpr_write_b32 a135, v8
    v_accvgpr_read_b32 v8, a136
    v_mul_f32 v8, v8, v9
    v_accvgpr_write_b32 a136, v8
    v_accvgpr_read_b32 v8, a137
    v_mul_f32 v8, v8, v9
    v_accvgpr_write_b32 a137, v8
    v_accvgpr_read_b32 v8, a138
    v_mul_f32 v8, v8, v9
    v_accvgpr_write_b32 a138, v8
    v_accvgpr_read_b32 v8, a139
    v_mul_f32 v8, v8, v9
    v_accvgpr_write_b32 a139, v8
    v_accvgpr_read_b32 v8, a140
    v_mul_f32 v8, v8, v9
    v_accvgpr_write_b32 a140, v8
    v_accvgpr_read_b32 v8, a141
    v_mul_f32 v8, v8, v9
    v_accvgpr_write_b32 a141, v8
    v_accvgpr_read_b32 v8, a142
    v_mul_f32 v8, v8, v9
    v_accvgpr_write_b32 a142, v8
    v_accvgpr_read_b32 v8, a143
    v_mul_f32 v8, v8, v9
    v_accvgpr_write_b32 a143, v8
    v_accvgpr_read_b32 v8, a144
    v_mul_f32 v8, v8, v9
    v_accvgpr_write_b32 a144, v8
    v_accvgpr_read_b32 v8, a145
    v_mul_f32 v8, v8, v9
    v_accvgpr_write_b32 a145, v8
    v_accvgpr_read_b32 v8, a146
    v_mul_f32 v8, v8, v9
    v_accvgpr_write_b32 a146, v8
    v_accvgpr_read_b32 v8, a147
    v_mul_f32 v8, v8, v9
    v_accvgpr_write_b32 a147, v8
    v_accvgpr_read_b32 v8, a148
    v_mul_f32 v8, v8, v9
    v_accvgpr_write_b32 a148, v8
    v_accvgpr_read_b32 v8, a149
    v_mul_f32 v8, v8, v9
    v_accvgpr_write_b32 a149, v8
    v_accvgpr_read_b32 v8, a150
    v_mul_f32 v8, v8, v9
    v_accvgpr_write_b32 a150, v8
    v_accvgpr_read_b32 v8, a151
    v_mul_f32 v8, v8, v9
    v_accvgpr_write_b32 a151, v8
    v_accvgpr_read_b32 v8, a152
    v_mul_f32 v8, v8, v9
    v_accvgpr_write_b32 a152, v8
    v_accvgpr_read_b32 v8, a153
    v_mul_f32 v8, v8, v9
    v_accvgpr_write_b32 a153, v8
    v_accvgpr_read_b32 v8, a154
    v_mul_f32 v8, v8, v9
    v_accvgpr_write_b32 a154, v8
    v_accvgpr_read_b32 v8, a155
    v_mul_f32 v8, v8, v9
    v_accvgpr_write_b32 a155, v8
    v_accvgpr_read_b32 v8, a156
    v_mul_f32 v8, v8, v9
    v_accvgpr_write_b32 a156, v8
    v_accvgpr_read_b32 v8, a157
    v_mul_f32 v8, v8, v9
    v_accvgpr_write_b32 a157, v8
    v_accvgpr_read_b32 v8, a158
    v_mul_f32 v8, v8, v9
    v_accvgpr_write_b32 a158, v8
    v_accvgpr_read_b32 v8, a159
    v_mul_f32 v8, v8, v9
    v_accvgpr_write_b32 a159, v8
    v_sub_f32 v48, v48, v7
    v_sub_f32 v80, v80, v7
    v_sub_f32 v49, v49, v7
    v_sub_f32 v81, v81, v7
    v_sub_f32 v50, v50, v7
    v_sub_f32 v82, v82, v7
    v_sub_f32 v51, v51, v7
    v_sub_f32 v83, v83, v7
    v_sub_f32 v52, v52, v7
    v_sub_f32 v84, v84, v7
    v_sub_f32 v53, v53, v7
    v_sub_f32 v85, v85, v7
    v_sub_f32 v54, v54, v7
    v_sub_f32 v86, v86, v7
    v_sub_f32 v55, v55, v7
    v_sub_f32 v87, v87, v7
    v_exp_f32 v112, v48
    v_exp_f32 v113, v49
    v_exp_f32 v114, v50
    v_exp_f32 v115, v51
    v_exp_f32 v116, v52
    v_exp_f32 v117, v53
    v_exp_f32 v118, v54
    v_exp_f32 v119, v55
    s_nop 0
    v_cvt_pk_bf16_f32 v120, v112, v113
    v_cvt_pk_bf16_f32 v121, v114, v115
    v_cvt_pk_bf16_f32 v122, v116, v117
    v_cvt_pk_bf16_f32 v123, v118, v119
    s_nop 1
    v_mfma_f32_16x16x32_bf16 v[16:19], a[240:243], v[120:123], v[32:35]
    v_log_f32 v8, v36
    v_max3_f32 v7, v56, v57, v58
    v_max3_f32 v7, v7, v59, v60
    v_max3_f32 v7, v7, v61, v62
    v_max3_f32 v7, v7, v63, 0
    v_max_f32 v7, v7, v8
    v_mov_b32 v8, v7
    s_nop 1
    v_permlane16_swap_b32 v7, v8
    v_max_f32 v7, v7, v8
    v_mov_b32 v8, v7
    s_nop 1
    v_permlane32_swap_b32 v7, v8
    v_max_f32 v7, v7, v8
    v_exp_f32 v9, -v7
    v_sub_f32 v156, v156, v7
    v_sub_f32 v157, v157, v7
    v_sub_f32 v158, v158, v7
    v_sub_f32 v159, v159, v7
    v_mul_f32 v36, v36, v9
    v_mul_f32 v37, v37, v9
    v_mul_f32 v38, v38, v9
    v_mul_f32 v39, v39, v9
    v_mul_f32 v192, v192, v9
    v_mul_f32 v193, v193, v9
    v_mul_f32 v194, v194, v9
    v_mul_f32 v195, v195, v9
    v_mul_f32 v196, v196, v9
    v_mul_f32 v197, v197, v9
    v_mul_f32 v198, v198, v9
    v_mul_f32 v199, v199, v9
    v_mul_f32 v200, v200, v9
    v_mul_f32 v201, v201, v9
    v_mul_f32 v202, v202, v9
    v_mul_f32 v203, v203, v9
    v_mul_f32 v204, v204, v9
    v_mul_f32 v205, v205, v9
    v_mul_f32 v206, v206, v9
    v_mul_f32 v207, v207, v9
    v_mul_f32 v208, v208, v9
    v_mul_f32 v209, v209, v9
    v_mul_f32 v210, v210, v9
    v_mul_f32 v211, v211, v9
    v_mul_f32 v212, v212, v9
    v_mul_f32 v213, v213, v9
    v_mul_f32 v214, v214, v9
    v_mul_f32 v215, v215, v9
    v_mul_f32 v216, v216, v9
    v_mul_f32 v217, v217, v9
    v_mul_f32 v218, v218, v9
    v_mul_f32 v219, v219, v9
    v_mul_f32 v220, v220, v9
    v_mul_f32 v221, v221, v9
    v_mul_f32 v222, v222, v9
    v_mul_f32 v223, v223, v9
    v_sub_f32 v56, v56, v7
    v_sub_f32 v88, v88, v7
    v_sub_f32 v57, v57, v7
    v_sub_f32 v89, v89, v7
    v_sub_f32 v58, v58, v7
    v_sub_f32 v90, v90, v7
    v_sub_f32 v59, v59, v7
    v_sub_f32 v91, v91, v7
    v_sub_f32 v60, v60, v7
    v_sub_f32 v92, v92, v7
    v_sub_f32 v61, v61, v7
    v_sub_f32 v93, v93, v7
    v_sub_f32 v62, v62, v7
    v_sub_f32 v94, v94, v7
    v_sub_f32 v63, v63, v7
    v_sub_f32 v95, v95, v7
    v_exp_f32 v112, v56
    v_exp_f32 v113, v57
    v_exp_f32 v114, v58
    v_exp_f32 v115, v59
    v_exp_f32 v116, v60
    v_exp_f32 v117, v61
    v_exp_f32 v118, v62
    v_exp_f32 v119, v63
    s_nop 0
    v_cvt_pk_bf16_f32 v124, v112, v113
    v_cvt_pk_bf16_f32 v125, v114, v115
    v_cvt_pk_bf16_f32 v126, v116, v117
    v_cvt_pk_bf16_f32 v127, v118, v119
    s_nop 1
    v_mfma_f32_16x16x32_bf16 v[20:23], a[240:243], v[124:127], v[36:39]
    v_exp_f32 v112, v80
    v_exp_f32 v113, v81
    v_exp_f32 v114, v82
    v_exp_f32 v115, v83
    s_nop 7
    s_branch K2_BACK11
K2_SLOW12:
    s_nop 7
    s_nop 3
    v_log_f32 v8, v16
    v_max3_f32 v7, v80, v81, v82
    v_max3_f32 v7, v7, v83, v84
    v_max3_f32 v7, v7, v85, v86
    v_max3_f32 v7, v7, v87, 0
    v_max_f32 v7, v7, v8
    v_mov_b32 v8, v7
    s_nop 1
    v_permlane16_swap_b32 v7, v8
    v_max_f32 v7, v7, v8
    v_mov_b32 v8, v7
    s_nop 1
    v_permlane32_swap_b32 v7, v8
    v_max_f32 v7, v7, v8
    v_exp_f32 v9, -v7
    v_sub_f32 v152, v152, v7
    v_sub_f32 v153, v153, v7
    v_sub_f32 v154, v154, v7
    v_sub_f32 v155, v155, v7
    v_mul_f32 v16, v16, v9
    v_mul_f32 v17, v17, v9
    v_mul_f32 v18, v18, v9
    v_mul_f32 v19, v19, v9
    v_accvgpr_read_b32 v8, a128
    v_mul_f32 v8, v8, v9
    v_accvgpr_write_b32 a128, v8
    v_accvgpr_read_b32 v8, a129
    v_mul_f32 v8, v8, v9
    v_accvgpr_write_b32 a129, v8
    v_accvgpr_read_b32 v8, a130
    v_mul_f32 v8, v8, v9
    v_accvgpr_write_b32 a130, v8
    v_accvgpr_read_b32 v8, a131
    v_mul_f32 v8, v8, v9
    v_accvgpr_write_b32 a131, v8
    v_accvgpr_read_b32 v8, a132
    v_mul_f32 v8, v8, v9
    v_accvgpr_write_b32 a132, v8
    v_accvgpr_read_b32 v8, a133
    v_mul_f32 v8, v8, v9
    v_accvgpr_write_b32 a133, v8
    v_accvgpr_read_b32 v8, a134
    v_mul_f32 v8, v8, v9
    v_accvgpr_write_b32 a134, v8
    v_accvgpr_read_b32 v8, a135
    v_mul_f32 v8, v8, v9
    v_accvgpr_write_b32 a135, v8
    v_accvgpr_read_b32 v8, a136
    v_mul_f32 v8, v8, v9
    v_accvgpr_write_b32 a136, v8
    v_accvgpr_read_b32 v8, a137
    v_mul_f32 v8, v8, v9
    v_accvgpr_write_b32 a137, v8
    v_accvgpr_read_b32 v8, a138
    v_mul_f32 v8, v8, v9
    v_accvgpr_write_b32 a138, v8
    v_accvgpr_read_b32 v8, a139
    v_mul_f32 v8, v8, v9
    v_accvgpr_write_b32 a139, v8
    v_accvgpr_read_b32 v8, a140
    v_mul_f32 v8, v8, v9
    v_accvgpr_write_b32 a140, v8
    v_accvgpr_read_b32 v8, a141
    v_mul_f32 v8, v8, v9
    v_accvgpr_write_b32 a141, v8
    v_accvgpr_read_b32 v8, a142
    v_mul_f32 v8, v8, v9
    v_accvgpr_write_b32 a142, v8
    v_accvgpr_read_b32 v8, a143
    v_mul_f32 v8, v8, v9
    v_accvgpr_write_b32 a143, v8
    v_accvgpr_read_b32 v8, a144
    v_mul_f32 v8, v8, v9
    v_accvgpr_write_b32 a144, v8
    v_accvgpr_read_b32 v8, a145
    v_mul_f32 v8, v8, v9
    v_accvgpr_write_b32 a145, v8
    v_accvgpr_read_b32 v8, a146
    v_mul_f32 v8, v8, v9
    v_accvgpr_write_b32 a146, v8
    v_accvgpr_read_b32 v8, a147
    v_mul_f32 v8, v8, v9
    v_accvgpr_write_b32 a147, v8
    v_accvgpr_read_b32 v8, a148
    v_mul_f32 v8, v8, v9
    v_accvgpr_write_b32 a148, v8
    v_accvgpr_read_b32 v8, a149
    v_mul_f32 v8, v8, v9
    v_accvgpr_write_b32 a149, v8
    v_accvgpr_read_b32 v8, a150
    v_mul_f32 v8, v8, v9
    v_accvgpr_write_b32 a150, v8
    v_accvgpr_read_b32 v8, a151
    v_mul_f32 v8, v8, v9
    v_accvgpr_write_b32 a151, v8
    v_accvgpr_read_b32 v8, a152
    v_mul_f32 v8, v8, v9
    v_accvgpr_write_b32 a152, v8
    v_accvgpr_read_b32 v8, a153
    v_mul_f32 v8, v8, v9
    v_accvgpr_write_b32 a153, v8
    v_accvgpr_read_b32 v8, a154
    v_mul_f32 v8, v8, v9
    v_accvgpr_write_b32 a154, v8
    v_accvgpr_read_b32 v8, a155
    v_mul_f32 v8, v8, v9
    v_accvgpr_write_b32 a155, v8
    v_accvgpr_read_b32 v8, a156
    v_mul_f32 v8, v8, v9
    v_accvgpr_write_b32 a156, v8
    v_accvgpr_read_b32 v8, a157
    v_mul_f32 v8, v8, v9
    v_accvgpr_write_b32 a157, v8
    v_accvgpr_read_b32 v8, a158
    v_mul_f32 v8, v8, v9
    v_accvgpr_write_b32 a158, v8
    v_accvgpr_read_b32 v8, a159
    v_mul_f32 v8, v8, v9
    v_accvgpr_write_b32 a159, v8
    v_sub_f32 v80, v80, v7
    v_sub_f32 v48, v48, v7
    v_sub_f32 v81, v81, v7
    v_sub_f32 v49, v49, v7
    v_sub_f32 v82, v82, v7
    v_sub_f32 v50, v50, v7
    v_sub_f32 v83, v83, v7
    v_sub_f32 v51, v51, v7
    v_sub_f32 v84, v84, v7
    v_sub_f32 v52, v52, v7
    v_sub_f32 v85, v85, v7
    v_sub_f32 v53, v53, v7
    v_sub_f32 v86, v86, v7
    v_sub_f32 v54, v54, v7
    v_sub_f32 v87, v87, v7
    v_sub_f32 v55, v55, v7
    v_exp_f32 v112, v80
    v_exp_f32 v113, v81
    v_exp_f32 v114, v82
    v_exp_f32 v115, v83
    v_exp_f32 v116, v84
    v_exp_f32 v117, v85
    v_exp_f32 v118, v86
    v_exp_f32 v119, v87
    s_nop 0
    v_cvt_pk_bf16_f32 v136, v112, v113
    v_cvt_pk_bf16_f32 v137, v114, v115
    v_cvt_pk_bf16_f32 v138, v116, v117
    v_cvt_pk_bf16_f32 v139, v118, v119
    s_nop 1
    v_mfma_f32_16x16x32_bf16 v[32:35], a[240:243], v[136:139], v[16:19]
    v_log_f32 v8, v20
    v_max3_f32 v7, v88, v89, v90
    v_max3_f32 v7, v7, v91, v92
    v_max3_f32 v7, v7, v93, v94
    v_max3_f32 v7, v7, v95, 0
    v_max_f32 v7, v7, v8
    v_mov_b32 v8, v7
    s_nop 1
    v_permlane16_swap_b32 v7, v8
    v_max_f32 v7, v7, v8
    v_mov_b32 v8, v7
    s_nop 1
    v_permlane32_swap_b32 v7, v8
    v_max_f32 v7, v7, v8
    v_exp_f32 v9, -v7
    v_sub_f32 v156, v156, v7
    v_sub_f32 v157, v157, v7
    v_sub_f32 v158, v158, v7
    v_sub_f32 v159, v159, v7
    v_mul_f32 v20, v20, v9
    v_mul_f32 v21, v21, v9
    v_mul_f32 v22, v22, v9
    v_mul_f32 v23, v23, v9
    v_mul_f32 v192, v192, v9
    v_mul_f32 v193, v193, v9
    v_mul_f32 v194, v194, v9
    v_mul_f32 v195, v195, v9
    v_mul_f32 v196, v196, v9
    v_mul_f32 v197, v197, v9
    v_mul_f32 v198, v198, v9
    v_mul_f32 v199, v199, v9
    v_mul_f32 v200, v200, v9
    v_mul_f32 v201, v201, v9
    v_mul_f32 v202, v202, v9
    v_mul_f32 v203, v203, v9
    v_mul_f32 v204, v204, v9
    v_mul_f32 v205, v205, v9
    v_mul_f32 v206, v206, v9
    v_mul_f32 v207, v207, v9
    v_mul_f32 v208, v208, v9
    v_mul_f32 v209, v209, v9
    v_mul_f32 v210, v210, v9
    v_mul_f32 v211, v211, v9
    v_mul_f32 v212, v212, v9
    v_mul_f32 v213, v213, v9
    v_mul_f32 v214, v214, v9
    v_mul_f32 v215, v215, v9
    v_mul_f32 v216, v216, v9
    v_mul_f32 v217, v217, v9
    v_mul_f32 v218, v218, v9
    v_mul_f32 v219, v219, v9
    v_mul_f32 v220, v220, v9
    v_mul_f32 v221, v221, v9
    v_mul_f32 v222, v222, v9
    v_mul_f32 v223, v223, v9
    v_sub_f32 v88, v88, v7
    v_sub_f32 v56, v56, v7
    v_sub_f32 v89, v89, v7
    v_sub_f32 v57, v57, v7
    v_sub_f32 v90, v90, v7
    v_sub_f32 v58, v58, v7
    v_sub_f32 v91, v91, v7
    v_sub_f32 v59, v59, v7
    v_sub_f32 v92, v92, v7
    v_sub_f32 v60, v60, v7
    v_sub_f32 v93, v93, v7
    v_sub_f32 v61, v61, v7
    v_sub_f32 v94, v94, v7
    v_sub_f32 v62, v62, v7
    v_sub_f32 v95, v95, v7
    v_sub_f32 v63, v63, v7
    v_exp_f32 v112, v88
    v_exp_f32 v113, v89
    v_exp_f32 v114, v90
    v_exp_f32 v115, v91
    v_exp_f32 v116, v92
    v_exp_f32 v117, v93
    v_exp_f32 v118, v94
    v_exp_f32 v119, v95
    s_nop 0
    v_cvt_pk_bf16_f32 v140, v112, v113
    v_cvt_pk_bf16_f32 v141, v114, v115
    v_cvt_pk_bf16_f32 v142, v116, v117
    v_cvt_pk_bf16_f32 v143, v118, v119
    s_nop 1
    v_mfma_f32_16x16x32_bf16 v[36:39], a[240:243], v[140:143], v[20:23]
    v_exp_f32 v112, v48
    v_exp_f32 v113, v49
    v_exp_f32 v114, v50
    v_exp_f32 v115, v51
    s_nop 7
    s_branch K2_BACK12
K2_SLOW13:
    s_nop 7
    s_nop 3
    v_log_f32 v8, v32
    v_max3_f32 v7, v48, v49, v50
    v_max3_f32 v7, v7, v51, v52
    v_max3_f32 v7, v7, v53, v54
    v_max3_f32 v7, v7, v55, 0
    v_max_f32 v7, v7, v8
    v_mov_b32 v8, v7
    s_nop 1
    v_permlane16_swap_b32 v7, v8
    v_max_f32 v7, v7, v8
    v_mov_b32 v8, v7
    s_nop 1
    v_permlane32_swap_b32 v7, v8
    v_max_f32 v7, v7, v8
    v_exp_f32 v9, -v7
    v_sub_f32 v152, v152, v7
    v_sub_f32 v153, v153, v7
    v_sub_f32 v154, v154, v7
    v_sub_f32 v155, v155, v7
    v_mul_f32 v32, v32, v9
    v_mul_f32 v33, v33, v9
    v_mul_f32 v34, v34, v9
    v_mul_f32 v35, v35, v9
    v_accvgpr_read_b32 v8, a128
    v_mul_f32 v8, v8, v9
    v_accvgpr_write_b32 a128, v8
    v_accvgpr_read_b32 v8, a129
    v_mul_f32 v8, v8, v9
    v_accvgpr_write_b32 a129, v8
    v_accvgpr_read_b32 v8, a130
    v_mul_f32 v8, v8, v9
    v_accvgpr_write_b32 a130, v8
    v_accvgpr_read_b32 v8, a131
    v_mul_f32 v8, v8, v9
    v_accvgpr_write_b32 a131, v8
    v_accvgpr_read_b32 v8, a132
    v_mul_f32 v8, v8, v9
    v_accvgpr_write_b32 a132, v8
    v_accvgpr_read_b32 v8, a133
    v_mul_f32 v8, v8, v9
    v_accvgpr_write_b32 a133, v8
    v_accvgpr_read_b32 v8, a134
    v_mul_f32 v8, v8, v9
    v_accvgpr_write_b32 a134, v8
    v_accvgpr_read_b32 v8, a135
    v_mul_f32 v8, v8, v9
    v_accvgpr_write_b32 a135, v8
    v_accvgpr_read_b32 v8, a136
    v_mul_f32 v8, v8, v9
    v_accvgpr_write_b32 a136, v8
    v_accvgpr_read_b32 v8, a137
    v_mul_f32 v8, v8, v9
    v_accvgpr_write_b32 a137, v8
    v_accvgpr_read_b32 v8, a138
    v_mul_f32 v8, v8, v9
    v_accvgpr_write_b32 a138, v8
    v_accvgpr_read_b32 v8, a139
    v_mul_f32 v8, v8, v9
    v_accvgpr_write_b32 a139, v8
    v_accvgpr_read_b32 v8, a140
    v_mul_f32 v8, v8, v9
    v_accvgpr_write_b32 a140, v8
    v_accvgpr_read_b32 v8, a141
    v_mul_f32 v8, v8, v9
    v_accvgpr_write_b32 a141, v8
    v_accvgpr_read_b32 v8, a142
    v_mul_f32 v8, v8, v9
    v_accvgpr_write_b32 a142, v8
    v_accvgpr_read_b32 v8, a143
    v_mul_f32 v8, v8, v9
    v_accvgpr_write_b32 a143, v8
    v_accvgpr_read_b32 v8, a144
    v_mul_f32 v8, v8, v9
    v_accvgpr_write_b32 a144, v8
    v_accvgpr_read_b32 v8, a145
    v_mul_f32 v8, v8, v9
    v_accvgpr_write_b32 a145, v8
    v_accvgpr_read_b32 v8, a146
    v_mul_f32 v8, v8, v9
    v_accvgpr_write_b32 a146, v8
    v_accvgpr_read_b32 v8, a147
    v_mul_f32 v8, v8, v9
    v_accvgpr_write_b32 a147, v8
    v_accvgpr_read_b32 v8, a148
    v_mul_f32 v8, v8, v9
    v_accvgpr_write_b32 a148, v8
    v_accvgpr_read_b32 v8, a149
    v_mul_f32 v8, v8, v9
    v_accvgpr_write_b32 a149, v8
    v_accvgpr_read_b32 v8, a150
    v_mul_f32 v8, v8, v9
    v_accvgpr_write_b32 a150, v8
    v_accvgpr_read_b32 v8, a151
    v_mul_f32 v8, v8, v9
    v_accvgpr_write_b32 a151, v8
    v_accvgpr_read_b32 v8, a152
    v_mul_f32 v8, v8, v9
    v_accvgpr_write_b32 a152, v8
    v_accvgpr_read_b32 v8, a153
    v_mul_f32 v8, v8, v9
    v_accvgpr_write_b32 a153, v8
    v_accvgpr_read_b32 v8, a154
    v_mul_f32 v8, v8, v9
    v_accvgpr_write_b32 a154, v8
    v_accvgpr_read_b32 v8, a155
    v_mul_f32 v8, v8, v9
    v_accvgpr_write_b32 a155, v8
    v_accvgpr_read_b32 v8, a156
    v_mul_f32 v8, v8, v9
    v_accvgpr_write_b32 a156, v8
    v_accvgpr_read_b32 v8, a157
    v_mul_f32 v8, v8, v9
    v_accvgpr_write_b32 a157, v8
    v_accvgpr_read_b32 v8, a158
    v_mul_f32 v8, v8, v9
    v_accvgpr_write_b32 a158, v8
    v_accvgpr_read_b32 v8, a159
    v_mul_f32 v8, v8, v9
    v_accvgpr_write_b32 a159, v8
    v_sub_f32 v48, v48, v7
    v_sub_f32 v80, v80, v7
    v_sub_f32 v49, v49, v7
    v_sub_f32 v81, v81, v7
    v_sub_f32 v50, v50, v7
    v_sub_f32 v82, v82, v7
    v_sub_f32 v51, v51, v7
    v_sub_f32 v83, v83, v7
    v_sub_f32 v52, v52, v7
    v_sub_f32 v84, v84, v7
    v_sub_f32 v53, v53, v7
    v_sub_f32 v85, v85, v7
    v_sub_f32 v54, v54, v7
    v_sub_f32 v86, v86, v7
    v_sub_f32 v55, v55, v7
    v_sub_f32 v87, v87, v7
    v_exp_f32 v112, v48
    v_exp_f32 v113, v49
    v_exp_f32 v114, v50
    v_exp_f32 v115, v51
    v_exp_f32 v116, v52
    v_exp_f32 v117, v53
    v_exp_f32 v118, v54
    v_exp_f32 v119, v55
    s_nop 0
    v_cvt_pk_bf16_f32 v120, v112, v113
    v_cvt_pk_bf16_f32 v121, v114, v115
    v_cvt_pk_bf16_f32 v122, v116, v117
    v_cvt_pk_bf16_f32 v123, v118, v119
    s_nop 1
    v_mfma_f32_16x16x32_bf16 v[16:19], a[240:243], v[120:123], v[32:35]
    v_log_f32 v8, v36
    v_max3_f32 v7, v56, v57, v58
    v_max3_f32 v7, v7, v59, v60
    v_max3_f32 v7, v7, v61, v62
    v_max3_f32 v7, v7, v63, 0
    v_max_f32 v7, v7, v8
    v_mov_b32 v8, v7
    s_nop 1
    v_permlane16_swap_b32 v7, v8
    v_max_f32 v7, v7, v8
    v_mov_b32 v8, v7
    s_nop 1
    v_permlane32_swap_b32 v7, v8
    v_max_f32 v7, v7, v8
    v_exp_f32 v9, -v7
    v_sub_f32 v156, v156, v7
    v_sub_f32 v157, v157, v7
    v_sub_f32 v158, v158, v7
    v_sub_f32 v159, v159, v7
    v_mul_f32 v36, v36, v9
    v_mul_f32 v37, v37, v9
    v_mul_f32 v38, v38, v9
    v_mul_f32 v39, v39, v9
    v_mul_f32 v192, v192, v9
    v_mul_f32 v193, v193, v9
    v_mul_f32 v194, v194, v9
    v_mul_f32 v195, v195, v9
    v_mul_f32 v196, v196, v9
    v_mul_f32 v197, v197, v9
    v_mul_f32 v198, v198, v9
    v_mul_f32 v199, v199, v9
    v_mul_f32 v200, v200, v9
    v_mul_f32 v201, v201, v9
    v_mul_f32 v202, v202, v9
    v_mul_f32 v203, v203, v9
    v_mul_f32 v204, v204, v9
    v_mul_f32 v205, v205, v9
    v_mul_f32 v206, v206, v9
    v_mul_f32 v207, v207, v9
    v_mul_f32 v208, v208, v9
    v_mul_f32 v209, v209, v9
    v_mul_f32 v210, v210, v9
    v_mul_f32 v211, v211, v9
    v_mul_f32 v212, v212, v9
    v_mul_f32 v213, v213, v9
    v_mul_f32 v214, v214, v9
    v_mul_f32 v215, v215, v9
    v_mul_f32 v216, v216, v9
    v_mul_f32 v217, v217, v9
    v_mul_f32 v218, v218, v9
    v_mul_f32 v219, v219, v9
    v_mul_f32 v220, v220, v9
    v_mul_f32 v221, v221, v9
    v_mul_f32 v222, v222, v9
    v_mul_f32 v223, v223, v9
    v_sub_f32 v56, v56, v7
    v_sub_f32 v88, v88, v7
    v_sub_f32 v57, v57, v7
    v_sub_f32 v89, v89, v7
    v_sub_f32 v58, v58, v7
    v_sub_f32 v90, v90, v7
    v_sub_f32 v59, v59, v7
    v_sub_f32 v91, v91, v7
    v_sub_f32 v60, v60, v7
    v_sub_f32 v92, v92, v7
    v_sub_f32 v61, v61, v7
    v_sub_f32 v93, v93, v7
    v_sub_f32 v62, v62, v7
    v_sub_f32 v94, v94, v7
    v_sub_f32 v63, v63, v7
    v_sub_f32 v95, v95, v7
    v_exp_f32 v112, v56
    v_exp_f32 v113, v57
    v_exp_f32 v114, v58
    v_exp_f32 v115, v59
    v_exp_f32 v116, v60
    v_exp_f32 v117, v61
    v_exp_f32 v118, v62
    v_exp_f32 v119, v63
    s_nop 0
    v_cvt_pk_bf16_f32 v124, v112, v113
    v_cvt_pk_bf16_f32 v125, v114, v115
    v_cvt_pk_bf16_f32 v126, v116, v117
    v_cvt_pk_bf16_f32 v127, v118, v119
    s_nop 1
    v_mfma_f32_16x16x32_bf16 v[20:23], a[240:243], v[124:127], v[36:39]
    v_exp_f32 v112, v80
    v_exp_f32 v113, v81
    v_exp_f32 v114, v82
    v_exp_f32 v115, v83
    s_nop 7
    s_branch K2_BACK13
K2_SLOW14:
    s_nop 7
    s_nop 3
    v_log_f32 v8, v16
    v_max3_f32 v7, v80, v81, v82
    v_max3_f32 v7, v7, v83, v84
    v_max3_f32 v7, v7, v85, v86
    v_max3_f32 v7, v7, v87, 0
    v_max_f32 v7, v7, v8
    v_mov_b32 v8, v7
    s_nop 1
    v_permlane16_swap_b32 v7, v8
    v_max_f32 v7, v7, v8
    v_mov_b32 v8, v7
    s_nop 1
    v_permlane32_swap_b32 v7, v8
    v_max_f32 v7, v7, v8
    v_exp_f32 v9, -v7
    v_sub_f32 v152, v152, v7
    v_sub_f32 v153, v153, v7
    v_sub_f32 v154, v154, v7
    v_sub_f32 v155, v155, v7
    v_mul_f32 v16, v16, v9
    v_mul_f32 v17, v17, v9
    v_mul_f32 v18, v18, v9
    v_mul_f32 v19, v19, v9
    v_accvgpr_read_b32 v8, a128
    v_mul_f32 v8, v8, v9
    v_accvgpr_write_b32 a128, v8
    v_accvgpr_read_b32 v8, a129
    v_mul_f32 v8, v8, v9
    v_accvgpr_write_b32 a129, v8
    v_accvgpr_read_b32 v8, a130
    v_mul_f32 v8, v8, v9
    v_accvgpr_write_b32 a130, v8
    v_accvgpr_read_b32 v8, a131
    v_mul_f32 v8, v8, v9
    v_accvgpr_write_b32 a131, v8
    v_accvgpr_read_b32 v8, a132
    v_mul_f32 v8, v8, v9
    v_accvgpr_write_b32 a132, v8
    v_accvgpr_read_b32 v8, a133
    v_mul_f32 v8, v8, v9
    v_accvgpr_write_b32 a133, v8
    v_accvgpr_read_b32 v8, a134
    v_mul_f32 v8, v8, v9
    v_accvgpr_write_b32 a134, v8
    v_accvgpr_read_b32 v8, a135
    v_mul_f32 v8, v8, v9
    v_accvgpr_write_b32 a135, v8
    v_accvgpr_read_b32 v8, a136
    v_mul_f32 v8, v8, v9
    v_accvgpr_write_b32 a136, v8
    v_accvgpr_read_b32 v8, a137
    v_mul_f32 v8, v8, v9
    v_accvgpr_write_b32 a137, v8
    v_accvgpr_read_b32 v8, a138
    v_mul_f32 v8, v8, v9
    v_accvgpr_write_b32 a138, v8
    v_accvgpr_read_b32 v8, a139
    v_mul_f32 v8, v8, v9
    v_accvgpr_write_b32 a139, v8
    v_accvgpr_read_b32 v8, a140
    v_mul_f32 v8, v8, v9
    v_accvgpr_write_b32 a140, v8
    v_accvgpr_read_b32 v8, a141
    v_mul_f32 v8, v8, v9
    v_accvgpr_write_b32 a141, v8
    v_accvgpr_read_b32 v8, a142
    v_mul_f32 v8, v8, v9
    v_accvgpr_write_b32 a142, v8
    v_accvgpr_read_b32 v8, a143
    v_mul_f32 v8, v8, v9
    v_accvgpr_write_b32 a143, v8
    v_accvgpr_read_b32 v8, a144
    v_mul_f32 v8, v8, v9
    v_accvgpr_write_b32 a144, v8
    v_accvgpr_read_b32 v8, a145
    v_mul_f32 v8, v8, v9
    v_accvgpr_write_b32 a145, v8
    v_accvgpr_read_b32 v8, a146
    v_mul_f32 v8, v8, v9
    v_accvgpr_write_b32 a146, v8
    v_accvgpr_read_b32 v8, a147
    v_mul_f32 v8, v8, v9
    v_accvgpr_write_b32 a147, v8
    v_accvgpr_read_b32 v8, a148
    v_mul_f32 v8, v8, v9
    v_accvgpr_write_b32 a148, v8
    v_accvgpr_read_b32 v8, a149
    v_mul_f32 v8, v8, v9
    v_accvgpr_write_b32 a149, v8
    v_accvgpr_read_b32 v8, a150
    v_mul_f32 v8, v8, v9
    v_accvgpr_write_b32 a150, v8
    v_accvgpr_read_b32 v8, a151
    v_mul_f32 v8, v8, v9
    v_accvgpr_write_b32 a151, v8
    v_accvgpr_read_b32 v8, a152
    v_mul_f32 v8, v8, v9
    v_accvgpr_write_b32 a152, v8
    v_accvgpr_read_b32 v8, a153
    v_mul_f32 v8, v8, v9
    v_accvgpr_write_b32 a153, v8
    v_accvgpr_read_b32 v8, a154
    v_mul_f32 v8, v8, v9
    v_accvgpr_write_b32 a154, v8
    v_accvgpr_read_b32 v8, a155
    v_mul_f32 v8, v8, v9
    v_accvgpr_write_b32 a155, v8
    v_accvgpr_read_b32 v8, a156
    v_mul_f32 v8, v8, v9
    v_accvgpr_write_b32 a156, v8
    v_accvgpr_read_b32 v8, a157
    v_mul_f32 v8, v8, v9
    v_accvgpr_write_b32 a157, v8
    v_accvgpr_read_b32 v8, a158
    v_mul_f32 v8, v8, v9
    v_accvgpr_write_b32 a158, v8
    v_accvgpr_read_b32 v8, a159
    v_mul_f32 v8, v8, v9
    v_accvgpr_write_b32 a159, v8
    v_sub_f32 v80, v80, v7
    v_sub_f32 v48, v48, v7
    v_sub_f32 v81, v81, v7
    v_sub_f32 v49, v49, v7
    v_sub_f32 v82, v82, v7
    v_sub_f32 v50, v50, v7
    v_sub_f32 v83, v83, v7
    v_sub_f32 v51, v51, v7
    v_sub_f32 v84, v84, v7
    v_sub_f32 v52, v52, v7
    v_sub_f32 v85, v85, v7
    v_sub_f32 v53, v53, v7
    v_sub_f32 v86, v86, v7
    v_sub_f32 v54, v54, v7
    v_sub_f32 v87, v87, v7
    v_sub_f32 v55, v55, v7
    v_exp_f32 v112, v80
    v_exp_f32 v113, v81
    v_exp_f32 v114, v82
    v_exp_f32 v115, v83
    v_exp_f32 v116, v84
    v_exp_f32 v117, v85
    v_exp_f32 v118, v86
    v_exp_f32 v119, v87
    s_nop 0
    v_cvt_pk_bf16_f32 v136, v112, v113
    v_cvt_pk_bf16_f32 v137, v114, v115
    v_cvt_pk_bf16_f32 v138, v116, v117
    v_cvt_pk_bf16_f32 v139, v118, v119
    s_nop 1
    v_mfma_f32_16x16x32_bf16 v[32:35], a[240:243], v[136:139], v[16:19]
    v_log_f32 v8, v20
    v_max3_f32 v7, v88, v89, v90
    v_max3_f32 v7, v7, v91, v92
    v_max3_f32 v7, v7, v93, v94
    v_max3_f32 v7, v7, v95, 0
    v_max_f32 v7, v7, v8
    v_mov_b32 v8, v7
    s_nop 1
    v_permlane16_swap_b32 v7, v8
    v_max_f32 v7, v7, v8
    v_mov_b32 v8, v7
    s_nop 1
    v_permlane32_swap_b32 v7, v8
    v_max_f32 v7, v7, v8
    v_exp_f32 v9, -v7
    v_sub_f32 v156, v156, v7
    v_sub_f32 v157, v157, v7
    v_sub_f32 v158, v158, v7
    v_sub_f32 v159, v159, v7
    v_mul_f32 v20, v20, v9
    v_mul_f32 v21, v21, v9
    v_mul_f32 v22, v22, v9
    v_mul_f32 v23, v23, v9
    v_mul_f32 v192, v192, v9
    v_mul_f32 v193, v193, v9
    v_mul_f32 v194, v194, v9
    v_mul_f32 v195, v195, v9
    v_mul_f32 v196, v196, v9
    v_mul_f32 v197, v197, v9
    v_mul_f32 v198, v198, v9
    v_mul_f32 v199, v199, v9
    v_mul_f32 v200, v200, v9
    v_mul_f32 v201, v201, v9
    v_mul_f32 v202, v202, v9
    v_mul_f32 v203, v203, v9
    v_mul_f32 v204, v204, v9
    v_mul_f32 v205, v205, v9
    v_mul_f32 v206, v206, v9
    v_mul_f32 v207, v207, v9
    v_mul_f32 v208, v208, v9
    v_mul_f32 v209, v209, v9
    v_mul_f32 v210, v210, v9
    v_mul_f32 v211, v211, v9
    v_mul_f32 v212, v212, v9
    v_mul_f32 v213, v213, v9
    v_mul_f32 v214, v214, v9
    v_mul_f32 v215, v215, v9
    v_mul_f32 v216, v216, v9
    v_mul_f32 v217, v217, v9
    v_mul_f32 v218, v218, v9
    v_mul_f32 v219, v219, v9
    v_mul_f32 v220, v220, v9
    v_mul_f32 v221, v221, v9
    v_mul_f32 v222, v222, v9
    v_mul_f32 v223, v223, v9
    v_sub_f32 v88, v88, v7
    v_sub_f32 v56, v56, v7
    v_sub_f32 v89, v89, v7
    v_sub_f32 v57, v57, v7
    v_sub_f32 v90, v90, v7
    v_sub_f32 v58, v58, v7
    v_sub_f32 v91, v91, v7
    v_sub_f32 v59, v59, v7
    v_sub_f32 v92, v92, v7
    v_sub_f32 v60, v60, v7
    v_sub_f32 v93, v93, v7
    v_sub_f32 v61, v61, v7
    v_sub_f32 v94, v94, v7
    v_sub_f32 v62, v62, v7
    v_sub_f32 v95, v95, v7
    v_sub_f32 v63, v63, v7
    v_exp_f32 v112, v88
    v_exp_f32 v113, v89
    v_exp_f32 v114, v90
    v_exp_f32 v115, v91
    v_exp_f32 v116, v92
    v_exp_f32 v117, v93
    v_exp_f32 v118, v94
    v_exp_f32 v119, v95
    s_nop 0
    v_cvt_pk_bf16_f32 v140, v112, v113
    v_cvt_pk_bf16_f32 v141, v114, v115
    v_cvt_pk_bf16_f32 v142, v116, v117
    v_cvt_pk_bf16_f32 v143, v118, v119
    s_nop 1
    v_mfma_f32_16x16x32_bf16 v[36:39], a[240:243], v[140:143], v[20:23]
    v_exp_f32 v112, v56
    v_exp_f32 v113, v57
    v_exp_f32 v114, v58
    v_exp_f32 v115, v59
    s_nop 7
    s_branch K2_BACK14
K2_SLOW15:
    s_nop 7
    s_nop 3
    v_log_f32 v8, v36
    v_max3_f32 v7, v56, v57, v58
    v_max3_f32 v7, v7, v59, v60
    v_max3_f32 v7, v7, v61, v62
    v_max3_f32 v7, v7, v63, 0
    v_max_f32 v7, v7, v8
    v_mov_b32 v8, v7
    s_nop 1
    v_permlane16_swap_b32 v7, v8
    v_max_f32 v7, v7, v8
    v_mov_b32 v8, v7
    s_nop 1
    v_permlane32_swap_b32 v7, v8
    v_max_f32 v7, v7, v8
    v_exp_f32 v9, -v7
    v_sub_f32 v156, v156, v7
    v_sub_f32 v157, v157, v7
    v_sub_f32 v158, v158, v7
    v_sub_f32 v159, v159, v7
    v_mul_f32 v36, v36, v9
    v_mul_f32 v37, v37, v9
    v_mul_f32 v38, v38, v9
    v_mul_f32 v39, v39, v9
    v_mul_f32 v192, v192, v9
    v_mul_f32 v193, v193, v9
    v_mul_f32 v194, v194, v9
    v_mul_f32 v195, v195, v9
    v_mul_f32 v196, v196, v9
    v_mul_f32 v197, v197, v9
    v_mul_f32 v198, v198, v9
    v_mul_f32 v199, v199, v9
    v_mul_f32 v200, v200, v9
    v_mul_f32 v201, v201, v9
    v_mul_f32 v202, v202, v9
    v_mul_f32 v203, v203, v9
    v_mul_f32 v204, v204, v9
    v_mul_f32 v205, v205, v9
    v_mul_f32 v206, v206, v9
    v_mul_f32 v207, v207, v9
    v_mul_f32 v208, v208, v9
    v_mul_f32 v209, v209, v9
    v_mul_f32 v210, v210, v9
    v_mul_f32 v211, v211, v9
    v_mul_f32 v212, v212, v9
    v_mul_f32 v213, v213, v9
    v_mul_f32 v214, v214, v9
    v_mul_f32 v215, v215, v9
    v_mul_f32 v216, v216, v9
    v_mul_f32 v217, v217, v9
    v_mul_f32 v218, v218, v9
    v_mul_f32 v219, v219, v9
    v_mul_f32 v220, v220, v9
    v_mul_f32 v221, v221, v9
    v_mul_f32 v222, v222, v9
    v_mul_f32 v223, v223, v9
    v_sub_f32 v56, v56, v7
    v_sub_f32 v88, v88, v7
    v_sub_f32 v57, v57, v7
    v_sub_f32 v89, v89, v7
    v_sub_f32 v58, v58, v7
    v_sub_f32 v90, v90, v7
    v_sub_f32 v59, v59, v7
    v_sub_f32 v91, v91, v7
    v_sub_f32 v60, v60, v7
    v_sub_f32 v92, v92, v7
    v_sub_f32 v61, v61, v7
    v_sub_f32 v93, v93, v7
    v_sub_f32 v62, v62, v7
    v_sub_f32 v94, v94, v7
    v_sub_f32 v63, v63, v7
    v_sub_f32 v95, v95, v7
    v_exp_f32 v112, v56
    v_exp_f32 v113, v57
    v_exp_f32 v114, v58
    v_exp_f32 v115, v59
    v_exp_f32 v116, v60
    v_exp_f32 v117, v61
    v_exp_f32 v118, v62
    v_exp_f32 v119, v63
    s_nop 0
    v_cvt_pk_bf16_f32 v124, v112, v113
    v_cvt_pk_bf16_f32 v125, v114, v115
    v_cvt_pk_bf16_f32 v126, v116, v117
    v_cvt_pk_bf16_f32 v127, v118, v119
    s_nop 1
    v_mfma_f32_16x16x32_bf16 v[20:23], a[240:243], v[124:127], v[36:39]
    v_exp_f32 v112, v88
    v_exp_f32 v113, v89
    v_exp_f32 v114, v90
    v_exp_f32 v115, v91
    s_nop 7
    s_branch K2_BACK15
K2_SLOW16:
    s_nop 7
    s_nop 3
    v_log_f32 v8, v20
    v_max3_f32 v7, v88, v89, v90
    v_max3_f32 v7, v7, v91, v92
    v_max3_f32 v7, v7, v93, v94
    v_max3_f32 v7, v7, v95, 0
    v_max_f32 v7, v7, v8
    v_mov_b32 v8, v7
    s_nop 1
    v_permlane16_swap_b32 v7, v8
    v_max_f32 v7, v7, v8
    v_mov_b32 v8, v7
    s_nop 1
    v_permlane32_swap_b32 v7, v8
    v_max_f32 v7, v7, v8
    v_exp_f32 v9, -v7
    v_sub_f32 v156, v156, v7
    v_sub_f32 v157, v157, v7
    v_sub_f32 v158, v158, v7
    v_sub_f32 v159, v159, v7
    v_mul_f32 v20, v20, v9
    v_mul_f32 v21, v21, v9
    v_mul_f32 v22, v22, v9
    v_mul_f32 v23, v23, v9
    v_mul_f32 v192, v192, v9
    v_mul_f32 v193, v193, v9
    v_mul_f32 v194, v194, v9
    v_mul_f32 v195, v195, v9
    v_mul_f32 v196, v196, v9
    v_mul_f32 v197, v197, v9
    v_mul_f32 v198, v198, v9
    v_mul_f32 v199, v199, v9
    v_mul_f32 v200, v200, v9
    v_mul_f32 v201, v201, v9
    v_mul_f32 v202, v202, v9
    v_mul_f32 v203, v203, v9
    v_mul_f32 v204, v204, v9
    v_mul_f32 v205, v205, v9
    v_mul_f32 v206, v206, v9
    v_mul_f32 v207, v207, v9
    v_mul_f32 v208, v208, v9
    v_mul_f32 v209, v209, v9
    v_mul_f32 v210, v210, v9
    v_mul_f32 v211, v211, v9
    v_mul_f32 v212, v212, v9
    v_mul_f32 v213, v213, v9
    v_mul_f32 v214, v214, v9
    v_mul_f32 v215, v215, v9
    v_mul_f32 v216, v216, v9
    v_mul_f32 v217, v217, v9
    v_mul_f32 v218, v218, v9
    v_mul_f32 v219, v219, v9
    v_mul_f32 v220, v220, v9
    v_mul_f32 v221, v221, v9
    v_mul_f32 v222, v222, v9
    v_mul_f32 v223, v223, v9
    v_sub_f32 v88, v88, v7
    v_sub_f32 v56, v56, v7
    v_sub_f32 v89, v89, v7
    v_sub_f32 v57, v57, v7
    v_sub_f32 v90, v90, v7
    v_sub_f32 v58, v58, v7
    v_sub_f32 v91, v91, v7
    v_sub_f32 v59, v59, v7
    v_sub_f32 v92, v92, v7
    v_sub_f32 v60, v60, v7
    v_sub_f32 v93, v93, v7
    v_sub_f32 v61, v61, v7
    v_sub_f32 v94, v94, v7
    v_sub_f32 v62, v62, v7
    v_sub_f32 v95, v95, v7
    v_sub_f32 v63, v63, v7
    v_exp_f32 v112, v88
    v_exp_f32 v113, v89
    v_exp_f32 v114, v90
    v_exp_f32 v115, v91
    v_exp_f32 v116, v92
    v_exp_f32 v117, v93
    v_exp_f32 v118, v94
    v_exp_f32 v119, v95
    s_nop 0
    v_cvt_pk_bf16_f32 v140, v112, v113
    v_cvt_pk_bf16_f32 v141, v114, v115
    v_cvt_pk_bf16_f32 v142, v116, v117
    v_cvt_pk_bf16_f32 v143, v118, v119
    s_nop 1
    v_mfma_f32_16x16x32_bf16 v[36:39], a[240:243], v[140:143], v[20:23]
    s_nop 7
    s_branch K2_BACK16

.section .rodata,"a"
.p2align 6
.amdhsa_kernel gated_mix__ssm_conv_h3__compressed_kv_cla__prompt_kernel
  .amdhsa_next_free_vgpr 512
  .amdhsa_next_free_sgpr 102
  .amdhsa_accum_offset 256
  .amdhsa_group_segment_fixed_size 0
  .amdhsa_kernarg_size 128
  .amdhsa_user_sgpr_count 2
  .amdhsa_user_sgpr_kernarg_segment_ptr 1
  .amdhsa_system_sgpr_workgroup_id_x 1
.end_amdhsa_kernel
```
